```python
import torch

def _softmax(x, axis=-1):
    return torch.softmax(x, dim=axis)
def _gelu(x):
    return torch.nn.functional.gelu(x, approximate="tanh")
def _silu(x):
    return torch.nn.functional.silu(x)
def _sigmoid(x):
    return torch.sigmoid(x)
def _layernorm(x, axis=-1, eps=1e-5):
    m = x.mean(dim=axis, keepdim=True)
    v = x.var(dim=axis, keepdim=True, unbiased=False)
    return (x - m) / torch.sqrt(v + eps)
def _scatter_add(tgt, idx, src, axis=0):
    return tgt.clone().index_add_(axis, idx, src)
def _segment_sum(src, seg, n):
    out = torch.zeros((n,) + src.shape[1:], dtype=src.dtype)
    return out.index_add_(0, seg, src)
def _pad(x, pw):
    flat = tuple(v for pair in reversed(pw) for v in pair)
    return torch.nn.functional.pad(x, flat)

kernel_name = 'parallel_sum__linear_kernel_hedgehog__glu_gated_reglu__prompt'

def setup_inputs():

    _w = (lambda a: (lambda t: t.to(torch.bfloat16) if t.is_floating_point() else t)(torch.as_tensor(a)))
    def _A_setup():
        B, S, D, H = 1, 2048, 640, 32
        Dh = D // H
        return {
            "x": _w((lambda *s: torch.randn(*s, dtype=torch.bfloat16) * 0.05)(B, S, D)),
            "wqkv": _w((lambda *s: torch.randn(*s, dtype=torch.bfloat16) * 0.2)(D, 3 * D)),
            "w_phi": _w((lambda *s: torch.randn(*s, dtype=torch.bfloat16) * 0.2)(H, Dh, Dh) * (Dh ** -0.5)),
            "wo": _w((lambda *s: torch.randn(*s, dtype=torch.bfloat16) * 0.05)(D, D)),
        }
    _A_in = _A_setup()

    def _B_setup():
        B, S, D, F = 1, 2048, 640, 1536
        return {
            "x": _w((lambda *s: torch.randn(*s, dtype=torch.bfloat16) * 0.05)(B, S, D)),
            "W_gate": _w((lambda *s: torch.randn(*s, dtype=torch.bfloat16) * 0.4)(D, F) * (2.0 / D) ** 0.5),
            "W_up": _w((lambda *s: torch.randn(*s, dtype=torch.bfloat16) * 0.4)(D, F) * (2.0 / D) ** 0.5),
            "W_down": _w((lambda *s: torch.randn(*s, dtype=torch.bfloat16) * 0.4)(F, D) * (1.0 / F) ** 0.5),
        }
    _B_in = _B_setup()

    return {
        "A_x": _A_in["x"],
        "A_wqkv": _A_in["wqkv"],
        "A_w_phi": _A_in["w_phi"],
        "A_wo": _A_in["wo"],
        "B_x": _B_in["x"],
        "B_W_gate": _B_in["W_gate"],
        "B_W_up": _B_in["W_up"],
        "B_W_down": _B_in["W_down"],
    }

def reference(A_x, A_wqkv, A_w_phi, A_wo, B_x, B_W_gate, B_W_up, B_W_down):
    def _A_ref(x, wqkv, w_phi, wo):
        B, S, D = x.shape
        H = 32; Dh = D // H
        qkv = (lambda x, *d: x.permute(*d))((x @ wqkv).reshape(B, S, 3, H, Dh), 2, 0, 3, 1, 4)
        q, k, v = qkv[0], qkv[1], qkv[2]
        pq = torch.einsum("bhsd,hdf->bhsf", q, w_phi)
        pk = torch.einsum("bhsd,hdf->bhsf", k, w_phi)
        phi_q = torch.concatenate([_softmax(pq, axis=-1), _softmax(-pq, axis=-1)], axis=-1)
        phi_k = torch.concatenate([_softmax(pk, axis=-1), _softmax(-pk, axis=-1)], axis=-1)
        kv = torch.einsum("bhsf,bhsd->bhfd", phi_k, v)
        z  = torch.einsum("bhsf->bhf", phi_k)
        num = torch.einsum("bhqf,bhfd->bhqd", phi_q, kv)
        den = torch.einsum("bhqf,bhf->bhq", phi_q, z)[..., None] + 1e-6
        o = num / den
        return (lambda x, *d: x.permute(*d))(o, 0, 2, 1, 3).reshape(B, S, D) @ wo

    def _B_ref(x, W_gate, W_up, W_down):
        gate = torch.einsum("bsd,df->bsf", x, W_gate)
        up = torch.einsum("bsd,df->bsf", x, W_up)
        gate = gate * (lambda x, dt: x.to(dt))(gate > 0, gate.dtype)
        h = gate * up
        return torch.einsum("bsf,fd->bsd", h, W_down)

    x = A_x
    xn = _layernorm(x, axis=-1)
    return x + _A_ref(xn, A_wqkv, A_w_phi, A_wo) + _B_ref(xn, B_W_gate, B_W_up, B_W_down)
```

```asm
; @launch grid=(256,1,1) block=(256,1,1) lds=163840
.amdgcn_target "amdgcn-amd-amdhsa--gfx950"
.text
.globl parallel_sum__linear_kernel_hedgehog__glu_gated_reglu__prompt_kernel
.p2align 8
.type parallel_sum__linear_kernel_hedgehog__glu_gated_reglu__prompt_kernel,@function
parallel_sum__linear_kernel_hedgehog__glu_gated_reglu__prompt_kernel:
F_start:
s_cmp_ge_u32 s2, 0x100
s_cbranch_scc1 F_end
s_load_dwordx8 s[4:11], s[0:1], 0
s_load_dwordx4 s[12:15], s[0:1], 40
s_load_dwordx2 s[98:99], s[0:1], 56
s_load_dwordx2 s[94:95], s[0:1], 64
s_load_dwordx4 s[16:19], s[0:1], 0x48
s_getpc_b64 s[64:65]
F_pc:
s_sub_u32 s64, s64, F_pc-F_start
s_subb_u32 s65, s65, 0
s_lshr_b32 s66, s2, 3
s_lshl_b32 s66, s66, 6
v_lshrrev_b32 v252, 6, v0
v_lshlrev_b32 v252, 4, v252
v_and_b32 v253, 15, v0
v_add3_u32 v252, v252, v253, s66
v_and_b32 v252, 0x3ff, v252
v_lshlrev_b32 v252, 7, v252
s_mov_b32 s66, F_codeend-F_start-4
v_min_u32 v252, s66, v252
v_mov_b32 v251, s65
v_add_co_u32 v250, vcc, s64, v252
s_nop 1
v_addc_co_u32 v251, vcc, 0, v251, vcc
s_mov_b64 exec, 0xffff
global_load_dword v254, v[250:251], off
s_mov_b64 exec, -1
v_and_b32 v1, 63, v0
v_lshrrev_b32 v5, 6, v0
v_lshlrev_b32 v2, 4, v1
v_readfirstlane_b32 s52, v5
v_lshlrev_b32 v3, 3, v1
v_lshlrev_b32 v4, 2, v1
s_and_b32 s57, s2, 7
s_lshr_b32 s58, s2, 3
s_and_b32 s53, s57, 1
s_lshl_b32 s53, s53, 3
s_and_b32 s59, s58, 7
s_add_u32 s53, s53, s59
s_lshr_b32 s57, s57, 1
s_lshl_b32 s57, s57, 2
s_lshr_b32 s58, s58, 3
s_add_u32 s57, s57, s58
s_lshr_b32 s54, s57, 1
s_and_b32 s63, s57, 1
s_mul_i32 s58, s58, 3
s_add_u32 s55, s58, s59
s_cmp_ge_u32 s55, 10
s_cselect_b32 s58, 10, 0
s_sub_u32 s55, s55, s58
s_mul_i32 s20, s55, 0x3c000
s_mul_i32 s21, s55, 0x30000
s_mov_b32 s61, 0xffff0000
s_mov_b32 s62, 0x3fb8aa3b
v_lshrrev_b32 v23, 3, v1
v_lshrrev_b32 v24, 4, v1
v_and_b32 v25, 7, v1
v_mul_u32_u24 v23, 0x500, v23
v_add_u32 v26, 0, v24
v_and_b32 v26, 7, v26
v_xor_b32 v26, v26, v25
v_lshl_add_u32 v26, v26, 4, v23
v_add_u32 v27, 0, v26
v_add_u32 v26, 4, v24
v_and_b32 v26, 7, v26
v_xor_b32 v26, v26, v25
v_lshl_add_u32 v26, v26, 4, v23
v_add_u32 v28, 0x2400, v26
v_add_u32 v26, 8, v24
v_and_b32 v26, 7, v26
v_xor_b32 v26, v26, v25
v_lshl_add_u32 v26, v26, 4, v23
v_add_u32 v29, 0x4800, v26
v_add_u32 v26, 12, v24
v_and_b32 v26, 7, v26
v_xor_b32 v26, v26, v25
v_lshl_add_u32 v26, v26, 4, v23
v_add_u32 v30, 0x6c00, v26
s_waitcnt lgkmcnt(0)
s_mov_b32 s24, s4
s_mov_b32 s25, s5
s_mov_b32 s26, 0x280000
s_mov_b32 s27, 0x20000
s_mov_b32 s28, s6
s_mov_b32 s29, s7
s_mov_b32 s30, 0x258000
s_mov_b32 s31, 0x20000
s_mov_b32 s40, s8
s_mov_b32 s41, s9
s_mov_b32 s42, 0x6400
s_mov_b32 s43, 0x20000
s_mov_b32 s36, s18
s_mov_b32 s37, s19
s_mov_b32 s38, 0xb51000
s_mov_b32 s39, 0x20000
s_mov_b32 s48, s16
s_mov_b32 s49, s17
s_mov_b32 s50, 0x100
s_mov_b32 s51, 0x20000
s_cmp_ge_u32 s52, 2
s_cselect_b32 s32, s14, s12
s_cselect_b32 s33, s15, s13
s_mov_b32 s34, 0x1e0000
s_mov_b32 s35, 0x20000
s_lshl_b32 s57, s53, 3
s_lshl_b32 s58, s52, 1
s_add_u32 s57, s57, s58
s_lshl_b32 s57, s57, 3
s_add_u32 s57, s57, s54
s_mul_i32 s22, s57, 0x1800
s_cmp_eq_u32 s63, 1
s_cbranch_scc1 F_Y
s_lshl_b32 s16, s53, 7
s_lshl_b32 s58, s52, 5
s_add_u32 s16, s16, s58
s_mul_i32 s16, s16, 0x500
s_mul_i32 s17, s52, 0x7000
s_add_u32 s17, s17, 0xa000
s_mov_b32 s18, s55
s_add_u32 m0, s17, 0
s_lshl_b32 s59, s18, 7
s_add_u32 s59, s59, s16
buffer_load_dwordx4 v27, s[24:27], s59 offen offset:0 lds
buffer_load_dwordx4 v28, s[24:27], s59 offen offset:1024 lds
buffer_load_dwordx4 v29, s[24:27], s59 offen offset:2048 lds
buffer_load_dwordx4 v30, s[24:27], s59 offen offset:3072 lds
s_add_u32 s18, s18, 1
s_cmp_eq_u32 s18, 10
s_cselect_b32 s18, 0, s18
v_mov_b32 v32, 0
v_mov_b32 v33, 0
v_mov_b32 v34, 0
v_mov_b32 v35, 0
s_mul_i32 s4, s54, 0xc80
s_mul_i32 s5, s52, 0x320
s_add_u32 s4, s4, s5
s_add_u32 m0, s5, 0x26000
s_nop 0
buffer_load_dwordx4 v2, s[40:43], s4 offen lds
s_cmp_eq_u32 s53, 0
s_cselect_b32 s4, 0, 0x7ff00000
s_lshl_b32 s5, s54, 2
s_add_u32 s5, s5, s52
s_mul_i32 s6, s5, 0xf00
s_add_u32 s6, s6, 0xb28000
s_lshl_b32 s5, s5, 2
s_add_u32 s5, s5, 0x80
v_add_u32 v36, s4, v2
buffer_store_dwordx4 v[32:35], v36, s[36:39], s6 offen offset:0 sc1
buffer_store_dwordx4 v[32:35], v36, s[36:39], s6 offen offset:1024 sc1
buffer_store_dwordx4 v[32:35], v36, s[36:39], s6 offen offset:2048 sc1
v_add_u32 v37, s4, v4
buffer_store_dword v32, v37, s[36:39], s6 offen offset:3072 sc1
buffer_store_dword v32, v37, s[36:39], s6 offen offset:3328 sc1
buffer_store_dword v32, v37, s[36:39], s6 offen offset:3584 sc1
v_mov_b32 v37, s5
v_add_u32 v37, s4, v37
s_add_u32 m0, s17, 0x1000
s_lshl_b32 s59, s18, 7
s_add_u32 s59, s59, s16
buffer_load_dwordx4 v27, s[24:27], s59 offen offset:0 lds
buffer_load_dwordx4 v28, s[24:27], s59 offen offset:1024 lds
buffer_load_dwordx4 v29, s[24:27], s59 offen offset:2048 lds
buffer_load_dwordx4 v30, s[24:27], s59 offen offset:3072 lds
s_add_u32 s18, s18, 1
s_cmp_eq_u32 s18, 10
s_cselect_b32 s18, 0, s18
v_add_u32 v42, 0x26e00, v2
ds_write_b128 v42, v[32:35]
ds_write_b128 v42, v[32:35] offset:1024
v_and_b32 v42, 31, v1
v_lshrrev_b32 v43, 5, v1
v_bfe_u32 v44, v1, 1, 3
v_xor_b32 v43, v43, v44
v_lshlrev_b32 v42, 7, v42
v_add_u32 v42, s17, v42
v_xor_b32 v44, 0, v43
v_lshl_add_u32 v38, v44, 4, v42
v_xor_b32 v44, 2, v43
v_lshl_add_u32 v39, v44, 4, v42
v_xor_b32 v44, 4, v43
v_lshl_add_u32 v40, v44, 4, v42
v_xor_b32 v44, 6, v43
v_lshl_add_u32 v41, v44, 4, v42
s_mul_i32 s96, s52, 0x1400
s_lshl_b32 s9, s52, 4
s_mul_i32 s13, s54, 0xa0
s_mov_b32 s8, 0
v_add_u32 v42, 0, v1
v_mul_u32_u24 v43, 0xccd, v42
v_lshrrev_b32 v43, 16, v43
v_mul_u32_u24 v44, 20, v43
v_sub_u32 v44, v42, v44
v_mul_u32_u24 v45, 52, v44
v_lshrrev_b32 v45, 8, v45
v_mul_u32_u24 v42, 5, v45
v_sub_u32 v44, v44, v42
v_and_b32 v42, 1, v45
v_mul_u32_u24 v42, 0x500, v42
v_lshl_add_u32 v44, v44, 4, v42
v_lshrrev_b32 v45, 1, v45
v_mul_u32_u24 v45, 0x50, v45
v_add3_u32 v44, v44, v45, s13
v_add_u32 v44, 0x500, v44
v_add_u32 v43, s9, v43
v_mul_u32_u24 v43, 0xf00, v43
v_add_u32 v5, v43, v44
v_add_u32 v42, 64, v1
v_mul_u32_u24 v43, 0xccd, v42
v_lshrrev_b32 v43, 16, v43
v_mul_u32_u24 v44, 20, v43
v_sub_u32 v44, v42, v44
v_mul_u32_u24 v45, 52, v44
v_lshrrev_b32 v45, 8, v45
v_mul_u32_u24 v42, 5, v45
v_sub_u32 v44, v44, v42
v_and_b32 v42, 1, v45
v_mul_u32_u24 v42, 0x500, v42
v_lshl_add_u32 v44, v44, 4, v42
v_lshrrev_b32 v45, 1, v45
v_mul_u32_u24 v45, 0x50, v45
v_add3_u32 v44, v44, v45, s13
v_add_u32 v44, 0x100, v44
v_add_u32 v43, s9, v43
v_mul_u32_u24 v43, 0xf00, v43
v_add_u32 v6, v43, v44
v_add_u32 v42, 0x80, v1
v_mul_u32_u24 v43, 0xccd, v42
v_lshrrev_b32 v43, 16, v43
v_mul_u32_u24 v44, 20, v43
v_sub_u32 v44, v42, v44
s_add_u32 m0, s17, 0x2000
s_lshl_b32 s59, s18, 7
s_add_u32 s59, s59, s16
buffer_load_dwordx4 v27, s[24:27], s59 offen offset:0 lds
buffer_load_dwordx4 v28, s[24:27], s59 offen offset:1024 lds
buffer_load_dwordx4 v29, s[24:27], s59 offen offset:2048 lds
buffer_load_dwordx4 v30, s[24:27], s59 offen offset:3072 lds
s_add_u32 s18, s18, 1
s_cmp_eq_u32 s18, 10
s_cselect_b32 s18, 0, s18
v_mul_u32_u24 v45, 52, v44
v_lshrrev_b32 v45, 8, v45
v_mul_u32_u24 v42, 5, v45
v_sub_u32 v44, v44, v42
v_and_b32 v42, 1, v45
v_mul_u32_u24 v42, 0x500, v42
v_lshl_add_u32 v44, v44, 4, v42
v_lshrrev_b32 v45, 1, v45
v_mul_u32_u24 v45, 0x50, v45
v_add3_u32 v44, v44, v45, s13
v_add_u32 v44, 0xfffffd00, v44
v_add_u32 v43, s9, v43
v_mul_u32_u24 v43, 0xf00, v43
v_add_u32 v7, v43, v44
v_add_u32 v42, 0xc0, v1
v_mul_u32_u24 v43, 0xccd, v42
v_lshrrev_b32 v43, 16, v43
v_mul_u32_u24 v44, 20, v43
v_sub_u32 v44, v42, v44
v_mul_u32_u24 v45, 52, v44
v_lshrrev_b32 v45, 8, v45
v_mul_u32_u24 v42, 5, v45
v_sub_u32 v44, v44, v42
v_and_b32 v42, 1, v45
v_mul_u32_u24 v42, 0x500, v42
v_lshl_add_u32 v44, v44, 4, v42
v_lshrrev_b32 v45, 1, v45
v_mul_u32_u24 v45, 0x50, v45
v_add3_u32 v44, v44, v45, s13
v_add_u32 v44, 0xfffff900, v44
v_add_u32 v43, s9, v43
v_mul_u32_u24 v43, 0xf00, v43
v_add_u32 v8, v43, v44
v_add_u32 v42, 0x100, v1
v_mul_u32_u24 v43, 0xccd, v42
v_lshrrev_b32 v43, 16, v43
v_mul_u32_u24 v44, 20, v43
v_sub_u32 v44, v42, v44
v_mul_u32_u24 v45, 52, v44
v_lshrrev_b32 v45, 8, v45
v_mul_u32_u24 v42, 5, v45
v_sub_u32 v44, v44, v42
v_and_b32 v42, 1, v45
v_mul_u32_u24 v42, 0x500, v42
v_lshl_add_u32 v44, v44, 4, v42
v_lshrrev_b32 v45, 1, v45
v_mul_u32_u24 v45, 0x50, v45
v_add3_u32 v44, v44, v45, s13
v_add_u32 v44, 0x500, v44
v_add_u32 v43, s9, v43
v_mul_u32_u24 v43, 0xf00, v43
v_add_u32 v9, v43, v44
v_bfe_u32 v42, v1, 4, 1
v_lshrrev_b32 v43, 5, v1
v_bfe_u32 v44, v1, 2, 2
v_and_b32 v45, 3, v1
v_lshl_add_u32 v44, v43, 3, v44
v_mul_u32_u24 v44, 0x140, v44
v_and_b32 v43, 1, v45
v_mul_u32_u24 v43, 0xa0, v43
v_add_u32 v44, v44, v43
v_lshrrev_b32 v45, 1, v45
v_lshl_add_u32 v45, v42, 1, v45
v_lshl_add_u32 v44, v45, 3, v44
v_add_u32 v16, s8, v44
s_add_u32 m0, s17, 0x3000
s_lshl_b32 s59, s18, 7
s_add_u32 s59, s59, s16
buffer_load_dwordx4 v27, s[24:27], s59 offen offset:0 lds
buffer_load_dwordx4 v28, s[24:27], s59 offen offset:1024 lds
buffer_load_dwordx4 v29, s[24:27], s59 offen offset:2048 lds
buffer_load_dwordx4 v30, s[24:27], s59 offen offset:3072 lds
s_add_u32 s18, s18, 1
s_cmp_eq_u32 s18, 10
s_cselect_b32 s18, 0, s18
s_lshr_b32 s8, s52, 1
s_mul_i32 s8, s8, 0x2800
s_and_b32 s9, s52, 1
s_mul_i32 s9, s9, 0x1400
s_add_u32 s97, s8, s9
s_lshr_b32 s12, s52, 1
s_lshl_b32 s12, s12, 2
s_and_b32 s9, s52, 1
s_lshl_b32 s9, s9, 5
s_mul_i32 s13, s54, 0x180
s_add_u32 s13, s13, 0
s_mov_b32 s8, 0
v_add_u32 v42, 0, v1
v_mul_u32_u24 v43, 0x199a, v42
v_lshrrev_b32 v43, 16, v43
v_mul_u32_u24 v44, 10, v43
v_sub_u32 v44, v42, v44
v_lshl_add_u32 v44, v44, 4, s13
v_xor_b32 v43, s12, v43
v_add_u32 v43, s9, v43
v_mul_u32_u24 v43, 0xc00, v43
v_add_u32 v10, v43, v44
v_add_u32 v42, 64, v1
v_mul_u32_u24 v43, 0x199a, v42
v_lshrrev_b32 v43, 16, v43
v_mul_u32_u24 v44, 10, v43
v_sub_u32 v44, v42, v44
v_lshl_add_u32 v44, v44, 4, s13
v_xor_b32 v43, s12, v43
v_add_u32 v43, s9, v43
v_mul_u32_u24 v43, 0xc00, v43
v_add_u32 v43, v43, v44
v_subrev_u32 v11, 0x400, v43
v_add_u32 v42, 0x80, v1
v_mul_u32_u24 v43, 0x199a, v42
v_lshrrev_b32 v43, 16, v43
v_mul_u32_u24 v44, 10, v43
v_sub_u32 v44, v42, v44
v_lshl_add_u32 v44, v44, 4, s13
v_xor_b32 v43, s12, v43
v_add_u32 v43, s9, v43
v_mul_u32_u24 v43, 0xc00, v43
v_add_u32 v43, v43, v44
v_subrev_u32 v12, 0x800, v43
v_add_u32 v42, 0xc0, v1
v_mul_u32_u24 v43, 0x199a, v42
v_lshrrev_b32 v43, 16, v43
v_mul_u32_u24 v44, 10, v43
v_sub_u32 v44, v42, v44
v_lshl_add_u32 v44, v44, 4, s13
v_xor_b32 v43, s12, v43
v_add_u32 v43, s9, v43
v_mul_u32_u24 v43, 0xc00, v43
v_add_u32 v43, v43, v44
v_subrev_u32 v13, 0xc00, v43
v_add_u32 v42, 0x100, v1
v_mul_u32_u24 v43, 0x199a, v42
v_lshrrev_b32 v43, 16, v43
v_mul_u32_u24 v44, 10, v43
v_sub_u32 v44, v42, v44
v_lshl_add_u32 v44, v44, 4, s13
v_xor_b32 v43, s12, v43
v_add_u32 v43, s9, v43
v_mul_u32_u24 v43, 0xc00, v43
v_add_u32 v14, v43, v44
v_bfe_u32 v42, v1, 4, 1
v_lshrrev_b32 v43, 5, v1
v_bfe_u32 v44, v1, 2, 2
v_and_b32 v45, 3, v1
v_lshl_add_u32 v44, v43, 3, v44
v_mul_u32_u24 v44, 0xa0, v44
v_mov_b32 v51, 0
v_mov_b32 v52, 0
v_mov_b32 v53, 0
v_mov_b32 v54, 0
s_mov_b32 s19, 0x3f803f80
s_waitcnt vmcnt(19)
ds_read_b128 v[96:99], v38 offset:0
ds_read_b128 v[100:103], v39 offset:0
ds_read_b128 v[104:107], v40 offset:0
ds_read_b128 v[108:111], v41 offset:0
s_add_u32 m0, s17, 0x4000
s_lshl_b32 s59, s18, 7
s_add_u32 s59, s59, s16
buffer_load_dwordx4 v27, s[24:27], s59 offen offset:0 lds
buffer_load_dwordx4 v28, s[24:27], s59 offen offset:1024 lds
buffer_load_dwordx4 v29, s[24:27], s59 offen offset:2048 lds
buffer_load_dwordx4 v30, s[24:27], s59 offen offset:3072 lds
s_add_u32 s18, s18, 1
s_cmp_eq_u32 s18, 10
s_cselect_b32 s18, 0, s18
v_lshl_add_u32 v44, v45, 3, v44
v_mul_u32_u24 v43, 0x2a80, v42
v_add3_u32 v17, v44, v43, s8
s_waitcnt vmcnt(12)
ds_read_b128 v[112:115], v38 offset:4096
ds_read_b128 v[116:119], v39 offset:4096
ds_read_b128 v[120:123], v40 offset:4096
ds_read_b128 v[124:127], v41 offset:4096
s_waitcnt lgkmcnt(7)
v_dot2c_f32_bf16 v51, s19, v96
v_dot2c_f32_bf16 v53, v96, v96
v_dot2c_f32_bf16 v52, s19, v97
v_dot2c_f32_bf16 v54, v97, v97
v_dot2c_f32_bf16 v51, s19, v98
v_dot2c_f32_bf16 v53, v98, v98
v_dot2c_f32_bf16 v52, s19, v99
v_dot2c_f32_bf16 v54, v99, v99
s_waitcnt lgkmcnt(6)
v_dot2c_f32_bf16 v51, s19, v100
v_dot2c_f32_bf16 v53, v100, v100
v_dot2c_f32_bf16 v52, s19, v101
v_dot2c_f32_bf16 v54, v101, v101
v_dot2c_f32_bf16 v51, s19, v102
v_dot2c_f32_bf16 v53, v102, v102
v_dot2c_f32_bf16 v52, s19, v103
v_dot2c_f32_bf16 v54, v103, v103
s_waitcnt lgkmcnt(5)
v_dot2c_f32_bf16 v51, s19, v104
v_dot2c_f32_bf16 v53, v104, v104
v_dot2c_f32_bf16 v52, s19, v105
v_dot2c_f32_bf16 v54, v105, v105
v_dot2c_f32_bf16 v51, s19, v106
v_dot2c_f32_bf16 v53, v106, v106
v_dot2c_f32_bf16 v52, s19, v107
v_dot2c_f32_bf16 v54, v107, v107
s_waitcnt lgkmcnt(4)
v_dot2c_f32_bf16 v51, s19, v108
v_dot2c_f32_bf16 v53, v108, v108
v_dot2c_f32_bf16 v52, s19, v109
v_dot2c_f32_bf16 v54, v109, v109
v_dot2c_f32_bf16 v51, s19, v110
v_dot2c_f32_bf16 v53, v110, v110
v_dot2c_f32_bf16 v52, s19, v111
v_dot2c_f32_bf16 v54, v111, v111
s_add_u32 m0, s17, 0x5000
s_lshl_b32 s59, s18, 7
s_add_u32 s59, s59, s16
buffer_load_dwordx4 v27, s[24:27], s59 offen offset:0 lds
buffer_load_dwordx4 v28, s[24:27], s59 offen offset:1024 lds
buffer_load_dwordx4 v29, s[24:27], s59 offen offset:2048 lds
buffer_load_dwordx4 v30, s[24:27], s59 offen offset:3072 lds
s_add_u32 s18, s18, 1
s_cmp_eq_u32 s18, 10
s_cselect_b32 s18, 0, s18
v_mul_u32_u24 v43, 0x2580, v42
v_add_u32 v43, 0x280, v43
v_add3_u32 v18, v44, v43, s8
s_waitcnt vmcnt(12)
ds_read_b128 v[128:131], v38 offset:8192
ds_read_b128 v[132:135], v39 offset:8192
ds_read_b128 v[136:139], v40 offset:8192
ds_read_b128 v[140:143], v41 offset:8192
s_waitcnt lgkmcnt(7)
v_dot2c_f32_bf16 v51, s19, v112
v_dot2c_f32_bf16 v53, v112, v112
v_dot2c_f32_bf16 v52, s19, v113
v_dot2c_f32_bf16 v54, v113, v113
v_dot2c_f32_bf16 v51, s19, v114
v_dot2c_f32_bf16 v53, v114, v114
v_dot2c_f32_bf16 v52, s19, v115
v_dot2c_f32_bf16 v54, v115, v115
s_waitcnt lgkmcnt(6)
v_dot2c_f32_bf16 v51, s19, v116
v_dot2c_f32_bf16 v53, v116, v116
v_dot2c_f32_bf16 v52, s19, v117
v_dot2c_f32_bf16 v54, v117, v117
v_dot2c_f32_bf16 v51, s19, v118
v_dot2c_f32_bf16 v53, v118, v118
v_dot2c_f32_bf16 v52, s19, v119
v_dot2c_f32_bf16 v54, v119, v119
s_waitcnt lgkmcnt(5)
v_dot2c_f32_bf16 v51, s19, v120
v_dot2c_f32_bf16 v53, v120, v120
v_dot2c_f32_bf16 v52, s19, v121
v_dot2c_f32_bf16 v54, v121, v121
v_dot2c_f32_bf16 v51, s19, v122
v_dot2c_f32_bf16 v53, v122, v122
v_dot2c_f32_bf16 v52, s19, v123
v_dot2c_f32_bf16 v54, v123, v123
s_waitcnt lgkmcnt(4)
v_dot2c_f32_bf16 v51, s19, v124
v_dot2c_f32_bf16 v53, v124, v124
v_dot2c_f32_bf16 v52, s19, v125
v_dot2c_f32_bf16 v54, v125, v125
v_dot2c_f32_bf16 v51, s19, v126
v_dot2c_f32_bf16 v53, v126, v126
v_dot2c_f32_bf16 v52, s19, v127
v_dot2c_f32_bf16 v54, v127, v127
s_add_u32 m0, s17, 0x6000
s_lshl_b32 s59, s18, 7
s_add_u32 s59, s59, s16
buffer_load_dwordx4 v27, s[24:27], s59 offen offset:0 lds
buffer_load_dwordx4 v28, s[24:27], s59 offen offset:1024 lds
buffer_load_dwordx4 v29, s[24:27], s59 offen offset:2048 lds
buffer_load_dwordx4 v30, s[24:27], s59 offen offset:3072 lds
s_add_u32 s18, s18, 1
s_cmp_eq_u32 s18, 10
s_cselect_b32 s18, 0, s18
v_lshrrev_b32 v42, 5, v1
v_bfe_u32 v43, v1, 4, 1
v_bfe_u32 v44, v1, 1, 1
s_waitcnt vmcnt(12)
ds_read_b128 v[144:147], v38 offset:12288
ds_read_b128 v[148:151], v39 offset:12288
ds_read_b128 v[152:155], v40 offset:12288
ds_read_b128 v[156:159], v41 offset:12288
s_waitcnt lgkmcnt(7)
v_dot2c_f32_bf16 v51, s19, v128
v_dot2c_f32_bf16 v53, v128, v128
v_dot2c_f32_bf16 v52, s19, v129
v_dot2c_f32_bf16 v54, v129, v129
v_dot2c_f32_bf16 v51, s19, v130
v_dot2c_f32_bf16 v53, v130, v130
v_dot2c_f32_bf16 v52, s19, v131
v_dot2c_f32_bf16 v54, v131, v131
s_waitcnt lgkmcnt(6)
v_dot2c_f32_bf16 v51, s19, v132
v_dot2c_f32_bf16 v53, v132, v132
v_dot2c_f32_bf16 v52, s19, v133
v_dot2c_f32_bf16 v54, v133, v133
v_dot2c_f32_bf16 v51, s19, v134
v_dot2c_f32_bf16 v53, v134, v134
v_dot2c_f32_bf16 v52, s19, v135
v_dot2c_f32_bf16 v54, v135, v135
s_waitcnt lgkmcnt(5)
v_dot2c_f32_bf16 v51, s19, v136
v_dot2c_f32_bf16 v53, v136, v136
v_dot2c_f32_bf16 v52, s19, v137
v_dot2c_f32_bf16 v54, v137, v137
v_dot2c_f32_bf16 v51, s19, v138
v_dot2c_f32_bf16 v53, v138, v138
v_dot2c_f32_bf16 v52, s19, v139
v_dot2c_f32_bf16 v54, v139, v139
s_waitcnt lgkmcnt(4)
v_dot2c_f32_bf16 v51, s19, v140
v_dot2c_f32_bf16 v53, v140, v140
v_dot2c_f32_bf16 v52, s19, v141
v_dot2c_f32_bf16 v54, v141, v141
v_dot2c_f32_bf16 v51, s19, v142
v_dot2c_f32_bf16 v53, v142, v142
v_dot2c_f32_bf16 v52, s19, v143
v_dot2c_f32_bf16 v54, v143, v143
s_add_u32 m0, s17, 0
s_lshl_b32 s59, s18, 7
s_add_u32 s59, s59, s16
buffer_load_dwordx4 v27, s[24:27], s59 offen offset:0 lds
buffer_load_dwordx4 v28, s[24:27], s59 offen offset:1024 lds
buffer_load_dwordx4 v29, s[24:27], s59 offen offset:2048 lds
buffer_load_dwordx4 v30, s[24:27], s59 offen offset:3072 lds
s_add_u32 s18, s18, 1
s_cmp_eq_u32 s18, 10
s_cselect_b32 s18, 0, s18
v_lshl_add_u32 v43, v43, 1, v44
v_mul_u32_u24 v45, 0x640, v42
v_bfe_u32 v44, v1, 2, 2
s_waitcnt vmcnt(12)
ds_read_b128 v[160:163], v38 offset:16384
ds_read_b128 v[164:167], v39 offset:16384
ds_read_b128 v[168:171], v40 offset:16384
ds_read_b128 v[172:175], v41 offset:16384
s_waitcnt lgkmcnt(7)
v_dot2c_f32_bf16 v51, s19, v144
v_dot2c_f32_bf16 v53, v144, v144
v_dot2c_f32_bf16 v52, s19, v145
v_dot2c_f32_bf16 v54, v145, v145
v_dot2c_f32_bf16 v51, s19, v146
v_dot2c_f32_bf16 v53, v146, v146
v_dot2c_f32_bf16 v52, s19, v147
v_dot2c_f32_bf16 v54, v147, v147
s_waitcnt lgkmcnt(6)
v_dot2c_f32_bf16 v51, s19, v148
v_dot2c_f32_bf16 v53, v148, v148
v_dot2c_f32_bf16 v52, s19, v149
v_dot2c_f32_bf16 v54, v149, v149
v_dot2c_f32_bf16 v51, s19, v150
v_dot2c_f32_bf16 v53, v150, v150
v_dot2c_f32_bf16 v52, s19, v151
v_dot2c_f32_bf16 v54, v151, v151
s_waitcnt lgkmcnt(5)
v_dot2c_f32_bf16 v51, s19, v152
v_dot2c_f32_bf16 v53, v152, v152
v_dot2c_f32_bf16 v52, s19, v153
v_dot2c_f32_bf16 v54, v153, v153
v_dot2c_f32_bf16 v51, s19, v154
v_dot2c_f32_bf16 v53, v154, v154
v_dot2c_f32_bf16 v52, s19, v155
v_dot2c_f32_bf16 v54, v155, v155
s_waitcnt lgkmcnt(4)
v_dot2c_f32_bf16 v51, s19, v156
v_dot2c_f32_bf16 v53, v156, v156
v_dot2c_f32_bf16 v52, s19, v157
v_dot2c_f32_bf16 v54, v157, v157
v_dot2c_f32_bf16 v51, s19, v158
v_dot2c_f32_bf16 v53, v158, v158
v_dot2c_f32_bf16 v52, s19, v159
v_dot2c_f32_bf16 v54, v159, v159
s_add_u32 m0, s17, 0x1000
s_lshl_b32 s59, s18, 7
s_add_u32 s59, s59, s16
buffer_load_dwordx4 v27, s[24:27], s59 offen offset:0 lds
buffer_load_dwordx4 v28, s[24:27], s59 offen offset:1024 lds
buffer_load_dwordx4 v29, s[24:27], s59 offen offset:2048 lds
buffer_load_dwordx4 v30, s[24:27], s59 offen offset:3072 lds
s_add_u32 s18, s18, 1
s_cmp_eq_u32 s18, 10
s_cselect_b32 s18, 0, s18
v_mul_u32_u24 v44, 40, v44
v_add_u32 v45, v45, v44
v_lshl_add_u32 v45, v43, 3, v45
s_waitcnt vmcnt(12)
ds_read_b128 v[176:179], v38 offset:20480
ds_read_b128 v[180:183], v39 offset:20480
ds_read_b128 v[184:187], v40 offset:20480
ds_read_b128 v[188:191], v41 offset:20480
s_waitcnt lgkmcnt(7)
v_dot2c_f32_bf16 v51, s19, v160
v_dot2c_f32_bf16 v53, v160, v160
v_dot2c_f32_bf16 v52, s19, v161
v_dot2c_f32_bf16 v54, v161, v161
v_dot2c_f32_bf16 v51, s19, v162
v_dot2c_f32_bf16 v53, v162, v162
v_dot2c_f32_bf16 v52, s19, v163
v_dot2c_f32_bf16 v54, v163, v163
s_waitcnt lgkmcnt(6)
v_dot2c_f32_bf16 v51, s19, v164
v_dot2c_f32_bf16 v53, v164, v164
v_dot2c_f32_bf16 v52, s19, v165
v_dot2c_f32_bf16 v54, v165, v165
v_dot2c_f32_bf16 v51, s19, v166
v_dot2c_f32_bf16 v53, v166, v166
v_dot2c_f32_bf16 v52, s19, v167
v_dot2c_f32_bf16 v54, v167, v167
s_waitcnt lgkmcnt(5)
v_dot2c_f32_bf16 v51, s19, v168
v_dot2c_f32_bf16 v53, v168, v168
v_dot2c_f32_bf16 v52, s19, v169
v_dot2c_f32_bf16 v54, v169, v169
v_dot2c_f32_bf16 v51, s19, v170
v_dot2c_f32_bf16 v53, v170, v170
v_dot2c_f32_bf16 v52, s19, v171
v_dot2c_f32_bf16 v54, v171, v171
s_waitcnt lgkmcnt(4)
v_dot2c_f32_bf16 v51, s19, v172
v_dot2c_f32_bf16 v53, v172, v172
v_dot2c_f32_bf16 v52, s19, v173
v_dot2c_f32_bf16 v54, v173, v173
v_dot2c_f32_bf16 v51, s19, v174
v_dot2c_f32_bf16 v53, v174, v174
v_dot2c_f32_bf16 v52, s19, v175
v_dot2c_f32_bf16 v54, v175, v175
s_add_u32 m0, s17, 0x2000
s_lshl_b32 s59, s18, 7
s_add_u32 s59, s59, s16
buffer_load_dwordx4 v27, s[24:27], s59 offen offset:0 lds
buffer_load_dwordx4 v28, s[24:27], s59 offen offset:1024 lds
buffer_load_dwordx4 v29, s[24:27], s59 offen offset:2048 lds
buffer_load_dwordx4 v30, s[24:27], s59 offen offset:3072 lds
s_add_u32 s18, s18, 1
s_cmp_eq_u32 s18, 10
s_cselect_b32 s18, 0, s18
v_add_u32 v45, 0x26000, v45
v_and_b32 v44, 1, v1
v_mov_b32 v50, 0x26e00
s_waitcnt vmcnt(12)
ds_read_b128 v[192:195], v38 offset:24576
ds_read_b128 v[196:199], v39 offset:24576
ds_read_b128 v[200:203], v40 offset:24576
ds_read_b128 v[204:207], v41 offset:24576
s_waitcnt lgkmcnt(7)
v_dot2c_f32_bf16 v51, s19, v176
v_dot2c_f32_bf16 v53, v176, v176
v_dot2c_f32_bf16 v52, s19, v177
v_dot2c_f32_bf16 v54, v177, v177
v_dot2c_f32_bf16 v51, s19, v178
v_dot2c_f32_bf16 v53, v178, v178
v_dot2c_f32_bf16 v52, s19, v179
v_dot2c_f32_bf16 v54, v179, v179
s_waitcnt lgkmcnt(6)
v_dot2c_f32_bf16 v51, s19, v180
v_dot2c_f32_bf16 v53, v180, v180
v_dot2c_f32_bf16 v52, s19, v181
v_dot2c_f32_bf16 v54, v181, v181
v_dot2c_f32_bf16 v51, s19, v182
v_dot2c_f32_bf16 v53, v182, v182
v_dot2c_f32_bf16 v52, s19, v183
v_dot2c_f32_bf16 v54, v183, v183
s_waitcnt lgkmcnt(5)
v_dot2c_f32_bf16 v51, s19, v184
v_dot2c_f32_bf16 v53, v184, v184
v_dot2c_f32_bf16 v52, s19, v185
v_dot2c_f32_bf16 v54, v185, v185
v_dot2c_f32_bf16 v51, s19, v186
v_dot2c_f32_bf16 v53, v186, v186
v_dot2c_f32_bf16 v52, s19, v187
v_dot2c_f32_bf16 v54, v187, v187
s_waitcnt lgkmcnt(4)
v_dot2c_f32_bf16 v51, s19, v188
v_dot2c_f32_bf16 v53, v188, v188
v_dot2c_f32_bf16 v52, s19, v189
v_dot2c_f32_bf16 v54, v189, v189
v_dot2c_f32_bf16 v51, s19, v190
v_dot2c_f32_bf16 v53, v190, v190
v_dot2c_f32_bf16 v52, s19, v191
v_dot2c_f32_bf16 v54, v191, v191
s_mov_b32 s56, s20
s_add_u32 m0, s96, 0
s_nop 0
buffer_load_dwordx4 v5, s[28:31], s56 offen offset:0 lds
buffer_load_dwordx4 v6, s[28:31], s56 offen offset:1024 lds
buffer_load_dwordx4 v7, s[28:31], s56 offen offset:2048 lds
buffer_load_dwordx4 v8, s[28:31], s56 offen offset:3072 lds
s_add_u32 m0, s96, 0x1000
s_nop 0
buffer_load_dwordx4 v9, s[28:31], s56 offen offset:0 lds
s_add_u32 s56, s56, 0x3c000
s_cmp_eq_u32 s56, 0x258000
s_cselect_b32 s56, 0, s56
s_add_u32 m0, s96, 0x5000
s_nop 0
buffer_load_dwordx4 v5, s[28:31], s56 offen offset:0 lds
buffer_load_dwordx4 v6, s[28:31], s56 offen offset:1024 lds
buffer_load_dwordx4 v7, s[28:31], s56 offen offset:2048 lds
buffer_load_dwordx4 v8, s[28:31], s56 offen offset:3072 lds
s_add_u32 m0, s96, 0x6000
s_nop 0
buffer_load_dwordx4 v9, s[28:31], s56 offen offset:0 lds
s_add_u32 s56, s56, 0x3c000
s_cmp_eq_u32 s56, 0x258000
s_cselect_b32 s56, 0, s56
v_cmp_eq_u32 vcc, v44, v42
s_nop 1
v_cndmask_b32 v46, v50, v45, vcc
v_cmp_eq_u32 vcc, 0, v43
s_waitcnt vmcnt(18)
ds_read_b128 v[208:211], v38 offset:0
ds_read_b128 v[212:215], v39 offset:0
ds_read_b128 v[216:219], v40 offset:0
ds_read_b128 v[220:223], v41 offset:0
s_waitcnt lgkmcnt(7)
v_dot2c_f32_bf16 v51, s19, v192
v_dot2c_f32_bf16 v53, v192, v192
v_dot2c_f32_bf16 v52, s19, v193
v_dot2c_f32_bf16 v54, v193, v193
v_dot2c_f32_bf16 v51, s19, v194
v_dot2c_f32_bf16 v53, v194, v194
v_dot2c_f32_bf16 v52, s19, v195
v_dot2c_f32_bf16 v54, v195, v195
s_waitcnt lgkmcnt(6)
v_dot2c_f32_bf16 v51, s19, v196
v_dot2c_f32_bf16 v53, v196, v196
v_dot2c_f32_bf16 v52, s19, v197
v_dot2c_f32_bf16 v54, v197, v197
v_dot2c_f32_bf16 v51, s19, v198
v_dot2c_f32_bf16 v53, v198, v198
v_dot2c_f32_bf16 v52, s19, v199
v_dot2c_f32_bf16 v54, v199, v199
s_waitcnt lgkmcnt(5)
v_dot2c_f32_bf16 v51, s19, v200
v_dot2c_f32_bf16 v53, v200, v200
v_dot2c_f32_bf16 v52, s19, v201
v_dot2c_f32_bf16 v54, v201, v201
v_dot2c_f32_bf16 v51, s19, v202
v_dot2c_f32_bf16 v53, v202, v202
v_dot2c_f32_bf16 v52, s19, v203
v_dot2c_f32_bf16 v54, v203, v203
s_waitcnt lgkmcnt(4)
v_dot2c_f32_bf16 v51, s19, v204
v_dot2c_f32_bf16 v53, v204, v204
v_dot2c_f32_bf16 v52, s19, v205
v_dot2c_f32_bf16 v54, v205, v205
v_dot2c_f32_bf16 v51, s19, v206
v_dot2c_f32_bf16 v53, v206, v206
v_dot2c_f32_bf16 v52, s19, v207
v_dot2c_f32_bf16 v54, v207, v207
v_cndmask_b32 v47, v50, v46, vcc
v_cmp_le_u32 vcc, 1, v43
s_nop 1
v_cndmask_b32 v48, v50, v46, vcc
s_waitcnt vmcnt(14)
ds_read_b128 v[224:227], v38 offset:4096
ds_read_b128 v[228:231], v39 offset:4096
ds_read_b128 v[232:235], v40 offset:4096
ds_read_b128 v[236:239], v41 offset:4096
s_waitcnt lgkmcnt(7)
v_dot2c_f32_bf16 v51, s19, v208
v_dot2c_f32_bf16 v53, v208, v208
v_dot2c_f32_bf16 v52, s19, v209
v_dot2c_f32_bf16 v54, v209, v209
v_dot2c_f32_bf16 v51, s19, v210
v_dot2c_f32_bf16 v53, v210, v210
v_dot2c_f32_bf16 v52, s19, v211
v_dot2c_f32_bf16 v54, v211, v211
s_waitcnt lgkmcnt(6)
v_dot2c_f32_bf16 v51, s19, v212
v_dot2c_f32_bf16 v53, v212, v212
v_dot2c_f32_bf16 v52, s19, v213
v_dot2c_f32_bf16 v54, v213, v213
v_dot2c_f32_bf16 v51, s19, v214
v_dot2c_f32_bf16 v53, v214, v214
v_dot2c_f32_bf16 v52, s19, v215
v_dot2c_f32_bf16 v54, v215, v215
s_waitcnt lgkmcnt(5)
v_dot2c_f32_bf16 v51, s19, v216
v_dot2c_f32_bf16 v53, v216, v216
v_dot2c_f32_bf16 v52, s19, v217
v_dot2c_f32_bf16 v54, v217, v217
v_dot2c_f32_bf16 v51, s19, v218
v_dot2c_f32_bf16 v53, v218, v218
v_dot2c_f32_bf16 v52, s19, v219
v_dot2c_f32_bf16 v54, v219, v219
s_waitcnt lgkmcnt(4)
v_dot2c_f32_bf16 v51, s19, v220
v_dot2c_f32_bf16 v53, v220, v220
v_dot2c_f32_bf16 v52, s19, v221
v_dot2c_f32_bf16 v54, v221, v221
v_dot2c_f32_bf16 v51, s19, v222
v_dot2c_f32_bf16 v53, v222, v222
v_dot2c_f32_bf16 v52, s19, v223
v_dot2c_f32_bf16 v54, v223, v223
v_cmp_ge_u32 vcc, 1, v43
s_nop 1
v_cndmask_b32 v49, v50, v46, vcc
s_waitcnt vmcnt(10)
ds_read_b128 v[240:243], v38 offset:8192
ds_read_b128 v[244:247], v39 offset:8192
ds_read_b128 v[248:251], v40 offset:8192
ds_read_b128 v[252:255], v41 offset:8192
s_waitcnt lgkmcnt(7)
v_dot2c_f32_bf16 v51, s19, v224
v_dot2c_f32_bf16 v53, v224, v224
v_dot2c_f32_bf16 v52, s19, v225
v_dot2c_f32_bf16 v54, v225, v225
v_dot2c_f32_bf16 v51, s19, v226
v_dot2c_f32_bf16 v53, v226, v226
v_dot2c_f32_bf16 v52, s19, v227
v_dot2c_f32_bf16 v54, v227, v227
s_waitcnt lgkmcnt(6)
v_dot2c_f32_bf16 v51, s19, v228
v_dot2c_f32_bf16 v53, v228, v228
v_dot2c_f32_bf16 v52, s19, v229
v_dot2c_f32_bf16 v54, v229, v229
v_dot2c_f32_bf16 v51, s19, v230
v_dot2c_f32_bf16 v53, v230, v230
v_dot2c_f32_bf16 v52, s19, v231
v_dot2c_f32_bf16 v54, v231, v231
s_waitcnt lgkmcnt(5)
v_dot2c_f32_bf16 v51, s19, v232
v_dot2c_f32_bf16 v53, v232, v232
v_dot2c_f32_bf16 v52, s19, v233
v_dot2c_f32_bf16 v54, v233, v233
v_dot2c_f32_bf16 v51, s19, v234
v_dot2c_f32_bf16 v53, v234, v234
v_dot2c_f32_bf16 v52, s19, v235
v_dot2c_f32_bf16 v54, v235, v235
s_waitcnt lgkmcnt(4)
v_dot2c_f32_bf16 v51, s19, v236
v_dot2c_f32_bf16 v53, v236, v236
v_dot2c_f32_bf16 v52, s19, v237
v_dot2c_f32_bf16 v54, v237, v237
v_dot2c_f32_bf16 v51, s19, v238
v_dot2c_f32_bf16 v53, v238, v238
v_dot2c_f32_bf16 v52, s19, v239
v_dot2c_f32_bf16 v54, v239, v239
s_waitcnt lgkmcnt(3)
v_dot2c_f32_bf16 v51, s19, v240
v_dot2c_f32_bf16 v53, v240, v240
v_dot2c_f32_bf16 v52, s19, v241
v_dot2c_f32_bf16 v54, v241, v241
v_dot2c_f32_bf16 v51, s19, v242
v_dot2c_f32_bf16 v53, v242, v242
v_dot2c_f32_bf16 v52, s19, v243
v_dot2c_f32_bf16 v54, v243, v243
s_waitcnt lgkmcnt(2)
v_dot2c_f32_bf16 v51, s19, v244
v_dot2c_f32_bf16 v53, v244, v244
v_dot2c_f32_bf16 v52, s19, v245
v_dot2c_f32_bf16 v54, v245, v245
v_dot2c_f32_bf16 v51, s19, v246
v_dot2c_f32_bf16 v53, v246, v246
v_dot2c_f32_bf16 v52, s19, v247
v_dot2c_f32_bf16 v54, v247, v247
s_waitcnt lgkmcnt(1)
v_dot2c_f32_bf16 v51, s19, v248
v_dot2c_f32_bf16 v53, v248, v248
v_dot2c_f32_bf16 v52, s19, v249
v_dot2c_f32_bf16 v54, v249, v249
v_dot2c_f32_bf16 v51, s19, v250
v_dot2c_f32_bf16 v53, v250, v250
v_dot2c_f32_bf16 v52, s19, v251
v_dot2c_f32_bf16 v54, v251, v251
s_waitcnt lgkmcnt(0)
v_dot2c_f32_bf16 v51, s19, v252
v_dot2c_f32_bf16 v53, v252, v252
v_dot2c_f32_bf16 v52, s19, v253
v_dot2c_f32_bf16 v54, v253, v253
v_dot2c_f32_bf16 v51, s19, v254
v_dot2c_f32_bf16 v53, v254, v254
v_dot2c_f32_bf16 v52, s19, v255
v_dot2c_f32_bf16 v54, v255, v255
v_mov_b32 v36, 1
s_mov_b64 exec, 1
buffer_store_dword v36, v37, s[48:51], 0 offen sc1
s_mov_b64 exec, -1
v_add_f32 v51, v51, v52
v_add_f32 v53, v53, v54
v_mov_b32 v52, v51
v_mov_b32 v54, v53
s_nop 0
v_permlane32_swap_b32 v51, v52
v_permlane32_swap_b32 v53, v54
v_add_f32 v51, v51, v52
v_add_f32 v53, v53, v54
v_mul_f32 v51, 0x3acccccd, v51
v_mul_f32 v53, 0x3acccccd, v53
v_fma_f32 v53, -v51, v51, v53
v_max_f32 v53, 0, v53
v_add_f32 v53, 0x3727c5ac, v53
v_rsq_f32 v21, v53
s_nop 0
v_mul_f32 v22, v51, v21
v_sub_f32 v22, 0, v22
v_lshlrev_b32 v23, 16, v96
v_and_b32 v24, s61, v96
v_fma_f32 v23, v23, v21, v22
v_fma_f32 v24, v24, v21, v22
v_cvt_pk_bf16_f32 v96, v23, v24
v_lshlrev_b32 v23, 16, v97
v_and_b32 v24, s61, v97
v_fma_f32 v23, v23, v21, v22
v_fma_f32 v24, v24, v21, v22
v_cvt_pk_bf16_f32 v97, v23, v24
v_lshlrev_b32 v23, 16, v98
v_and_b32 v24, s61, v98
v_fma_f32 v23, v23, v21, v22
v_fma_f32 v24, v24, v21, v22
v_cvt_pk_bf16_f32 v98, v23, v24
v_lshlrev_b32 v23, 16, v99
v_and_b32 v24, s61, v99
v_fma_f32 v23, v23, v21, v22
v_fma_f32 v24, v24, v21, v22
v_cvt_pk_bf16_f32 v99, v23, v24
v_lshlrev_b32 v23, 16, v100
v_and_b32 v24, s61, v100
v_fma_f32 v23, v23, v21, v22
v_fma_f32 v24, v24, v21, v22
v_cvt_pk_bf16_f32 v100, v23, v24
v_lshlrev_b32 v23, 16, v101
v_and_b32 v24, s61, v101
v_fma_f32 v23, v23, v21, v22
v_fma_f32 v24, v24, v21, v22
v_cvt_pk_bf16_f32 v101, v23, v24
v_lshlrev_b32 v23, 16, v102
v_and_b32 v24, s61, v102
v_fma_f32 v23, v23, v21, v22
v_fma_f32 v24, v24, v21, v22
v_cvt_pk_bf16_f32 v102, v23, v24
v_lshlrev_b32 v23, 16, v103
v_and_b32 v24, s61, v103
v_fma_f32 v23, v23, v21, v22
v_fma_f32 v24, v24, v21, v22
v_cvt_pk_bf16_f32 v103, v23, v24
s_waitcnt vmcnt(6)
s_barrier
ds_read_b64_tr_b16 a[160:161], v16 offset:0
ds_read_b64_tr_b16 a[162:163], v16 offset:1280
ds_read_b64_tr_b16 a[164:165], v16 offset:32
ds_read_b64_tr_b16 a[166:167], v16 offset:1312
ds_read_b64_tr_b16 a[168:169], v16 offset:64
ds_read_b64_tr_b16 a[170:171], v16 offset:1344
ds_read_b64_tr_b16 a[172:173], v16 offset:96
ds_read_b64_tr_b16 a[174:175], v16 offset:1376
ds_read_b64_tr_b16 a[176:177], v16 offset:128
ds_read_b64_tr_b16 a[178:179], v16 offset:1408
ds_read_b64_tr_b16 a[180:181], v16 offset:5120
ds_read_b64_tr_b16 a[182:183], v16 offset:6400
ds_read_b64_tr_b16 a[184:185], v16 offset:5152
ds_read_b64_tr_b16 a[186:187], v16 offset:6432
s_waitcnt lgkmcnt(12)
v_mfma_f32_32x32x16_bf16 a[0:15], a[160:163], v[96:99], 0
s_add_u32 m0, s96, 0xa000
ds_read_b64_tr_b16 a[188:189], v16 offset:5184
ds_read_b64_tr_b16 a[190:191], v16 offset:6464
buffer_load_dwordx4 v5, s[28:31], s56 offen offset:0 lds
s_waitcnt lgkmcnt(6)
v_lshlrev_b32 v23, 16, v104
v_and_b32 v24, s61, v104
v_fma_f32 v23, v23, v21, v22
v_fma_f32 v24, v24, v21, v22
v_mfma_f32_32x32x16_bf16 a[16:31], a[164:167], v[96:99], 0
ds_read_b64_tr_b16 a[160:161], v16 offset:5216
ds_read_b64_tr_b16 a[162:163], v16 offset:6496
buffer_load_dwordx4 v6, s[28:31], s56 offen offset:1024 lds
v_cvt_pk_bf16_f32 v104, v23, v24
v_lshlrev_b32 v23, 16, v105
v_and_b32 v24, s61, v105
v_fma_f32 v23, v23, v21, v22
v_mfma_f32_32x32x16_bf16 a[32:47], a[168:171], v[96:99], 0
ds_read_b64_tr_b16 a[164:165], v16 offset:5248
ds_read_b64_tr_b16 a[166:167], v16 offset:6528
buffer_load_dwordx4 v7, s[28:31], s56 offen offset:2048 lds
v_fma_f32 v24, v24, v21, v22
v_cvt_pk_bf16_f32 v105, v23, v24
v_mfma_f32_32x32x16_bf16 a[48:63], a[172:175], v[96:99], 0
ds_read_b64_tr_b16 a[168:169], v16 offset:10240
ds_read_b64_tr_b16 a[170:171], v16 offset:11520
buffer_load_dwordx4 v8, s[28:31], s56 offen offset:3072 lds
ds_read_b64_tr_b16 a[192:193], v46 offset:0
v_lshlrev_b32 v23, 16, v106
v_and_b32 v24, s61, v106
v_fma_f32 v23, v23, v21, v22
v_fma_f32 v24, v24, v21, v22
v_mfma_f32_32x32x16_bf16 a[64:79], a[176:179], v[96:99], 0
ds_read_b64_tr_b16 a[172:173], v16 offset:10272
ds_read_b64_tr_b16 a[174:175], v16 offset:11552
s_waitcnt lgkmcnt(7)
v_cvt_pk_bf16_f32 v106, v23, v24
v_lshlrev_b32 v23, 16, v107
v_and_b32 v24, s61, v107
v_fma_f32 v23, v23, v21, v22
v_mfma_f32_32x32x16_bf16 a[0:15], a[180:183], v[100:103], a[0:15]
ds_read_b64_tr_b16 a[176:177], v16 offset:10304
ds_read_b64_tr_b16 a[178:179], v16 offset:11584
v_fma_f32 v24, v24, v21, v22
v_cvt_pk_bf16_f32 v107, v23, v24
v_lshlrev_b32 v25, 16, v108
v_and_b32 v26, s61, v108
v_mfma_f32_32x32x16_bf16 a[16:31], a[184:187], v[100:103], a[16:31]
ds_read_b64_tr_b16 a[180:181], v16 offset:10336
ds_read_b64_tr_b16 a[182:183], v16 offset:11616
v_fma_f32 v25, v25, v21, v22
v_fma_f32 v26, v26, v21, v22
v_cvt_pk_bf16_f32 v108, v25, v26
v_lshlrev_b32 v25, 16, v109
v_mfma_f32_32x32x16_bf16 a[32:47], a[188:191], v[100:103], a[32:47]
s_add_u32 m0, s96, 0xb000
ds_read_b64_tr_b16 a[184:185], v16 offset:10368
ds_read_b64_tr_b16 a[186:187], v16 offset:11648
buffer_load_dwordx4 v9, s[28:31], s56 offen offset:0 lds
s_add_u32 s56, s56, 0x3c000
s_cmp_eq_u32 s56, 0x258000
s_cselect_b32 s56, 0, s56
v_and_b32 v26, s61, v109
v_fma_f32 v25, v25, v21, v22
v_fma_f32 v26, v26, v21, v22
v_cvt_pk_bf16_f32 v109, v25, v26
v_mfma_f32_32x32x16_bf16 a[48:63], a[160:163], v[100:103], a[48:63]
ds_read_b64_tr_b16 a[188:189], v16 offset:15360
ds_read_b64_tr_b16 a[190:191], v16 offset:16640
s_waitcnt lgkmcnt(6)
ds_read_b64_tr_b16 a[194:195], v46 offset:160
v_lshlrev_b32 v25, 16, v110
v_and_b32 v26, s61, v110
v_fma_f32 v25, v25, v21, v22
v_fma_f32 v26, v26, v21, v22
v_mfma_f32_32x32x16_bf16 a[64:79], a[164:167], v[100:103], a[64:79]
ds_read_b64_tr_b16 a[160:161], v16 offset:15392
ds_read_b64_tr_b16 a[162:163], v16 offset:16672
v_cvt_pk_bf16_f32 v110, v25, v26
v_lshlrev_b32 v25, 16, v111
v_and_b32 v26, s61, v111
v_fma_f32 v25, v25, v21, v22
v_mfma_f32_32x32x16_bf16 a[0:15], a[168:171], v[104:107], a[0:15]
ds_read_b64_tr_b16 a[164:165], v16 offset:15424
ds_read_b64_tr_b16 a[166:167], v16 offset:16704
v_fma_f32 v26, v26, v21, v22
v_cvt_pk_bf16_f32 v111, v25, v26
v_lshlrev_b32 v23, 16, v112
v_and_b32 v24, s61, v112
v_mfma_f32_32x32x16_bf16 a[16:31], a[172:175], v[104:107], a[16:31]
s_add_u32 m0, s96, 0xf000
ds_read_b64_tr_b16 a[168:169], v16 offset:15456
ds_read_b64_tr_b16 a[170:171], v16 offset:16736
buffer_load_dwordx4 v5, s[28:31], s56 offen offset:0 lds
v_fma_f32 v23, v23, v21, v22
v_fma_f32 v24, v24, v21, v22
v_cvt_pk_bf16_f32 v112, v23, v24
v_lshlrev_b32 v23, 16, v113
v_mfma_f32_32x32x16_bf16 a[32:47], a[176:179], v[104:107], a[32:47]
ds_read_b64_tr_b16 a[172:173], v16 offset:15488
ds_read_b64_tr_b16 a[174:175], v16 offset:16768
s_waitcnt lgkmcnt(6)
v_and_b32 v24, s61, v113
v_fma_f32 v23, v23, v21, v22
v_fma_f32 v24, v24, v21, v22
v_cvt_pk_bf16_f32 v113, v23, v24
v_mfma_f32_32x32x16_bf16 a[48:63], a[180:183], v[104:107], a[48:63]
s_waitcnt vmcnt(7)
s_barrier
v_add_u32 v16, 0x5000, v16
ds_read_b64_tr_b16 a[176:177], v16 offset:0
ds_read_b64_tr_b16 a[178:179], v16 offset:1280
ds_read_b64_tr_b16 a[196:197], v46 offset:320
v_lshlrev_b32 v23, 16, v114
v_and_b32 v24, s61, v114
v_fma_f32 v23, v23, v21, v22
v_fma_f32 v24, v24, v21, v22
v_mfma_f32_32x32x16_bf16 a[64:79], a[184:187], v[104:107], a[64:79]
ds_read_b64_tr_b16 a[180:181], v16 offset:32
ds_read_b64_tr_b16 a[182:183], v16 offset:1312
buffer_load_dwordx4 v6, s[28:31], s56 offen offset:1024 lds
v_cvt_pk_bf16_f32 v114, v23, v24
v_lshlrev_b32 v23, 16, v115
v_and_b32 v24, s61, v115
v_fma_f32 v23, v23, v21, v22
v_mfma_f32_32x32x16_bf16 a[0:15], a[188:191], v[108:111], a[0:15]
ds_read_b64_tr_b16 a[184:185], v16 offset:64
ds_read_b64_tr_b16 a[186:187], v16 offset:1344
buffer_load_dwordx4 v7, s[28:31], s56 offen offset:2048 lds
v_fma_f32 v24, v24, v21, v22
v_cvt_pk_bf16_f32 v115, v23, v24
v_lshlrev_b32 v25, 16, v116
v_and_b32 v26, s61, v116
v_mfma_f32_32x32x16_bf16 a[16:31], a[160:163], v[108:111], a[16:31]
ds_read_b64_tr_b16 a[188:189], v16 offset:96
ds_read_b64_tr_b16 a[190:191], v16 offset:1376
buffer_load_dwordx4 v8, s[28:31], s56 offen offset:3072 lds
s_waitcnt lgkmcnt(7)
v_fma_f32 v25, v25, v21, v22
v_fma_f32 v26, v26, v21, v22
v_cvt_pk_bf16_f32 v116, v25, v26
v_lshlrev_b32 v25, 16, v117
v_mfma_f32_32x32x16_bf16 a[32:47], a[164:167], v[108:111], a[32:47]
ds_read_b64_tr_b16 a[160:161], v16 offset:128
ds_read_b64_tr_b16 a[162:163], v16 offset:1408
v_and_b32 v26, s61, v117
v_fma_f32 v25, v25, v21, v22
v_fma_f32 v26, v26, v21, v22
v_cvt_pk_bf16_f32 v117, v25, v26
v_mfma_f32_32x32x16_bf16 a[48:63], a[168:171], v[108:111], a[48:63]
ds_read_b64_tr_b16 a[164:165], v16 offset:5120
ds_read_b64_tr_b16 a[166:167], v16 offset:6400
ds_read_b64_tr_b16 a[198:199], v46 offset:480
v_lshlrev_b32 v25, 16, v118
v_and_b32 v26, s61, v118
v_fma_f32 v25, v25, v21, v22
v_fma_f32 v26, v26, v21, v22
v_mfma_f32_32x32x16_bf16 a[64:79], a[172:175], v[108:111], a[64:79]
ds_read_b64_tr_b16 a[168:169], v16 offset:5152
ds_read_b64_tr_b16 a[170:171], v16 offset:6432
v_cvt_pk_bf16_f32 v118, v25, v26
v_lshlrev_b32 v25, 16, v119
v_and_b32 v26, s61, v119
v_fma_f32 v25, v25, v21, v22
v_mfma_f32_32x32x16_bf16 a[0:15], a[176:179], v[112:115], a[0:15]
s_add_u32 m0, s96, 0x10000
ds_read_b64_tr_b16 a[172:173], v16 offset:5184
ds_read_b64_tr_b16 a[174:175], v16 offset:6464
buffer_load_dwordx4 v9, s[28:31], s56 offen offset:0 lds
s_add_u32 s56, s56, 0x3c000
s_cmp_eq_u32 s56, 0x258000
s_cselect_b32 s56, 0, s56
s_waitcnt lgkmcnt(7)
v_fma_f32 v26, v26, v21, v22
v_cvt_pk_bf16_f32 v119, v25, v26
v_lshlrev_b32 v23, 16, v120
v_and_b32 v24, s61, v120
v_mfma_f32_32x32x16_bf16 a[16:31], a[180:183], v[112:115], a[16:31]
ds_read_b64_tr_b16 a[176:177], v16 offset:5216
ds_read_b64_tr_b16 a[178:179], v16 offset:6496
v_fma_f32 v23, v23, v21, v22
v_fma_f32 v24, v24, v21, v22
v_cvt_pk_bf16_f32 v120, v23, v24
v_lshlrev_b32 v23, 16, v121
v_mfma_f32_32x32x16_bf16 a[32:47], a[184:187], v[112:115], a[32:47]
ds_read_b64_tr_b16 a[180:181], v16 offset:5248
ds_read_b64_tr_b16 a[182:183], v16 offset:6528
v_and_b32 v24, s61, v121
v_fma_f32 v23, v23, v21, v22
v_fma_f32 v24, v24, v21, v22
v_cvt_pk_bf16_f32 v121, v23, v24
v_mfma_f32_32x32x16_bf16 a[48:63], a[188:191], v[112:115], a[48:63]
ds_read_b64_tr_b16 a[184:185], v16 offset:10240
ds_read_b64_tr_b16 a[186:187], v16 offset:11520
ds_read_b64_tr_b16 a[200:201], v46 offset:640
v_lshlrev_b32 v23, 16, v122
v_and_b32 v24, s61, v122
v_fma_f32 v23, v23, v21, v22
v_fma_f32 v24, v24, v21, v22
v_mfma_f32_32x32x16_bf16 a[64:79], a[160:163], v[112:115], a[64:79]
s_add_u32 m0, s96, 0x14000
ds_read_b64_tr_b16 a[188:189], v16 offset:10272
ds_read_b64_tr_b16 a[190:191], v16 offset:11552
buffer_load_dwordx4 v5, s[28:31], s56 offen offset:0 lds
s_waitcnt lgkmcnt(7)
v_cvt_pk_bf16_f32 v122, v23, v24
v_lshlrev_b32 v23, 16, v123
v_and_b32 v24, s61, v123
v_fma_f32 v23, v23, v21, v22
v_mfma_f32_32x32x16_bf16 a[0:15], a[164:167], v[116:119], a[0:15]
ds_read_b64_tr_b16 a[160:161], v16 offset:10304
ds_read_b64_tr_b16 a[162:163], v16 offset:11584
v_fma_f32 v24, v24, v21, v22
v_cvt_pk_bf16_f32 v123, v23, v24
v_lshlrev_b32 v25, 16, v124
v_and_b32 v26, s61, v124
v_mfma_f32_32x32x16_bf16 a[16:31], a[168:171], v[116:119], a[16:31]
ds_read_b64_tr_b16 a[164:165], v16 offset:10336
ds_read_b64_tr_b16 a[166:167], v16 offset:11616
v_fma_f32 v25, v25, v21, v22
v_fma_f32 v26, v26, v21, v22
v_cvt_pk_bf16_f32 v124, v25, v26
v_lshlrev_b32 v25, 16, v125
v_mfma_f32_32x32x16_bf16 a[32:47], a[172:175], v[116:119], a[32:47]
ds_read_b64_tr_b16 a[168:169], v16 offset:10368
ds_read_b64_tr_b16 a[170:171], v16 offset:11648
v_and_b32 v26, s61, v125
v_fma_f32 v25, v25, v21, v22
v_fma_f32 v26, v26, v21, v22
v_cvt_pk_bf16_f32 v125, v25, v26
v_mfma_f32_32x32x16_bf16 a[48:63], a[176:179], v[116:119], a[48:63]
ds_read_b64_tr_b16 a[172:173], v16 offset:15360
ds_read_b64_tr_b16 a[174:175], v16 offset:16640
buffer_load_dwordx4 v6, s[28:31], s56 offen offset:1024 lds
s_waitcnt lgkmcnt(6)
ds_read_b64_tr_b16 a[202:203], v50
v_lshlrev_b32 v25, 16, v126
v_and_b32 v26, s61, v126
v_fma_f32 v25, v25, v21, v22
v_fma_f32 v26, v26, v21, v22
v_mfma_f32_32x32x16_bf16 a[64:79], a[180:183], v[116:119], a[64:79]
ds_read_b64_tr_b16 a[176:177], v16 offset:15392
ds_read_b64_tr_b16 a[178:179], v16 offset:16672
v_cvt_pk_bf16_f32 v126, v25, v26
v_lshlrev_b32 v25, 16, v127
v_and_b32 v26, s61, v127
v_fma_f32 v25, v25, v21, v22
v_mfma_f32_32x32x16_bf16 a[0:15], a[184:187], v[120:123], a[0:15]
ds_read_b64_tr_b16 a[180:181], v16 offset:15424
ds_read_b64_tr_b16 a[182:183], v16 offset:16704
v_fma_f32 v26, v26, v21, v22
v_cvt_pk_bf16_f32 v127, v25, v26
v_lshlrev_b32 v23, 16, v128
v_and_b32 v24, s61, v128
v_mfma_f32_32x32x16_bf16 a[16:31], a[188:191], v[120:123], a[16:31]
ds_read_b64_tr_b16 a[184:185], v16 offset:15456
ds_read_b64_tr_b16 a[186:187], v16 offset:16736
v_fma_f32 v23, v23, v21, v22
v_fma_f32 v24, v24, v21, v22
v_cvt_pk_bf16_f32 v128, v23, v24
v_lshlrev_b32 v23, 16, v129
v_mfma_f32_32x32x16_bf16 a[32:47], a[160:163], v[120:123], a[32:47]
ds_read_b64_tr_b16 a[188:189], v16 offset:15488
ds_read_b64_tr_b16 a[190:191], v16 offset:16768
buffer_load_dwordx4 v7, s[28:31], s56 offen offset:2048 lds
s_waitcnt lgkmcnt(6)
v_and_b32 v24, s61, v129
v_fma_f32 v23, v23, v21, v22
v_fma_f32 v24, v24, v21, v22
v_cvt_pk_bf16_f32 v129, v23, v24
v_mfma_f32_32x32x16_bf16 a[48:63], a[164:167], v[120:123], a[48:63]
s_waitcnt vmcnt(8)
s_barrier
v_add_u32 v16, 0x5000, v16
ds_read_b64_tr_b16 a[160:161], v16 offset:0
ds_read_b64_tr_b16 a[162:163], v16 offset:1280
ds_read_b64_tr_b16 a[204:205], v47 offset:32
v_lshlrev_b32 v23, 16, v130
v_and_b32 v24, s61, v130
v_fma_f32 v23, v23, v21, v22
v_fma_f32 v24, v24, v21, v22
v_mfma_f32_32x32x16_bf16 a[64:79], a[168:171], v[120:123], a[64:79]
ds_read_b64_tr_b16 a[164:165], v16 offset:32
ds_read_b64_tr_b16 a[166:167], v16 offset:1312
buffer_load_dwordx4 v8, s[28:31], s56 offen offset:3072 lds
v_cvt_pk_bf16_f32 v130, v23, v24
v_lshlrev_b32 v23, 16, v131
v_and_b32 v24, s61, v131
v_fma_f32 v23, v23, v21, v22
v_mfma_f32_32x32x16_bf16 a[0:15], a[172:175], v[124:127], a[0:15]
ds_read_b64_tr_b16 a[168:169], v16 offset:64
ds_read_b64_tr_b16 a[170:171], v16 offset:1344
v_fma_f32 v24, v24, v21, v22
v_cvt_pk_bf16_f32 v131, v23, v24
v_lshlrev_b32 v25, 16, v132
v_and_b32 v26, s61, v132
v_mfma_f32_32x32x16_bf16 a[16:31], a[176:179], v[124:127], a[16:31]
ds_read_b64_tr_b16 a[172:173], v16 offset:96
ds_read_b64_tr_b16 a[174:175], v16 offset:1376
s_waitcnt lgkmcnt(7)
v_fma_f32 v25, v25, v21, v22
v_fma_f32 v26, v26, v21, v22
v_cvt_pk_bf16_f32 v132, v25, v26
v_lshlrev_b32 v25, 16, v133
v_mfma_f32_32x32x16_bf16 a[32:47], a[180:183], v[124:127], a[32:47]
ds_read_b64_tr_b16 a[176:177], v16 offset:128
ds_read_b64_tr_b16 a[178:179], v16 offset:1408
v_and_b32 v26, s61, v133
v_fma_f32 v25, v25, v21, v22
v_fma_f32 v26, v26, v21, v22
v_cvt_pk_bf16_f32 v133, v25, v26
v_mfma_f32_32x32x16_bf16 a[48:63], a[184:187], v[124:127], a[48:63]
s_add_u32 m0, s96, 0x15000
ds_read_b64_tr_b16 a[180:181], v16 offset:5120
ds_read_b64_tr_b16 a[182:183], v16 offset:6400
buffer_load_dwordx4 v9, s[28:31], s56 offen offset:0 lds
s_add_u32 s56, s56, 0x3c000
s_cmp_eq_u32 s56, 0x258000
s_cselect_b32 s56, 0, s56
ds_read_b64_tr_b16 a[206:207], v47 offset:192
v_lshlrev_b32 v25, 16, v134
v_and_b32 v26, s61, v134
v_fma_f32 v25, v25, v21, v22
v_fma_f32 v26, v26, v21, v22
v_mfma_f32_32x32x16_bf16 a[64:79], a[188:191], v[124:127], a[64:79]
ds_read_b64_tr_b16 a[184:185], v16 offset:5152
ds_read_b64_tr_b16 a[186:187], v16 offset:6432
v_cvt_pk_bf16_f32 v134, v25, v26
v_lshlrev_b32 v25, 16, v135
v_and_b32 v26, s61, v135
v_fma_f32 v25, v25, v21, v22
v_mfma_f32_32x32x16_bf16 a[0:15], a[160:163], v[128:131], a[0:15]
ds_read_b64_tr_b16 a[188:189], v16 offset:5184
ds_read_b64_tr_b16 a[190:191], v16 offset:6464
s_waitcnt lgkmcnt(7)
v_fma_f32 v26, v26, v21, v22
v_cvt_pk_bf16_f32 v135, v25, v26
v_lshlrev_b32 v23, 16, v136
v_and_b32 v24, s61, v136
v_mfma_f32_32x32x16_bf16 a[16:31], a[164:167], v[128:131], a[16:31]
ds_read_b64_tr_b16 a[160:161], v16 offset:5216
ds_read_b64_tr_b16 a[162:163], v16 offset:6496
v_fma_f32 v23, v23, v21, v22
v_fma_f32 v24, v24, v21, v22
v_cvt_pk_bf16_f32 v136, v23, v24
v_lshlrev_b32 v23, 16, v137
v_mfma_f32_32x32x16_bf16 a[32:47], a[168:171], v[128:131], a[32:47]
s_add_u32 m0, s96, 0
ds_read_b64_tr_b16 a[164:165], v16 offset:5248
ds_read_b64_tr_b16 a[166:167], v16 offset:6528
buffer_load_dwordx4 v5, s[28:31], s56 offen offset:0 lds
v_and_b32 v24, s61, v137
v_fma_f32 v23, v23, v21, v22
v_fma_f32 v24, v24, v21, v22
v_cvt_pk_bf16_f32 v137, v23, v24
v_mfma_f32_32x32x16_bf16 a[48:63], a[172:175], v[128:131], a[48:63]
ds_read_b64_tr_b16 a[168:169], v16 offset:10240
ds_read_b64_tr_b16 a[170:171], v16 offset:11520
ds_read_b64_tr_b16 a[208:209], v47 offset:352
v_lshlrev_b32 v23, 16, v138
v_and_b32 v24, s61, v138
v_fma_f32 v23, v23, v21, v22
v_fma_f32 v24, v24, v21, v22
v_mfma_f32_32x32x16_bf16 a[64:79], a[176:179], v[128:131], a[64:79]
ds_read_b64_tr_b16 a[172:173], v16 offset:10272
ds_read_b64_tr_b16 a[174:175], v16 offset:11552
s_waitcnt lgkmcnt(7)
v_cvt_pk_bf16_f32 v138, v23, v24
v_lshlrev_b32 v23, 16, v139
v_and_b32 v24, s61, v139
v_fma_f32 v23, v23, v21, v22
v_mfma_f32_32x32x16_bf16 a[0:15], a[180:183], v[132:135], a[0:15]
ds_read_b64_tr_b16 a[176:177], v16 offset:10304
ds_read_b64_tr_b16 a[178:179], v16 offset:11584
v_fma_f32 v24, v24, v21, v22
v_cvt_pk_bf16_f32 v139, v23, v24
v_lshlrev_b32 v25, 16, v140
v_and_b32 v26, s61, v140
v_mfma_f32_32x32x16_bf16 a[16:31], a[184:187], v[132:135], a[16:31]
ds_read_b64_tr_b16 a[180:181], v16 offset:10336
ds_read_b64_tr_b16 a[182:183], v16 offset:11616
buffer_load_dwordx4 v6, s[28:31], s56 offen offset:1024 lds
v_fma_f32 v25, v25, v21, v22
v_fma_f32 v26, v26, v21, v22
v_cvt_pk_bf16_f32 v140, v25, v26
v_lshlrev_b32 v25, 16, v141
v_mfma_f32_32x32x16_bf16 a[32:47], a[188:191], v[132:135], a[32:47]
ds_read_b64_tr_b16 a[184:185], v16 offset:10368
ds_read_b64_tr_b16 a[186:187], v16 offset:11648
v_and_b32 v26, s61, v141
v_fma_f32 v25, v25, v21, v22
v_fma_f32 v26, v26, v21, v22
v_cvt_pk_bf16_f32 v141, v25, v26
v_mfma_f32_32x32x16_bf16 a[48:63], a[160:163], v[132:135], a[48:63]
ds_read_b64_tr_b16 a[188:189], v16 offset:15360
ds_read_b64_tr_b16 a[190:191], v16 offset:16640
s_waitcnt lgkmcnt(6)
ds_read_b64_tr_b16 a[210:211], v47 offset:512
v_lshlrev_b32 v25, 16, v142
v_and_b32 v26, s61, v142
v_fma_f32 v25, v25, v21, v22
v_fma_f32 v26, v26, v21, v22
v_mfma_f32_32x32x16_bf16 a[64:79], a[164:167], v[132:135], a[64:79]
ds_read_b64_tr_b16 a[160:161], v16 offset:15392
ds_read_b64_tr_b16 a[162:163], v16 offset:16672
v_cvt_pk_bf16_f32 v142, v25, v26
v_lshlrev_b32 v25, 16, v143
v_and_b32 v26, s61, v143
v_fma_f32 v25, v25, v21, v22
v_mfma_f32_32x32x16_bf16 a[0:15], a[168:171], v[136:139], a[0:15]
ds_read_b64_tr_b16 a[164:165], v16 offset:15424
ds_read_b64_tr_b16 a[166:167], v16 offset:16704
buffer_load_dwordx4 v7, s[28:31], s56 offen offset:2048 lds
v_fma_f32 v26, v26, v21, v22
v_cvt_pk_bf16_f32 v143, v25, v26
v_lshlrev_b32 v23, 16, v144
v_and_b32 v24, s61, v144
v_mfma_f32_32x32x16_bf16 a[16:31], a[172:175], v[136:139], a[16:31]
ds_read_b64_tr_b16 a[168:169], v16 offset:15456
ds_read_b64_tr_b16 a[170:171], v16 offset:16736
v_fma_f32 v23, v23, v21, v22
v_fma_f32 v24, v24, v21, v22
v_cvt_pk_bf16_f32 v144, v23, v24
v_lshlrev_b32 v23, 16, v145
v_mfma_f32_32x32x16_bf16 a[32:47], a[176:179], v[136:139], a[32:47]
ds_read_b64_tr_b16 a[172:173], v16 offset:15488
ds_read_b64_tr_b16 a[174:175], v16 offset:16768
s_waitcnt lgkmcnt(6)
v_and_b32 v24, s61, v145
v_fma_f32 v23, v23, v21, v22
v_fma_f32 v24, v24, v21, v22
v_cvt_pk_bf16_f32 v145, v23, v24
v_mfma_f32_32x32x16_bf16 a[48:63], a[180:183], v[136:139], a[48:63]
s_waitcnt vmcnt(8)
s_barrier
v_add_u32 v16, 0x5000, v16
ds_read_b64_tr_b16 a[176:177], v16 offset:0
ds_read_b64_tr_b16 a[178:179], v16 offset:1280
ds_read_b64_tr_b16 a[212:213], v47 offset:672
v_lshlrev_b32 v23, 16, v146
v_and_b32 v24, s61, v146
v_fma_f32 v23, v23, v21, v22
v_fma_f32 v24, v24, v21, v22
v_mfma_f32_32x32x16_bf16 a[64:79], a[184:187], v[136:139], a[64:79]
ds_read_b64_tr_b16 a[180:181], v16 offset:32
ds_read_b64_tr_b16 a[182:183], v16 offset:1312
buffer_load_dwordx4 v8, s[28:31], s56 offen offset:3072 lds
v_cvt_pk_bf16_f32 v146, v23, v24
v_lshlrev_b32 v23, 16, v147
v_and_b32 v24, s61, v147
v_fma_f32 v23, v23, v21, v22
v_mfma_f32_32x32x16_bf16 a[0:15], a[188:191], v[140:143], a[0:15]
ds_read_b64_tr_b16 a[184:185], v16 offset:64
ds_read_b64_tr_b16 a[186:187], v16 offset:1344
v_fma_f32 v24, v24, v21, v22
v_cvt_pk_bf16_f32 v147, v23, v24
v_lshlrev_b32 v25, 16, v148
v_and_b32 v26, s61, v148
v_mfma_f32_32x32x16_bf16 a[16:31], a[160:163], v[140:143], a[16:31]
ds_read_b64_tr_b16 a[188:189], v16 offset:96
ds_read_b64_tr_b16 a[190:191], v16 offset:1376
s_waitcnt lgkmcnt(7)
v_fma_f32 v25, v25, v21, v22
v_fma_f32 v26, v26, v21, v22
v_cvt_pk_bf16_f32 v148, v25, v26
v_lshlrev_b32 v25, 16, v149
v_mfma_f32_32x32x16_bf16 a[32:47], a[164:167], v[140:143], a[32:47]
ds_read_b64_tr_b16 a[160:161], v16 offset:128
ds_read_b64_tr_b16 a[162:163], v16 offset:1408
v_and_b32 v26, s61, v149
v_fma_f32 v25, v25, v21, v22
v_fma_f32 v26, v26, v21, v22
v_cvt_pk_bf16_f32 v149, v25, v26
v_mfma_f32_32x32x16_bf16 a[48:63], a[168:171], v[140:143], a[48:63]
s_add_u32 m0, s96, 0x1000
ds_read_b64_tr_b16 a[164:165], v16 offset:5120
ds_read_b64_tr_b16 a[166:167], v16 offset:6400
buffer_load_dwordx4 v9, s[28:31], s56 offen offset:0 lds
s_add_u32 s56, s56, 0x3c000
s_cmp_eq_u32 s56, 0x258000
s_cselect_b32 s56, 0, s56
ds_read_b64_tr_b16 a[214:215], v48 offset:792
v_lshlrev_b32 v25, 16, v150
v_and_b32 v26, s61, v150
v_fma_f32 v25, v25, v21, v22
v_fma_f32 v26, v26, v21, v22
v_mfma_f32_32x32x16_bf16 a[64:79], a[172:175], v[140:143], a[64:79]
ds_read_b64_tr_b16 a[168:169], v16 offset:5152
ds_read_b64_tr_b16 a[170:171], v16 offset:6432
v_cvt_pk_bf16_f32 v150, v25, v26
v_lshlrev_b32 v25, 16, v151
v_and_b32 v26, s61, v151
v_fma_f32 v25, v25, v21, v22
v_mfma_f32_32x32x16_bf16 a[0:15], a[176:179], v[144:147], a[0:15]
ds_read_b64_tr_b16 a[172:173], v16 offset:5184
ds_read_b64_tr_b16 a[174:175], v16 offset:6464
s_waitcnt lgkmcnt(7)
v_fma_f32 v26, v26, v21, v22
v_cvt_pk_bf16_f32 v151, v25, v26
v_lshlrev_b32 v23, 16, v152
v_and_b32 v24, s61, v152
v_mfma_f32_32x32x16_bf16 a[16:31], a[180:183], v[144:147], a[16:31]
ds_read_b64_tr_b16 a[176:177], v16 offset:5216
ds_read_b64_tr_b16 a[178:179], v16 offset:6496
v_fma_f32 v23, v23, v21, v22
v_fma_f32 v24, v24, v21, v22
v_cvt_pk_bf16_f32 v152, v23, v24
v_lshlrev_b32 v23, 16, v153
v_mfma_f32_32x32x16_bf16 a[32:47], a[184:187], v[144:147], a[32:47]
s_add_u32 m0, s96, 0x5000
ds_read_b64_tr_b16 a[180:181], v16 offset:5248
ds_read_b64_tr_b16 a[182:183], v16 offset:6528
buffer_load_dwordx4 v5, s[28:31], s56 offen offset:0 lds
v_and_b32 v24, s61, v153
v_fma_f32 v23, v23, v21, v22
v_fma_f32 v24, v24, v21, v22
v_cvt_pk_bf16_f32 v153, v23, v24
v_mfma_f32_32x32x16_bf16 a[48:63], a[188:191], v[144:147], a[48:63]
ds_read_b64_tr_b16 a[184:185], v16 offset:10240
ds_read_b64_tr_b16 a[186:187], v16 offset:11520
ds_read_b64_tr_b16 a[216:217], v48 offset:952
v_lshlrev_b32 v23, 16, v154
v_and_b32 v24, s61, v154
v_fma_f32 v23, v23, v21, v22
v_fma_f32 v24, v24, v21, v22
v_mfma_f32_32x32x16_bf16 a[64:79], a[160:163], v[144:147], a[64:79]
ds_read_b64_tr_b16 a[188:189], v16 offset:10272
ds_read_b64_tr_b16 a[190:191], v16 offset:11552
s_waitcnt lgkmcnt(7)
v_cvt_pk_bf16_f32 v154, v23, v24
v_lshlrev_b32 v23, 16, v155
v_and_b32 v24, s61, v155
v_fma_f32 v23, v23, v21, v22
v_mfma_f32_32x32x16_bf16 a[0:15], a[164:167], v[148:151], a[0:15]
ds_read_b64_tr_b16 a[160:161], v16 offset:10304
ds_read_b64_tr_b16 a[162:163], v16 offset:11584
v_fma_f32 v24, v24, v21, v22
v_cvt_pk_bf16_f32 v155, v23, v24
v_lshlrev_b32 v25, 16, v156
v_and_b32 v26, s61, v156
v_mfma_f32_32x32x16_bf16 a[16:31], a[168:171], v[148:151], a[16:31]
ds_read_b64_tr_b16 a[164:165], v16 offset:10336
ds_read_b64_tr_b16 a[166:167], v16 offset:11616
buffer_load_dwordx4 v6, s[28:31], s56 offen offset:1024 lds
v_fma_f32 v25, v25, v21, v22
v_fma_f32 v26, v26, v21, v22
v_cvt_pk_bf16_f32 v156, v25, v26
v_lshlrev_b32 v25, 16, v157
v_mfma_f32_32x32x16_bf16 a[32:47], a[172:175], v[148:151], a[32:47]
ds_read_b64_tr_b16 a[168:169], v16 offset:10368
ds_read_b64_tr_b16 a[170:171], v16 offset:11648
v_and_b32 v26, s61, v157
v_fma_f32 v25, v25, v21, v22
v_fma_f32 v26, v26, v21, v22
v_cvt_pk_bf16_f32 v157, v25, v26
v_mfma_f32_32x32x16_bf16 a[48:63], a[176:179], v[148:151], a[48:63]
ds_read_b64_tr_b16 a[172:173], v16 offset:15360
ds_read_b64_tr_b16 a[174:175], v16 offset:16640
s_waitcnt lgkmcnt(6)
ds_read_b64_tr_b16 a[218:219], v48 offset:1112
v_lshlrev_b32 v25, 16, v158
v_and_b32 v26, s61, v158
v_fma_f32 v25, v25, v21, v22
v_fma_f32 v26, v26, v21, v22
v_mfma_f32_32x32x16_bf16 a[64:79], a[180:183], v[148:151], a[64:79]
ds_read_b64_tr_b16 a[176:177], v16 offset:15392
ds_read_b64_tr_b16 a[178:179], v16 offset:16672
v_cvt_pk_bf16_f32 v158, v25, v26
v_lshlrev_b32 v25, 16, v159
v_and_b32 v26, s61, v159
v_fma_f32 v25, v25, v21, v22
v_mfma_f32_32x32x16_bf16 a[0:15], a[184:187], v[152:155], a[0:15]
ds_read_b64_tr_b16 a[180:181], v16 offset:15424
ds_read_b64_tr_b16 a[182:183], v16 offset:16704
buffer_load_dwordx4 v7, s[28:31], s56 offen offset:2048 lds
v_fma_f32 v26, v26, v21, v22
v_cvt_pk_bf16_f32 v159, v25, v26
v_lshlrev_b32 v23, 16, v160
v_and_b32 v24, s61, v160
v_mfma_f32_32x32x16_bf16 a[16:31], a[188:191], v[152:155], a[16:31]
ds_read_b64_tr_b16 a[184:185], v16 offset:15456
ds_read_b64_tr_b16 a[186:187], v16 offset:16736
v_fma_f32 v23, v23, v21, v22
v_fma_f32 v24, v24, v21, v22
v_cvt_pk_bf16_f32 v160, v23, v24
v_lshlrev_b32 v23, 16, v161
v_mfma_f32_32x32x16_bf16 a[32:47], a[160:163], v[152:155], a[32:47]
ds_read_b64_tr_b16 a[188:189], v16 offset:15488
ds_read_b64_tr_b16 a[190:191], v16 offset:16768
s_waitcnt lgkmcnt(6)
v_and_b32 v24, s61, v161
v_fma_f32 v23, v23, v21, v22
v_fma_f32 v24, v24, v21, v22
v_cvt_pk_bf16_f32 v161, v23, v24
v_mfma_f32_32x32x16_bf16 a[48:63], a[164:167], v[152:155], a[48:63]
s_waitcnt vmcnt(8)
s_barrier
v_add_u32 v16, 0x5000, v16
ds_read_b64_tr_b16 a[160:161], v16 offset:0
ds_read_b64_tr_b16 a[162:163], v16 offset:1280
ds_read_b64_tr_b16 a[220:221], v48 offset:1272
v_lshlrev_b32 v23, 16, v162
v_and_b32 v24, s61, v162
v_fma_f32 v23, v23, v21, v22
v_fma_f32 v24, v24, v21, v22
v_mfma_f32_32x32x16_bf16 a[64:79], a[168:171], v[152:155], a[64:79]
ds_read_b64_tr_b16 a[164:165], v16 offset:32
ds_read_b64_tr_b16 a[166:167], v16 offset:1312
buffer_load_dwordx4 v8, s[28:31], s56 offen offset:3072 lds
v_cvt_pk_bf16_f32 v162, v23, v24
v_lshlrev_b32 v23, 16, v163
v_and_b32 v24, s61, v163
v_fma_f32 v23, v23, v21, v22
v_mfma_f32_32x32x16_bf16 a[0:15], a[172:175], v[156:159], a[0:15]
ds_read_b64_tr_b16 a[168:169], v16 offset:64
ds_read_b64_tr_b16 a[170:171], v16 offset:1344
v_fma_f32 v24, v24, v21, v22
v_cvt_pk_bf16_f32 v163, v23, v24
v_lshlrev_b32 v25, 16, v164
v_and_b32 v26, s61, v164
v_mfma_f32_32x32x16_bf16 a[16:31], a[176:179], v[156:159], a[16:31]
ds_read_b64_tr_b16 a[172:173], v16 offset:96
ds_read_b64_tr_b16 a[174:175], v16 offset:1376
s_waitcnt lgkmcnt(7)
v_fma_f32 v25, v25, v21, v22
v_fma_f32 v26, v26, v21, v22
v_cvt_pk_bf16_f32 v164, v25, v26
v_lshlrev_b32 v25, 16, v165
v_mfma_f32_32x32x16_bf16 a[32:47], a[180:183], v[156:159], a[32:47]
ds_read_b64_tr_b16 a[176:177], v16 offset:128
ds_read_b64_tr_b16 a[178:179], v16 offset:1408
v_and_b32 v26, s61, v165
v_fma_f32 v25, v25, v21, v22
v_fma_f32 v26, v26, v21, v22
v_cvt_pk_bf16_f32 v165, v25, v26
v_mfma_f32_32x32x16_bf16 a[48:63], a[184:187], v[156:159], a[48:63]
s_add_u32 m0, s96, 0x6000
ds_read_b64_tr_b16 a[180:181], v16 offset:5120
ds_read_b64_tr_b16 a[182:183], v16 offset:6400
buffer_load_dwordx4 v9, s[28:31], s56 offen offset:0 lds
s_add_u32 s56, s56, 0x3c000
s_cmp_eq_u32 s56, 0x258000
s_cselect_b32 s56, 0, s56
ds_read_b64_tr_b16 a[222:223], v48 offset:1432
v_lshlrev_b32 v25, 16, v166
v_and_b32 v26, s61, v166
v_fma_f32 v25, v25, v21, v22
v_fma_f32 v26, v26, v21, v22
v_mfma_f32_32x32x16_bf16 a[64:79], a[188:191], v[156:159], a[64:79]
ds_read_b64_tr_b16 a[184:185], v16 offset:5152
ds_read_b64_tr_b16 a[186:187], v16 offset:6432
v_cvt_pk_bf16_f32 v166, v25, v26
v_lshlrev_b32 v25, 16, v167
v_and_b32 v26, s61, v167
v_fma_f32 v25, v25, v21, v22
v_mfma_f32_32x32x16_bf16 a[0:15], a[160:163], v[160:163], a[0:15]
ds_read_b64_tr_b16 a[188:189], v16 offset:5184
ds_read_b64_tr_b16 a[190:191], v16 offset:6464
s_waitcnt lgkmcnt(7)
v_fma_f32 v26, v26, v21, v22
v_cvt_pk_bf16_f32 v167, v25, v26
v_lshlrev_b32 v23, 16, v168
v_and_b32 v24, s61, v168
v_mfma_f32_32x32x16_bf16 a[16:31], a[164:167], v[160:163], a[16:31]
ds_read_b64_tr_b16 a[160:161], v16 offset:5216
ds_read_b64_tr_b16 a[162:163], v16 offset:6496
v_fma_f32 v23, v23, v21, v22
v_fma_f32 v24, v24, v21, v22
v_cvt_pk_bf16_f32 v168, v23, v24
v_lshlrev_b32 v23, 16, v169
v_mfma_f32_32x32x16_bf16 a[32:47], a[168:171], v[160:163], a[32:47]
s_add_u32 m0, s96, 0xa000
ds_read_b64_tr_b16 a[164:165], v16 offset:5248
ds_read_b64_tr_b16 a[166:167], v16 offset:6528
buffer_load_dwordx4 v5, s[28:31], s56 offen offset:0 lds
v_and_b32 v24, s61, v169
v_fma_f32 v23, v23, v21, v22
v_fma_f32 v24, v24, v21, v22
v_cvt_pk_bf16_f32 v169, v23, v24
v_mfma_f32_32x32x16_bf16 a[48:63], a[172:175], v[160:163], a[48:63]
ds_read_b64_tr_b16 a[168:169], v16 offset:10240
ds_read_b64_tr_b16 a[170:171], v16 offset:11520
ds_read_b64_tr_b16 a[224:225], v50
v_lshlrev_b32 v23, 16, v170
v_and_b32 v24, s61, v170
v_fma_f32 v23, v23, v21, v22
v_fma_f32 v24, v24, v21, v22
v_mfma_f32_32x32x16_bf16 a[64:79], a[176:179], v[160:163], a[64:79]
ds_read_b64_tr_b16 a[172:173], v16 offset:10272
ds_read_b64_tr_b16 a[174:175], v16 offset:11552
s_waitcnt lgkmcnt(7)
v_cvt_pk_bf16_f32 v170, v23, v24
v_lshlrev_b32 v23, 16, v171
v_and_b32 v24, s61, v171
v_fma_f32 v23, v23, v21, v22
v_mfma_f32_32x32x16_bf16 a[0:15], a[180:183], v[164:167], a[0:15]
ds_read_b64_tr_b16 a[176:177], v16 offset:10304
ds_read_b64_tr_b16 a[178:179], v16 offset:11584
v_fma_f32 v24, v24, v21, v22
v_cvt_pk_bf16_f32 v171, v23, v24
v_lshlrev_b32 v25, 16, v172
v_and_b32 v26, s61, v172
v_mfma_f32_32x32x16_bf16 a[16:31], a[184:187], v[164:167], a[16:31]
ds_read_b64_tr_b16 a[180:181], v16 offset:10336
ds_read_b64_tr_b16 a[182:183], v16 offset:11616
buffer_load_dwordx4 v6, s[28:31], s56 offen offset:1024 lds
v_fma_f32 v25, v25, v21, v22
v_fma_f32 v26, v26, v21, v22
v_cvt_pk_bf16_f32 v172, v25, v26
v_lshlrev_b32 v25, 16, v173
v_mfma_f32_32x32x16_bf16 a[32:47], a[188:191], v[164:167], a[32:47]
ds_read_b64_tr_b16 a[184:185], v16 offset:10368
ds_read_b64_tr_b16 a[186:187], v16 offset:11648
v_and_b32 v26, s61, v173
v_fma_f32 v25, v25, v21, v22
v_fma_f32 v26, v26, v21, v22
v_cvt_pk_bf16_f32 v173, v25, v26
v_mfma_f32_32x32x16_bf16 a[48:63], a[160:163], v[164:167], a[48:63]
ds_read_b64_tr_b16 a[188:189], v16 offset:15360
ds_read_b64_tr_b16 a[190:191], v16 offset:16640
s_waitcnt lgkmcnt(6)
ds_read_b64_tr_b16 a[226:227], v49 offset:824
v_lshlrev_b32 v25, 16, v174
v_and_b32 v26, s61, v174
v_fma_f32 v25, v25, v21, v22
v_fma_f32 v26, v26, v21, v22
v_mfma_f32_32x32x16_bf16 a[64:79], a[164:167], v[164:167], a[64:79]
ds_read_b64_tr_b16 a[160:161], v16 offset:15392
ds_read_b64_tr_b16 a[162:163], v16 offset:16672
v_cvt_pk_bf16_f32 v174, v25, v26
v_lshlrev_b32 v25, 16, v175
v_and_b32 v26, s61, v175
v_fma_f32 v25, v25, v21, v22
v_mfma_f32_32x32x16_bf16 a[0:15], a[168:171], v[168:171], a[0:15]
ds_read_b64_tr_b16 a[164:165], v16 offset:15424
ds_read_b64_tr_b16 a[166:167], v16 offset:16704
buffer_load_dwordx4 v7, s[28:31], s56 offen offset:2048 lds
v_fma_f32 v26, v26, v21, v22
v_cvt_pk_bf16_f32 v175, v25, v26
v_lshlrev_b32 v23, 16, v176
v_and_b32 v24, s61, v176
v_mfma_f32_32x32x16_bf16 a[16:31], a[172:175], v[168:171], a[16:31]
ds_read_b64_tr_b16 a[168:169], v16 offset:15456
ds_read_b64_tr_b16 a[170:171], v16 offset:16736
v_fma_f32 v23, v23, v21, v22
v_fma_f32 v24, v24, v21, v22
v_cvt_pk_bf16_f32 v176, v23, v24
v_lshlrev_b32 v23, 16, v177
v_mfma_f32_32x32x16_bf16 a[32:47], a[176:179], v[168:171], a[32:47]
ds_read_b64_tr_b16 a[172:173], v16 offset:15488
ds_read_b64_tr_b16 a[174:175], v16 offset:16768
s_waitcnt lgkmcnt(6)
v_and_b32 v24, s61, v177
v_fma_f32 v23, v23, v21, v22
v_fma_f32 v24, v24, v21, v22
v_cvt_pk_bf16_f32 v177, v23, v24
v_mfma_f32_32x32x16_bf16 a[48:63], a[180:183], v[168:171], a[48:63]
s_waitcnt vmcnt(8)
s_barrier
v_add_u32 v16, 0xfffec000, v16
ds_read_b64_tr_b16 a[176:177], v16 offset:0
ds_read_b64_tr_b16 a[178:179], v16 offset:1280
ds_read_b64_tr_b16 a[228:229], v49 offset:984
v_lshlrev_b32 v23, 16, v178
v_and_b32 v24, s61, v178
v_fma_f32 v23, v23, v21, v22
v_fma_f32 v24, v24, v21, v22
v_mfma_f32_32x32x16_bf16 a[64:79], a[184:187], v[168:171], a[64:79]
ds_read_b64_tr_b16 a[180:181], v16 offset:32
ds_read_b64_tr_b16 a[182:183], v16 offset:1312
buffer_load_dwordx4 v8, s[28:31], s56 offen offset:3072 lds
v_cvt_pk_bf16_f32 v178, v23, v24
v_lshlrev_b32 v23, 16, v179
v_and_b32 v24, s61, v179
v_fma_f32 v23, v23, v21, v22
v_mfma_f32_32x32x16_bf16 a[0:15], a[188:191], v[172:175], a[0:15]
ds_read_b64_tr_b16 a[184:185], v16 offset:64
ds_read_b64_tr_b16 a[186:187], v16 offset:1344
v_fma_f32 v24, v24, v21, v22
v_cvt_pk_bf16_f32 v179, v23, v24
v_lshlrev_b32 v25, 16, v180
v_and_b32 v26, s61, v180
v_mfma_f32_32x32x16_bf16 a[16:31], a[160:163], v[172:175], a[16:31]
ds_read_b64_tr_b16 a[188:189], v16 offset:96
ds_read_b64_tr_b16 a[190:191], v16 offset:1376
s_waitcnt lgkmcnt(7)
v_fma_f32 v25, v25, v21, v22
v_fma_f32 v26, v26, v21, v22
v_cvt_pk_bf16_f32 v180, v25, v26
v_lshlrev_b32 v25, 16, v181
v_mfma_f32_32x32x16_bf16 a[32:47], a[164:167], v[172:175], a[32:47]
ds_read_b64_tr_b16 a[160:161], v16 offset:128
ds_read_b64_tr_b16 a[162:163], v16 offset:1408
v_and_b32 v26, s61, v181
v_fma_f32 v25, v25, v21, v22
v_fma_f32 v26, v26, v21, v22
v_cvt_pk_bf16_f32 v181, v25, v26
v_mfma_f32_32x32x16_bf16 a[48:63], a[168:171], v[172:175], a[48:63]
s_add_u32 m0, s96, 0xb000
ds_read_b64_tr_b16 a[164:165], v16 offset:5120
ds_read_b64_tr_b16 a[166:167], v16 offset:6400
buffer_load_dwordx4 v9, s[28:31], s56 offen offset:0 lds
s_add_u32 s56, s56, 0x3c000
s_cmp_eq_u32 s56, 0x258000
s_cselect_b32 s56, 0, s56
ds_read_b64_tr_b16 a[230:231], v49 offset:1144
v_lshlrev_b32 v25, 16, v182
v_and_b32 v26, s61, v182
v_fma_f32 v25, v25, v21, v22
v_fma_f32 v26, v26, v21, v22
v_mfma_f32_32x32x16_bf16 a[64:79], a[172:175], v[172:175], a[64:79]
ds_read_b64_tr_b16 a[168:169], v16 offset:5152
ds_read_b64_tr_b16 a[170:171], v16 offset:6432
v_cvt_pk_bf16_f32 v182, v25, v26
v_lshlrev_b32 v25, 16, v183
v_and_b32 v26, s61, v183
v_fma_f32 v25, v25, v21, v22
v_mfma_f32_32x32x16_bf16 a[0:15], a[176:179], v[176:179], a[0:15]
ds_read_b64_tr_b16 a[172:173], v16 offset:5184
ds_read_b64_tr_b16 a[174:175], v16 offset:6464
s_waitcnt lgkmcnt(7)
v_fma_f32 v26, v26, v21, v22
v_cvt_pk_bf16_f32 v183, v25, v26
v_lshlrev_b32 v23, 16, v184
v_and_b32 v24, s61, v184
v_mfma_f32_32x32x16_bf16 a[16:31], a[180:183], v[176:179], a[16:31]
ds_read_b64_tr_b16 a[176:177], v16 offset:5216
ds_read_b64_tr_b16 a[178:179], v16 offset:6496
v_fma_f32 v23, v23, v21, v22
v_fma_f32 v24, v24, v21, v22
v_cvt_pk_bf16_f32 v184, v23, v24
v_lshlrev_b32 v23, 16, v185
v_mfma_f32_32x32x16_bf16 a[32:47], a[184:187], v[176:179], a[32:47]
s_add_u32 m0, s96, 0xf000
ds_read_b64_tr_b16 a[180:181], v16 offset:5248
ds_read_b64_tr_b16 a[182:183], v16 offset:6528
buffer_load_dwordx4 v5, s[28:31], s56 offen offset:0 lds
v_and_b32 v24, s61, v185
v_fma_f32 v23, v23, v21, v22
v_fma_f32 v24, v24, v21, v22
v_cvt_pk_bf16_f32 v185, v23, v24
v_mfma_f32_32x32x16_bf16 a[48:63], a[188:191], v[176:179], a[48:63]
ds_read_b64_tr_b16 a[184:185], v16 offset:10240
ds_read_b64_tr_b16 a[186:187], v16 offset:11520
ds_read_b64_tr_b16 a[232:233], v49 offset:1304
v_lshlrev_b32 v23, 16, v186
v_and_b32 v24, s61, v186
v_fma_f32 v23, v23, v21, v22
v_fma_f32 v24, v24, v21, v22
v_mfma_f32_32x32x16_bf16 a[64:79], a[160:163], v[176:179], a[64:79]
ds_read_b64_tr_b16 a[188:189], v16 offset:10272
ds_read_b64_tr_b16 a[190:191], v16 offset:11552
s_waitcnt lgkmcnt(7)
v_cvt_pk_bf16_f32 v186, v23, v24
v_lshlrev_b32 v23, 16, v187
v_and_b32 v24, s61, v187
v_fma_f32 v23, v23, v21, v22
v_mfma_f32_32x32x16_bf16 a[0:15], a[164:167], v[180:183], a[0:15]
ds_read_b64_tr_b16 a[160:161], v16 offset:10304
ds_read_b64_tr_b16 a[162:163], v16 offset:11584
v_fma_f32 v24, v24, v21, v22
v_cvt_pk_bf16_f32 v187, v23, v24
v_lshlrev_b32 v25, 16, v188
v_and_b32 v26, s61, v188
v_mfma_f32_32x32x16_bf16 a[16:31], a[168:171], v[180:183], a[16:31]
ds_read_b64_tr_b16 a[164:165], v16 offset:10336
ds_read_b64_tr_b16 a[166:167], v16 offset:11616
buffer_load_dwordx4 v6, s[28:31], s56 offen offset:1024 lds
v_fma_f32 v25, v25, v21, v22
v_fma_f32 v26, v26, v21, v22
v_cvt_pk_bf16_f32 v188, v25, v26
v_lshlrev_b32 v25, 16, v189
v_mfma_f32_32x32x16_bf16 a[32:47], a[172:175], v[180:183], a[32:47]
ds_read_b64_tr_b16 a[168:169], v16 offset:10368
ds_read_b64_tr_b16 a[170:171], v16 offset:11648
v_and_b32 v26, s61, v189
v_fma_f32 v25, v25, v21, v22
v_fma_f32 v26, v26, v21, v22
v_cvt_pk_bf16_f32 v189, v25, v26
v_mfma_f32_32x32x16_bf16 a[48:63], a[176:179], v[180:183], a[48:63]
ds_read_b64_tr_b16 a[172:173], v16 offset:15360
ds_read_b64_tr_b16 a[174:175], v16 offset:16640
s_waitcnt lgkmcnt(6)
ds_read_b64_tr_b16 a[234:235], v49 offset:1464
v_lshlrev_b32 v25, 16, v190
v_and_b32 v26, s61, v190
v_fma_f32 v25, v25, v21, v22
v_fma_f32 v26, v26, v21, v22
v_mfma_f32_32x32x16_bf16 a[64:79], a[180:183], v[180:183], a[64:79]
ds_read_b64_tr_b16 a[176:177], v16 offset:15392
ds_read_b64_tr_b16 a[178:179], v16 offset:16672
v_cvt_pk_bf16_f32 v190, v25, v26
v_lshlrev_b32 v25, 16, v191
v_and_b32 v26, s61, v191
v_fma_f32 v25, v25, v21, v22
v_mfma_f32_32x32x16_bf16 a[0:15], a[184:187], v[184:187], a[0:15]
ds_read_b64_tr_b16 a[180:181], v16 offset:15424
ds_read_b64_tr_b16 a[182:183], v16 offset:16704
buffer_load_dwordx4 v7, s[28:31], s56 offen offset:2048 lds
v_fma_f32 v26, v26, v21, v22
v_cvt_pk_bf16_f32 v191, v25, v26
v_lshlrev_b32 v23, 16, v192
v_and_b32 v24, s61, v192
v_mfma_f32_32x32x16_bf16 a[16:31], a[188:191], v[184:187], a[16:31]
ds_read_b64_tr_b16 a[184:185], v16 offset:15456
ds_read_b64_tr_b16 a[186:187], v16 offset:16736
v_fma_f32 v23, v23, v21, v22
v_fma_f32 v24, v24, v21, v22
v_cvt_pk_bf16_f32 v192, v23, v24
v_lshlrev_b32 v23, 16, v193
v_mfma_f32_32x32x16_bf16 a[32:47], a[160:163], v[184:187], a[32:47]
ds_read_b64_tr_b16 a[188:189], v16 offset:15488
ds_read_b64_tr_b16 a[190:191], v16 offset:16768
s_waitcnt lgkmcnt(6)
v_and_b32 v24, s61, v193
v_fma_f32 v23, v23, v21, v22
v_fma_f32 v24, v24, v21, v22
v_cvt_pk_bf16_f32 v193, v23, v24
v_mfma_f32_32x32x16_bf16 a[48:63], a[164:167], v[184:187], a[48:63]
s_waitcnt vmcnt(8)
s_barrier
v_add_u32 v16, 0x5000, v16
ds_read_b64_tr_b16 a[160:161], v16 offset:0
ds_read_b64_tr_b16 a[162:163], v16 offset:1280
v_lshlrev_b32 v23, 16, v194
v_and_b32 v24, s61, v194
v_fma_f32 v23, v23, v21, v22
v_fma_f32 v24, v24, v21, v22
v_mfma_f32_32x32x16_bf16 a[64:79], a[168:171], v[184:187], a[64:79]
ds_read_b64_tr_b16 a[164:165], v16 offset:32
ds_read_b64_tr_b16 a[166:167], v16 offset:1312
buffer_load_dwordx4 v8, s[28:31], s56 offen offset:3072 lds
v_cvt_pk_bf16_f32 v194, v23, v24
v_lshlrev_b32 v23, 16, v195
v_and_b32 v24, s61, v195
v_fma_f32 v23, v23, v21, v22
v_mfma_f32_32x32x16_bf16 a[0:15], a[172:175], v[188:191], a[0:15]
ds_read_b64_tr_b16 a[168:169], v16 offset:64
ds_read_b64_tr_b16 a[170:171], v16 offset:1344
v_fma_f32 v24, v24, v21, v22
v_cvt_pk_bf16_f32 v195, v23, v24
v_lshlrev_b32 v25, 16, v196
v_and_b32 v26, s61, v196
v_mfma_f32_32x32x16_bf16 a[16:31], a[176:179], v[188:191], a[16:31]
ds_read_b64_tr_b16 a[172:173], v16 offset:96
ds_read_b64_tr_b16 a[174:175], v16 offset:1376
s_waitcnt lgkmcnt(6)
v_fma_f32 v25, v25, v21, v22
v_fma_f32 v26, v26, v21, v22
v_cvt_pk_bf16_f32 v196, v25, v26
v_lshlrev_b32 v25, 16, v197
v_mfma_f32_32x32x16_bf16 a[32:47], a[180:183], v[188:191], a[32:47]
ds_read_b64_tr_b16 a[176:177], v16 offset:128
ds_read_b64_tr_b16 a[178:179], v16 offset:1408
v_and_b32 v26, s61, v197
v_fma_f32 v25, v25, v21, v22
v_fma_f32 v26, v26, v21, v22
v_cvt_pk_bf16_f32 v197, v25, v26
v_mfma_f32_32x32x16_bf16 a[48:63], a[184:187], v[188:191], a[48:63]
s_add_u32 m0, s96, 0x10000
ds_read_b64_tr_b16 a[180:181], v16 offset:5120
ds_read_b64_tr_b16 a[182:183], v16 offset:6400
buffer_load_dwordx4 v9, s[28:31], s56 offen offset:0 lds
s_add_u32 s56, s56, 0x3c000
s_cmp_eq_u32 s56, 0x258000
s_cselect_b32 s56, 0, s56
v_lshlrev_b32 v25, 16, v198
v_and_b32 v26, s61, v198
v_fma_f32 v25, v25, v21, v22
v_fma_f32 v26, v26, v21, v22
v_mfma_f32_32x32x16_bf16 a[64:79], a[188:191], v[188:191], a[64:79]
ds_read_b64_tr_b16 a[184:185], v16 offset:5152
ds_read_b64_tr_b16 a[186:187], v16 offset:6432
v_cvt_pk_bf16_f32 v198, v25, v26
v_lshlrev_b32 v25, 16, v199
v_and_b32 v26, s61, v199
v_fma_f32 v25, v25, v21, v22
v_mfma_f32_32x32x16_bf16 a[0:15], a[160:163], v[192:195], a[0:15]
ds_read_b64_tr_b16 a[188:189], v16 offset:5184
ds_read_b64_tr_b16 a[190:191], v16 offset:6464
s_waitcnt lgkmcnt(6)
v_fma_f32 v26, v26, v21, v22
v_cvt_pk_bf16_f32 v199, v25, v26
v_lshlrev_b32 v23, 16, v200
v_and_b32 v24, s61, v200
v_mfma_f32_32x32x16_bf16 a[16:31], a[164:167], v[192:195], a[16:31]
ds_read_b64_tr_b16 a[160:161], v16 offset:5216
ds_read_b64_tr_b16 a[162:163], v16 offset:6496
v_fma_f32 v23, v23, v21, v22
v_fma_f32 v24, v24, v21, v22
v_cvt_pk_bf16_f32 v200, v23, v24
v_lshlrev_b32 v23, 16, v201
v_mfma_f32_32x32x16_bf16 a[32:47], a[168:171], v[192:195], a[32:47]
s_add_u32 m0, s96, 0x14000
ds_read_b64_tr_b16 a[164:165], v16 offset:5248
ds_read_b64_tr_b16 a[166:167], v16 offset:6528
buffer_load_dwordx4 v5, s[28:31], s56 offen offset:0 lds
v_and_b32 v24, s61, v201
v_fma_f32 v23, v23, v21, v22
v_fma_f32 v24, v24, v21, v22
v_cvt_pk_bf16_f32 v201, v23, v24
v_mfma_f32_32x32x16_bf16 a[48:63], a[172:175], v[192:195], a[48:63]
ds_read_b64_tr_b16 a[168:169], v16 offset:10240
ds_read_b64_tr_b16 a[170:171], v16 offset:11520
v_lshlrev_b32 v23, 16, v202
v_and_b32 v24, s61, v202
v_fma_f32 v23, v23, v21, v22
v_fma_f32 v24, v24, v21, v22
v_mfma_f32_32x32x16_bf16 a[64:79], a[176:179], v[192:195], a[64:79]
ds_read_b64_tr_b16 a[172:173], v16 offset:10272
ds_read_b64_tr_b16 a[174:175], v16 offset:11552
s_waitcnt lgkmcnt(6)
v_cvt_pk_bf16_f32 v202, v23, v24
v_lshlrev_b32 v23, 16, v203
v_and_b32 v24, s61, v203
v_fma_f32 v23, v23, v21, v22
v_mfma_f32_32x32x16_bf16 a[0:15], a[180:183], v[196:199], a[0:15]
ds_read_b64_tr_b16 a[176:177], v16 offset:10304
ds_read_b64_tr_b16 a[178:179], v16 offset:11584
v_fma_f32 v24, v24, v21, v22
v_cvt_pk_bf16_f32 v203, v23, v24
v_lshlrev_b32 v25, 16, v204
v_and_b32 v26, s61, v204
v_mfma_f32_32x32x16_bf16 a[16:31], a[184:187], v[196:199], a[16:31]
ds_read_b64_tr_b16 a[180:181], v16 offset:10336
ds_read_b64_tr_b16 a[182:183], v16 offset:11616
buffer_load_dwordx4 v6, s[28:31], s56 offen offset:1024 lds
v_fma_f32 v25, v25, v21, v22
v_fma_f32 v26, v26, v21, v22
v_cvt_pk_bf16_f32 v204, v25, v26
v_lshlrev_b32 v25, 16, v205
v_mfma_f32_32x32x16_bf16 a[32:47], a[188:191], v[196:199], a[32:47]
ds_read_b64_tr_b16 a[184:185], v16 offset:10368
ds_read_b64_tr_b16 a[186:187], v16 offset:11648
v_and_b32 v26, s61, v205
v_fma_f32 v25, v25, v21, v22
v_fma_f32 v26, v26, v21, v22
v_cvt_pk_bf16_f32 v205, v25, v26
v_mfma_f32_32x32x16_bf16 a[48:63], a[160:163], v[196:199], a[48:63]
ds_read_b64_tr_b16 a[188:189], v16 offset:15360
ds_read_b64_tr_b16 a[190:191], v16 offset:16640
s_waitcnt lgkmcnt(6)
v_lshlrev_b32 v25, 16, v206
v_and_b32 v26, s61, v206
v_fma_f32 v25, v25, v21, v22
v_fma_f32 v26, v26, v21, v22
v_mfma_f32_32x32x16_bf16 a[64:79], a[164:167], v[196:199], a[64:79]
ds_read_b64_tr_b16 a[160:161], v16 offset:15392
ds_read_b64_tr_b16 a[162:163], v16 offset:16672
v_cvt_pk_bf16_f32 v206, v25, v26
v_lshlrev_b32 v25, 16, v207
v_and_b32 v26, s61, v207
v_fma_f32 v25, v25, v21, v22
v_mfma_f32_32x32x16_bf16 a[0:15], a[168:171], v[200:203], a[0:15]
ds_read_b64_tr_b16 a[164:165], v16 offset:15424
ds_read_b64_tr_b16 a[166:167], v16 offset:16704
buffer_load_dwordx4 v7, s[28:31], s56 offen offset:2048 lds
v_fma_f32 v26, v26, v21, v22
v_cvt_pk_bf16_f32 v207, v25, v26
v_lshlrev_b32 v23, 16, v208
v_and_b32 v24, s61, v208
v_mfma_f32_32x32x16_bf16 a[16:31], a[172:175], v[200:203], a[16:31]
ds_read_b64_tr_b16 a[168:169], v16 offset:15456
ds_read_b64_tr_b16 a[170:171], v16 offset:16736
v_fma_f32 v23, v23, v21, v22
v_fma_f32 v24, v24, v21, v22
v_cvt_pk_bf16_f32 v208, v23, v24
v_lshlrev_b32 v23, 16, v209
v_mfma_f32_32x32x16_bf16 a[32:47], a[176:179], v[200:203], a[32:47]
ds_read_b64_tr_b16 a[172:173], v16 offset:15488
ds_read_b64_tr_b16 a[174:175], v16 offset:16768
s_waitcnt lgkmcnt(6)
v_and_b32 v24, s61, v209
v_fma_f32 v23, v23, v21, v22
v_fma_f32 v24, v24, v21, v22
v_cvt_pk_bf16_f32 v209, v23, v24
v_mfma_f32_32x32x16_bf16 a[48:63], a[180:183], v[200:203], a[48:63]
s_waitcnt vmcnt(8)
s_barrier
v_add_u32 v16, 0x5000, v16
ds_read_b64_tr_b16 a[176:177], v16 offset:0
ds_read_b64_tr_b16 a[178:179], v16 offset:1280
v_lshlrev_b32 v23, 16, v210
v_and_b32 v24, s61, v210
v_fma_f32 v23, v23, v21, v22
v_fma_f32 v24, v24, v21, v22
v_mfma_f32_32x32x16_bf16 a[64:79], a[184:187], v[200:203], a[64:79]
ds_read_b64_tr_b16 a[180:181], v16 offset:32
ds_read_b64_tr_b16 a[182:183], v16 offset:1312
buffer_load_dwordx4 v8, s[28:31], s56 offen offset:3072 lds
v_cvt_pk_bf16_f32 v210, v23, v24
v_lshlrev_b32 v23, 16, v211
v_and_b32 v24, s61, v211
v_fma_f32 v23, v23, v21, v22
v_mfma_f32_32x32x16_bf16 a[0:15], a[188:191], v[204:207], a[0:15]
ds_read_b64_tr_b16 a[184:185], v16 offset:64
ds_read_b64_tr_b16 a[186:187], v16 offset:1344
v_fma_f32 v24, v24, v21, v22
v_cvt_pk_bf16_f32 v211, v23, v24
v_lshlrev_b32 v25, 16, v212
v_and_b32 v26, s61, v212
v_mfma_f32_32x32x16_bf16 a[16:31], a[160:163], v[204:207], a[16:31]
ds_read_b64_tr_b16 a[188:189], v16 offset:96
ds_read_b64_tr_b16 a[190:191], v16 offset:1376
s_waitcnt lgkmcnt(6)
v_fma_f32 v25, v25, v21, v22
v_fma_f32 v26, v26, v21, v22
v_cvt_pk_bf16_f32 v212, v25, v26
v_lshlrev_b32 v25, 16, v213
v_mfma_f32_32x32x16_bf16 a[32:47], a[164:167], v[204:207], a[32:47]
ds_read_b64_tr_b16 a[160:161], v16 offset:128
ds_read_b64_tr_b16 a[162:163], v16 offset:1408
v_and_b32 v26, s61, v213
v_fma_f32 v25, v25, v21, v22
v_fma_f32 v26, v26, v21, v22
v_cvt_pk_bf16_f32 v213, v25, v26
v_mfma_f32_32x32x16_bf16 a[48:63], a[168:171], v[204:207], a[48:63]
s_add_u32 m0, s96, 0x15000
ds_read_b64_tr_b16 a[164:165], v16 offset:5120
ds_read_b64_tr_b16 a[166:167], v16 offset:6400
buffer_load_dwordx4 v9, s[28:31], s56 offen offset:0 lds
s_add_u32 s56, s56, 0x3c000
s_cmp_eq_u32 s56, 0x258000
s_cselect_b32 s56, 0, s56
v_lshlrev_b32 v25, 16, v214
v_and_b32 v26, s61, v214
v_fma_f32 v25, v25, v21, v22
v_fma_f32 v26, v26, v21, v22
v_mfma_f32_32x32x16_bf16 a[64:79], a[172:175], v[204:207], a[64:79]
ds_read_b64_tr_b16 a[168:169], v16 offset:5152
ds_read_b64_tr_b16 a[170:171], v16 offset:6432
v_cvt_pk_bf16_f32 v214, v25, v26
v_lshlrev_b32 v25, 16, v215
v_and_b32 v26, s61, v215
v_fma_f32 v25, v25, v21, v22
v_mfma_f32_32x32x16_bf16 a[0:15], a[176:179], v[208:211], a[0:15]
ds_read_b64_tr_b16 a[172:173], v16 offset:5184
ds_read_b64_tr_b16 a[174:175], v16 offset:6464
s_waitcnt lgkmcnt(6)
v_fma_f32 v26, v26, v21, v22
v_cvt_pk_bf16_f32 v215, v25, v26
v_lshlrev_b32 v23, 16, v216
v_and_b32 v24, s61, v216
v_mfma_f32_32x32x16_bf16 a[16:31], a[180:183], v[208:211], a[16:31]
ds_read_b64_tr_b16 a[176:177], v16 offset:5216
ds_read_b64_tr_b16 a[178:179], v16 offset:6496
v_fma_f32 v23, v23, v21, v22
v_fma_f32 v24, v24, v21, v22
v_cvt_pk_bf16_f32 v216, v23, v24
v_lshlrev_b32 v23, 16, v217
v_mfma_f32_32x32x16_bf16 a[32:47], a[184:187], v[208:211], a[32:47]
s_mov_b32 s56, s21
s_add_u32 m0, s97, 0
ds_read_b64_tr_b16 a[180:181], v16 offset:5248
ds_read_b64_tr_b16 a[182:183], v16 offset:6528
buffer_load_dwordx4 v10, s[32:35], s56 offen offset:0 lds
v_and_b32 v24, s61, v217
v_fma_f32 v23, v23, v21, v22
v_fma_f32 v24, v24, v21, v22
v_cvt_pk_bf16_f32 v217, v23, v24
v_mfma_f32_32x32x16_bf16 a[48:63], a[188:191], v[208:211], a[48:63]
ds_read_b64_tr_b16 a[184:185], v16 offset:10240
ds_read_b64_tr_b16 a[186:187], v16 offset:11520
v_lshlrev_b32 v23, 16, v218
v_and_b32 v24, s61, v218
v_fma_f32 v23, v23, v21, v22
v_fma_f32 v24, v24, v21, v22
v_mfma_f32_32x32x16_bf16 a[64:79], a[160:163], v[208:211], a[64:79]
ds_read_b64_tr_b16 a[188:189], v16 offset:10272
ds_read_b64_tr_b16 a[190:191], v16 offset:11552
s_waitcnt lgkmcnt(6)
v_cvt_pk_bf16_f32 v218, v23, v24
v_lshlrev_b32 v23, 16, v219
v_and_b32 v24, s61, v219
v_fma_f32 v23, v23, v21, v22
v_mfma_f32_32x32x16_bf16 a[0:15], a[164:167], v[212:215], a[0:15]
ds_read_b64_tr_b16 a[160:161], v16 offset:10304
ds_read_b64_tr_b16 a[162:163], v16 offset:11584
v_fma_f32 v24, v24, v21, v22
v_cvt_pk_bf16_f32 v219, v23, v24
v_and_b32 v51, 3, v1
v_lshlrev_b32 v51, 2, v51
v_mfma_f32_32x32x16_bf16 a[16:31], a[168:171], v[212:215], a[16:31]
ds_read_b64_tr_b16 a[164:165], v16 offset:10336
ds_read_b64_tr_b16 a[166:167], v16 offset:11616
buffer_load_dwordx4 v11, s[32:35], s56 offen offset:1024 lds
buffer_load_dword v52, v51, s[48:51], 0 offen offset:64 sc1
v_lshlrev_b32 v25, 16, v220
v_and_b32 v26, s61, v220
v_fma_f32 v25, v25, v21, v22
v_fma_f32 v26, v26, v21, v22
v_mfma_f32_32x32x16_bf16 a[32:47], a[172:175], v[212:215], a[32:47]
ds_read_b64_tr_b16 a[168:169], v16 offset:10368
ds_read_b64_tr_b16 a[170:171], v16 offset:11648
v_cvt_pk_bf16_f32 v220, v25, v26
v_lshlrev_b32 v25, 16, v221
v_and_b32 v26, s61, v221
v_fma_f32 v25, v25, v21, v22
v_mfma_f32_32x32x16_bf16 a[48:63], a[176:179], v[212:215], a[48:63]
ds_read_b64_tr_b16 a[172:173], v16 offset:15360
ds_read_b64_tr_b16 a[174:175], v16 offset:16640
s_waitcnt lgkmcnt(6)
v_fma_f32 v26, v26, v21, v22
v_cvt_pk_bf16_f32 v221, v25, v26
v_lshlrev_b32 v25, 16, v222
v_and_b32 v26, s61, v222
v_mfma_f32_32x32x16_bf16 a[64:79], a[180:183], v[212:215], a[64:79]
ds_read_b64_tr_b16 a[176:177], v16 offset:15392
ds_read_b64_tr_b16 a[178:179], v16 offset:16672
v_fma_f32 v25, v25, v21, v22
v_fma_f32 v26, v26, v21, v22
v_cvt_pk_bf16_f32 v222, v25, v26
v_lshlrev_b32 v25, 16, v223
v_mfma_f32_32x32x16_bf16 a[0:15], a[184:187], v[216:219], a[0:15]
ds_read_b64_tr_b16 a[180:181], v16 offset:15424
ds_read_b64_tr_b16 a[182:183], v16 offset:16704
buffer_load_dwordx4 v12, s[32:35], s56 offen offset:2048 lds
v_and_b32 v26, s61, v223
v_fma_f32 v25, v25, v21, v22
v_fma_f32 v26, v26, v21, v22
v_cvt_pk_bf16_f32 v223, v25, v26
v_mfma_f32_32x32x16_bf16 a[16:31], a[188:191], v[216:219], a[16:31]
ds_read_b64_tr_b16 a[184:185], v16 offset:15456
ds_read_b64_tr_b16 a[186:187], v16 offset:16736
v_lshlrev_b32 v23, 16, v224
v_and_b32 v24, s61, v224
v_fma_f32 v23, v23, v21, v22
v_fma_f32 v24, v24, v21, v22
v_mfma_f32_32x32x16_bf16 a[32:47], a[160:163], v[216:219], a[32:47]
ds_read_b64_tr_b16 a[188:189], v16 offset:15488
ds_read_b64_tr_b16 a[190:191], v16 offset:16768
s_waitcnt lgkmcnt(6)
v_cvt_pk_bf16_f32 v224, v23, v24
v_lshlrev_b32 v23, 16, v225
v_and_b32 v24, s61, v225
v_fma_f32 v23, v23, v21, v22
v_mfma_f32_32x32x16_bf16 a[48:63], a[164:167], v[216:219], a[48:63]
s_waitcnt vmcnt(9)
s_barrier
v_add_u32 v16, 0x5000, v16
ds_read_b64_tr_b16 a[160:161], v16 offset:0
ds_read_b64_tr_b16 a[162:163], v16 offset:1280
v_fma_f32 v24, v24, v21, v22
v_cvt_pk_bf16_f32 v225, v23, v24
v_lshlrev_b32 v23, 16, v226
v_and_b32 v24, s61, v226
v_mfma_f32_32x32x16_bf16 a[64:79], a[168:171], v[216:219], a[64:79]
ds_read_b64_tr_b16 a[164:165], v16 offset:32
ds_read_b64_tr_b16 a[166:167], v16 offset:1312
buffer_load_dwordx4 v13, s[32:35], s56 offen offset:3072 lds
v_fma_f32 v23, v23, v21, v22
v_fma_f32 v24, v24, v21, v22
v_cvt_pk_bf16_f32 v226, v23, v24
v_lshlrev_b32 v23, 16, v227
v_mfma_f32_32x32x16_bf16 a[0:15], a[172:175], v[220:223], a[0:15]
ds_read_b64_tr_b16 a[168:169], v16 offset:64
ds_read_b64_tr_b16 a[170:171], v16 offset:1344
v_and_b32 v24, s61, v227
v_fma_f32 v23, v23, v21, v22
v_fma_f32 v24, v24, v21, v22
v_cvt_pk_bf16_f32 v227, v23, v24
v_mfma_f32_32x32x16_bf16 a[16:31], a[176:179], v[220:223], a[16:31]
ds_read_b64_tr_b16 a[172:173], v16 offset:96
ds_read_b64_tr_b16 a[174:175], v16 offset:1376
s_waitcnt lgkmcnt(6)
v_lshlrev_b32 v25, 16, v228
v_and_b32 v26, s61, v228
v_fma_f32 v25, v25, v21, v22
v_fma_f32 v26, v26, v21, v22
v_mfma_f32_32x32x16_bf16 a[32:47], a[180:183], v[220:223], a[32:47]
ds_read_b64_tr_b16 a[176:177], v16 offset:128
ds_read_b64_tr_b16 a[178:179], v16 offset:1408
v_cvt_pk_bf16_f32 v228, v25, v26
v_lshlrev_b32 v25, 16, v229
v_and_b32 v26, s61, v229
v_fma_f32 v25, v25, v21, v22
v_mfma_f32_32x32x16_bf16 a[48:63], a[184:187], v[220:223], a[48:63]
s_add_u32 m0, s97, 0x1000
ds_read_b64_tr_b16 a[180:181], v16 offset:5120
ds_read_b64_tr_b16 a[182:183], v16 offset:6400
buffer_load_dwordx4 v14, s[32:35], s56 offen offset:0 lds
s_add_u32 s56, s56, 0x30000
s_cmp_eq_u32 s56, 0x1e0000
s_cselect_b32 s56, 0, s56
v_fma_f32 v26, v26, v21, v22
v_cvt_pk_bf16_f32 v229, v25, v26
v_lshlrev_b32 v25, 16, v230
v_and_b32 v26, s61, v230
v_mfma_f32_32x32x16_bf16 a[64:79], a[188:191], v[220:223], a[64:79]
ds_read_b64_tr_b16 a[184:185], v16 offset:5152
ds_read_b64_tr_b16 a[186:187], v16 offset:6432
v_fma_f32 v25, v25, v21, v22
v_fma_f32 v26, v26, v21, v22
v_cvt_pk_bf16_f32 v230, v25, v26
v_lshlrev_b32 v25, 16, v231
v_mfma_f32_32x32x16_bf16 a[0:15], a[160:163], v[224:227], a[0:15]
ds_read_b64_tr_b16 a[188:189], v16 offset:5184
ds_read_b64_tr_b16 a[190:191], v16 offset:6464
s_waitcnt lgkmcnt(6)
v_and_b32 v26, s61, v231
v_fma_f32 v25, v25, v21, v22
v_fma_f32 v26, v26, v21, v22
v_cvt_pk_bf16_f32 v231, v25, v26
v_mfma_f32_32x32x16_bf16 a[16:31], a[164:167], v[224:227], a[16:31]
ds_read_b64_tr_b16 a[160:161], v16 offset:5216
ds_read_b64_tr_b16 a[162:163], v16 offset:6496
v_lshlrev_b32 v23, 16, v232
v_and_b32 v24, s61, v232
v_fma_f32 v23, v23, v21, v22
v_fma_f32 v24, v24, v21, v22
v_mfma_f32_32x32x16_bf16 a[32:47], a[168:171], v[224:227], a[32:47]
s_add_u32 m0, s97, 0x5000
ds_read_b64_tr_b16 a[164:165], v16 offset:5248
ds_read_b64_tr_b16 a[166:167], v16 offset:6528
buffer_load_dwordx4 v10, s[32:35], s56 offen offset:0 lds
v_cvt_pk_bf16_f32 v232, v23, v24
v_lshlrev_b32 v23, 16, v233
v_and_b32 v24, s61, v233
v_fma_f32 v23, v23, v21, v22
v_mfma_f32_32x32x16_bf16 a[48:63], a[172:175], v[224:227], a[48:63]
ds_read_b64_tr_b16 a[168:169], v16 offset:10240
ds_read_b64_tr_b16 a[170:171], v16 offset:11520
v_fma_f32 v24, v24, v21, v22
v_cvt_pk_bf16_f32 v233, v23, v24
v_lshlrev_b32 v23, 16, v234
v_and_b32 v24, s61, v234
v_mfma_f32_32x32x16_bf16 a[64:79], a[176:179], v[224:227], a[64:79]
ds_read_b64_tr_b16 a[172:173], v16 offset:10272
ds_read_b64_tr_b16 a[174:175], v16 offset:11552
s_waitcnt lgkmcnt(6)
v_fma_f32 v23, v23, v21, v22
v_fma_f32 v24, v24, v21, v22
v_cvt_pk_bf16_f32 v234, v23, v24
v_lshlrev_b32 v23, 16, v235
v_mfma_f32_32x32x16_bf16 a[0:15], a[180:183], v[228:231], a[0:15]
ds_read_b64_tr_b16 a[176:177], v16 offset:10304
ds_read_b64_tr_b16 a[178:179], v16 offset:11584
v_and_b32 v24, s61, v235
v_fma_f32 v23, v23, v21, v22
v_fma_f32 v24, v24, v21, v22
v_cvt_pk_bf16_f32 v235, v23, v24
v_mfma_f32_32x32x16_bf16 a[16:31], a[184:187], v[228:231], a[16:31]
ds_read_b64_tr_b16 a[180:181], v16 offset:10336
ds_read_b64_tr_b16 a[182:183], v16 offset:11616
buffer_load_dwordx4 v11, s[32:35], s56 offen offset:1024 lds
v_lshlrev_b32 v25, 16, v236
v_and_b32 v26, s61, v236
v_fma_f32 v25, v25, v21, v22
v_fma_f32 v26, v26, v21, v22
v_mfma_f32_32x32x16_bf16 a[32:47], a[188:191], v[228:231], a[32:47]
ds_read_b64_tr_b16 a[184:185], v16 offset:10368
ds_read_b64_tr_b16 a[186:187], v16 offset:11648
v_cvt_pk_bf16_f32 v236, v25, v26
v_lshlrev_b32 v25, 16, v237
v_and_b32 v26, s61, v237
v_fma_f32 v25, v25, v21, v22
v_mfma_f32_32x32x16_bf16 a[48:63], a[160:163], v[228:231], a[48:63]
ds_read_b64_tr_b16 a[188:189], v16 offset:15360
ds_read_b64_tr_b16 a[190:191], v16 offset:16640
s_waitcnt lgkmcnt(6)
v_fma_f32 v26, v26, v21, v22
v_cvt_pk_bf16_f32 v237, v25, v26
v_lshlrev_b32 v25, 16, v238
v_and_b32 v26, s61, v238
v_mfma_f32_32x32x16_bf16 a[64:79], a[164:167], v[228:231], a[64:79]
ds_read_b64_tr_b16 a[160:161], v16 offset:15392
ds_read_b64_tr_b16 a[162:163], v16 offset:16672
v_fma_f32 v25, v25, v21, v22
v_fma_f32 v26, v26, v21, v22
v_cvt_pk_bf16_f32 v238, v25, v26
v_lshlrev_b32 v25, 16, v239
v_mfma_f32_32x32x16_bf16 a[0:15], a[168:171], v[232:235], a[0:15]
ds_read_b64_tr_b16 a[164:165], v16 offset:15424
ds_read_b64_tr_b16 a[166:167], v16 offset:16704
buffer_load_dwordx4 v12, s[32:35], s56 offen offset:2048 lds
v_and_b32 v26, s61, v239
v_fma_f32 v25, v25, v21, v22
v_fma_f32 v26, v26, v21, v22
v_cvt_pk_bf16_f32 v239, v25, v26
v_mfma_f32_32x32x16_bf16 a[16:31], a[172:175], v[232:235], a[16:31]
ds_read_b64_tr_b16 a[168:169], v16 offset:15456
ds_read_b64_tr_b16 a[170:171], v16 offset:16736
v_lshlrev_b32 v23, 16, v240
v_and_b32 v24, s61, v240
v_fma_f32 v23, v23, v21, v22
v_fma_f32 v24, v24, v21, v22
v_mfma_f32_32x32x16_bf16 a[32:47], a[176:179], v[232:235], a[32:47]
ds_read_b64_tr_b16 a[172:173], v16 offset:15488
ds_read_b64_tr_b16 a[174:175], v16 offset:16768
s_waitcnt lgkmcnt(6)
v_cvt_pk_bf16_f32 v240, v23, v24
v_lshlrev_b32 v23, 16, v241
v_and_b32 v24, s61, v241
v_fma_f32 v23, v23, v21, v22
v_mfma_f32_32x32x16_bf16 a[48:63], a[180:183], v[232:235], a[48:63]
s_waitcnt vmcnt(9)
s_barrier
v_add_u32 v16, 0x5000, v16
ds_read_b64_tr_b16 a[176:177], v16 offset:0
ds_read_b64_tr_b16 a[178:179], v16 offset:1280
v_fma_f32 v24, v24, v21, v22
v_cvt_pk_bf16_f32 v241, v23, v24
v_lshlrev_b32 v23, 16, v242
v_and_b32 v24, s61, v242
v_mfma_f32_32x32x16_bf16 a[64:79], a[184:187], v[232:235], a[64:79]
ds_read_b64_tr_b16 a[180:181], v16 offset:32
ds_read_b64_tr_b16 a[182:183], v16 offset:1312
buffer_load_dwordx4 v13, s[32:35], s56 offen offset:3072 lds
v_fma_f32 v23, v23, v21, v22
v_fma_f32 v24, v24, v21, v22
v_cvt_pk_bf16_f32 v242, v23, v24
v_lshlrev_b32 v23, 16, v243
v_mfma_f32_32x32x16_bf16 a[0:15], a[188:191], v[236:239], a[0:15]
ds_read_b64_tr_b16 a[184:185], v16 offset:64
ds_read_b64_tr_b16 a[186:187], v16 offset:1344
v_and_b32 v24, s61, v243
v_fma_f32 v23, v23, v21, v22
v_fma_f32 v24, v24, v21, v22
v_cvt_pk_bf16_f32 v243, v23, v24
v_mfma_f32_32x32x16_bf16 a[16:31], a[160:163], v[236:239], a[16:31]
ds_read_b64_tr_b16 a[188:189], v16 offset:96
ds_read_b64_tr_b16 a[190:191], v16 offset:1376
s_waitcnt lgkmcnt(6)
v_lshlrev_b32 v25, 16, v244
v_and_b32 v26, s61, v244
v_fma_f32 v25, v25, v21, v22
v_fma_f32 v26, v26, v21, v22
v_mfma_f32_32x32x16_bf16 a[32:47], a[164:167], v[236:239], a[32:47]
ds_read_b64_tr_b16 a[160:161], v16 offset:128
ds_read_b64_tr_b16 a[162:163], v16 offset:1408
v_cvt_pk_bf16_f32 v244, v25, v26
v_lshlrev_b32 v25, 16, v245
v_and_b32 v26, s61, v245
v_fma_f32 v25, v25, v21, v22
v_mfma_f32_32x32x16_bf16 a[48:63], a[168:171], v[236:239], a[48:63]
s_add_u32 m0, s97, 0x6000
ds_read_b64_tr_b16 a[164:165], v16 offset:5120
ds_read_b64_tr_b16 a[166:167], v16 offset:6400
buffer_load_dwordx4 v14, s[32:35], s56 offen offset:0 lds
s_add_u32 s56, s56, 0x30000
s_cmp_eq_u32 s56, 0x1e0000
s_cselect_b32 s56, 0, s56
v_fma_f32 v26, v26, v21, v22
v_cvt_pk_bf16_f32 v245, v25, v26
v_lshlrev_b32 v25, 16, v246
v_and_b32 v26, s61, v246
v_mfma_f32_32x32x16_bf16 a[64:79], a[172:175], v[236:239], a[64:79]
ds_read_b64_tr_b16 a[168:169], v16 offset:5152
ds_read_b64_tr_b16 a[170:171], v16 offset:6432
v_fma_f32 v25, v25, v21, v22
v_fma_f32 v26, v26, v21, v22
v_cvt_pk_bf16_f32 v246, v25, v26
v_lshlrev_b32 v25, 16, v247
v_mfma_f32_32x32x16_bf16 a[0:15], a[176:179], v[240:243], a[0:15]
ds_read_b64_tr_b16 a[172:173], v16 offset:5184
ds_read_b64_tr_b16 a[174:175], v16 offset:6464
s_waitcnt lgkmcnt(6)
v_and_b32 v26, s61, v247
v_fma_f32 v25, v25, v21, v22
v_fma_f32 v26, v26, v21, v22
v_cvt_pk_bf16_f32 v247, v25, v26
v_mfma_f32_32x32x16_bf16 a[16:31], a[180:183], v[240:243], a[16:31]
ds_read_b64_tr_b16 a[176:177], v16 offset:5216
ds_read_b64_tr_b16 a[178:179], v16 offset:6496
v_lshlrev_b32 v23, 16, v248
v_and_b32 v24, s61, v248
v_fma_f32 v23, v23, v21, v22
v_fma_f32 v24, v24, v21, v22
v_mfma_f32_32x32x16_bf16 a[32:47], a[184:187], v[240:243], a[32:47]
s_add_u32 m0, s97, 0xa000
ds_read_b64_tr_b16 a[180:181], v16 offset:5248
ds_read_b64_tr_b16 a[182:183], v16 offset:6528
buffer_load_dwordx4 v10, s[32:35], s56 offen offset:0 lds
v_cvt_pk_bf16_f32 v248, v23, v24
v_lshlrev_b32 v23, 16, v249
v_and_b32 v24, s61, v249
v_fma_f32 v23, v23, v21, v22
v_mfma_f32_32x32x16_bf16 a[48:63], a[188:191], v[240:243], a[48:63]
ds_read_b64_tr_b16 a[184:185], v16 offset:10240
ds_read_b64_tr_b16 a[186:187], v16 offset:11520
v_fma_f32 v24, v24, v21, v22
v_cvt_pk_bf16_f32 v249, v23, v24
v_lshlrev_b32 v23, 16, v250
v_and_b32 v24, s61, v250
v_mfma_f32_32x32x16_bf16 a[64:79], a[160:163], v[240:243], a[64:79]
ds_read_b64_tr_b16 a[188:189], v16 offset:10272
ds_read_b64_tr_b16 a[190:191], v16 offset:11552
s_waitcnt lgkmcnt(6)
v_fma_f32 v23, v23, v21, v22
v_fma_f32 v24, v24, v21, v22
v_cvt_pk_bf16_f32 v250, v23, v24
v_lshlrev_b32 v23, 16, v251
v_mfma_f32_32x32x16_bf16 a[0:15], a[164:167], v[244:247], a[0:15]
ds_read_b64_tr_b16 a[160:161], v16 offset:10304
ds_read_b64_tr_b16 a[162:163], v16 offset:11584
v_and_b32 v24, s61, v251
v_fma_f32 v23, v23, v21, v22
v_fma_f32 v24, v24, v21, v22
v_cvt_pk_bf16_f32 v251, v23, v24
v_mfma_f32_32x32x16_bf16 a[16:31], a[168:171], v[244:247], a[16:31]
ds_read_b64_tr_b16 a[164:165], v16 offset:10336
ds_read_b64_tr_b16 a[166:167], v16 offset:11616
buffer_load_dwordx4 v11, s[32:35], s56 offen offset:1024 lds
v_lshlrev_b32 v25, 16, v252
v_and_b32 v26, s61, v252
v_fma_f32 v25, v25, v21, v22
v_fma_f32 v26, v26, v21, v22
v_mfma_f32_32x32x16_bf16 a[32:47], a[172:175], v[244:247], a[32:47]
ds_read_b64_tr_b16 a[168:169], v16 offset:10368
ds_read_b64_tr_b16 a[170:171], v16 offset:11648
v_cvt_pk_bf16_f32 v252, v25, v26
v_lshlrev_b32 v25, 16, v253
v_and_b32 v26, s61, v253
v_fma_f32 v25, v25, v21, v22
v_mfma_f32_32x32x16_bf16 a[48:63], a[176:179], v[244:247], a[48:63]
ds_read_b64_tr_b16 a[172:173], v16 offset:15360
ds_read_b64_tr_b16 a[174:175], v16 offset:16640
s_waitcnt lgkmcnt(6)
v_fma_f32 v26, v26, v21, v22
v_cvt_pk_bf16_f32 v253, v25, v26
v_lshlrev_b32 v25, 16, v254
v_and_b32 v26, s61, v254
v_mfma_f32_32x32x16_bf16 a[64:79], a[180:183], v[244:247], a[64:79]
ds_read_b64_tr_b16 a[176:177], v16 offset:15392
ds_read_b64_tr_b16 a[178:179], v16 offset:16672
v_fma_f32 v25, v25, v21, v22
v_fma_f32 v26, v26, v21, v22
v_cvt_pk_bf16_f32 v254, v25, v26
v_lshlrev_b32 v25, 16, v255
v_mfma_f32_32x32x16_bf16 a[0:15], a[184:187], v[248:251], a[0:15]
ds_read_b64_tr_b16 a[180:181], v16 offset:15424
ds_read_b64_tr_b16 a[182:183], v16 offset:16704
buffer_load_dwordx4 v12, s[32:35], s56 offen offset:2048 lds
v_and_b32 v26, s61, v255
v_fma_f32 v25, v25, v21, v22
v_fma_f32 v26, v26, v21, v22
v_cvt_pk_bf16_f32 v255, v25, v26
v_mfma_f32_32x32x16_bf16 a[16:31], a[188:191], v[248:251], a[16:31]
ds_read_b64_tr_b16 a[184:185], v16 offset:15456
ds_read_b64_tr_b16 a[186:187], v16 offset:16736
v_mfma_f32_32x32x16_bf16 a[32:47], a[160:163], v[248:251], a[32:47]
ds_read_b64_tr_b16 a[188:189], v16 offset:15488
ds_read_b64_tr_b16 a[190:191], v16 offset:16768
s_waitcnt lgkmcnt(6)
v_mfma_f32_32x32x16_bf16 a[48:63], a[164:167], v[248:251], a[48:63]
s_waitcnt vmcnt(8)
s_barrier
ds_read_b64_tr_b16 a[160:161], v17 offset:0
ds_read_b64_tr_b16 a[162:163], v18 offset:0
v_mfma_f32_32x32x16_bf16 a[64:79], a[168:171], v[248:251], a[64:79]
ds_read_b64_tr_b16 a[164:165], v17 offset:32
ds_read_b64_tr_b16 a[166:167], v18 offset:32
buffer_load_dwordx4 v13, s[32:35], s56 offen offset:3072 lds
v_mfma_f32_32x32x16_bf16 a[0:15], a[172:175], v[252:255], a[0:15]
ds_read_b64_tr_b16 a[168:169], v17 offset:64
ds_read_b64_tr_b16 a[170:171], v18 offset:64
v_mfma_f32_32x32x16_bf16 a[16:31], a[176:179], v[252:255], a[16:31]
ds_read_b64_tr_b16 a[172:173], v17 offset:96
ds_read_b64_tr_b16 a[174:175], v18 offset:96
s_waitcnt lgkmcnt(6)
v_mfma_f32_32x32x16_bf16 a[32:47], a[180:183], v[252:255], a[32:47]
ds_read_b64_tr_b16 a[176:177], v17 offset:128
ds_read_b64_tr_b16 a[178:179], v18 offset:128
v_mfma_f32_32x32x16_bf16 a[48:63], a[184:187], v[252:255], a[48:63]
s_add_u32 m0, s97, 0xb000
ds_read_b64_tr_b16 a[180:181], v17 offset:2560
ds_read_b64_tr_b16 a[182:183], v18 offset:2560
buffer_load_dwordx4 v14, s[32:35], s56 offen offset:0 lds
s_add_u32 s56, s56, 0x30000
s_cmp_eq_u32 s56, 0x1e0000
s_cselect_b32 s56, 0, s56
v_mfma_f32_32x32x16_bf16 a[64:79], a[188:191], v[252:255], a[64:79]
ds_read_b64_tr_b16 a[184:185], v17 offset:2592
ds_read_b64_tr_b16 a[186:187], v18 offset:2592
v_mfma_f32_32x32x16_bf16 a[80:95], a[160:163], v[96:99], 0
ds_read_b64_tr_b16 a[188:189], v17 offset:2624
ds_read_b64_tr_b16 a[190:191], v18 offset:2624
s_waitcnt lgkmcnt(6)
v_cmp_eq_u32 vcc, 1, v52
s_nop 3
s_cmp_eq_u64 vcc, -1
s_cbranch_scc1 X_g_ok
s_mov_b32 s60, 0
X_g_spin:
s_add_u32 s60, s60, 1
s_cmp_ge_u32 s60, 0x40000
s_cbranch_scc1 X_g_ok
s_sleep 16
buffer_load_dword v52, v51, s[48:51], 0 offen offset:64 sc1
s_waitcnt vmcnt(0)
v_cmp_eq_u32 vcc, 1, v52
s_nop 3
s_cmp_eq_u64 vcc, -1
s_cbranch_scc0 X_g_spin
X_g_ok:
v_mfma_f32_32x32x16_bf16 a[96:111], a[164:167], v[96:99], 0
ds_read_b64_tr_b16 a[160:161], v17 offset:2656
ds_read_b64_tr_b16 a[162:163], v18 offset:2656
v_and_b32 v23, 31, v1
s_lshl_b32 s57, s52, 5
v_add_u32 v23, s57, v23
v_lshrrev_b32 v92, 5, v1
v_mul_u32_u24 v23, 0x50, v23
v_mul_u32_u24 v93, 0x5000, v92
v_mfma_f32_32x32x16_bf16 a[112:127], a[168:171], v[96:99], 0
s_add_u32 m0, s97, 0xf000
ds_read_b64_tr_b16 a[164:165], v17 offset:2688
ds_read_b64_tr_b16 a[166:167], v18 offset:2688
buffer_load_dwordx4 v10, s[32:35], s56 offen offset:0 lds
v_mul_u32_u24 v92, 0x2800, v92
v_add_u32 v19, v23, v93
v_add_u32 v20, v23, v92
v_add_u32 v19, 0x19000, v19
v_add_u32 v20, 0x23000, v20
v_mfma_f32_32x32x16_bf16 a[128:143], a[172:175], v[96:99], 0
ds_read_b64_tr_b16 a[168:169], v17 offset:5120
ds_read_b64_tr_b16 a[170:171], v18 offset:5120
v_accvgpr_read_b32 v23, a0
v_accvgpr_read_b32 v92, a1
v_cvt_pk_bf16_f32 v72, v23, v92
v_accvgpr_read_b32 v94, a2
v_accvgpr_read_b32 v95, a3
v_mfma_f32_32x32x16_bf16 a[144:159], a[176:179], v[96:99], 0
ds_read_b64_tr_b16 a[172:173], v17 offset:5152
ds_read_b64_tr_b16 a[174:175], v18 offset:5152
s_waitcnt lgkmcnt(6)
v_cvt_pk_bf16_f32 v73, v94, v95
v_accvgpr_read_b32 v23, a4
v_accvgpr_read_b32 v92, a5
v_cvt_pk_bf16_f32 v74, v23, v92
v_accvgpr_read_b32 v94, a6
v_mfma_f32_32x32x16_bf16 a[80:95], a[180:183], v[100:103], a[80:95]
ds_read_b64_tr_b16 a[176:177], v17 offset:5184
ds_read_b64_tr_b16 a[178:179], v18 offset:5184
v_accvgpr_read_b32 v95, a7
v_cvt_pk_bf16_f32 v75, v94, v95
v_accvgpr_read_b32 v23, a8
v_accvgpr_read_b32 v92, a9
v_cvt_pk_bf16_f32 v76, v23, v92
v_mfma_f32_32x32x16_bf16 a[96:111], a[184:187], v[100:103], a[96:111]
ds_read_b64_tr_b16 a[180:181], v17 offset:5216
ds_read_b64_tr_b16 a[182:183], v18 offset:5216
buffer_load_dwordx4 v11, s[32:35], s56 offen offset:1024 lds
v_accvgpr_read_b32 v94, a10
v_accvgpr_read_b32 v95, a11
v_cvt_pk_bf16_f32 v77, v94, v95
v_accvgpr_read_b32 v23, a12
v_accvgpr_read_b32 v92, a13
v_mfma_f32_32x32x16_bf16 a[112:127], a[188:191], v[100:103], a[112:127]
ds_read_b64_tr_b16 a[184:185], v17 offset:5248
ds_read_b64_tr_b16 a[186:187], v18 offset:5248
v_cvt_pk_bf16_f32 v78, v23, v92
v_accvgpr_read_b32 v94, a14
v_accvgpr_read_b32 v95, a15
v_cvt_pk_bf16_f32 v79, v94, v95
v_accvgpr_read_b32 v23, a16
v_mfma_f32_32x32x16_bf16 a[128:143], a[160:163], v[100:103], a[128:143]
ds_read_b64_tr_b16 a[188:189], v17 offset:7680
ds_read_b64_tr_b16 a[190:191], v18 offset:7680
s_waitcnt lgkmcnt(6)
v_accvgpr_read_b32 v92, a17
v_cvt_pk_bf16_f32 v80, v23, v92
v_accvgpr_read_b32 v94, a18
v_accvgpr_read_b32 v95, a19
v_cvt_pk_bf16_f32 v81, v94, v95
v_mfma_f32_32x32x16_bf16 a[144:159], a[164:167], v[100:103], a[144:159]
ds_read_b64_tr_b16 a[160:161], v17 offset:7712
ds_read_b64_tr_b16 a[162:163], v18 offset:7712
v_accvgpr_read_b32 v23, a20
v_accvgpr_read_b32 v92, a21
v_cvt_pk_bf16_f32 v82, v23, v92
v_accvgpr_read_b32 v94, a22
v_accvgpr_read_b32 v95, a23
v_mfma_f32_32x32x16_bf16 a[80:95], a[168:171], v[104:107], a[80:95]
ds_read_b64_tr_b16 a[164:165], v17 offset:7744
ds_read_b64_tr_b16 a[166:167], v18 offset:7744
buffer_load_dwordx4 v12, s[32:35], s56 offen offset:2048 lds
v_cvt_pk_bf16_f32 v83, v94, v95
v_accvgpr_read_b32 v23, a24
v_accvgpr_read_b32 v92, a25
v_cvt_pk_bf16_f32 v84, v23, v92
v_accvgpr_read_b32 v94, a26
v_mfma_f32_32x32x16_bf16 a[96:111], a[172:175], v[104:107], a[96:111]
ds_read_b64_tr_b16 a[168:169], v17 offset:7776
ds_read_b64_tr_b16 a[170:171], v18 offset:7776
v_accvgpr_read_b32 v95, a27
v_cvt_pk_bf16_f32 v85, v94, v95
v_accvgpr_read_b32 v23, a28
v_accvgpr_read_b32 v92, a29
v_cvt_pk_bf16_f32 v86, v23, v92
v_mfma_f32_32x32x16_bf16 a[112:127], a[176:179], v[104:107], a[112:127]
ds_read_b64_tr_b16 a[172:173], v17 offset:7808
ds_read_b64_tr_b16 a[174:175], v18 offset:7808
s_waitcnt lgkmcnt(6)
v_accvgpr_read_b32 v94, a30
v_accvgpr_read_b32 v95, a31
v_cvt_pk_bf16_f32 v87, v94, v95
v_accvgpr_read_b32 v23, a32
v_accvgpr_read_b32 v92, a33
v_mfma_f32_32x32x16_bf16 a[128:143], a[180:183], v[104:107], a[128:143]
s_waitcnt vmcnt(8)
s_barrier
v_add_u32 v17, 0x5000, v17
v_add_u32 v18, 0x5000, v18
ds_read_b64_tr_b16 a[176:177], v17 offset:0
ds_read_b64_tr_b16 a[178:179], v18 offset:0
v_cvt_pk_bf16_f32 v88, v23, v92
v_accvgpr_read_b32 v94, a34
v_accvgpr_read_b32 v95, a35
v_cvt_pk_bf16_f32 v89, v94, v95
v_accvgpr_read_b32 v23, a36
v_mfma_f32_32x32x16_bf16 a[144:159], a[184:187], v[104:107], a[144:159]
ds_read_b64_tr_b16 a[180:181], v17 offset:32
ds_read_b64_tr_b16 a[182:183], v18 offset:32
buffer_load_dwordx4 v13, s[32:35], s56 offen offset:3072 lds
v_accvgpr_read_b32 v92, a37
v_cvt_pk_bf16_f32 v90, v23, v92
v_accvgpr_read_b32 v94, a38
v_accvgpr_read_b32 v95, a39
v_cvt_pk_bf16_f32 v91, v94, v95
v_mfma_f32_32x32x16_bf16 v[24:39], a[192:195], v[72:75], 0
v_mfma_f32_32x32x16_bf16 v[24:39], a[196:199], v[76:79], v[24:39]
v_mfma_f32_32x32x16_bf16 v[24:39], a[200:203], v[80:83], v[24:39]
v_mfma_f32_32x32x16_bf16 v[40:55], a[204:207], v[72:75], 0
v_mfma_f32_32x32x16_bf16 v[40:55], a[208:211], v[76:79], v[40:55]
v_mfma_f32_32x32x16_bf16 v[40:55], a[212:215], v[80:83], v[40:55]
v_mfma_f32_32x32x16_bf16 v[40:55], a[216:219], v[84:87], v[40:55]
v_mfma_f32_32x32x16_bf16 v[40:55], a[220:223], v[88:91], v[40:55]
v_mfma_f32_32x32x16_bf16 v[56:71], a[224:227], v[80:83], 0
v_mfma_f32_32x32x16_bf16 v[56:71], a[228:231], v[84:87], v[56:71]
v_mfma_f32_32x32x16_bf16 v[56:71], a[232:235], v[88:91], v[56:71]
v_accvgpr_read_b32 v23, a40
v_accvgpr_read_b32 v92, a41
v_cvt_pk_bf16_f32 v72, v23, v92
v_accvgpr_read_b32 v94, a42
v_accvgpr_read_b32 v95, a43
v_mfma_f32_32x32x16_bf16 a[80:95], a[188:191], v[108:111], a[80:95]
ds_read_b64_tr_b16 a[184:185], v17 offset:64
ds_read_b64_tr_b16 a[186:187], v18 offset:64
v_cvt_pk_bf16_f32 v73, v94, v95
v_accvgpr_read_b32 v23, a44
v_accvgpr_read_b32 v92, a45
v_cvt_pk_bf16_f32 v74, v23, v92
v_accvgpr_read_b32 v94, a46
v_mfma_f32_32x32x16_bf16 a[96:111], a[160:163], v[108:111], a[96:111]
ds_read_b64_tr_b16 a[188:189], v17 offset:96
ds_read_b64_tr_b16 a[190:191], v18 offset:96
s_waitcnt lgkmcnt(6)
v_accvgpr_read_b32 v95, a47
v_cvt_pk_bf16_f32 v75, v94, v95
v_accvgpr_read_b32 v23, a48
v_accvgpr_read_b32 v92, a49
v_cvt_pk_bf16_f32 v76, v23, v92
v_mfma_f32_32x32x16_bf16 a[112:127], a[164:167], v[108:111], a[112:127]
ds_read_b64_tr_b16 a[160:161], v17 offset:128
ds_read_b64_tr_b16 a[162:163], v18 offset:128
v_accvgpr_read_b32 v94, a50
v_accvgpr_read_b32 v95, a51
v_cvt_pk_bf16_f32 v77, v94, v95
v_accvgpr_read_b32 v23, a52
v_accvgpr_read_b32 v92, a53
v_mfma_f32_32x32x16_bf16 a[128:143], a[168:171], v[108:111], a[128:143]
s_add_u32 m0, s97, 0x10000
ds_read_b64_tr_b16 a[164:165], v17 offset:2560
ds_read_b64_tr_b16 a[166:167], v18 offset:2560
buffer_load_dwordx4 v14, s[32:35], s56 offen offset:0 lds
s_add_u32 s56, s56, 0x30000
s_cmp_eq_u32 s56, 0x1e0000
s_cselect_b32 s56, 0, s56
v_cvt_pk_bf16_f32 v78, v23, v92
v_accvgpr_read_b32 v94, a54
v_accvgpr_read_b32 v95, a55
v_cvt_pk_bf16_f32 v79, v94, v95
v_accvgpr_read_b32 v23, a56
v_mfma_f32_32x32x16_bf16 a[144:159], a[172:175], v[108:111], a[144:159]
ds_read_b64_tr_b16 a[168:169], v17 offset:2592
ds_read_b64_tr_b16 a[170:171], v18 offset:2592
v_accvgpr_read_b32 v92, a57
v_cvt_pk_bf16_f32 v80, v23, v92
v_accvgpr_read_b32 v94, a58
v_accvgpr_read_b32 v95, a59
v_cvt_pk_bf16_f32 v81, v94, v95
v_mfma_f32_32x32x16_bf16 a[80:95], a[176:179], v[112:115], a[80:95]
ds_read_b64_tr_b16 a[172:173], v17 offset:2624
ds_read_b64_tr_b16 a[174:175], v18 offset:2624
s_waitcnt lgkmcnt(6)
v_accvgpr_read_b32 v23, a60
v_accvgpr_read_b32 v92, a61
v_cvt_pk_bf16_f32 v82, v23, v92
v_accvgpr_read_b32 v94, a62
v_accvgpr_read_b32 v95, a63
v_mfma_f32_32x32x16_bf16 a[96:111], a[180:183], v[112:115], a[96:111]
ds_read_b64_tr_b16 a[176:177], v17 offset:2656
ds_read_b64_tr_b16 a[178:179], v18 offset:2656
v_cvt_pk_bf16_f32 v83, v94, v95
v_accvgpr_read_b32 v23, a64
v_accvgpr_read_b32 v92, a65
v_cvt_pk_bf16_f32 v84, v23, v92
v_accvgpr_read_b32 v94, a66
v_mfma_f32_32x32x16_bf16 a[112:127], a[184:187], v[112:115], a[112:127]
s_add_u32 m0, s97, 0x14000
ds_read_b64_tr_b16 a[180:181], v17 offset:2688
ds_read_b64_tr_b16 a[182:183], v18 offset:2688
buffer_load_dwordx4 v10, s[32:35], s56 offen offset:0 lds
v_accvgpr_read_b32 v95, a67
v_cvt_pk_bf16_f32 v85, v94, v95
v_accvgpr_read_b32 v23, a68
v_accvgpr_read_b32 v92, a69
v_cvt_pk_bf16_f32 v86, v23, v92
v_mfma_f32_32x32x16_bf16 a[128:143], a[188:191], v[112:115], a[128:143]
ds_read_b64_tr_b16 a[184:185], v17 offset:5120
ds_read_b64_tr_b16 a[186:187], v18 offset:5120
v_accvgpr_read_b32 v94, a70
v_accvgpr_read_b32 v95, a71
v_cvt_pk_bf16_f32 v87, v94, v95
v_accvgpr_read_b32 v23, a72
v_accvgpr_read_b32 v92, a73
v_mfma_f32_32x32x16_bf16 a[144:159], a[160:163], v[112:115], a[144:159]
ds_read_b64_tr_b16 a[188:189], v17 offset:5152
ds_read_b64_tr_b16 a[190:191], v18 offset:5152
s_waitcnt lgkmcnt(6)
v_cvt_pk_bf16_f32 v88, v23, v92
v_accvgpr_read_b32 v94, a74
v_accvgpr_read_b32 v95, a75
v_cvt_pk_bf16_f32 v89, v94, v95
v_accvgpr_read_b32 v23, a76
v_mfma_f32_32x32x16_bf16 a[80:95], a[164:167], v[116:119], a[80:95]
ds_read_b64_tr_b16 a[160:161], v17 offset:5184
ds_read_b64_tr_b16 a[162:163], v18 offset:5184
v_accvgpr_read_b32 v92, a77
v_cvt_pk_bf16_f32 v90, v23, v92
v_accvgpr_read_b32 v94, a78
v_accvgpr_read_b32 v95, a79
v_cvt_pk_bf16_f32 v91, v94, v95
v_mfma_f32_32x32x16_bf16 a[96:111], a[168:171], v[116:119], a[96:111]
ds_read_b64_tr_b16 a[164:165], v17 offset:5216
ds_read_b64_tr_b16 a[166:167], v18 offset:5216
buffer_load_dwordx4 v11, s[32:35], s56 offen offset:1024 lds
ds_write_b128 v20, v[72:75] offset:0
ds_write_b128 v20, v[76:79] offset:16
v_mfma_f32_32x32x16_bf16 a[112:127], a[172:175], v[116:119], a[112:127]
ds_read_b64_tr_b16 a[168:169], v17 offset:5248
ds_read_b64_tr_b16 a[170:171], v18 offset:5248
ds_write_b128 v20, v[80:83] offset:32
ds_write_b128 v20, v[84:87] offset:48
v_mfma_f32_32x32x16_bf16 a[128:143], a[176:179], v[116:119], a[128:143]
ds_read_b64_tr_b16 a[172:173], v17 offset:7680
ds_read_b64_tr_b16 a[174:175], v18 offset:7680
s_waitcnt lgkmcnt(10)
ds_write_b128 v20, v[88:91] offset:64
s_lshl_b32 s57, s54, 2
s_add_u32 s57, s57, s52
s_lshl_b32 s63, s57, 2
s_add_u32 s63, s63, 0x80
v_mov_b32 v16, 0
v_mfma_f32_32x32x16_bf16 a[144:159], a[180:183], v[116:119], a[144:159]
ds_read_b64_tr_b16 a[176:177], v17 offset:7712
ds_read_b64_tr_b16 a[178:179], v18 offset:7712
buffer_load_dword v15, v16, s[48:51], s63 offen sc1
v_max3_f32 v23, v24, v25, v26
v_min3_f32 v92, v24, v25, v26
v_max3_f32 v23, v23, v27, v28
v_min3_f32 v92, v92, v27, v28
v_max3_f32 v23, v23, v29, v30
v_mfma_f32_32x32x16_bf16 a[80:95], a[184:187], v[120:123], a[80:95]
ds_read_b64_tr_b16 a[180:181], v17 offset:7744
ds_read_b64_tr_b16 a[182:183], v18 offset:7744
buffer_load_dwordx4 v12, s[32:35], s56 offen offset:2048 lds
v_min3_f32 v92, v92, v29, v30
v_max3_f32 v23, v23, v31, v32
v_min3_f32 v92, v92, v31, v32
v_max3_f32 v23, v23, v33, v34
v_min3_f32 v92, v92, v33, v34
v_mfma_f32_32x32x16_bf16 a[96:111], a[188:191], v[120:123], a[96:111]
ds_read_b64_tr_b16 a[184:185], v17 offset:7776
ds_read_b64_tr_b16 a[186:187], v18 offset:7776
v_max3_f32 v23, v23, v35, v36
v_min3_f32 v92, v92, v35, v36
v_max3_f32 v23, v23, v37, v38
v_min3_f32 v92, v92, v37, v38
v_max3_f32 v23, v23, v39, v40
v_mfma_f32_32x32x16_bf16 a[112:127], a[160:163], v[120:123], a[112:127]
ds_read_b64_tr_b16 a[188:189], v17 offset:7808
ds_read_b64_tr_b16 a[190:191], v18 offset:7808
s_waitcnt lgkmcnt(6)
v_min3_f32 v92, v92, v39, v40
v_max3_f32 v23, v23, v41, v42
v_min3_f32 v92, v92, v41, v42
v_max_f32 v23, v23, v43
v_min_f32 v92, v92, v43
v_mfma_f32_32x32x16_bf16 a[128:143], a[164:167], v[120:123], a[128:143]
s_waitcnt vmcnt(9)
s_barrier
v_add_u32 v17, 0x5000, v17
v_add_u32 v18, 0x5000, v18
ds_read_b64_tr_b16 a[160:161], v17 offset:0
ds_read_b64_tr_b16 a[162:163], v18 offset:0
v_mul_f32 v23, s62, v23
v_mul_f32 v92, s62, v92
v_fma_f32 v72, v24, s62, -v23
v_fma_f32 v24, -v24, s62, v92
v_fma_f32 v73, v25, s62, -v23
v_mfma_f32_32x32x16_bf16 a[144:159], a[168:171], v[120:123], a[144:159]
ds_read_b64_tr_b16 a[164:165], v17 offset:32
ds_read_b64_tr_b16 a[166:167], v18 offset:32
buffer_load_dwordx4 v13, s[32:35], s56 offen offset:3072 lds
v_fma_f32 v25, -v25, s62, v92
v_fma_f32 v74, v26, s62, -v23
v_fma_f32 v26, -v26, s62, v92
v_fma_f32 v75, v27, s62, -v23
v_fma_f32 v27, -v27, s62, v92
v_mfma_f32_32x32x16_bf16 a[80:95], a[172:175], v[124:127], a[80:95]
ds_read_b64_tr_b16 a[168:169], v17 offset:64
ds_read_b64_tr_b16 a[170:171], v18 offset:64
v_fma_f32 v76, v28, s62, -v23
v_fma_f32 v28, -v28, s62, v92
v_fma_f32 v77, v29, s62, -v23
v_fma_f32 v29, -v29, s62, v92
v_fma_f32 v78, v30, s62, -v23
v_mfma_f32_32x32x16_bf16 a[96:111], a[176:179], v[124:127], a[96:111]
ds_read_b64_tr_b16 a[172:173], v17 offset:96
ds_read_b64_tr_b16 a[174:175], v18 offset:96
s_waitcnt lgkmcnt(6)
v_fma_f32 v30, -v30, s62, v92
v_fma_f32 v79, v31, s62, -v23
v_fma_f32 v31, -v31, s62, v92
v_fma_f32 v80, v32, s62, -v23
v_fma_f32 v32, -v32, s62, v92
v_mfma_f32_32x32x16_bf16 a[112:127], a[180:183], v[124:127], a[112:127]
ds_read_b64_tr_b16 a[176:177], v17 offset:128
ds_read_b64_tr_b16 a[178:179], v18 offset:128
v_fma_f32 v81, v33, s62, -v23
v_fma_f32 v33, -v33, s62, v92
v_fma_f32 v82, v34, s62, -v23
v_fma_f32 v34, -v34, s62, v92
v_fma_f32 v83, v35, s62, -v23
v_mfma_f32_32x32x16_bf16 a[128:143], a[184:187], v[124:127], a[128:143]
s_add_u32 m0, s97, 0x15000
ds_read_b64_tr_b16 a[180:181], v17 offset:2560
ds_read_b64_tr_b16 a[182:183], v18 offset:2560
buffer_load_dwordx4 v14, s[32:35], s56 offen offset:0 lds
s_add_u32 s56, s56, 0x30000
s_cmp_eq_u32 s56, 0x1e0000
s_cselect_b32 s56, 0, s56
v_fma_f32 v35, -v35, s62, v92
v_fma_f32 v84, v36, s62, -v23
v_fma_f32 v36, -v36, s62, v92
v_fma_f32 v85, v37, s62, -v23
v_fma_f32 v37, -v37, s62, v92
v_mfma_f32_32x32x16_bf16 a[144:159], a[188:191], v[124:127], a[144:159]
ds_read_b64_tr_b16 a[184:185], v17 offset:2592
ds_read_b64_tr_b16 a[186:187], v18 offset:2592
v_fma_f32 v86, v38, s62, -v23
v_fma_f32 v38, -v38, s62, v92
v_fma_f32 v87, v39, s62, -v23
v_fma_f32 v39, -v39, s62, v92
v_fma_f32 v88, v40, s62, -v23
v_mfma_f32_32x32x16_bf16 a[80:95], a[160:163], v[128:131], a[80:95]
ds_read_b64_tr_b16 a[188:189], v17 offset:2624
ds_read_b64_tr_b16 a[190:191], v18 offset:2624
s_waitcnt lgkmcnt(6)
v_fma_f32 v40, -v40, s62, v92
v_fma_f32 v89, v41, s62, -v23
v_fma_f32 v41, -v41, s62, v92
v_fma_f32 v90, v42, s62, -v23
v_fma_f32 v42, -v42, s62, v92
v_mfma_f32_32x32x16_bf16 a[96:111], a[164:167], v[128:131], a[96:111]
ds_read_b64_tr_b16 a[160:161], v17 offset:2656
ds_read_b64_tr_b16 a[162:163], v18 offset:2656
v_fma_f32 v91, v43, s62, -v23
v_fma_f32 v43, -v43, s62, v92
v_exp_f32 v72, v72
v_mfma_f32_32x32x16_bf16 a[112:127], a[168:171], v[128:131], a[112:127]
s_add_u32 m0, s97, 0
ds_read_b64_tr_b16 a[164:165], v17 offset:2688
ds_read_b64_tr_b16 a[166:167], v18 offset:2688
buffer_load_dwordx4 v10, s[32:35], s56 offen offset:0 lds
v_exp_f32 v24, v24
v_exp_f32 v73, v73
v_mfma_f32_32x32x16_bf16 a[128:143], a[172:175], v[128:131], a[128:143]
ds_read_b64_tr_b16 a[168:169], v17 offset:5120
ds_read_b64_tr_b16 a[170:171], v18 offset:5120
v_exp_f32 v25, v25
v_exp_f32 v74, v74
v_mfma_f32_32x32x16_bf16 a[144:159], a[176:179], v[128:131], a[144:159]
ds_read_b64_tr_b16 a[172:173], v17 offset:5152
ds_read_b64_tr_b16 a[174:175], v18 offset:5152
s_waitcnt lgkmcnt(6)
v_exp_f32 v26, v26
v_exp_f32 v75, v75
v_mfma_f32_32x32x16_bf16 a[80:95], a[180:183], v[132:135], a[80:95]
ds_read_b64_tr_b16 a[176:177], v17 offset:5184
ds_read_b64_tr_b16 a[178:179], v18 offset:5184
v_exp_f32 v27, v27
v_exp_f32 v76, v76
v_mfma_f32_32x32x16_bf16 a[96:111], a[184:187], v[132:135], a[96:111]
ds_read_b64_tr_b16 a[180:181], v17 offset:5216
ds_read_b64_tr_b16 a[182:183], v18 offset:5216
buffer_load_dwordx4 v11, s[32:35], s56 offen offset:1024 lds
v_exp_f32 v28, v28
v_exp_f32 v77, v77
v_mfma_f32_32x32x16_bf16 a[112:127], a[188:191], v[132:135], a[112:127]
ds_read_b64_tr_b16 a[184:185], v17 offset:5248
ds_read_b64_tr_b16 a[186:187], v18 offset:5248
v_exp_f32 v29, v29
v_exp_f32 v78, v78
v_mfma_f32_32x32x16_bf16 a[128:143], a[160:163], v[132:135], a[128:143]
ds_read_b64_tr_b16 a[188:189], v17 offset:7680
ds_read_b64_tr_b16 a[190:191], v18 offset:7680
s_waitcnt lgkmcnt(6)
v_exp_f32 v30, v30
v_exp_f32 v79, v79
v_mfma_f32_32x32x16_bf16 a[144:159], a[164:167], v[132:135], a[144:159]
ds_read_b64_tr_b16 a[160:161], v17 offset:7712
ds_read_b64_tr_b16 a[162:163], v18 offset:7712
v_exp_f32 v31, v31
v_exp_f32 v80, v80
v_mfma_f32_32x32x16_bf16 a[80:95], a[168:171], v[136:139], a[80:95]
ds_read_b64_tr_b16 a[164:165], v17 offset:7744
ds_read_b64_tr_b16 a[166:167], v18 offset:7744
buffer_load_dwordx4 v12, s[32:35], s56 offen offset:2048 lds
v_exp_f32 v32, v32
v_exp_f32 v81, v81
v_mfma_f32_32x32x16_bf16 a[96:111], a[172:175], v[136:139], a[96:111]
ds_read_b64_tr_b16 a[168:169], v17 offset:7776
ds_read_b64_tr_b16 a[170:171], v18 offset:7776
v_exp_f32 v33, v33
v_exp_f32 v82, v82
v_mfma_f32_32x32x16_bf16 a[112:127], a[176:179], v[136:139], a[112:127]
ds_read_b64_tr_b16 a[172:173], v17 offset:7808
ds_read_b64_tr_b16 a[174:175], v18 offset:7808
s_waitcnt lgkmcnt(6)
v_exp_f32 v34, v34
v_exp_f32 v83, v83
v_mfma_f32_32x32x16_bf16 a[128:143], a[180:183], v[136:139], a[128:143]
s_waitcnt vmcnt(9)
s_barrier
v_add_u32 v17, 0x5000, v17
v_add_u32 v18, 0x5000, v18
ds_read_b64_tr_b16 a[176:177], v17 offset:0
ds_read_b64_tr_b16 a[178:179], v18 offset:0
v_exp_f32 v35, v35
v_exp_f32 v84, v84
v_mfma_f32_32x32x16_bf16 a[144:159], a[184:187], v[136:139], a[144:159]
ds_read_b64_tr_b16 a[180:181], v17 offset:32
ds_read_b64_tr_b16 a[182:183], v18 offset:32
buffer_load_dwordx4 v13, s[32:35], s56 offen offset:3072 lds
v_exp_f32 v36, v36
v_exp_f32 v85, v85
v_mfma_f32_32x32x16_bf16 a[80:95], a[188:191], v[140:143], a[80:95]
ds_read_b64_tr_b16 a[184:185], v17 offset:64
ds_read_b64_tr_b16 a[186:187], v18 offset:64
v_exp_f32 v37, v37
v_exp_f32 v86, v86
v_mfma_f32_32x32x16_bf16 a[96:111], a[160:163], v[140:143], a[96:111]
ds_read_b64_tr_b16 a[188:189], v17 offset:96
ds_read_b64_tr_b16 a[190:191], v18 offset:96
s_waitcnt lgkmcnt(6)
v_exp_f32 v38, v38
v_exp_f32 v87, v87
v_mfma_f32_32x32x16_bf16 a[112:127], a[164:167], v[140:143], a[112:127]
ds_read_b64_tr_b16 a[160:161], v17 offset:128
ds_read_b64_tr_b16 a[162:163], v18 offset:128
v_exp_f32 v39, v39
v_exp_f32 v88, v88
v_mfma_f32_32x32x16_bf16 a[128:143], a[168:171], v[140:143], a[128:143]
s_add_u32 m0, s97, 0x1000
ds_read_b64_tr_b16 a[164:165], v17 offset:2560
ds_read_b64_tr_b16 a[166:167], v18 offset:2560
buffer_load_dwordx4 v14, s[32:35], s56 offen offset:0 lds
s_add_u32 s56, s56, 0x30000
s_cmp_eq_u32 s56, 0x1e0000
s_cselect_b32 s56, 0, s56
v_exp_f32 v40, v40
v_exp_f32 v89, v89
v_mfma_f32_32x32x16_bf16 a[144:159], a[172:175], v[140:143], a[144:159]
ds_read_b64_tr_b16 a[168:169], v17 offset:2592
ds_read_b64_tr_b16 a[170:171], v18 offset:2592
v_exp_f32 v41, v41
v_exp_f32 v90, v90
v_mfma_f32_32x32x16_bf16 a[80:95], a[176:179], v[144:147], a[80:95]
ds_read_b64_tr_b16 a[172:173], v17 offset:2624
ds_read_b64_tr_b16 a[174:175], v18 offset:2624
s_waitcnt lgkmcnt(6)
v_exp_f32 v42, v42
v_exp_f32 v91, v91
v_mfma_f32_32x32x16_bf16 a[96:111], a[180:183], v[144:147], a[96:111]
ds_read_b64_tr_b16 a[176:177], v17 offset:2656
ds_read_b64_tr_b16 a[178:179], v18 offset:2656
v_exp_f32 v43, v43
v_add_f32 v93, v72, v73
v_add_f32 v94, v24, v25
v_add_f32 v23, v74, v75
v_mfma_f32_32x32x16_bf16 a[112:127], a[184:187], v[144:147], a[112:127]
s_add_u32 m0, s97, 0x5000
ds_read_b64_tr_b16 a[180:181], v17 offset:2688
ds_read_b64_tr_b16 a[182:183], v18 offset:2688
buffer_load_dwordx4 v10, s[32:35], s56 offen offset:0 lds
v_add_f32 v92, v26, v27
v_add_f32 v93, v93, v76
v_add_f32 v94, v94, v28
v_add_f32 v23, v23, v77
v_add_f32 v92, v92, v29
v_mfma_f32_32x32x16_bf16 a[128:143], a[188:191], v[144:147], a[128:143]
ds_read_b64_tr_b16 a[184:185], v17 offset:5120
ds_read_b64_tr_b16 a[186:187], v18 offset:5120
v_add_f32 v93, v93, v78
v_add_f32 v94, v94, v30
v_add_f32 v23, v23, v79
v_add_f32 v92, v92, v31
v_add_f32 v93, v93, v80
v_mfma_f32_32x32x16_bf16 a[144:159], a[160:163], v[144:147], a[144:159]
ds_read_b64_tr_b16 a[188:189], v17 offset:5152
ds_read_b64_tr_b16 a[190:191], v18 offset:5152
s_waitcnt lgkmcnt(6)
v_add_f32 v94, v94, v32
v_add_f32 v23, v23, v81
v_add_f32 v92, v92, v33
v_add_f32 v93, v93, v82
v_add_f32 v94, v94, v34
v_mfma_f32_32x32x16_bf16 a[80:95], a[164:167], v[148:151], a[80:95]
ds_read_b64_tr_b16 a[160:161], v17 offset:5184
ds_read_b64_tr_b16 a[162:163], v18 offset:5184
v_add_f32 v23, v23, v83
v_add_f32 v92, v92, v35
v_add_f32 v93, v93, v84
v_add_f32 v94, v94, v36
v_add_f32 v23, v23, v85
v_mfma_f32_32x32x16_bf16 a[96:111], a[168:171], v[148:151], a[96:111]
ds_read_b64_tr_b16 a[164:165], v17 offset:5216
ds_read_b64_tr_b16 a[166:167], v18 offset:5216
buffer_load_dwordx4 v11, s[32:35], s56 offen offset:1024 lds
v_add_f32 v92, v92, v37
v_add_f32 v93, v93, v86
v_add_f32 v94, v94, v38
v_add_f32 v23, v23, v87
v_add_f32 v92, v92, v39
v_mfma_f32_32x32x16_bf16 a[112:127], a[172:175], v[148:151], a[112:127]
ds_read_b64_tr_b16 a[168:169], v17 offset:5248
ds_read_b64_tr_b16 a[170:171], v18 offset:5248
v_add_f32 v93, v93, v88
v_add_f32 v94, v94, v40
v_add_f32 v23, v23, v89
v_add_f32 v92, v92, v41
v_add_f32 v93, v93, v90
v_mfma_f32_32x32x16_bf16 a[128:143], a[176:179], v[148:151], a[128:143]
ds_read_b64_tr_b16 a[172:173], v17 offset:7680
ds_read_b64_tr_b16 a[174:175], v18 offset:7680
s_waitcnt lgkmcnt(6)
v_add_f32 v94, v94, v42
v_add_f32 v23, v23, v91
v_add_f32 v92, v92, v43
v_add_f32 v93, v93, v23
v_add_f32 v94, v94, v92
v_mfma_f32_32x32x16_bf16 a[144:159], a[180:183], v[148:151], a[144:159]
ds_read_b64_tr_b16 a[176:177], v17 offset:7712
ds_read_b64_tr_b16 a[178:179], v18 offset:7712
v_rcp_f32 v93, v93
v_rcp_f32 v94, v94
v_mul_f32 v72, v93, v72
v_mfma_f32_32x32x16_bf16 a[80:95], a[184:187], v[152:155], a[80:95]
ds_read_b64_tr_b16 a[180:181], v17 offset:7744
ds_read_b64_tr_b16 a[182:183], v18 offset:7744
buffer_load_dwordx4 v12, s[32:35], s56 offen offset:2048 lds
v_mul_f32 v73, v93, v73
v_mul_f32 v74, v93, v74
v_mul_f32 v75, v93, v75
v_mul_f32 v76, v93, v76
v_mul_f32 v77, v93, v77
v_mfma_f32_32x32x16_bf16 a[96:111], a[188:191], v[152:155], a[96:111]
ds_read_b64_tr_b16 a[184:185], v17 offset:7776
ds_read_b64_tr_b16 a[186:187], v18 offset:7776
v_mul_f32 v78, v93, v78
v_mul_f32 v79, v93, v79
v_mul_f32 v80, v93, v80
v_mul_f32 v81, v93, v81
v_mul_f32 v82, v93, v82
v_mfma_f32_32x32x16_bf16 a[112:127], a[160:163], v[152:155], a[112:127]
ds_read_b64_tr_b16 a[188:189], v17 offset:7808
ds_read_b64_tr_b16 a[190:191], v18 offset:7808
s_waitcnt lgkmcnt(6)
v_mul_f32 v83, v93, v83
v_mul_f32 v84, v93, v84
v_mul_f32 v85, v93, v85
v_mul_f32 v86, v93, v86
v_mul_f32 v87, v93, v87
v_mfma_f32_32x32x16_bf16 a[128:143], a[164:167], v[152:155], a[128:143]
s_waitcnt vmcnt(8)
s_barrier
v_add_u32 v17, 0x5000, v17
v_add_u32 v18, 0x5000, v18
ds_read_b64_tr_b16 a[160:161], v17 offset:0
ds_read_b64_tr_b16 a[162:163], v18 offset:0
v_mul_f32 v88, v93, v88
v_mul_f32 v89, v93, v89
v_mul_f32 v90, v93, v90
v_mul_f32 v91, v93, v91
v_mul_f32 v24, v94, v24
v_mfma_f32_32x32x16_bf16 a[144:159], a[168:171], v[152:155], a[144:159]
ds_read_b64_tr_b16 a[164:165], v17 offset:32
ds_read_b64_tr_b16 a[166:167], v18 offset:32
buffer_load_dwordx4 v13, s[32:35], s56 offen offset:3072 lds
v_mul_f32 v25, v94, v25
v_mul_f32 v26, v94, v26
v_mul_f32 v27, v94, v27
v_mul_f32 v28, v94, v28
v_mul_f32 v29, v94, v29
v_mfma_f32_32x32x16_bf16 a[80:95], a[172:175], v[156:159], a[80:95]
ds_read_b64_tr_b16 a[168:169], v17 offset:64
ds_read_b64_tr_b16 a[170:171], v18 offset:64
v_mul_f32 v30, v94, v30
v_mul_f32 v31, v94, v31
v_mul_f32 v32, v94, v32
v_mul_f32 v33, v94, v33
v_mul_f32 v34, v94, v34
v_mfma_f32_32x32x16_bf16 a[96:111], a[176:179], v[156:159], a[96:111]
ds_read_b64_tr_b16 a[172:173], v17 offset:96
ds_read_b64_tr_b16 a[174:175], v18 offset:96
s_waitcnt lgkmcnt(6)
v_mul_f32 v35, v94, v35
v_mul_f32 v36, v94, v36
v_mul_f32 v37, v94, v37
v_mul_f32 v38, v94, v38
v_mul_f32 v39, v94, v39
v_mfma_f32_32x32x16_bf16 a[112:127], a[180:183], v[156:159], a[112:127]
ds_read_b64_tr_b16 a[176:177], v17 offset:128
ds_read_b64_tr_b16 a[178:179], v18 offset:128
v_mul_f32 v40, v94, v40
v_mul_f32 v41, v94, v41
v_mul_f32 v42, v94, v42
v_mul_f32 v43, v94, v43
v_cvt_pk_bf16_f32 v24, v24, v25
v_mfma_f32_32x32x16_bf16 a[128:143], a[184:187], v[156:159], a[128:143]
s_add_u32 m0, s97, 0x6000
ds_read_b64_tr_b16 a[180:181], v17 offset:2560
ds_read_b64_tr_b16 a[182:183], v18 offset:2560
buffer_load_dwordx4 v14, s[32:35], s56 offen offset:0 lds
s_add_u32 s56, s56, 0x30000
s_cmp_eq_u32 s56, 0x1e0000
s_cselect_b32 s56, 0, s56
v_cvt_pk_bf16_f32 v25, v26, v27
v_cvt_pk_bf16_f32 v26, v28, v29
v_cvt_pk_bf16_f32 v27, v30, v31
v_cvt_pk_bf16_f32 v28, v32, v33
v_cvt_pk_bf16_f32 v29, v34, v35
v_mfma_f32_32x32x16_bf16 a[144:159], a[188:191], v[156:159], a[144:159]
ds_read_b64_tr_b16 a[184:185], v17 offset:2592
ds_read_b64_tr_b16 a[186:187], v18 offset:2592
v_cvt_pk_bf16_f32 v30, v36, v37
v_cvt_pk_bf16_f32 v31, v38, v39
v_cvt_pk_bf16_f32 v32, v40, v41
v_cvt_pk_bf16_f32 v33, v42, v43
v_cvt_pk_bf16_f32 v34, v72, v73
v_mfma_f32_32x32x16_bf16 a[80:95], a[160:163], v[160:163], a[80:95]
ds_read_b64_tr_b16 a[188:189], v17 offset:2624
ds_read_b64_tr_b16 a[190:191], v18 offset:2624
s_waitcnt lgkmcnt(6)
v_cvt_pk_bf16_f32 v35, v74, v75
v_cvt_pk_bf16_f32 v36, v76, v77
v_cvt_pk_bf16_f32 v37, v78, v79
v_cvt_pk_bf16_f32 v38, v80, v81
v_cvt_pk_bf16_f32 v39, v82, v83
v_mfma_f32_32x32x16_bf16 a[96:111], a[164:167], v[160:163], a[96:111]
ds_read_b64_tr_b16 a[160:161], v17 offset:2656
ds_read_b64_tr_b16 a[162:163], v18 offset:2656
v_cvt_pk_bf16_f32 v40, v84, v85
v_cvt_pk_bf16_f32 v41, v86, v87
v_cvt_pk_bf16_f32 v42, v88, v89
v_cvt_pk_bf16_f32 v43, v90, v91
v_mfma_f32_32x32x16_bf16 a[112:127], a[168:171], v[160:163], a[112:127]
s_add_u32 m0, s97, 0xa000
ds_read_b64_tr_b16 a[164:165], v17 offset:2688
ds_read_b64_tr_b16 a[166:167], v18 offset:2688
buffer_load_dwordx4 v10, s[32:35], s56 offen offset:0 lds
ds_write_b128 v19, v[24:27] offset:0
ds_write_b128 v19, v[28:31] offset:16
v_mfma_f32_32x32x16_bf16 a[128:143], a[172:175], v[160:163], a[128:143]
ds_read_b64_tr_b16 a[168:169], v17 offset:5120
ds_read_b64_tr_b16 a[170:171], v18 offset:5120
ds_write_b128 v19, v[32:35] offset:32
ds_write_b128 v19, v[36:39] offset:48
v_mfma_f32_32x32x16_bf16 a[144:159], a[176:179], v[160:163], a[144:159]
ds_read_b64_tr_b16 a[172:173], v17 offset:5152
ds_read_b64_tr_b16 a[174:175], v18 offset:5152
s_waitcnt lgkmcnt(10)
ds_write_b128 v19, v[40:43] offset:64
v_max3_f32 v23, v44, v45, v46
v_min3_f32 v92, v44, v45, v46
v_max3_f32 v23, v23, v47, v48
v_min3_f32 v92, v92, v47, v48
v_max3_f32 v23, v23, v49, v50
v_mfma_f32_32x32x16_bf16 a[80:95], a[180:183], v[164:167], a[80:95]
ds_read_b64_tr_b16 a[176:177], v17 offset:5184
ds_read_b64_tr_b16 a[178:179], v18 offset:5184
v_min3_f32 v92, v92, v49, v50
v_max3_f32 v23, v23, v51, v52
v_min3_f32 v92, v92, v51, v52
v_max3_f32 v23, v23, v53, v54
v_min3_f32 v92, v92, v53, v54
v_mfma_f32_32x32x16_bf16 a[96:111], a[184:187], v[164:167], a[96:111]
ds_read_b64_tr_b16 a[180:181], v17 offset:5216
ds_read_b64_tr_b16 a[182:183], v18 offset:5216
buffer_load_dwordx4 v11, s[32:35], s56 offen offset:1024 lds
v_max3_f32 v23, v23, v55, v56
v_min3_f32 v92, v92, v55, v56
v_max3_f32 v23, v23, v57, v58
v_min3_f32 v92, v92, v57, v58
v_max3_f32 v23, v23, v59, v60
v_mfma_f32_32x32x16_bf16 a[112:127], a[188:191], v[164:167], a[112:127]
ds_read_b64_tr_b16 a[184:185], v17 offset:5248
ds_read_b64_tr_b16 a[186:187], v18 offset:5248
v_min3_f32 v92, v92, v59, v60
v_max3_f32 v23, v23, v61, v62
v_min3_f32 v92, v92, v61, v62
v_max_f32 v23, v23, v63
v_min_f32 v92, v92, v63
v_mfma_f32_32x32x16_bf16 a[128:143], a[160:163], v[164:167], a[128:143]
ds_read_b64_tr_b16 a[188:189], v17 offset:7680
ds_read_b64_tr_b16 a[190:191], v18 offset:7680
s_waitcnt lgkmcnt(6)
v_mul_f32 v23, s62, v23
v_mul_f32 v92, s62, v92
v_fma_f32 v72, v44, s62, -v23
v_fma_f32 v44, -v44, s62, v92
v_fma_f32 v73, v45, s62, -v23
v_mfma_f32_32x32x16_bf16 a[144:159], a[164:167], v[164:167], a[144:159]
ds_read_b64_tr_b16 a[160:161], v17 offset:7712
ds_read_b64_tr_b16 a[162:163], v18 offset:7712
v_fma_f32 v45, -v45, s62, v92
v_fma_f32 v74, v46, s62, -v23
v_fma_f32 v46, -v46, s62, v92
v_fma_f32 v75, v47, s62, -v23
v_fma_f32 v47, -v47, s62, v92
v_mfma_f32_32x32x16_bf16 a[80:95], a[168:171], v[168:171], a[80:95]
ds_read_b64_tr_b16 a[164:165], v17 offset:7744
ds_read_b64_tr_b16 a[166:167], v18 offset:7744
buffer_load_dwordx4 v12, s[32:35], s56 offen offset:2048 lds
v_fma_f32 v76, v48, s62, -v23
v_fma_f32 v48, -v48, s62, v92
v_fma_f32 v77, v49, s62, -v23
v_fma_f32 v49, -v49, s62, v92
v_fma_f32 v78, v50, s62, -v23
v_mfma_f32_32x32x16_bf16 a[96:111], a[172:175], v[168:171], a[96:111]
ds_read_b64_tr_b16 a[168:169], v17 offset:7776
ds_read_b64_tr_b16 a[170:171], v18 offset:7776
v_fma_f32 v50, -v50, s62, v92
v_fma_f32 v79, v51, s62, -v23
v_fma_f32 v51, -v51, s62, v92
v_fma_f32 v80, v52, s62, -v23
v_fma_f32 v52, -v52, s62, v92
v_mfma_f32_32x32x16_bf16 a[112:127], a[176:179], v[168:171], a[112:127]
ds_read_b64_tr_b16 a[172:173], v17 offset:7808
ds_read_b64_tr_b16 a[174:175], v18 offset:7808
s_waitcnt lgkmcnt(6)
v_fma_f32 v81, v53, s62, -v23
v_fma_f32 v53, -v53, s62, v92
v_fma_f32 v82, v54, s62, -v23
v_fma_f32 v54, -v54, s62, v92
v_fma_f32 v83, v55, s62, -v23
v_mfma_f32_32x32x16_bf16 a[128:143], a[180:183], v[168:171], a[128:143]
s_waitcnt vmcnt(8)
s_barrier
v_add_u32 v17, 0xfffec000, v17
v_add_u32 v18, 0xfffec000, v18
ds_read_b64_tr_b16 a[176:177], v17 offset:0
ds_read_b64_tr_b16 a[178:179], v18 offset:0
v_fma_f32 v55, -v55, s62, v92
v_fma_f32 v84, v56, s62, -v23
v_fma_f32 v56, -v56, s62, v92
v_fma_f32 v85, v57, s62, -v23
v_fma_f32 v57, -v57, s62, v92
v_mfma_f32_32x32x16_bf16 a[144:159], a[184:187], v[168:171], a[144:159]
ds_read_b64_tr_b16 a[180:181], v17 offset:32
ds_read_b64_tr_b16 a[182:183], v18 offset:32
buffer_load_dwordx4 v13, s[32:35], s56 offen offset:3072 lds
v_fma_f32 v86, v58, s62, -v23
v_fma_f32 v58, -v58, s62, v92
v_fma_f32 v87, v59, s62, -v23
v_fma_f32 v59, -v59, s62, v92
v_fma_f32 v88, v60, s62, -v23
v_mfma_f32_32x32x16_bf16 a[80:95], a[188:191], v[172:175], a[80:95]
ds_read_b64_tr_b16 a[184:185], v17 offset:64
ds_read_b64_tr_b16 a[186:187], v18 offset:64
v_fma_f32 v60, -v60, s62, v92
v_fma_f32 v89, v61, s62, -v23
v_fma_f32 v61, -v61, s62, v92
v_fma_f32 v90, v62, s62, -v23
v_fma_f32 v62, -v62, s62, v92
v_mfma_f32_32x32x16_bf16 a[96:111], a[160:163], v[172:175], a[96:111]
ds_read_b64_tr_b16 a[188:189], v17 offset:96
ds_read_b64_tr_b16 a[190:191], v18 offset:96
s_waitcnt lgkmcnt(6)
v_fma_f32 v91, v63, s62, -v23
v_fma_f32 v63, -v63, s62, v92
v_exp_f32 v72, v72
v_mfma_f32_32x32x16_bf16 a[112:127], a[164:167], v[172:175], a[112:127]
ds_read_b64_tr_b16 a[160:161], v17 offset:128
ds_read_b64_tr_b16 a[162:163], v18 offset:128
v_exp_f32 v44, v44
v_exp_f32 v73, v73
v_mfma_f32_32x32x16_bf16 a[128:143], a[168:171], v[172:175], a[128:143]
s_add_u32 m0, s97, 0xb000
ds_read_b64_tr_b16 a[164:165], v17 offset:2560
ds_read_b64_tr_b16 a[166:167], v18 offset:2560
buffer_load_dwordx4 v14, s[32:35], s56 offen offset:0 lds
s_add_u32 s56, s56, 0x30000
s_cmp_eq_u32 s56, 0x1e0000
s_cselect_b32 s56, 0, s56
v_exp_f32 v45, v45
v_exp_f32 v74, v74
v_mfma_f32_32x32x16_bf16 a[144:159], a[172:175], v[172:175], a[144:159]
ds_read_b64_tr_b16 a[168:169], v17 offset:2592
ds_read_b64_tr_b16 a[170:171], v18 offset:2592
v_exp_f32 v46, v46
v_exp_f32 v75, v75
v_mfma_f32_32x32x16_bf16 a[80:95], a[176:179], v[176:179], a[80:95]
ds_read_b64_tr_b16 a[172:173], v17 offset:2624
ds_read_b64_tr_b16 a[174:175], v18 offset:2624
s_waitcnt lgkmcnt(6)
v_exp_f32 v47, v47
v_exp_f32 v76, v76
v_mfma_f32_32x32x16_bf16 a[96:111], a[180:183], v[176:179], a[96:111]
ds_read_b64_tr_b16 a[176:177], v17 offset:2656
ds_read_b64_tr_b16 a[178:179], v18 offset:2656
v_exp_f32 v48, v48
v_exp_f32 v77, v77
v_mfma_f32_32x32x16_bf16 a[112:127], a[184:187], v[176:179], a[112:127]
s_add_u32 m0, s97, 0xf000
ds_read_b64_tr_b16 a[180:181], v17 offset:2688
ds_read_b64_tr_b16 a[182:183], v18 offset:2688
buffer_load_dwordx4 v10, s[32:35], s56 offen offset:0 lds
v_exp_f32 v49, v49
v_exp_f32 v78, v78
v_mfma_f32_32x32x16_bf16 a[128:143], a[188:191], v[176:179], a[128:143]
ds_read_b64_tr_b16 a[184:185], v17 offset:5120
ds_read_b64_tr_b16 a[186:187], v18 offset:5120
v_exp_f32 v50, v50
v_exp_f32 v79, v79
v_mfma_f32_32x32x16_bf16 a[144:159], a[160:163], v[176:179], a[144:159]
ds_read_b64_tr_b16 a[188:189], v17 offset:5152
ds_read_b64_tr_b16 a[190:191], v18 offset:5152
s_waitcnt lgkmcnt(6)
v_exp_f32 v51, v51
v_exp_f32 v80, v80
v_mfma_f32_32x32x16_bf16 a[80:95], a[164:167], v[180:183], a[80:95]
ds_read_b64_tr_b16 a[160:161], v17 offset:5184
ds_read_b64_tr_b16 a[162:163], v18 offset:5184
v_exp_f32 v52, v52
v_exp_f32 v81, v81
v_mfma_f32_32x32x16_bf16 a[96:111], a[168:171], v[180:183], a[96:111]
ds_read_b64_tr_b16 a[164:165], v17 offset:5216
ds_read_b64_tr_b16 a[166:167], v18 offset:5216
buffer_load_dwordx4 v11, s[32:35], s56 offen offset:1024 lds
v_exp_f32 v53, v53
v_exp_f32 v82, v82
v_mfma_f32_32x32x16_bf16 a[112:127], a[172:175], v[180:183], a[112:127]
ds_read_b64_tr_b16 a[168:169], v17 offset:5248
ds_read_b64_tr_b16 a[170:171], v18 offset:5248
v_exp_f32 v54, v54
v_exp_f32 v83, v83
v_mfma_f32_32x32x16_bf16 a[128:143], a[176:179], v[180:183], a[128:143]
ds_read_b64_tr_b16 a[172:173], v17 offset:7680
ds_read_b64_tr_b16 a[174:175], v18 offset:7680
s_waitcnt lgkmcnt(6)
v_exp_f32 v55, v55
v_exp_f32 v84, v84
v_mfma_f32_32x32x16_bf16 a[144:159], a[180:183], v[180:183], a[144:159]
ds_read_b64_tr_b16 a[176:177], v17 offset:7712
ds_read_b64_tr_b16 a[178:179], v18 offset:7712
v_exp_f32 v56, v56
v_exp_f32 v85, v85
v_mfma_f32_32x32x16_bf16 a[80:95], a[184:187], v[184:187], a[80:95]
ds_read_b64_tr_b16 a[180:181], v17 offset:7744
ds_read_b64_tr_b16 a[182:183], v18 offset:7744
buffer_load_dwordx4 v12, s[32:35], s56 offen offset:2048 lds
v_exp_f32 v57, v57
v_exp_f32 v86, v86
v_mfma_f32_32x32x16_bf16 a[96:111], a[188:191], v[184:187], a[96:111]
ds_read_b64_tr_b16 a[184:185], v17 offset:7776
ds_read_b64_tr_b16 a[186:187], v18 offset:7776
v_exp_f32 v58, v58
v_exp_f32 v87, v87
v_mfma_f32_32x32x16_bf16 a[112:127], a[160:163], v[184:187], a[112:127]
ds_read_b64_tr_b16 a[188:189], v17 offset:7808
ds_read_b64_tr_b16 a[190:191], v18 offset:7808
s_waitcnt lgkmcnt(6)
v_exp_f32 v59, v59
v_exp_f32 v88, v88
v_mfma_f32_32x32x16_bf16 a[128:143], a[164:167], v[184:187], a[128:143]
s_waitcnt vmcnt(8)
s_barrier
v_add_u32 v17, 0x5000, v17
v_add_u32 v18, 0x5000, v18
ds_read_b64_tr_b16 a[160:161], v17 offset:0
ds_read_b64_tr_b16 a[162:163], v18 offset:0
v_exp_f32 v60, v60
v_exp_f32 v89, v89
v_mfma_f32_32x32x16_bf16 a[144:159], a[168:171], v[184:187], a[144:159]
ds_read_b64_tr_b16 a[164:165], v17 offset:32
ds_read_b64_tr_b16 a[166:167], v18 offset:32
buffer_load_dwordx4 v13, s[32:35], s56 offen offset:3072 lds
v_exp_f32 v61, v61
v_exp_f32 v90, v90
v_mfma_f32_32x32x16_bf16 a[80:95], a[172:175], v[188:191], a[80:95]
ds_read_b64_tr_b16 a[168:169], v17 offset:64
ds_read_b64_tr_b16 a[170:171], v18 offset:64
v_exp_f32 v62, v62
v_exp_f32 v91, v91
v_mfma_f32_32x32x16_bf16 a[96:111], a[176:179], v[188:191], a[96:111]
ds_read_b64_tr_b16 a[172:173], v17 offset:96
ds_read_b64_tr_b16 a[174:175], v18 offset:96
s_waitcnt lgkmcnt(6)
v_exp_f32 v63, v63
v_add_f32 v93, v72, v73
v_add_f32 v94, v44, v45
v_add_f32 v23, v74, v75
v_mfma_f32_32x32x16_bf16 a[112:127], a[180:183], v[188:191], a[112:127]
ds_read_b64_tr_b16 a[176:177], v17 offset:128
ds_read_b64_tr_b16 a[178:179], v18 offset:128
v_add_f32 v92, v46, v47
v_add_f32 v93, v93, v76
v_add_f32 v94, v94, v48
v_add_f32 v23, v23, v77
v_add_f32 v92, v92, v49
v_mfma_f32_32x32x16_bf16 a[128:143], a[184:187], v[188:191], a[128:143]
s_add_u32 m0, s97, 0x10000
ds_read_b64_tr_b16 a[180:181], v17 offset:2560
ds_read_b64_tr_b16 a[182:183], v18 offset:2560
buffer_load_dwordx4 v14, s[32:35], s56 offen offset:0 lds
s_add_u32 s56, s56, 0x30000
s_cmp_eq_u32 s56, 0x1e0000
s_cselect_b32 s56, 0, s56
v_add_f32 v93, v93, v78
v_add_f32 v94, v94, v50
v_add_f32 v23, v23, v79
v_add_f32 v92, v92, v51
v_add_f32 v93, v93, v80
v_mfma_f32_32x32x16_bf16 a[144:159], a[188:191], v[188:191], a[144:159]
ds_read_b64_tr_b16 a[184:185], v17 offset:2592
ds_read_b64_tr_b16 a[186:187], v18 offset:2592
v_add_f32 v94, v94, v52
v_add_f32 v23, v23, v81
v_add_f32 v92, v92, v53
v_add_f32 v93, v93, v82
v_add_f32 v94, v94, v54
v_mfma_f32_32x32x16_bf16 a[80:95], a[160:163], v[192:195], a[80:95]
ds_read_b64_tr_b16 a[188:189], v17 offset:2624
ds_read_b64_tr_b16 a[190:191], v18 offset:2624
s_waitcnt lgkmcnt(6)
v_add_f32 v23, v23, v83
v_add_f32 v92, v92, v55
v_add_f32 v93, v93, v84
v_add_f32 v94, v94, v56
v_add_f32 v23, v23, v85
v_mfma_f32_32x32x16_bf16 a[96:111], a[164:167], v[192:195], a[96:111]
ds_read_b64_tr_b16 a[160:161], v17 offset:2656
ds_read_b64_tr_b16 a[162:163], v18 offset:2656
v_add_f32 v92, v92, v57
v_add_f32 v93, v93, v86
v_add_f32 v94, v94, v58
v_add_f32 v23, v23, v87
v_add_f32 v92, v92, v59
v_mfma_f32_32x32x16_bf16 a[112:127], a[168:171], v[192:195], a[112:127]
s_add_u32 m0, s97, 0x14000
ds_read_b64_tr_b16 a[164:165], v17 offset:2688
ds_read_b64_tr_b16 a[166:167], v18 offset:2688
buffer_load_dwordx4 v10, s[32:35], s56 offen offset:0 lds
v_add_f32 v93, v93, v88
v_add_f32 v94, v94, v60
v_add_f32 v23, v23, v89
v_add_f32 v92, v92, v61
v_add_f32 v93, v93, v90
v_mfma_f32_32x32x16_bf16 a[128:143], a[172:175], v[192:195], a[128:143]
ds_read_b64_tr_b16 a[168:169], v17 offset:5120
ds_read_b64_tr_b16 a[170:171], v18 offset:5120
v_add_f32 v94, v94, v62
v_add_f32 v23, v23, v91
v_add_f32 v92, v92, v63
v_add_f32 v93, v93, v23
v_add_f32 v94, v94, v92
v_mfma_f32_32x32x16_bf16 a[144:159], a[176:179], v[192:195], a[144:159]
ds_read_b64_tr_b16 a[172:173], v17 offset:5152
ds_read_b64_tr_b16 a[174:175], v18 offset:5152
s_waitcnt lgkmcnt(6)
v_rcp_f32 v93, v93
v_rcp_f32 v94, v94
v_mul_f32 v72, v93, v72
v_mfma_f32_32x32x16_bf16 a[80:95], a[180:183], v[196:199], a[80:95]
ds_read_b64_tr_b16 a[176:177], v17 offset:5184
ds_read_b64_tr_b16 a[178:179], v18 offset:5184
v_mul_f32 v73, v93, v73
v_mul_f32 v74, v93, v74
v_mul_f32 v75, v93, v75
v_mul_f32 v76, v93, v76
v_mul_f32 v77, v93, v77
v_mfma_f32_32x32x16_bf16 a[96:111], a[184:187], v[196:199], a[96:111]
ds_read_b64_tr_b16 a[180:181], v17 offset:5216
ds_read_b64_tr_b16 a[182:183], v18 offset:5216
buffer_load_dwordx4 v11, s[32:35], s56 offen offset:1024 lds
v_mul_f32 v78, v93, v78
v_mul_f32 v79, v93, v79
v_mul_f32 v80, v93, v80
v_mul_f32 v81, v93, v81
v_mul_f32 v82, v93, v82
v_mfma_f32_32x32x16_bf16 a[112:127], a[188:191], v[196:199], a[112:127]
ds_read_b64_tr_b16 a[184:185], v17 offset:5248
ds_read_b64_tr_b16 a[186:187], v18 offset:5248
v_mul_f32 v83, v93, v83
v_mul_f32 v84, v93, v84
v_mul_f32 v85, v93, v85
v_mul_f32 v86, v93, v86
v_mul_f32 v87, v93, v87
v_mfma_f32_32x32x16_bf16 a[128:143], a[160:163], v[196:199], a[128:143]
ds_read_b64_tr_b16 a[188:189], v17 offset:7680
ds_read_b64_tr_b16 a[190:191], v18 offset:7680
s_waitcnt lgkmcnt(6)
v_mul_f32 v88, v93, v88
v_mul_f32 v89, v93, v89
v_mul_f32 v90, v93, v90
v_mul_f32 v91, v93, v91
v_mul_f32 v44, v94, v44
v_mfma_f32_32x32x16_bf16 a[144:159], a[164:167], v[196:199], a[144:159]
ds_read_b64_tr_b16 a[160:161], v17 offset:7712
ds_read_b64_tr_b16 a[162:163], v18 offset:7712
v_mul_f32 v45, v94, v45
v_mul_f32 v46, v94, v46
v_mul_f32 v47, v94, v47
v_mul_f32 v48, v94, v48
v_mul_f32 v49, v94, v49
v_mfma_f32_32x32x16_bf16 a[80:95], a[168:171], v[200:203], a[80:95]
ds_read_b64_tr_b16 a[164:165], v17 offset:7744
ds_read_b64_tr_b16 a[166:167], v18 offset:7744
buffer_load_dwordx4 v12, s[32:35], s56 offen offset:2048 lds
v_mul_f32 v50, v94, v50
v_mul_f32 v51, v94, v51
v_mul_f32 v52, v94, v52
v_mul_f32 v53, v94, v53
v_mul_f32 v54, v94, v54
v_mfma_f32_32x32x16_bf16 a[96:111], a[172:175], v[200:203], a[96:111]
ds_read_b64_tr_b16 a[168:169], v17 offset:7776
ds_read_b64_tr_b16 a[170:171], v18 offset:7776
v_mul_f32 v55, v94, v55
v_mul_f32 v56, v94, v56
v_mul_f32 v57, v94, v57
v_mul_f32 v58, v94, v58
v_mul_f32 v59, v94, v59
v_mfma_f32_32x32x16_bf16 a[112:127], a[176:179], v[200:203], a[112:127]
ds_read_b64_tr_b16 a[172:173], v17 offset:7808
ds_read_b64_tr_b16 a[174:175], v18 offset:7808
s_waitcnt lgkmcnt(6)
v_mul_f32 v60, v94, v60
v_mul_f32 v61, v94, v61
v_mul_f32 v62, v94, v62
v_mul_f32 v63, v94, v63
v_cvt_pk_bf16_f32 v44, v44, v45
v_mfma_f32_32x32x16_bf16 a[128:143], a[180:183], v[200:203], a[128:143]
s_waitcnt vmcnt(8)
s_barrier
v_add_u32 v17, 0x5000, v17
v_add_u32 v18, 0x5000, v18
ds_read_b64_tr_b16 a[176:177], v17 offset:0
ds_read_b64_tr_b16 a[178:179], v18 offset:0
v_cvt_pk_bf16_f32 v45, v46, v47
v_cvt_pk_bf16_f32 v46, v48, v49
v_cvt_pk_bf16_f32 v47, v50, v51
v_cvt_pk_bf16_f32 v48, v52, v53
v_cvt_pk_bf16_f32 v49, v54, v55
v_mfma_f32_32x32x16_bf16 a[144:159], a[184:187], v[200:203], a[144:159]
ds_read_b64_tr_b16 a[180:181], v17 offset:32
ds_read_b64_tr_b16 a[182:183], v18 offset:32
buffer_load_dwordx4 v13, s[32:35], s56 offen offset:3072 lds
v_cvt_pk_bf16_f32 v50, v56, v57
v_cvt_pk_bf16_f32 v51, v58, v59
v_cvt_pk_bf16_f32 v52, v60, v61
v_cvt_pk_bf16_f32 v53, v62, v63
v_cvt_pk_bf16_f32 v54, v72, v73
v_mfma_f32_32x32x16_bf16 a[80:95], a[188:191], v[204:207], a[80:95]
ds_read_b64_tr_b16 a[184:185], v17 offset:64
ds_read_b64_tr_b16 a[186:187], v18 offset:64
v_cvt_pk_bf16_f32 v55, v74, v75
v_cvt_pk_bf16_f32 v56, v76, v77
v_cvt_pk_bf16_f32 v57, v78, v79
v_cvt_pk_bf16_f32 v58, v80, v81
v_cvt_pk_bf16_f32 v59, v82, v83
v_mfma_f32_32x32x16_bf16 a[96:111], a[160:163], v[204:207], a[96:111]
ds_read_b64_tr_b16 a[188:189], v17 offset:96
ds_read_b64_tr_b16 a[190:191], v18 offset:96
s_waitcnt lgkmcnt(6)
v_cvt_pk_bf16_f32 v60, v84, v85
v_cvt_pk_bf16_f32 v61, v86, v87
v_cvt_pk_bf16_f32 v62, v88, v89
v_cvt_pk_bf16_f32 v63, v90, v91
v_lshrrev_b32 v8, 4, v1
v_mfma_f32_32x32x16_bf16 a[112:127], a[164:167], v[204:207], a[112:127]
ds_read_b64_tr_b16 a[160:161], v17 offset:128
ds_read_b64_tr_b16 a[162:163], v18 offset:128
v_bfe_u32 v9, v1, 2, 2
v_lshl_add_u32 v8, v8, 3, v9
v_and_b32 v9, 3, v1
v_lshlrev_b32 v9, 3, v9
v_mul_u32_u24 v7, 0x50, v8
s_mul_i32 s4, s52, 0x2800
s_add_u32 s4, s4, 0x19000
v_mfma_f32_32x32x16_bf16 a[128:143], a[168:171], v[204:207], a[128:143]
s_add_u32 m0, s97, 0x15000
ds_read_b64_tr_b16 a[164:165], v17 offset:2560
ds_read_b64_tr_b16 a[166:167], v18 offset:2560
buffer_load_dwordx4 v14, s[32:35], s56 offen offset:0 lds
s_add_u32 s56, s56, 0x30000
s_cmp_eq_u32 s56, 0x1e0000
s_cselect_b32 s56, 0, s56
v_add3_u32 v5, v7, v9, s4
v_mfma_f32_32x32x16_bf16 a[144:159], a[172:175], v[204:207], a[144:159]
ds_read_b64_tr_b16 a[168:169], v17 offset:2592
ds_read_b64_tr_b16 a[170:171], v18 offset:2592
s_lshr_b32 s5, s52, 1
s_mul_i32 s5, s5, 0x2800
s_and_b32 s4, s52, 1
s_mul_i32 s4, s4, 40
s_add_u32 s5, s5, s4
s_add_u32 s5, s5, 0x23000
v_add3_u32 v6, v7, v9, s5
v_add_u32 v7, s5, v7
v_add_u32 v7, 32, v7
v_and_b32 v8, 15, v1
v_cmp_eq_u32 s[6:7], 4, v8
v_mfma_f32_32x32x16_bf16 a[80:95], a[176:179], v[208:211], a[80:95]
ds_read_b64_tr_b16 a[172:173], v17 offset:2624
ds_read_b64_tr_b16 a[174:175], v18 offset:2624
s_waitcnt lgkmcnt(6)
v_mov_b32 v9, 0x3f803f80
v_mfma_f32_32x32x16_bf16 a[96:111], a[180:183], v[208:211], a[96:111]
ds_read_b64_tr_b16 a[176:177], v17 offset:2656
ds_read_b64_tr_b16 a[178:179], v18 offset:2656
ds_write_b128 v19, v[44:47] offset:10240
ds_write_b128 v19, v[48:51] offset:10256
v_mfma_f32_32x32x16_bf16 a[112:127], a[184:187], v[208:211], a[112:127]
ds_read_b64_tr_b16 a[180:181], v17 offset:2688
ds_read_b64_tr_b16 a[182:183], v18 offset:2688
ds_write_b128 v19, v[52:55] offset:10272
ds_write_b128 v19, v[56:59] offset:10288
v_mfma_f32_32x32x16_bf16 a[128:143], a[188:191], v[208:211], a[128:143]
ds_read_b64_tr_b16 a[184:185], v17 offset:5120
ds_read_b64_tr_b16 a[186:187], v18 offset:5120
ds_write_b128 v19, v[60:63] offset:10304
v_cmp_eq_u32 vcc, 1, v15
s_nop 3
s_cmp_eq_u64 vcc, -1
s_cbranch_scc1 X_z_ok
s_mov_b32 s60, 0
X_z_spin:
s_add_u32 s60, s60, 1
s_cmp_ge_u32 s60, 0x40000
s_cbranch_scc1 X_z_ok
s_sleep 16
buffer_load_dword v15, v16, s[48:51], s63 offen offset:0 sc1
s_waitcnt vmcnt(0)
v_cmp_eq_u32 vcc, 1, v15
s_nop 3
s_cmp_eq_u64 vcc, -1
s_cbranch_scc0 X_z_spin
X_z_ok:
s_waitcnt lgkmcnt(0)
s_barrier
ds_read_b64_tr_b16 v[48:49], v5 offset:0
ds_read_b64_tr_b16 v[52:53], v5 offset:32
ds_read_b64_tr_b16 v[56:57], v5 offset:64
ds_read_b64_tr_b16 v[72:73], v6 offset:0
ds_read_b64_tr_b16 v[76:77], v7 offset:0
ds_read_b64_tr_b16 v[50:51], v5 offset:320
ds_read_b64_tr_b16 v[54:55], v5 offset:352
ds_read_b64_tr_b16 v[58:59], v5 offset:384
ds_read_b64_tr_b16 v[74:75], v6 offset:320
ds_read_b64_tr_b16 v[78:79], v7 offset:320
ds_read_b64_tr_b16 v[60:61], v5 offset:2560
ds_read_b64_tr_b16 v[64:65], v5 offset:2592
ds_read_b64_tr_b16 v[68:69], v5 offset:2624
ds_read_b64_tr_b16 v[80:81], v6 offset:2560
ds_read_b64_tr_b16 v[84:85], v7 offset:2560
ds_read_b64_tr_b16 v[62:63], v5 offset:2880
ds_read_b64_tr_b16 v[66:67], v5 offset:2912
ds_read_b64_tr_b16 v[70:71], v5 offset:2944
ds_read_b64_tr_b16 v[82:83], v6 offset:2880
ds_read_b64_tr_b16 v[86:87], v7 offset:2880
s_waitcnt lgkmcnt(15)
v_cndmask_b32 v76, v76, v9, s[6:7]
v_cndmask_b32 v77, v77, v9, s[6:7]
s_waitcnt lgkmcnt(10)
v_cndmask_b32 v78, v78, v9, s[6:7]
v_cndmask_b32 v79, v79, v9, s[6:7]
v_mfma_f32_16x16x32_bf16 v[24:27], v[48:51], v[72:75], 0
v_mfma_f32_16x16x32_bf16 v[28:31], v[52:55], v[72:75], 0
v_mfma_f32_16x16x32_bf16 v[32:35], v[56:59], v[72:75], 0
v_mfma_f32_16x16x32_bf16 v[36:39], v[48:51], v[76:79], 0
v_mfma_f32_16x16x32_bf16 v[40:43], v[52:55], v[76:79], 0
v_mfma_f32_16x16x32_bf16 v[44:47], v[56:59], v[76:79], 0
ds_read_b64_tr_b16 v[48:49], v5 offset:5120
ds_read_b64_tr_b16 v[52:53], v5 offset:5152
ds_read_b64_tr_b16 v[56:57], v5 offset:5184
ds_read_b64_tr_b16 v[72:73], v6 offset:5120
ds_read_b64_tr_b16 v[76:77], v7 offset:5120
ds_read_b64_tr_b16 v[50:51], v5 offset:5440
ds_read_b64_tr_b16 v[54:55], v5 offset:5472
ds_read_b64_tr_b16 v[58:59], v5 offset:5504
ds_read_b64_tr_b16 v[74:75], v6 offset:5440
ds_read_b64_tr_b16 v[78:79], v7 offset:5440
s_waitcnt lgkmcnt(15)
v_cndmask_b32 v84, v84, v9, s[6:7]
v_cndmask_b32 v85, v85, v9, s[6:7]
s_waitcnt lgkmcnt(10)
v_cndmask_b32 v86, v86, v9, s[6:7]
v_cndmask_b32 v87, v87, v9, s[6:7]
v_mfma_f32_16x16x32_bf16 v[24:27], v[60:63], v[80:83], v[24:27]
v_mfma_f32_16x16x32_bf16 v[28:31], v[64:67], v[80:83], v[28:31]
v_mfma_f32_16x16x32_bf16 v[32:35], v[68:71], v[80:83], v[32:35]
v_mfma_f32_16x16x32_bf16 v[36:39], v[60:63], v[84:87], v[36:39]
v_mfma_f32_16x16x32_bf16 v[40:43], v[64:67], v[84:87], v[40:43]
v_mfma_f32_16x16x32_bf16 v[44:47], v[68:71], v[84:87], v[44:47]
ds_read_b64_tr_b16 v[60:61], v5 offset:7680
ds_read_b64_tr_b16 v[64:65], v5 offset:7712
ds_read_b64_tr_b16 v[68:69], v5 offset:7744
ds_read_b64_tr_b16 v[80:81], v6 offset:7680
ds_read_b64_tr_b16 v[84:85], v7 offset:7680
ds_read_b64_tr_b16 v[62:63], v5 offset:8000
ds_read_b64_tr_b16 v[66:67], v5 offset:8032
ds_read_b64_tr_b16 v[70:71], v5 offset:8064
ds_read_b64_tr_b16 v[82:83], v6 offset:8000
ds_read_b64_tr_b16 v[86:87], v7 offset:8000
s_waitcnt lgkmcnt(15)
v_cndmask_b32 v76, v76, v9, s[6:7]
v_cndmask_b32 v77, v77, v9, s[6:7]
s_waitcnt lgkmcnt(10)
v_cndmask_b32 v78, v78, v9, s[6:7]
v_cndmask_b32 v79, v79, v9, s[6:7]
v_mfma_f32_16x16x32_bf16 v[24:27], v[48:51], v[72:75], v[24:27]
v_mfma_f32_16x16x32_bf16 v[28:31], v[52:55], v[72:75], v[28:31]
v_mfma_f32_16x16x32_bf16 v[32:35], v[56:59], v[72:75], v[32:35]
v_mfma_f32_16x16x32_bf16 v[36:39], v[48:51], v[76:79], v[36:39]
v_mfma_f32_16x16x32_bf16 v[40:43], v[52:55], v[76:79], v[40:43]
v_mfma_f32_16x16x32_bf16 v[44:47], v[56:59], v[76:79], v[44:47]
s_waitcnt lgkmcnt(5)
v_cndmask_b32 v84, v84, v9, s[6:7]
v_cndmask_b32 v85, v85, v9, s[6:7]
s_waitcnt lgkmcnt(0)
v_cndmask_b32 v86, v86, v9, s[6:7]
v_cndmask_b32 v87, v87, v9, s[6:7]
v_mfma_f32_16x16x32_bf16 v[24:27], v[60:63], v[80:83], v[24:27]
v_mfma_f32_16x16x32_bf16 v[28:31], v[64:67], v[80:83], v[28:31]
v_mfma_f32_16x16x32_bf16 v[32:35], v[68:71], v[80:83], v[32:35]
v_mfma_f32_16x16x32_bf16 v[36:39], v[60:63], v[84:87], v[36:39]
v_mfma_f32_16x16x32_bf16 v[40:43], v[64:67], v[84:87], v[40:43]
v_mfma_f32_16x16x32_bf16 v[44:47], v[68:71], v[84:87], v[44:47]
v_mfma_f32_32x32x16_bf16 a[144:159], a[160:163], v[208:211], a[144:159]
ds_read_b64_tr_b16 a[188:189], v17 offset:5152
ds_read_b64_tr_b16 a[190:191], v18 offset:5152
s_lshl_b32 s8, s54, 2
s_add_u32 s8, s8, s52
s_mul_i32 s8, s8, 0xf00
s_add_u32 s8, s8, 0xb28000
s_mul_i32 s9, s52, 0x2800
s_add_u32 s9, s9, 0x19000
v_and_b32 v5, 15, v1
v_mul_u32_u24 v5, 0xa0, v5
v_lshrrev_b32 v6, 4, v1
v_lshl_add_u32 v5, v6, 4, v5
v_add_u32 v5, s9, v5
v_mfma_f32_32x32x16_bf16 a[80:95], a[164:167], v[212:215], a[80:95]
ds_read_b64_tr_b16 a[160:161], v17 offset:5184
ds_read_b64_tr_b16 a[162:163], v18 offset:5184
v_add_u32 v6, s9, v4
v_mfma_f32_32x32x16_bf16 a[96:111], a[168:171], v[212:215], a[96:111]
ds_read_b64_tr_b16 a[164:165], v17 offset:5216
ds_read_b64_tr_b16 a[166:167], v18 offset:5216
ds_write_b128 v5, v[24:27] offset:0
ds_write_b128 v5, v[28:31] offset:64
v_mfma_f32_32x32x16_bf16 a[112:127], a[172:175], v[212:215], a[112:127]
ds_read_b64_tr_b16 a[168:169], v17 offset:5248
ds_read_b64_tr_b16 a[170:171], v18 offset:5248
s_mov_b32 s100, 0xffffffff
s_mov_b32 s101, 0
s_mov_b64 exec, s[100:101]
ds_write_b128 v5, v[32:35] offset:128
s_mov_b64 exec, -1
s_mov_b32 s100, 0x1f001f
s_mov_b32 s101, 0x1f001f
s_mov_b64 exec, s[100:101]
ds_write_b128 v5, v[36:39] offset:2560
s_mov_b64 exec, -1
v_mfma_f32_32x32x16_bf16 a[128:143], a[176:179], v[212:215], a[128:143]
ds_read_b64_tr_b16 a[172:173], v17 offset:7680
ds_read_b64_tr_b16 a[174:175], v18 offset:7680
s_waitcnt lgkmcnt(10)
s_mov_b32 s100, 0x1f001f
s_mov_b32 s101, 0x1f001f
s_mov_b64 exec, s[100:101]
ds_write_b128 v5, v[40:43] offset:2624
s_mov_b64 exec, -1
s_mov_b32 s100, 0x1f001f
s_mov_b32 s101, 0
s_mov_b64 exec, s[100:101]
ds_write_b128 v5, v[44:47] offset:2688
s_mov_b64 exec, -1
v_mfma_f32_32x32x16_bf16 a[144:159], a[180:183], v[212:215], a[144:159]
ds_read_b64_tr_b16 a[176:177], v17 offset:7712
ds_read_b64_tr_b16 a[178:179], v18 offset:7712
ds_read_b32 v48, v6 offset:0
ds_read_b32 v49, v6 offset:256
v_mfma_f32_32x32x16_bf16 a[80:95], a[184:187], v[216:219], a[80:95]
ds_read_b64_tr_b16 a[180:181], v17 offset:7744
ds_read_b64_tr_b16 a[182:183], v18 offset:7744
ds_read_b32 v50, v6 offset:512
ds_read_b32 v51, v6 offset:768
v_mfma_f32_32x32x16_bf16 a[96:111], a[188:191], v[216:219], a[96:111]
ds_read_b64_tr_b16 a[184:185], v17 offset:7776
ds_read_b64_tr_b16 a[186:187], v18 offset:7776
ds_read_b32 v52, v6 offset:1024
ds_read_b32 v53, v6 offset:1280
v_mfma_f32_32x32x16_bf16 a[112:127], a[160:163], v[216:219], a[112:127]
ds_read_b64_tr_b16 a[188:189], v17 offset:7808
ds_read_b64_tr_b16 a[190:191], v18 offset:7808
s_waitcnt lgkmcnt(12)
ds_read_b32 v54, v6 offset:1536
ds_read_b32 v55, v6 offset:1792
v_mfma_f32_32x32x16_bf16 a[128:143], a[164:167], v[216:219], a[128:143]
s_waitcnt vmcnt(5)
s_barrier
v_add_u32 v17, 0x5000, v17
v_add_u32 v18, 0x5000, v18
ds_read_b64_tr_b16 a[160:161], v17 offset:0
ds_read_b64_tr_b16 a[162:163], v18 offset:0
ds_read_b32 v56, v6 offset:2048
ds_read_b32 v57, v6 offset:2304
v_mfma_f32_32x32x16_bf16 a[144:159], a[168:171], v[216:219], a[144:159]
ds_read_b64_tr_b16 a[164:165], v17 offset:32
ds_read_b64_tr_b16 a[166:167], v18 offset:32
ds_read_b32 v58, v6 offset:2560
ds_read_b32 v59, v6 offset:2816
v_mfma_f32_32x32x16_bf16 a[80:95], a[172:175], v[220:223], a[80:95]
ds_read_b64_tr_b16 a[168:169], v17 offset:64
ds_read_b64_tr_b16 a[170:171], v18 offset:64
ds_read_b32 v60, v6 offset:3072
ds_read_b32 v61, v6 offset:3328
v_mfma_f32_32x32x16_bf16 a[96:111], a[176:179], v[220:223], a[96:111]
ds_read_b64_tr_b16 a[172:173], v17 offset:96
ds_read_b64_tr_b16 a[174:175], v18 offset:96
s_waitcnt lgkmcnt(12)
buffer_atomic_add_f32 v48, v4, s[36:39], s8 offen offset:0
v_mfma_f32_32x32x16_bf16 a[112:127], a[180:183], v[220:223], a[112:127]
ds_read_b64_tr_b16 a[176:177], v17 offset:128
ds_read_b64_tr_b16 a[178:179], v18 offset:128
v_mfma_f32_32x32x16_bf16 a[128:143], a[184:187], v[220:223], a[128:143]
ds_read_b64_tr_b16 a[180:181], v17 offset:2560
ds_read_b64_tr_b16 a[182:183], v18 offset:2560
buffer_atomic_add_f32 v49, v4, s[36:39], s8 offen offset:256
v_mfma_f32_32x32x16_bf16 a[144:159], a[188:191], v[220:223], a[144:159]
ds_read_b64_tr_b16 a[184:185], v17 offset:2592
ds_read_b64_tr_b16 a[186:187], v18 offset:2592
v_mfma_f32_32x32x16_bf16 a[80:95], a[160:163], v[224:227], a[80:95]
ds_read_b64_tr_b16 a[188:189], v17 offset:2624
ds_read_b64_tr_b16 a[190:191], v18 offset:2624
s_waitcnt lgkmcnt(6)
buffer_atomic_add_f32 v50, v4, s[36:39], s8 offen offset:512
v_mfma_f32_32x32x16_bf16 a[96:111], a[164:167], v[224:227], a[96:111]
ds_read_b64_tr_b16 a[160:161], v17 offset:2656
ds_read_b64_tr_b16 a[162:163], v18 offset:2656
v_mfma_f32_32x32x16_bf16 a[112:127], a[168:171], v[224:227], a[112:127]
ds_read_b64_tr_b16 a[164:165], v17 offset:2688
ds_read_b64_tr_b16 a[166:167], v18 offset:2688
buffer_atomic_add_f32 v51, v4, s[36:39], s8 offen offset:768
v_mfma_f32_32x32x16_bf16 a[128:143], a[172:175], v[224:227], a[128:143]
ds_read_b64_tr_b16 a[168:169], v17 offset:5120
ds_read_b64_tr_b16 a[170:171], v18 offset:5120
v_mfma_f32_32x32x16_bf16 a[144:159], a[176:179], v[224:227], a[144:159]
ds_read_b64_tr_b16 a[172:173], v17 offset:5152
ds_read_b64_tr_b16 a[174:175], v18 offset:5152
s_waitcnt lgkmcnt(6)
buffer_atomic_add_f32 v52, v4, s[36:39], s8 offen offset:1024
v_mfma_f32_32x32x16_bf16 a[80:95], a[180:183], v[228:231], a[80:95]
ds_read_b64_tr_b16 a[176:177], v17 offset:5184
ds_read_b64_tr_b16 a[178:179], v18 offset:5184
v_mfma_f32_32x32x16_bf16 a[96:111], a[184:187], v[228:231], a[96:111]
ds_read_b64_tr_b16 a[180:181], v17 offset:5216
ds_read_b64_tr_b16 a[182:183], v18 offset:5216
buffer_atomic_add_f32 v53, v4, s[36:39], s8 offen offset:1280
v_mfma_f32_32x32x16_bf16 a[112:127], a[188:191], v[228:231], a[112:127]
ds_read_b64_tr_b16 a[184:185], v17 offset:5248
ds_read_b64_tr_b16 a[186:187], v18 offset:5248
v_mfma_f32_32x32x16_bf16 a[128:143], a[160:163], v[228:231], a[128:143]
ds_read_b64_tr_b16 a[188:189], v17 offset:7680
ds_read_b64_tr_b16 a[190:191], v18 offset:7680
s_waitcnt lgkmcnt(6)
buffer_atomic_add_f32 v54, v4, s[36:39], s8 offen offset:1536
v_mfma_f32_32x32x16_bf16 a[144:159], a[164:167], v[228:231], a[144:159]
ds_read_b64_tr_b16 a[160:161], v17 offset:7712
ds_read_b64_tr_b16 a[162:163], v18 offset:7712
v_mfma_f32_32x32x16_bf16 a[80:95], a[168:171], v[232:235], a[80:95]
ds_read_b64_tr_b16 a[164:165], v17 offset:7744
ds_read_b64_tr_b16 a[166:167], v18 offset:7744
buffer_atomic_add_f32 v55, v4, s[36:39], s8 offen offset:1792
v_mfma_f32_32x32x16_bf16 a[96:111], a[172:175], v[232:235], a[96:111]
ds_read_b64_tr_b16 a[168:169], v17 offset:7776
ds_read_b64_tr_b16 a[170:171], v18 offset:7776
v_mfma_f32_32x32x16_bf16 a[112:127], a[176:179], v[232:235], a[112:127]
ds_read_b64_tr_b16 a[172:173], v17 offset:7808
ds_read_b64_tr_b16 a[174:175], v18 offset:7808
s_waitcnt lgkmcnt(6)
buffer_atomic_add_f32 v56, v4, s[36:39], s8 offen offset:2048
v_mfma_f32_32x32x16_bf16 a[128:143], a[180:183], v[232:235], a[128:143]
s_waitcnt vmcnt(9)
s_barrier
v_add_u32 v17, 0x5000, v17
v_add_u32 v18, 0x5000, v18
ds_read_b64_tr_b16 a[176:177], v17 offset:0
ds_read_b64_tr_b16 a[178:179], v18 offset:0
v_mfma_f32_32x32x16_bf16 a[144:159], a[184:187], v[232:235], a[144:159]
ds_read_b64_tr_b16 a[180:181], v17 offset:2560
ds_read_b64_tr_b16 a[182:183], v18 offset:2560
buffer_atomic_add_f32 v57, v4, s[36:39], s8 offen offset:2304
v_mfma_f32_32x32x16_bf16 a[80:95], a[188:191], v[236:239], a[80:95]
ds_read_b64_tr_b16 a[184:185], v17 offset:5120
ds_read_b64_tr_b16 a[186:187], v18 offset:5120
v_mfma_f32_32x32x16_bf16 a[96:111], a[160:163], v[236:239], a[96:111]
ds_read_b64_tr_b16 a[188:189], v17 offset:7680
ds_read_b64_tr_b16 a[190:191], v18 offset:7680
s_waitcnt lgkmcnt(6)
buffer_atomic_add_f32 v58, v4, s[36:39], s8 offen offset:2560
v_mfma_f32_32x32x16_bf16 a[112:127], a[164:167], v[236:239], a[112:127]
ds_read_b64_tr_b16 a[160:161], v17 offset:32
ds_read_b64_tr_b16 a[162:163], v18 offset:32
v_mfma_f32_32x32x16_bf16 a[128:143], a[168:171], v[236:239], a[128:143]
ds_read_b64_tr_b16 a[164:165], v17 offset:2592
ds_read_b64_tr_b16 a[166:167], v18 offset:2592
buffer_atomic_add_f32 v59, v4, s[36:39], s8 offen offset:2816
v_mfma_f32_32x32x16_bf16 a[144:159], a[172:175], v[236:239], a[144:159]
ds_read_b64_tr_b16 a[168:169], v17 offset:5152
ds_read_b64_tr_b16 a[170:171], v18 offset:5152
v_mfma_f32_32x32x16_bf16 a[80:95], a[176:179], v[240:243], a[80:95]
ds_read_b64_tr_b16 a[172:173], v17 offset:7712
ds_read_b64_tr_b16 a[174:175], v18 offset:7712
s_waitcnt lgkmcnt(6)
buffer_atomic_add_f32 v60, v4, s[36:39], s8 offen offset:3072
v_mfma_f32_32x32x16_bf16 a[80:95], a[180:183], v[244:247], a[80:95]
ds_read_b64_tr_b16 a[176:177], v17 offset:64
ds_read_b64_tr_b16 a[178:179], v18 offset:64
v_mfma_f32_32x32x16_bf16 a[80:95], a[184:187], v[248:251], a[80:95]
ds_read_b64_tr_b16 a[180:181], v17 offset:2624
ds_read_b64_tr_b16 a[182:183], v18 offset:2624
s_mov_b64 exec, 0xff
buffer_atomic_add_f32 v61, v4, s[36:39], s8 offen offset:3328
s_mov_b64 exec, -1
v_mfma_f32_32x32x16_bf16 a[80:95], a[188:191], v[252:255], a[80:95]
ds_read_b64_tr_b16 a[184:185], v17 offset:5184
ds_read_b64_tr_b16 a[186:187], v18 offset:5184
v_mfma_f32_32x32x16_bf16 a[96:111], a[160:163], v[240:243], a[96:111]
ds_read_b64_tr_b16 a[188:189], v17 offset:7744
ds_read_b64_tr_b16 a[190:191], v18 offset:7744
s_waitcnt lgkmcnt(6)
v_mfma_f32_32x32x16_bf16 a[96:111], a[164:167], v[244:247], a[96:111]
ds_read_b64_tr_b16 a[160:161], v17 offset:96
ds_read_b64_tr_b16 a[162:163], v18 offset:96
v_mfma_f32_32x32x16_bf16 a[96:111], a[168:171], v[248:251], a[96:111]
ds_read_b64_tr_b16 a[164:165], v17 offset:2656
ds_read_b64_tr_b16 a[166:167], v18 offset:2656
v_accvgpr_read_b32 v72, a80
v_accvgpr_read_b32 v73, a81
v_accvgpr_read_b32 v74, a82
v_accvgpr_read_b32 v75, a83
v_accvgpr_read_b32 v76, a84
v_mfma_f32_32x32x16_bf16 a[96:111], a[172:175], v[252:255], a[96:111]
ds_read_b64_tr_b16 a[168:169], v17 offset:5216
ds_read_b64_tr_b16 a[170:171], v18 offset:5216
v_accvgpr_read_b32 v77, a85
v_accvgpr_read_b32 v78, a86
v_accvgpr_read_b32 v79, a87
v_accvgpr_read_b32 v80, a88
v_accvgpr_read_b32 v81, a89
v_mfma_f32_32x32x16_bf16 a[112:127], a[176:179], v[240:243], a[112:127]
ds_read_b64_tr_b16 a[172:173], v17 offset:7776
ds_read_b64_tr_b16 a[174:175], v18 offset:7776
s_waitcnt lgkmcnt(6)
v_accvgpr_read_b32 v82, a90
v_accvgpr_read_b32 v83, a91
v_accvgpr_read_b32 v84, a92
v_accvgpr_read_b32 v85, a93
v_accvgpr_read_b32 v86, a94
v_mfma_f32_32x32x16_bf16 a[112:127], a[180:183], v[244:247], a[112:127]
ds_read_b64_tr_b16 a[176:177], v17 offset:128
ds_read_b64_tr_b16 a[178:179], v18 offset:128
v_accvgpr_read_b32 v87, a95
v_max_f32 v72, 0, v72
v_max_f32 v73, 0, v73
v_max_f32 v74, 0, v74
v_max_f32 v75, 0, v75
v_mfma_f32_32x32x16_bf16 a[112:127], a[184:187], v[248:251], a[112:127]
ds_read_b64_tr_b16 a[180:181], v17 offset:2688
ds_read_b64_tr_b16 a[182:183], v18 offset:2688
v_max_f32 v76, 0, v76
v_max_f32 v77, 0, v77
v_max_f32 v78, 0, v78
v_max_f32 v79, 0, v79
v_mul_f32 v80, v72, v80
v_mfma_f32_32x32x16_bf16 a[112:127], a[188:191], v[252:255], a[112:127]
ds_read_b64_tr_b16 a[184:185], v17 offset:5248
ds_read_b64_tr_b16 a[186:187], v18 offset:5248
v_mul_f32 v81, v73, v81
v_mul_f32 v82, v74, v82
v_mul_f32 v83, v75, v83
v_mul_f32 v84, v76, v84
v_mul_f32 v85, v77, v85
v_mfma_f32_32x32x16_bf16 a[128:143], a[160:163], v[240:243], a[128:143]
ds_read_b64_tr_b16 a[188:189], v17 offset:7808
ds_read_b64_tr_b16 a[190:191], v18 offset:7808
s_waitcnt lgkmcnt(6)
v_mul_f32 v86, v78, v86
v_mul_f32 v87, v79, v87
v_cvt_pk_bf16_f32 v64, v80, v81
v_cvt_pk_bf16_f32 v65, v82, v83
v_cvt_pk_bf16_f32 v66, v84, v85
v_mfma_f32_32x32x16_bf16 a[128:143], a[164:167], v[244:247], a[128:143]
v_cvt_pk_bf16_f32 v67, v86, v87
v_accvgpr_read_b32 v72, a96
v_accvgpr_read_b32 v73, a97
v_accvgpr_read_b32 v74, a98
v_accvgpr_read_b32 v75, a99
v_mfma_f32_32x32x16_bf16 a[128:143], a[168:171], v[248:251], a[128:143]
v_accvgpr_read_b32 v76, a100
v_accvgpr_read_b32 v77, a101
v_accvgpr_read_b32 v78, a102
v_accvgpr_read_b32 v79, a103
v_accvgpr_read_b32 v80, a104
v_mfma_f32_32x32x16_bf16 a[128:143], a[172:175], v[252:255], a[128:143]
v_accvgpr_read_b32 v81, a105
v_accvgpr_read_b32 v82, a106
v_accvgpr_read_b32 v83, a107
v_accvgpr_read_b32 v84, a108
v_accvgpr_read_b32 v85, a109
v_mfma_f32_32x32x16_bf16 a[144:159], a[176:179], v[240:243], a[144:159]
s_waitcnt lgkmcnt(0)
v_accvgpr_read_b32 v86, a110
v_accvgpr_read_b32 v87, a111
v_max_f32 v72, 0, v72
v_max_f32 v73, 0, v73
v_max_f32 v74, 0, v74
v_mfma_f32_32x32x16_bf16 a[144:159], a[180:183], v[244:247], a[144:159]
v_max_f32 v75, 0, v75
v_max_f32 v76, 0, v76
v_max_f32 v77, 0, v77
v_max_f32 v78, 0, v78
v_max_f32 v79, 0, v79
v_mfma_f32_32x32x16_bf16 a[144:159], a[184:187], v[248:251], a[144:159]
v_mul_f32 v80, v72, v80
v_mul_f32 v81, v73, v81
v_mul_f32 v82, v74, v82
v_mul_f32 v83, v75, v83
v_mul_f32 v84, v76, v84
v_mfma_f32_32x32x16_bf16 a[144:159], a[188:191], v[252:255], a[144:159]
v_mul_f32 v85, v77, v85
v_mul_f32 v86, v78, v86
v_mul_f32 v87, v79, v87
v_cvt_pk_bf16_f32 v68, v80, v81
v_cvt_pk_bf16_f32 v69, v82, v83
s_barrier
v_cvt_pk_bf16_f32 v70, v84, v85
v_cvt_pk_bf16_f32 v71, v86, v87
v_permlane16_swap_b32 v64, v68
v_permlane16_swap_b32 v65, v69
v_permlane16_swap_b32 v66, v70
v_permlane16_swap_b32 v67, v71
s_add_u32 s57, s22, 0
buffer_store_dwordx4 v[64:67], v2, s[36:39], s57 offen sc1
s_add_u32 s57, s22, 0xc000
buffer_store_dwordx4 v[68:71], v2, s[36:39], s57 offen sc1
v_accvgpr_read_b32 v72, a112
v_accvgpr_read_b32 v73, a113
v_accvgpr_read_b32 v74, a114
v_accvgpr_read_b32 v75, a115
v_accvgpr_read_b32 v76, a116
v_accvgpr_read_b32 v77, a117
v_accvgpr_read_b32 v78, a118
v_accvgpr_read_b32 v79, a119
v_accvgpr_read_b32 v80, a120
v_accvgpr_read_b32 v81, a121
v_accvgpr_read_b32 v82, a122
v_accvgpr_read_b32 v83, a123
v_accvgpr_read_b32 v84, a124
v_accvgpr_read_b32 v85, a125
v_accvgpr_read_b32 v86, a126
v_accvgpr_read_b32 v87, a127
v_max_f32 v72, 0, v72
v_max_f32 v73, 0, v73
v_max_f32 v74, 0, v74
v_max_f32 v75, 0, v75
v_max_f32 v76, 0, v76
v_max_f32 v77, 0, v77
v_max_f32 v78, 0, v78
v_max_f32 v79, 0, v79
v_mul_f32 v80, v72, v80
v_mul_f32 v81, v73, v81
v_mul_f32 v82, v74, v82
v_mul_f32 v83, v75, v83
v_mul_f32 v84, v76, v84
v_mul_f32 v85, v77, v85
v_mul_f32 v86, v78, v86
v_mul_f32 v87, v79, v87
v_cvt_pk_bf16_f32 v64, v80, v81
v_cvt_pk_bf16_f32 v65, v82, v83
v_cvt_pk_bf16_f32 v66, v84, v85
v_cvt_pk_bf16_f32 v67, v86, v87
v_accvgpr_read_b32 v72, a128
v_accvgpr_read_b32 v73, a129
v_accvgpr_read_b32 v74, a130
v_accvgpr_read_b32 v75, a131
v_accvgpr_read_b32 v76, a132
v_accvgpr_read_b32 v77, a133
v_accvgpr_read_b32 v78, a134
v_accvgpr_read_b32 v79, a135
v_accvgpr_read_b32 v80, a136
v_accvgpr_read_b32 v81, a137
v_accvgpr_read_b32 v82, a138
v_accvgpr_read_b32 v83, a139
v_accvgpr_read_b32 v84, a140
v_accvgpr_read_b32 v85, a141
v_accvgpr_read_b32 v86, a142
v_accvgpr_read_b32 v87, a143
v_max_f32 v72, 0, v72
v_max_f32 v73, 0, v73
v_max_f32 v74, 0, v74
v_max_f32 v75, 0, v75
v_max_f32 v76, 0, v76
v_max_f32 v77, 0, v77
v_max_f32 v78, 0, v78
v_max_f32 v79, 0, v79
v_mul_f32 v80, v72, v80
v_mul_f32 v81, v73, v81
v_mul_f32 v82, v74, v82
v_mul_f32 v83, v75, v83
v_mul_f32 v84, v76, v84
v_mul_f32 v85, v77, v85
v_mul_f32 v86, v78, v86
v_mul_f32 v87, v79, v87
v_cvt_pk_bf16_f32 v68, v80, v81
v_cvt_pk_bf16_f32 v69, v82, v83
v_cvt_pk_bf16_f32 v70, v84, v85
v_cvt_pk_bf16_f32 v71, v86, v87
v_permlane16_swap_b32 v64, v68
v_permlane16_swap_b32 v65, v69
v_permlane16_swap_b32 v66, v70
v_permlane16_swap_b32 v67, v71
s_add_u32 s57, s22, 0x400
buffer_store_dwordx4 v[64:67], v2, s[36:39], s57 offen sc1
s_add_u32 s57, s22, 0xc400
buffer_store_dwordx4 v[68:71], v2, s[36:39], s57 offen sc1
v_accvgpr_read_b32 v72, a144
v_accvgpr_read_b32 v73, a145
v_accvgpr_read_b32 v74, a146
v_accvgpr_read_b32 v75, a147
v_accvgpr_read_b32 v76, a148
v_accvgpr_read_b32 v77, a149
v_accvgpr_read_b32 v78, a150
v_accvgpr_read_b32 v79, a151
v_accvgpr_read_b32 v80, a152
v_accvgpr_read_b32 v81, a153
v_accvgpr_read_b32 v82, a154
v_accvgpr_read_b32 v83, a155
v_accvgpr_read_b32 v84, a156
v_accvgpr_read_b32 v85, a157
v_accvgpr_read_b32 v86, a158
v_accvgpr_read_b32 v87, a159
v_max_f32 v72, 0, v72
v_max_f32 v73, 0, v73
v_max_f32 v74, 0, v74
v_max_f32 v75, 0, v75
v_max_f32 v76, 0, v76
v_max_f32 v77, 0, v77
v_max_f32 v78, 0, v78
v_max_f32 v79, 0, v79
v_mul_f32 v80, v72, v80
v_mul_f32 v81, v73, v81
v_mul_f32 v82, v74, v82
v_mul_f32 v83, v75, v83
v_mul_f32 v84, v76, v84
v_mul_f32 v85, v77, v85
v_mul_f32 v86, v78, v86
v_mul_f32 v87, v79, v87
v_cvt_pk_bf16_f32 v64, v80, v81
v_cvt_pk_bf16_f32 v65, v82, v83
v_cvt_pk_bf16_f32 v66, v84, v85
v_cvt_pk_bf16_f32 v67, v86, v87
s_nop 0
v_permlane16_swap_b32 v64, v66
v_permlane16_swap_b32 v65, v67
s_add_u32 s57, s22, 0x800
buffer_store_dwordx2 v[64:65], v3, s[36:39], s57 offen sc1
s_add_u32 s57, s22, 0xc800
buffer_store_dwordx2 v[66:67], v3, s[36:39], s57 offen sc1
s_and_b32 s85, s2, 7
s_lshr_b32 s86, s2, 3
s_lshr_b32 s43, s85, 1
s_lshl_b32 s43, s43, 3
s_and_b32 s87, s86, 7
s_add_u32 s43, s43, s87
s_and_b32 s23, s85, 1
s_lshl_b32 s23, s23, 2
s_lshr_b32 s88, s86, 3
s_add_u32 s23, s23, s88
s_mul_i32 s88, s88, 3
s_add_u32 s80, s88, s87
s_add_u32 s85, s80, 0
s_and_b32 s76, s85, 3
s_lshr_b32 s86, s76, 1
s_mul_i32 s86, s86, 4
s_add_u32 s86, s86, s76
s_add_u32 s86, s86, 4
s_lshl_b32 s64, s86, 10
s_add_u32 s85, s80, 1
s_and_b32 s77, s85, 3
s_lshr_b32 s86, s77, 1
s_mul_i32 s86, s86, 4
s_add_u32 s86, s86, s77
s_add_u32 s86, s86, 4
s_lshl_b32 s65, s86, 10
s_add_u32 s85, s80, 2
s_and_b32 s78, s85, 3
s_lshr_b32 s86, s78, 1
s_mul_i32 s86, s86, 4
s_add_u32 s86, s86, s78
s_add_u32 s86, s86, 4
s_lshl_b32 s66, s86, 10
s_add_u32 s85, s80, 3
s_and_b32 s79, s85, 3
s_lshr_b32 s86, s79, 1
s_mul_i32 s86, s86, 4
s_add_u32 s86, s86, s79
s_add_u32 s86, s86, 4
s_lshl_b32 s67, s86, 10
s_lshl_b32 s85, s43, 5
s_lshl_b32 s86, s52, 1
s_add_u32 s85, s85, s86
s_mul_i32 s28, s85, 0x1800
s_mul_i32 s29, s85, 0xa00
s_add_u32 s29, s29, 0x600000
s_mul_i32 s30, s52, 0x2a8
s_mul_i32 s86, s23, 5
s_add_u32 s30, s30, s86
s_lshl_b32 s30, s30, 10
s_add_u32 s30, s30, 0x880000
s_lshl_b32 s85, s43, 3
s_lshl_b32 s86, s52, 1
s_add_u32 s85, s85, s86
s_lshl_b32 s42, s85, 3
s_add_u32 s42, s42, 0xb4f400
s_lshl_b32 s85, s43, 2
s_add_u32 s85, s85, s52
s_lshl_b32 s85, s85, 7
s_add_u32 s31, s85, 0xb46000
s_add_u32 s40, s85, 0xb4a000
s_mul_i32 s85, s23, 0x50
s_lshr_b32 s85, s85, 6
s_mul_i32 s86, s52, 10
s_add_u32 s85, s85, s86
s_lshl_b32 s41, s85, 7
s_add_u32 s41, s41, 0xb4e000
v_and_b32 v105, 31, v1
v_min_u32 v105, 16, v105
v_lshrrev_b32 v104, 5, v1
v_lshlrev_b32 v104, 7, v104
v_lshl_add_u32 v105, v105, 2, v104
buffer_load_dword v104, v105, s[36:39], s41 offen sc1
v_and_b32 v107, 3, v1
v_lshlrev_b32 v107, 2, v107
buffer_load_dword v106, v107, s[36:39], s42 offen sc1
s_waitcnt vmcnt(8)
s_lshl_b32 s57, s54, 2
s_add_u32 s57, s57, s52
s_lshl_b32 s57, s57, 4
s_add_u32 s57, s57, s53
s_lshl_b32 s57, s57, 2
s_add_u32 s57, s57, 0xb4fc00
v_mov_b32 v91, 1
s_mov_b64 exec, 1
buffer_store_dword v91, off, s[36:39], s57 sc1
s_mov_b64 exec, -1
v_add_u32 v9, 0, v3
v_add_u32 v13, 0, v2
v_add_u32 v17, 0, v3
v_add_u32 v10, 0xc000, v3
v_add_u32 v14, 0x5000, v2
v_add_u32 v18, 0x5000, v3
v_add_u32 v11, 0x18000, v3
v_add_u32 v15, 0xa000, v2
v_add_u32 v19, 0xa000, v3
v_add_u32 v12, 0x24000, v3
v_add_u32 v16, 0xf000, v2
v_add_u32 v20, 0xf000, v3
s_waitcnt vmcnt(3)
s_lshl_b32 s57, s53, 1
s_lshr_b32 s58, s52, 1
s_add_u32 s57, s57, s58
s_lshl_b32 s57, s57, 2
s_lshr_b32 s58, s54, 1
s_add_u32 s57, s57, s58
s_lshl_b32 s57, s57, 5
s_and_b32 s58, s54, 1
s_lshl_b32 s58, s58, 2
s_add_u32 s57, s57, s58
s_and_b32 s58, s52, 1
s_add_u32 s57, s57, s58
s_lshl_b32 s57, s57, 2
s_add_u32 s57, s57, 0xb46000
v_mov_b32 v90, 1
s_mov_b64 exec, 1
buffer_store_dword v90, off, s[36:39], s57 sc1
s_mov_b64 exec, -1
v_add_u32 v5, 0, v2
v_add_u32 v6, 0xc000, v2
v_add_u32 v7, 0x18000, v2
v_add_u32 v8, 0x24000, v2
v_add_u32 v21, 0x1000, v2
s_waitcnt vmcnt(3)
v_cmp_eq_u32 vcc, 1, v104
s_nop 3
s_cmp_eq_u64 vcc, -1
s_cbranch_scc1 X_fw_ok
s_mov_b32 s60, 0
X_fw_spin:
s_add_u32 s60, s60, 1
s_cmp_ge_u32 s60, 0x40000
s_cbranch_scc1 X_fw_ok
s_sleep 16
buffer_load_dword v104, v105, s[36:39], s41 offen offset:0 sc1
s_waitcnt vmcnt(0)
v_cmp_eq_u32 vcc, 1, v104
s_nop 3
s_cmp_eq_u64 vcc, -1
s_cbranch_scc0 X_fw_spin
X_fw_ok:
s_waitcnt vmcnt(2)
v_cmp_eq_u32 vcc, 1, v106
s_nop 3
s_cmp_eq_u64 vcc, -1
s_cbranch_scc1 X_fe_ok
s_mov_b32 s60, 0
X_fe_spin:
s_add_u32 s60, s60, 1
s_cmp_ge_u32 s60, 0x40000
s_cbranch_scc1 X_fe_ok
s_sleep 16
buffer_load_dword v106, v107, s[36:39], s42 offen offset:0 sc1
s_waitcnt vmcnt(0)
v_cmp_eq_u32 vcc, 1, v106
s_nop 3
s_cmp_eq_u64 vcc, -1
s_cbranch_scc0 X_fe_spin
X_fe_ok:
s_add_u32 s83, s64, s28
buffer_load_dwordx4 a[160:163], v5, s[36:39], s83 offen sc1
buffer_load_dwordx4 a[164:167], v6, s[36:39], s83 offen sc1
buffer_load_dwordx4 a[168:171], v7, s[36:39], s83 offen sc1
buffer_load_dwordx4 a[172:175], v8, s[36:39], s83 offen sc1
s_mul_i32 s84, s64, 40
s_add_u32 s84, s84, s30
buffer_load_dwordx4 a[176:179], v2, s[36:39], s84 offen offset:0 sc1
buffer_load_dwordx4 a[180:183], v2, s[36:39], s84 offen offset:1024 sc1
buffer_load_dwordx4 a[184:187], v2, s[36:39], s84 offen offset:2048 sc1
buffer_load_dwordx4 a[188:191], v2, s[36:39], s84 offen offset:3072 sc1
buffer_load_dwordx4 a[192:195], v21, s[36:39], s84 offen offset:0 sc1
s_add_u32 s85, s65, s28
buffer_load_dwordx4 a[196:199], v5, s[36:39], s85 offen sc1
buffer_load_dwordx4 a[200:203], v6, s[36:39], s85 offen sc1
buffer_load_dwordx4 a[204:207], v7, s[36:39], s85 offen sc1
buffer_load_dwordx4 a[208:211], v8, s[36:39], s85 offen sc1
s_mul_i32 s86, s65, 40
s_add_u32 s86, s86, s30
buffer_load_dwordx4 a[212:215], v2, s[36:39], s86 offen offset:0 sc1
buffer_load_dwordx4 a[216:219], v2, s[36:39], s86 offen offset:1024 sc1
buffer_load_dwordx4 a[220:223], v2, s[36:39], s86 offen offset:2048 sc1
buffer_load_dwordx4 a[224:227], v2, s[36:39], s86 offen offset:3072 sc1
buffer_load_dwordx4 a[228:231], v21, s[36:39], s86 offen offset:0 sc1
s_add_u32 s87, s66, s28
buffer_load_dwordx4 a[232:235], v5, s[36:39], s87 offen sc1
buffer_load_dwordx4 a[236:239], v6, s[36:39], s87 offen sc1
buffer_load_dwordx4 a[240:243], v7, s[36:39], s87 offen sc1
buffer_load_dwordx4 a[244:247], v8, s[36:39], s87 offen sc1
s_mul_i32 s88, s66, 40
s_add_u32 s88, s88, s30
buffer_load_dwordx4 a[248:251], v2, s[36:39], s88 offen offset:0 sc1
buffer_load_dwordx4 a[252:255], v2, s[36:39], s88 offen offset:1024 sc1
buffer_load_dwordx4 a[80:83], v2, s[36:39], s88 offen offset:2048 sc1
buffer_load_dwordx4 a[84:87], v2, s[36:39], s88 offen offset:3072 sc1
buffer_load_dwordx4 a[88:91], v21, s[36:39], s88 offen offset:0 sc1
s_mul_i32 s4, s80, 43
s_lshr_b32 s4, s4, 8
s_mul_i32 s4, s4, 6
s_sub_u32 s4, s80, s4
s_cmp_ge_u32 s4, 3
s_cselect_b32 s5, 3, 0
s_sub_u32 s6, s4, s5
s_lshl_b32 s5, s5, 1
s_add_u32 s5, s5, s6
s_cmp_ge_u32 s6, 2
s_cselect_b32 s6, 1, 0
s_add_u32 s5, s5, s6
s_lshl_b32 s68, s5, 10
s_add_u32 s4, s4, 1
s_cmp_eq_u32 s4, 6
s_cselect_b32 s4, 0, s4
s_cmp_ge_u32 s4, 3
s_cselect_b32 s5, 3, 0
s_sub_u32 s6, s4, s5
s_lshl_b32 s5, s5, 1
s_add_u32 s5, s5, s6
s_cmp_ge_u32 s6, 2
s_cselect_b32 s6, 1, 0
s_add_u32 s5, s5, s6
s_lshl_b32 s69, s5, 10
s_add_u32 s4, s4, 1
s_cmp_eq_u32 s4, 6
s_cselect_b32 s4, 0, s4
s_cmp_ge_u32 s4, 3
s_cselect_b32 s5, 3, 0
s_sub_u32 s6, s4, s5
s_lshl_b32 s5, s5, 1
s_add_u32 s5, s5, s6
s_cmp_ge_u32 s6, 2
s_cselect_b32 s6, 1, 0
s_add_u32 s5, s5, s6
s_lshl_b32 s71, s5, 10
s_add_u32 s4, s4, 1
s_cmp_eq_u32 s4, 6
s_cselect_b32 s4, 0, s4
s_cmp_ge_u32 s4, 3
s_cselect_b32 s5, 3, 0
s_sub_u32 s6, s4, s5
s_lshl_b32 s5, s5, 1
s_add_u32 s5, s5, s6
s_cmp_ge_u32 s6, 2
s_cselect_b32 s6, 1, 0
s_add_u32 s5, s5, s6
s_lshl_b32 s72, s5, 10
s_add_u32 s4, s4, 1
s_cmp_eq_u32 s4, 6
s_cselect_b32 s4, 0, s4
s_cmp_ge_u32 s4, 3
s_cselect_b32 s5, 3, 0
s_sub_u32 s6, s4, s5
s_lshl_b32 s5, s5, 1
s_add_u32 s5, s5, s6
s_cmp_ge_u32 s6, 2
s_cselect_b32 s6, 1, 0
s_add_u32 s5, s5, s6
s_lshl_b32 s73, s5, 10
s_add_u32 s4, s4, 1
s_cmp_eq_u32 s4, 6
s_cselect_b32 s4, 0, s4
s_cmp_ge_u32 s4, 3
s_cselect_b32 s5, 3, 0
s_sub_u32 s6, s4, s5
s_lshl_b32 s5, s5, 1
s_add_u32 s5, s5, s6
s_cmp_ge_u32 s6, 2
s_cselect_b32 s6, 1, 0
s_add_u32 s5, s5, s6
s_lshl_b32 s75, s5, 10
s_and_b32 s4, s80, 1
s_mul_i32 s5, s4, 0x1800
s_add_u32 s70, s5, 0x800
s_sub_u32 s74, 0x2000, s5
s_mov_b32 s44, s94
s_mov_b32 s45, s95
s_mov_b32 s46, 0x280000
s_mov_b32 s47, 0x20000
v_and_b32 v23, 7, v1
v_lshlrev_b32 v23, 2, v23
buffer_load_dword v22, v23, s[36:39], s31 offen sc1
s_waitcnt vmcnt(23)
v_mfma_f32_16x16x32_bf16 a[0:3], a[176:179], a[160:163], 0
v_mfma_f32_16x16x32_bf16 a[20:23], a[176:179], a[164:167], 0
s_add_u32 s89, s67, s28
buffer_load_dwordx4 a[92:95], v5, s[36:39], s89 offen sc1
v_mfma_f32_16x16x32_bf16 a[40:43], a[176:179], a[168:171], 0
v_mfma_f32_16x16x32_bf16 a[60:63], a[176:179], a[172:175], 0
buffer_load_dwordx4 a[96:99], v6, s[36:39], s89 offen sc1
s_waitcnt vmcnt(24)
v_mfma_f32_16x16x32_bf16 a[4:7], a[180:183], a[160:163], 0
v_mfma_f32_16x16x32_bf16 a[24:27], a[180:183], a[164:167], 0
buffer_load_dwordx4 a[100:103], v7, s[36:39], s89 offen sc1
v_mfma_f32_16x16x32_bf16 a[44:47], a[180:183], a[168:171], 0
v_mfma_f32_16x16x32_bf16 a[64:67], a[180:183], a[172:175], 0
buffer_load_dwordx4 a[104:107], v8, s[36:39], s89 offen sc1
s_waitcnt vmcnt(25)
v_mfma_f32_16x16x32_bf16 a[8:11], a[184:187], a[160:163], 0
v_mfma_f32_16x16x32_bf16 a[28:31], a[184:187], a[164:167], 0
s_mul_i32 s82, s67, 40
s_add_u32 s82, s82, s30
buffer_load_dwordx4 a[108:111], v2, s[36:39], s82 offen offset:0 sc1
v_mfma_f32_16x16x32_bf16 a[48:51], a[184:187], a[168:171], 0
v_mfma_f32_16x16x32_bf16 a[68:71], a[184:187], a[172:175], 0
buffer_load_dwordx4 a[112:115], v2, s[36:39], s82 offen offset:1024 sc1
s_waitcnt vmcnt(26)
v_mfma_f32_16x16x32_bf16 a[12:15], a[188:191], a[160:163], 0
v_mfma_f32_16x16x32_bf16 a[32:35], a[188:191], a[164:167], 0
buffer_load_dwordx4 a[116:119], v2, s[36:39], s82 offen offset:2048 sc1
v_mfma_f32_16x16x32_bf16 a[52:55], a[188:191], a[168:171], 0
v_mfma_f32_16x16x32_bf16 a[72:75], a[188:191], a[172:175], 0
buffer_load_dwordx4 a[120:123], v2, s[36:39], s82 offen offset:3072 sc1
s_waitcnt vmcnt(27)
v_mfma_f32_16x16x32_bf16 a[16:19], a[192:195], a[160:163], 0
v_mfma_f32_16x16x32_bf16 a[36:39], a[192:195], a[164:167], 0
buffer_load_dwordx4 a[124:127], v21, s[36:39], s82 offen offset:0 sc1
v_mfma_f32_16x16x32_bf16 a[56:59], a[192:195], a[168:171], 0
v_mfma_f32_16x16x32_bf16 a[76:79], a[192:195], a[172:175], 0
s_waitcnt vmcnt(9)
v_cmp_eq_u32 vcc, 1, v22
s_nop 3
s_cmp_eq_u64 vcc, -1
s_cbranch_scc1 X_fh_ok
s_mov_b32 s60, 0
X_fh_spin:
s_add_u32 s60, s60, 1
s_cmp_ge_u32 s60, 0x40000
s_cbranch_scc1 X_fh_ok
s_sleep 16
buffer_load_dword v22, v23, s[36:39], s31 offen offset:0 sc1
s_waitcnt vmcnt(0)
v_cmp_eq_u32 vcc, 1, v22
s_nop 3
s_cmp_eq_u64 vcc, -1
s_cbranch_scc0 X_fh_spin
X_fh_ok:
v_mfma_f32_16x16x32_bf16 a[0:3], a[212:215], a[196:199], a[0:3]
v_mfma_f32_16x16x32_bf16 a[20:23], a[212:215], a[200:203], a[20:23]
s_add_u32 s83, s68, s28
buffer_load_dwordx4 a[160:163], v5, s[36:39], s83 offen sc1
v_mfma_f32_16x16x32_bf16 a[40:43], a[212:215], a[204:207], a[40:43]
v_mfma_f32_16x16x32_bf16 a[60:63], a[212:215], a[208:211], a[60:63]
buffer_load_dwordx4 a[164:167], v6, s[36:39], s83 offen sc1
v_mfma_f32_16x16x32_bf16 a[4:7], a[216:219], a[196:199], a[4:7]
v_mfma_f32_16x16x32_bf16 a[24:27], a[216:219], a[200:203], a[24:27]
buffer_load_dwordx4 a[168:171], v7, s[36:39], s83 offen sc1
v_mfma_f32_16x16x32_bf16 a[44:47], a[216:219], a[204:207], a[44:47]
v_mfma_f32_16x16x32_bf16 a[64:67], a[216:219], a[208:211], a[64:67]
buffer_load_dwordx4 a[172:175], v8, s[36:39], s83 offen sc1
v_mfma_f32_16x16x32_bf16 a[8:11], a[220:223], a[196:199], a[8:11]
v_mfma_f32_16x16x32_bf16 a[28:31], a[220:223], a[200:203], a[28:31]
s_mul_i32 s84, s68, 40
s_add_u32 s84, s84, s30
buffer_load_dwordx4 a[176:179], v2, s[36:39], s84 offen offset:0 sc1
v_mfma_f32_16x16x32_bf16 a[48:51], a[220:223], a[204:207], a[48:51]
v_mfma_f32_16x16x32_bf16 a[68:71], a[220:223], a[208:211], a[68:71]
buffer_load_dwordx4 a[180:183], v2, s[36:39], s84 offen offset:1024 sc1
v_mfma_f32_16x16x32_bf16 a[12:15], a[224:227], a[196:199], a[12:15]
v_mfma_f32_16x16x32_bf16 a[32:35], a[224:227], a[200:203], a[32:35]
buffer_load_dwordx4 a[184:187], v2, s[36:39], s84 offen offset:2048 sc1
v_mfma_f32_16x16x32_bf16 a[52:55], a[224:227], a[204:207], a[52:55]
v_mfma_f32_16x16x32_bf16 a[72:75], a[224:227], a[208:211], a[72:75]
buffer_load_dwordx4 a[188:191], v2, s[36:39], s84 offen offset:3072 sc1
v_mfma_f32_16x16x32_bf16 a[16:19], a[228:231], a[196:199], a[16:19]
v_mfma_f32_16x16x32_bf16 a[36:39], a[228:231], a[200:203], a[36:39]
buffer_load_dwordx4 a[192:195], v21, s[36:39], s84 offen offset:0 sc1
v_mfma_f32_16x16x32_bf16 a[56:59], a[228:231], a[204:207], a[56:59]
v_mfma_f32_16x16x32_bf16 a[76:79], a[228:231], a[208:211], a[76:79]
v_mfma_f32_16x16x32_bf16 a[0:3], a[248:251], a[232:235], a[0:3]
v_mfma_f32_16x16x32_bf16 a[20:23], a[248:251], a[236:239], a[20:23]
s_add_u32 s85, s69, s28
buffer_load_dwordx4 a[196:199], v5, s[36:39], s85 offen sc1
v_mfma_f32_16x16x32_bf16 a[40:43], a[248:251], a[240:243], a[40:43]
v_mfma_f32_16x16x32_bf16 a[60:63], a[248:251], a[244:247], a[60:63]
buffer_load_dwordx4 a[200:203], v6, s[36:39], s85 offen sc1
v_mfma_f32_16x16x32_bf16 a[4:7], a[252:255], a[232:235], a[4:7]
v_mfma_f32_16x16x32_bf16 a[24:27], a[252:255], a[236:239], a[24:27]
buffer_load_dwordx4 a[204:207], v7, s[36:39], s85 offen sc1
v_mfma_f32_16x16x32_bf16 a[44:47], a[252:255], a[240:243], a[44:47]
v_mfma_f32_16x16x32_bf16 a[64:67], a[252:255], a[244:247], a[64:67]
buffer_load_dwordx4 a[208:211], v8, s[36:39], s85 offen sc1
v_mfma_f32_16x16x32_bf16 a[8:11], a[80:83], a[232:235], a[8:11]
v_mfma_f32_16x16x32_bf16 a[28:31], a[80:83], a[236:239], a[28:31]
s_mul_i32 s86, s69, 40
s_add_u32 s86, s86, s30
buffer_load_dwordx4 a[212:215], v2, s[36:39], s86 offen offset:0 sc1
v_mfma_f32_16x16x32_bf16 a[48:51], a[80:83], a[240:243], a[48:51]
v_mfma_f32_16x16x32_bf16 a[68:71], a[80:83], a[244:247], a[68:71]
buffer_load_dwordx4 a[216:219], v2, s[36:39], s86 offen offset:1024 sc1
v_mfma_f32_16x16x32_bf16 a[12:15], a[84:87], a[232:235], a[12:15]
v_mfma_f32_16x16x32_bf16 a[32:35], a[84:87], a[236:239], a[32:35]
buffer_load_dwordx4 a[220:223], v2, s[36:39], s86 offen offset:2048 sc1
v_mfma_f32_16x16x32_bf16 a[52:55], a[84:87], a[240:243], a[52:55]
v_mfma_f32_16x16x32_bf16 a[72:75], a[84:87], a[244:247], a[72:75]
buffer_load_dwordx4 a[224:227], v2, s[36:39], s86 offen offset:3072 sc1
v_mfma_f32_16x16x32_bf16 a[16:19], a[88:91], a[232:235], a[16:19]
v_mfma_f32_16x16x32_bf16 a[36:39], a[88:91], a[236:239], a[36:39]
buffer_load_dwordx4 a[228:231], v21, s[36:39], s86 offen offset:0 sc1
v_mfma_f32_16x16x32_bf16 a[56:59], a[88:91], a[240:243], a[56:59]
v_mfma_f32_16x16x32_bf16 a[76:79], a[88:91], a[244:247], a[76:79]
s_waitcnt vmcnt(22)
v_mfma_f32_16x16x32_bf16 a[0:3], a[108:111], a[92:95], a[0:3]
s_lshl_b32 s80, s43, 6
s_mul_i32 s80, s80, 0x500
s_mul_i32 s81, s23, 0xa0
s_add_u32 s80, s80, s81
s_lshl_b32 s81, s52, 6
s_add_u32 s81, s81, 0
v_add_u32 v84, s81, v1
v_mul_u32_u24 v85, 0xccd, v84
v_lshrrev_b32 v85, 16, v85
v_mul_u32_u24 v86, 20, v85
v_mfma_f32_16x16x32_bf16 a[20:23], a[108:111], a[96:99], a[20:23]
s_add_u32 s87, s70, s28
buffer_load_dwordx2 a[232:233], v9, s[36:39], s87 offen sc1
v_sub_u32 v86, v84, v86
v_mul_u32_u24 v87, 0x500, v85
v_lshl_add_u32 v87, v86, 3, v87
v_add_u32 v64, s80, v87
v_mfma_f32_16x16x32_bf16 a[40:43], a[108:111], a[100:103], a[40:43]
v_mul_u32_u24 v87, 0x150, v85
v_lshl_add_u32 v87, v86, 4, v87
v_add_u32 v69, 0x4000, v87
v_mfma_f32_16x16x32_bf16 a[60:63], a[108:111], a[104:107], a[60:63]
buffer_load_dwordx2 a[234:235], v9, s[36:39], s87 offen offset:512 sc1
buffer_load_dwordx2 v[74:75], v64, s[24:27], 0 offen
s_lshl_b32 s81, s52, 6
s_add_u32 s81, s81, 0x100
v_add_u32 v84, s81, v1
v_mul_u32_u24 v85, 0xccd, v84
v_lshrrev_b32 v85, 16, v85
v_mul_u32_u24 v86, 20, v85
s_waitcnt vmcnt(24)
v_mfma_f32_16x16x32_bf16 a[4:7], a[112:115], a[92:95], a[4:7]
v_sub_u32 v86, v84, v86
v_mul_u32_u24 v87, 0x500, v85
v_lshl_add_u32 v87, v86, 3, v87
v_add_u32 v65, s80, v87
v_mfma_f32_16x16x32_bf16 a[24:27], a[112:115], a[96:99], a[24:27]
buffer_load_dwordx2 a[236:237], v10, s[36:39], s87 offen sc1
v_mul_u32_u24 v87, 0x150, v85
v_lshl_add_u32 v87, v86, 4, v87
v_add_u32 v70, 0x4000, v87
v_mfma_f32_16x16x32_bf16 a[44:47], a[112:115], a[100:103], a[44:47]
buffer_load_dwordx2 v[76:77], v65, s[24:27], 0 offen
s_lshl_b32 s81, s52, 6
s_add_u32 s81, s81, 0x200
v_add_u32 v84, s81, v1
v_mul_u32_u24 v85, 0xccd, v84
v_lshrrev_b32 v85, 16, v85
v_mul_u32_u24 v86, 20, v85
v_mfma_f32_16x16x32_bf16 a[64:67], a[112:115], a[104:107], a[64:67]
buffer_load_dwordx2 a[238:239], v10, s[36:39], s87 offen offset:512 sc1
v_sub_u32 v86, v84, v86
v_mul_u32_u24 v87, 0x500, v85
v_lshl_add_u32 v87, v86, 3, v87
v_add_u32 v66, s80, v87
s_waitcnt vmcnt(26)
v_mfma_f32_16x16x32_bf16 a[8:11], a[116:119], a[92:95], a[8:11]
v_mul_u32_u24 v87, 0x150, v85
v_lshl_add_u32 v87, v86, 4, v87
v_add_u32 v71, 0x4000, v87
v_mfma_f32_16x16x32_bf16 a[28:31], a[116:119], a[96:99], a[28:31]
buffer_load_dwordx2 a[240:241], v11, s[36:39], s87 offen sc1
buffer_load_dwordx2 v[78:79], v66, s[24:27], 0 offen
s_lshl_b32 s81, s52, 6
s_add_u32 s81, s81, 0x300
v_add_u32 v84, s81, v1
v_mul_u32_u24 v85, 0xccd, v84
v_lshrrev_b32 v85, 16, v85
v_mul_u32_u24 v86, 20, v85
v_mfma_f32_16x16x32_bf16 a[48:51], a[116:119], a[100:103], a[48:51]
v_sub_u32 v86, v84, v86
v_mul_u32_u24 v87, 0x500, v85
v_lshl_add_u32 v87, v86, 3, v87
v_add_u32 v67, s80, v87
v_mfma_f32_16x16x32_bf16 a[68:71], a[116:119], a[104:107], a[68:71]
buffer_load_dwordx2 a[242:243], v11, s[36:39], s87 offen offset:512 sc1
v_mul_u32_u24 v87, 0x150, v85
v_lshl_add_u32 v87, v86, 4, v87
v_add_u32 v72, 0x4000, v87
s_waitcnt vmcnt(28)
v_mfma_f32_16x16x32_bf16 a[12:15], a[120:123], a[92:95], a[12:15]
buffer_load_dwordx2 v[80:81], v67, s[24:27], 0 offen
s_lshl_b32 s81, s52, 6
s_add_u32 s81, s81, 0x400
v_add_u32 v84, s81, v1
v_mul_u32_u24 v85, 0xccd, v84
v_lshrrev_b32 v85, 16, v85
v_mul_u32_u24 v86, 20, v85
v_mfma_f32_16x16x32_bf16 a[32:35], a[120:123], a[96:99], a[32:35]
buffer_load_dwordx2 a[244:245], v12, s[36:39], s87 offen sc1
v_sub_u32 v86, v84, v86
v_mul_u32_u24 v87, 0x500, v85
v_lshl_add_u32 v87, v86, 3, v87
v_add_u32 v68, s80, v87
v_mfma_f32_16x16x32_bf16 a[52:55], a[120:123], a[100:103], a[52:55]
buffer_load_dwordx2 a[246:247], v12, s[36:39], s87 offen offset:512 sc1
v_mul_u32_u24 v87, 0x150, v85
v_lshl_add_u32 v87, v86, 4, v87
v_add_u32 v73, 0x4000, v87
v_mfma_f32_16x16x32_bf16 a[72:75], a[120:123], a[104:107], a[72:75]
s_mul_i32 s88, s70, 40
s_add_u32 s88, s88, s30
buffer_load_dwordx4 a[248:251], v2, s[36:39], s88 offen offset:0 sc1
buffer_load_dwordx2 v[82:83], v68, s[24:27], 0 offen
s_waitcnt vmcnt(32)
v_mfma_f32_16x16x32_bf16 a[16:19], a[124:127], a[92:95], a[16:19]
buffer_load_dwordx4 a[252:255], v2, s[36:39], s88 offen offset:1024 sc1
v_mfma_f32_16x16x32_bf16 a[36:39], a[124:127], a[96:99], a[36:39]
buffer_load_dwordx4 a[80:83], v2, s[36:39], s88 offen offset:2048 sc1
v_mfma_f32_16x16x32_bf16 a[56:59], a[124:127], a[100:103], a[56:59]
buffer_load_dwordx4 a[84:87], v2, s[36:39], s88 offen offset:3072 sc1
v_mfma_f32_16x16x32_bf16 a[76:79], a[124:127], a[104:107], a[76:79]
buffer_load_dwordx4 a[88:91], v21, s[36:39], s88 offen offset:0 sc1
s_waitcnt vmcnt(31)
v_mfma_f32_16x16x32_bf16 a[0:3], a[176:179], a[160:163], a[0:3]
v_mfma_f32_16x16x32_bf16 a[20:23], a[176:179], a[164:167], a[20:23]
s_add_u32 s89, s71, s28
buffer_load_dwordx4 a[92:95], v5, s[36:39], s89 offen sc1
v_mfma_f32_16x16x32_bf16 a[40:43], a[176:179], a[168:171], a[40:43]
v_mfma_f32_16x16x32_bf16 a[60:63], a[176:179], a[172:175], a[60:63]
buffer_load_dwordx4 a[96:99], v6, s[36:39], s89 offen sc1
s_waitcnt vmcnt(32)
v_mfma_f32_16x16x32_bf16 a[4:7], a[180:183], a[160:163], a[4:7]
v_mfma_f32_16x16x32_bf16 a[24:27], a[180:183], a[164:167], a[24:27]
buffer_load_dwordx4 a[100:103], v7, s[36:39], s89 offen sc1
v_mfma_f32_16x16x32_bf16 a[44:47], a[180:183], a[168:171], a[44:47]
v_mfma_f32_16x16x32_bf16 a[64:67], a[180:183], a[172:175], a[64:67]
buffer_load_dwordx4 a[104:107], v8, s[36:39], s89 offen sc1
s_waitcnt vmcnt(33)
v_mfma_f32_16x16x32_bf16 a[8:11], a[184:187], a[160:163], a[8:11]
v_mfma_f32_16x16x32_bf16 a[28:31], a[184:187], a[164:167], a[28:31]
s_mul_i32 s82, s71, 40
s_add_u32 s82, s82, s30
buffer_load_dwordx4 a[108:111], v2, s[36:39], s82 offen offset:0 sc1
v_mfma_f32_16x16x32_bf16 a[48:51], a[184:187], a[168:171], a[48:51]
v_mfma_f32_16x16x32_bf16 a[68:71], a[184:187], a[172:175], a[68:71]
buffer_load_dwordx4 a[112:115], v2, s[36:39], s82 offen offset:1024 sc1
s_waitcnt vmcnt(34)
v_mfma_f32_16x16x32_bf16 a[12:15], a[188:191], a[160:163], a[12:15]
v_mfma_f32_16x16x32_bf16 a[32:35], a[188:191], a[164:167], a[32:35]
buffer_load_dwordx4 a[116:119], v2, s[36:39], s82 offen offset:2048 sc1
v_mfma_f32_16x16x32_bf16 a[52:55], a[188:191], a[168:171], a[52:55]
v_mfma_f32_16x16x32_bf16 a[72:75], a[188:191], a[172:175], a[72:75]
buffer_load_dwordx4 a[120:123], v2, s[36:39], s82 offen offset:3072 sc1
s_waitcnt vmcnt(35)
v_mfma_f32_16x16x32_bf16 a[16:19], a[192:195], a[160:163], a[16:19]
v_mfma_f32_16x16x32_bf16 a[36:39], a[192:195], a[164:167], a[36:39]
buffer_load_dwordx4 a[124:127], v21, s[36:39], s82 offen offset:0 sc1
v_mfma_f32_16x16x32_bf16 a[56:59], a[192:195], a[168:171], a[56:59]
v_mfma_f32_16x16x32_bf16 a[76:79], a[192:195], a[172:175], a[76:79]
s_waitcnt vmcnt(31)
v_mfma_f32_16x16x32_bf16 a[0:3], a[212:215], a[196:199], a[0:3]
v_mfma_f32_16x16x32_bf16 a[20:23], a[212:215], a[200:203], a[20:23]
s_add_u32 s83, s72, s28
buffer_load_dwordx4 a[160:163], v5, s[36:39], s83 offen sc1
v_mfma_f32_16x16x32_bf16 a[40:43], a[212:215], a[204:207], a[40:43]
v_mfma_f32_16x16x32_bf16 a[60:63], a[212:215], a[208:211], a[60:63]
buffer_load_dwordx4 a[164:167], v6, s[36:39], s83 offen sc1
s_waitcnt vmcnt(32)
v_mfma_f32_16x16x32_bf16 a[4:7], a[216:219], a[196:199], a[4:7]
v_mfma_f32_16x16x32_bf16 a[24:27], a[216:219], a[200:203], a[24:27]
buffer_load_dwordx4 a[168:171], v7, s[36:39], s83 offen sc1
v_mfma_f32_16x16x32_bf16 a[44:47], a[216:219], a[204:207], a[44:47]
v_mfma_f32_16x16x32_bf16 a[64:67], a[216:219], a[208:211], a[64:67]
buffer_load_dwordx4 a[172:175], v8, s[36:39], s83 offen sc1
s_waitcnt vmcnt(33)
v_mfma_f32_16x16x32_bf16 a[8:11], a[220:223], a[196:199], a[8:11]
v_mfma_f32_16x16x32_bf16 a[28:31], a[220:223], a[200:203], a[28:31]
s_mul_i32 s84, s72, 40
s_add_u32 s84, s84, s30
buffer_load_dwordx4 a[176:179], v2, s[36:39], s84 offen offset:0 sc1
v_mfma_f32_16x16x32_bf16 a[48:51], a[220:223], a[204:207], a[48:51]
v_mfma_f32_16x16x32_bf16 a[68:71], a[220:223], a[208:211], a[68:71]
buffer_load_dwordx4 a[180:183], v2, s[36:39], s84 offen offset:1024 sc1
s_waitcnt vmcnt(34)
v_mfma_f32_16x16x32_bf16 a[12:15], a[224:227], a[196:199], a[12:15]
v_mfma_f32_16x16x32_bf16 a[32:35], a[224:227], a[200:203], a[32:35]
buffer_load_dwordx4 a[184:187], v2, s[36:39], s84 offen offset:2048 sc1
v_mfma_f32_16x16x32_bf16 a[52:55], a[224:227], a[204:207], a[52:55]
v_mfma_f32_16x16x32_bf16 a[72:75], a[224:227], a[208:211], a[72:75]
buffer_load_dwordx4 a[188:191], v2, s[36:39], s84 offen offset:3072 sc1
s_waitcnt vmcnt(35)
v_mfma_f32_16x16x32_bf16 a[16:19], a[228:231], a[196:199], a[16:19]
v_mfma_f32_16x16x32_bf16 a[36:39], a[228:231], a[200:203], a[36:39]
buffer_load_dwordx4 a[192:195], v21, s[36:39], s84 offen offset:0 sc1
v_mfma_f32_16x16x32_bf16 a[56:59], a[228:231], a[204:207], a[56:59]
v_mfma_f32_16x16x32_bf16 a[76:79], a[228:231], a[208:211], a[76:79]
s_waitcnt vmcnt(23)
v_mfma_f32_16x16x32_bf16 a[0:3], a[248:251], a[232:235], a[0:3]
v_mfma_f32_16x16x32_bf16 a[20:23], a[248:251], a[236:239], a[20:23]
s_add_u32 s85, s73, s28
buffer_load_dwordx4 a[196:199], v5, s[36:39], s85 offen sc1
v_mfma_f32_16x16x32_bf16 a[40:43], a[248:251], a[240:243], a[40:43]
v_mfma_f32_16x16x32_bf16 a[60:63], a[248:251], a[244:247], a[60:63]
buffer_load_dwordx4 a[200:203], v6, s[36:39], s85 offen sc1
s_waitcnt vmcnt(23)
v_mfma_f32_16x16x32_bf16 a[4:7], a[252:255], a[232:235], a[4:7]
v_mfma_f32_16x16x32_bf16 a[24:27], a[252:255], a[236:239], a[24:27]
buffer_load_dwordx4 a[204:207], v7, s[36:39], s85 offen sc1
v_mfma_f32_16x16x32_bf16 a[44:47], a[252:255], a[240:243], a[44:47]
v_mfma_f32_16x16x32_bf16 a[64:67], a[252:255], a[244:247], a[64:67]
buffer_load_dwordx4 a[208:211], v8, s[36:39], s85 offen sc1
s_waitcnt vmcnt(24)
v_mfma_f32_16x16x32_bf16 a[8:11], a[80:83], a[232:235], a[8:11]
v_mfma_f32_16x16x32_bf16 a[28:31], a[80:83], a[236:239], a[28:31]
s_mul_i32 s86, s73, 40
s_add_u32 s86, s86, s30
buffer_load_dwordx4 a[212:215], v2, s[36:39], s86 offen offset:0 sc1
v_mfma_f32_16x16x32_bf16 a[48:51], a[80:83], a[240:243], a[48:51]
v_mfma_f32_16x16x32_bf16 a[68:71], a[80:83], a[244:247], a[68:71]
buffer_load_dwordx4 a[216:219], v2, s[36:39], s86 offen offset:1024 sc1
s_waitcnt vmcnt(25)
v_mfma_f32_16x16x32_bf16 a[12:15], a[84:87], a[232:235], a[12:15]
v_mfma_f32_16x16x32_bf16 a[32:35], a[84:87], a[236:239], a[32:35]
buffer_load_dwordx4 a[220:223], v2, s[36:39], s86 offen offset:2048 sc1
v_mfma_f32_16x16x32_bf16 a[52:55], a[84:87], a[240:243], a[52:55]
v_mfma_f32_16x16x32_bf16 a[72:75], a[84:87], a[244:247], a[72:75]
buffer_load_dwordx4 a[224:227], v2, s[36:39], s86 offen offset:3072 sc1
s_waitcnt vmcnt(26)
v_mfma_f32_16x16x32_bf16 a[16:19], a[88:91], a[232:235], a[16:19]
v_mfma_f32_16x16x32_bf16 a[36:39], a[88:91], a[236:239], a[36:39]
buffer_load_dwordx4 a[228:231], v21, s[36:39], s86 offen offset:0 sc1
v_mfma_f32_16x16x32_bf16 a[56:59], a[88:91], a[240:243], a[56:59]
v_mfma_f32_16x16x32_bf16 a[76:79], a[88:91], a[244:247], a[76:79]
s_waitcnt vmcnt(22)
v_mfma_f32_16x16x32_bf16 a[0:3], a[108:111], a[92:95], a[0:3]
v_mfma_f32_16x16x32_bf16 a[20:23], a[108:111], a[96:99], a[20:23]
s_add_u32 s87, s74, s28
buffer_load_dwordx2 a[232:233], v9, s[36:39], s87 offen sc1
v_mfma_f32_16x16x32_bf16 a[40:43], a[108:111], a[100:103], a[40:43]
v_mfma_f32_16x16x32_bf16 a[60:63], a[108:111], a[104:107], a[60:63]
buffer_load_dwordx2 a[234:235], v9, s[36:39], s87 offen offset:512 sc1
s_waitcnt vmcnt(23)
v_mfma_f32_16x16x32_bf16 a[4:7], a[112:115], a[92:95], a[4:7]
v_mfma_f32_16x16x32_bf16 a[24:27], a[112:115], a[96:99], a[24:27]
buffer_load_dwordx2 a[236:237], v10, s[36:39], s87 offen sc1
v_mfma_f32_16x16x32_bf16 a[44:47], a[112:115], a[100:103], a[44:47]
v_mfma_f32_16x16x32_bf16 a[64:67], a[112:115], a[104:107], a[64:67]
buffer_load_dwordx2 a[238:239], v10, s[36:39], s87 offen offset:512 sc1
s_waitcnt vmcnt(24)
v_mfma_f32_16x16x32_bf16 a[8:11], a[116:119], a[92:95], a[8:11]
v_mfma_f32_16x16x32_bf16 a[28:31], a[116:119], a[96:99], a[28:31]
buffer_load_dwordx2 a[240:241], v11, s[36:39], s87 offen sc1
v_mfma_f32_16x16x32_bf16 a[48:51], a[116:119], a[100:103], a[48:51]
v_mfma_f32_16x16x32_bf16 a[68:71], a[116:119], a[104:107], a[68:71]
buffer_load_dwordx2 a[242:243], v11, s[36:39], s87 offen offset:512 sc1
s_waitcnt vmcnt(25)
v_mfma_f32_16x16x32_bf16 a[12:15], a[120:123], a[92:95], a[12:15]
v_mfma_f32_16x16x32_bf16 a[32:35], a[120:123], a[96:99], a[32:35]
buffer_load_dwordx2 a[244:245], v12, s[36:39], s87 offen sc1
v_mfma_f32_16x16x32_bf16 a[52:55], a[120:123], a[100:103], a[52:55]
buffer_load_dwordx2 a[246:247], v12, s[36:39], s87 offen offset:512 sc1
v_mfma_f32_16x16x32_bf16 a[72:75], a[120:123], a[104:107], a[72:75]
s_mul_i32 s88, s74, 40
s_add_u32 s88, s88, s30
buffer_load_dwordx4 a[248:251], v2, s[36:39], s88 offen offset:0 sc1
s_waitcnt vmcnt(27)
v_mfma_f32_16x16x32_bf16 a[16:19], a[124:127], a[92:95], a[16:19]
buffer_load_dwordx4 a[252:255], v2, s[36:39], s88 offen offset:1024 sc1
v_mfma_f32_16x16x32_bf16 a[36:39], a[124:127], a[96:99], a[36:39]
buffer_load_dwordx4 a[80:83], v2, s[36:39], s88 offen offset:2048 sc1
v_mfma_f32_16x16x32_bf16 a[56:59], a[124:127], a[100:103], a[56:59]
buffer_load_dwordx4 a[84:87], v2, s[36:39], s88 offen offset:3072 sc1
v_mfma_f32_16x16x32_bf16 a[76:79], a[124:127], a[104:107], a[76:79]
buffer_load_dwordx4 a[88:91], v21, s[36:39], s88 offen offset:0 sc1
s_waitcnt vmcnt(26)
v_mfma_f32_16x16x32_bf16 a[0:3], a[176:179], a[160:163], a[0:3]
v_mfma_f32_16x16x32_bf16 a[20:23], a[176:179], a[164:167], a[20:23]
s_add_u32 s89, s75, s28
buffer_load_dwordx4 a[92:95], v5, s[36:39], s89 offen sc1
v_mfma_f32_16x16x32_bf16 a[40:43], a[176:179], a[168:171], a[40:43]
v_mfma_f32_16x16x32_bf16 a[60:63], a[176:179], a[172:175], a[60:63]
buffer_load_dwordx4 a[96:99], v6, s[36:39], s89 offen sc1
s_waitcnt vmcnt(27)
v_mfma_f32_16x16x32_bf16 a[4:7], a[180:183], a[160:163], a[4:7]
v_mfma_f32_16x16x32_bf16 a[24:27], a[180:183], a[164:167], a[24:27]
buffer_load_dwordx4 a[100:103], v7, s[36:39], s89 offen sc1
v_mfma_f32_16x16x32_bf16 a[44:47], a[180:183], a[168:171], a[44:47]
v_mfma_f32_16x16x32_bf16 a[64:67], a[180:183], a[172:175], a[64:67]
buffer_load_dwordx4 a[104:107], v8, s[36:39], s89 offen sc1
s_waitcnt vmcnt(28)
v_mfma_f32_16x16x32_bf16 a[8:11], a[184:187], a[160:163], a[8:11]
v_mfma_f32_16x16x32_bf16 a[28:31], a[184:187], a[164:167], a[28:31]
s_mul_i32 s82, s75, 40
s_add_u32 s82, s82, s30
buffer_load_dwordx4 a[108:111], v2, s[36:39], s82 offen offset:0 sc1
v_mfma_f32_16x16x32_bf16 a[48:51], a[184:187], a[168:171], a[48:51]
v_mfma_f32_16x16x32_bf16 a[68:71], a[184:187], a[172:175], a[68:71]
buffer_load_dwordx4 a[112:115], v2, s[36:39], s82 offen offset:1024 sc1
s_waitcnt vmcnt(29)
v_mfma_f32_16x16x32_bf16 a[12:15], a[188:191], a[160:163], a[12:15]
v_mfma_f32_16x16x32_bf16 a[32:35], a[188:191], a[164:167], a[32:35]
buffer_load_dwordx4 a[116:119], v2, s[36:39], s82 offen offset:2048 sc1
v_mfma_f32_16x16x32_bf16 a[52:55], a[188:191], a[168:171], a[52:55]
v_mfma_f32_16x16x32_bf16 a[72:75], a[188:191], a[172:175], a[72:75]
buffer_load_dwordx4 a[120:123], v2, s[36:39], s82 offen offset:3072 sc1
s_waitcnt vmcnt(30)
v_mfma_f32_16x16x32_bf16 a[16:19], a[192:195], a[160:163], a[16:19]
v_mfma_f32_16x16x32_bf16 a[36:39], a[192:195], a[164:167], a[36:39]
buffer_load_dwordx4 a[124:127], v21, s[36:39], s82 offen offset:0 sc1
v_mfma_f32_16x16x32_bf16 a[56:59], a[192:195], a[168:171], a[56:59]
v_mfma_f32_16x16x32_bf16 a[76:79], a[192:195], a[172:175], a[76:79]
v_and_b32 v23, 3, v1
v_lshlrev_b32 v23, 2, v23
buffer_load_dword v22, v23, s[36:39], s40 offen sc1
s_waitcnt vmcnt(27)
v_mfma_f32_16x16x32_bf16 a[0:3], a[212:215], a[196:199], a[0:3]
v_mfma_f32_16x16x32_bf16 a[20:23], a[212:215], a[200:203], a[20:23]
s_add_u32 s83, s76, 12
s_mul_i32 s83, s83, 0xa000
s_add_u32 s83, s83, s30
buffer_load_dwordx4 a[176:179], v2, s[36:39], s83 offen offset:0 sc1
v_mfma_f32_16x16x32_bf16 a[40:43], a[212:215], a[204:207], a[40:43]
v_mfma_f32_16x16x32_bf16 a[60:63], a[212:215], a[208:211], a[60:63]
buffer_load_dwordx4 a[180:183], v2, s[36:39], s83 offen offset:1024 sc1
s_waitcnt vmcnt(28)
v_mfma_f32_16x16x32_bf16 a[4:7], a[216:219], a[196:199], a[4:7]
v_mfma_f32_16x16x32_bf16 a[24:27], a[216:219], a[200:203], a[24:27]
buffer_load_dwordx4 a[184:187], v2, s[36:39], s83 offen offset:2048 sc1
v_mfma_f32_16x16x32_bf16 a[44:47], a[216:219], a[204:207], a[44:47]
v_mfma_f32_16x16x32_bf16 a[64:67], a[216:219], a[208:211], a[64:67]
buffer_load_dwordx4 a[188:191], v2, s[36:39], s83 offen offset:3072 sc1
s_waitcnt vmcnt(29)
v_mfma_f32_16x16x32_bf16 a[8:11], a[220:223], a[196:199], a[8:11]
v_mfma_f32_16x16x32_bf16 a[28:31], a[220:223], a[200:203], a[28:31]
buffer_load_dwordx4 a[192:195], v21, s[36:39], s83 offen offset:0 sc1
v_mfma_f32_16x16x32_bf16 a[48:51], a[220:223], a[204:207], a[48:51]
v_mfma_f32_16x16x32_bf16 a[68:71], a[220:223], a[208:211], a[68:71]
s_waitcnt vmcnt(29)
v_mfma_f32_16x16x32_bf16 a[12:15], a[224:227], a[196:199], a[12:15]
v_mfma_f32_16x16x32_bf16 a[32:35], a[224:227], a[200:203], a[32:35]
v_mfma_f32_16x16x32_bf16 a[52:55], a[224:227], a[204:207], a[52:55]
v_mfma_f32_16x16x32_bf16 a[72:75], a[224:227], a[208:211], a[72:75]
s_waitcnt vmcnt(28)
v_mfma_f32_16x16x32_bf16 a[16:19], a[228:231], a[196:199], a[16:19]
v_mfma_f32_16x16x32_bf16 a[36:39], a[228:231], a[200:203], a[36:39]
v_mfma_f32_16x16x32_bf16 a[56:59], a[228:231], a[204:207], a[56:59]
v_mfma_f32_16x16x32_bf16 a[76:79], a[228:231], a[208:211], a[76:79]
s_waitcnt vmcnt(5)
v_cmp_eq_u32 vcc, 1, v22
s_nop 3
s_cmp_eq_u64 vcc, -1
s_cbranch_scc1 X_fo_ok
s_mov_b32 s60, 0
X_fo_spin:
s_add_u32 s60, s60, 1
s_cmp_ge_u32 s60, 0x40000
s_cbranch_scc1 X_fo_ok
s_sleep 16
buffer_load_dword v22, v23, s[36:39], s40 offen offset:0 sc1
s_waitcnt vmcnt(0)
v_cmp_eq_u32 vcc, 1, v22
s_nop 3
s_cmp_eq_u64 vcc, -1
s_cbranch_scc0 X_fo_spin
X_fo_ok:
v_mfma_f32_16x16x32_bf16 a[0:3], a[248:251], a[232:235], a[0:3]
v_mfma_f32_16x16x32_bf16 a[20:23], a[248:251], a[236:239], a[20:23]
s_lshr_b32 s84, s76, 1
s_mul_i32 s84, s84, 0xa00
s_and_b32 s85, s76, 1
s_lshl_b32 s85, s85, 10
s_add_u32 s84, s84, s85
s_add_u32 s84, s84, s29
buffer_load_dwordx4 a[160:163], v13, s[36:39], s84 offen sc1
v_mfma_f32_16x16x32_bf16 a[40:43], a[248:251], a[240:243], a[40:43]
v_mfma_f32_16x16x32_bf16 a[60:63], a[248:251], a[244:247], a[60:63]
buffer_load_dwordx4 a[164:167], v14, s[36:39], s84 offen sc1
v_mfma_f32_16x16x32_bf16 a[4:7], a[252:255], a[232:235], a[4:7]
v_mfma_f32_16x16x32_bf16 a[24:27], a[252:255], a[236:239], a[24:27]
buffer_load_dwordx4 a[168:171], v15, s[36:39], s84 offen sc1
v_mfma_f32_16x16x32_bf16 a[44:47], a[252:255], a[240:243], a[44:47]
v_mfma_f32_16x16x32_bf16 a[64:67], a[252:255], a[244:247], a[64:67]
buffer_load_dwordx4 a[172:175], v16, s[36:39], s84 offen sc1
v_mfma_f32_16x16x32_bf16 a[8:11], a[80:83], a[232:235], a[8:11]
v_mfma_f32_16x16x32_bf16 a[28:31], a[80:83], a[236:239], a[28:31]
s_lshr_b32 s86, s77, 1
s_mul_i32 s86, s86, 0xa00
s_and_b32 s87, s77, 1
s_lshl_b32 s87, s87, 10
s_add_u32 s86, s86, s87
s_add_u32 s86, s86, s29
buffer_load_dwordx4 a[196:199], v13, s[36:39], s86 offen sc1
v_mfma_f32_16x16x32_bf16 a[48:51], a[80:83], a[240:243], a[48:51]
v_mfma_f32_16x16x32_bf16 a[68:71], a[80:83], a[244:247], a[68:71]
buffer_load_dwordx4 a[200:203], v14, s[36:39], s86 offen sc1
v_mfma_f32_16x16x32_bf16 a[12:15], a[84:87], a[232:235], a[12:15]
v_mfma_f32_16x16x32_bf16 a[32:35], a[84:87], a[236:239], a[32:35]
buffer_load_dwordx4 a[204:207], v15, s[36:39], s86 offen sc1
v_mfma_f32_16x16x32_bf16 a[52:55], a[84:87], a[240:243], a[52:55]
buffer_load_dwordx4 a[208:211], v16, s[36:39], s86 offen sc1
v_mfma_f32_16x16x32_bf16 a[72:75], a[84:87], a[244:247], a[72:75]
s_add_u32 s88, s77, 12
s_mul_i32 s88, s88, 0xa000
s_add_u32 s88, s88, s30
buffer_load_dwordx4 a[212:215], v2, s[36:39], s88 offen offset:0 sc1
v_mfma_f32_16x16x32_bf16 a[16:19], a[88:91], a[232:235], a[16:19]
buffer_load_dwordx4 a[216:219], v2, s[36:39], s88 offen offset:1024 sc1
v_mfma_f32_16x16x32_bf16 a[36:39], a[88:91], a[236:239], a[36:39]
buffer_load_dwordx4 a[220:223], v2, s[36:39], s88 offen offset:2048 sc1
v_mfma_f32_16x16x32_bf16 a[56:59], a[88:91], a[240:243], a[56:59]
buffer_load_dwordx4 a[224:227], v2, s[36:39], s88 offen offset:3072 sc1
v_mfma_f32_16x16x32_bf16 a[76:79], a[88:91], a[244:247], a[76:79]
buffer_load_dwordx4 a[228:231], v21, s[36:39], s88 offen offset:0 sc1
v_mfma_f32_16x16x32_bf16 a[0:3], a[108:111], a[92:95], a[0:3]
v_mfma_f32_16x16x32_bf16 a[20:23], a[108:111], a[96:99], a[20:23]
s_lshr_b32 s89, s78, 1
s_mul_i32 s89, s89, 0xa00
s_and_b32 s82, s78, 1
s_lshl_b32 s82, s82, 10
s_add_u32 s89, s89, s82
s_add_u32 s89, s89, s29
buffer_load_dwordx4 a[232:235], v13, s[36:39], s89 offen sc1
v_mfma_f32_16x16x32_bf16 a[40:43], a[108:111], a[100:103], a[40:43]
v_mfma_f32_16x16x32_bf16 a[60:63], a[108:111], a[104:107], a[60:63]
buffer_load_dwordx4 a[236:239], v14, s[36:39], s89 offen sc1
v_mfma_f32_16x16x32_bf16 a[4:7], a[112:115], a[92:95], a[4:7]
v_mfma_f32_16x16x32_bf16 a[24:27], a[112:115], a[96:99], a[24:27]
buffer_load_dwordx4 a[240:243], v15, s[36:39], s89 offen sc1
v_mfma_f32_16x16x32_bf16 a[44:47], a[112:115], a[100:103], a[44:47]
v_mfma_f32_16x16x32_bf16 a[64:67], a[112:115], a[104:107], a[64:67]
buffer_load_dwordx4 a[244:247], v16, s[36:39], s89 offen sc1
v_mfma_f32_16x16x32_bf16 a[8:11], a[116:119], a[92:95], a[8:11]
v_mfma_f32_16x16x32_bf16 a[28:31], a[116:119], a[96:99], a[28:31]
s_add_u32 s83, s78, 12
s_mul_i32 s83, s83, 0xa000
s_add_u32 s83, s83, s30
buffer_load_dwordx4 a[248:251], v2, s[36:39], s83 offen offset:0 sc1
v_mfma_f32_16x16x32_bf16 a[48:51], a[116:119], a[100:103], a[48:51]
v_mfma_f32_16x16x32_bf16 a[68:71], a[116:119], a[104:107], a[68:71]
buffer_load_dwordx4 a[252:255], v2, s[36:39], s83 offen offset:1024 sc1
v_mfma_f32_16x16x32_bf16 a[12:15], a[120:123], a[92:95], a[12:15]
v_mfma_f32_16x16x32_bf16 a[32:35], a[120:123], a[96:99], a[32:35]
buffer_load_dwordx4 a[80:83], v2, s[36:39], s83 offen offset:2048 sc1
v_mfma_f32_16x16x32_bf16 a[52:55], a[120:123], a[100:103], a[52:55]
v_mfma_f32_16x16x32_bf16 a[72:75], a[120:123], a[104:107], a[72:75]
buffer_load_dwordx4 a[84:87], v2, s[36:39], s83 offen offset:3072 sc1
v_mfma_f32_16x16x32_bf16 a[16:19], a[124:127], a[92:95], a[16:19]
v_mfma_f32_16x16x32_bf16 a[36:39], a[124:127], a[96:99], a[36:39]
buffer_load_dwordx4 a[88:91], v21, s[36:39], s83 offen offset:0 sc1
v_mfma_f32_16x16x32_bf16 a[56:59], a[124:127], a[100:103], a[56:59]
v_mfma_f32_16x16x32_bf16 a[76:79], a[124:127], a[104:107], a[76:79]
s_waitcnt vmcnt(21)
v_mfma_f32_16x16x32_bf16 a[0:3], a[176:179], a[160:163], a[0:3]
s_waitcnt vmcnt(20)
v_mfma_f32_16x16x32_bf16 a[20:23], a[176:179], a[164:167], a[20:23]
s_lshr_b32 s84, s79, 1
s_mul_i32 s84, s84, 0xa00
s_and_b32 s85, s79, 1
s_lshl_b32 s85, s85, 10
s_add_u32 s84, s84, s85
s_add_u32 s84, s84, s29
buffer_load_dwordx4 a[92:95], v13, s[36:39], s84 offen sc1
s_waitcnt vmcnt(20)
v_mfma_f32_16x16x32_bf16 a[40:43], a[176:179], a[168:171], a[40:43]
s_waitcnt vmcnt(19)
v_mfma_f32_16x16x32_bf16 a[60:63], a[176:179], a[172:175], a[60:63]
buffer_load_dwordx4 a[96:99], v14, s[36:39], s84 offen sc1
v_mfma_f32_16x16x32_bf16 a[4:7], a[180:183], a[160:163], a[4:7]
v_mfma_f32_16x16x32_bf16 a[24:27], a[180:183], a[164:167], a[24:27]
buffer_load_dwordx4 a[100:103], v15, s[36:39], s84 offen sc1
v_mfma_f32_16x16x32_bf16 a[44:47], a[180:183], a[168:171], a[44:47]
v_mfma_f32_16x16x32_bf16 a[64:67], a[180:183], a[172:175], a[64:67]
buffer_load_dwordx4 a[104:107], v16, s[36:39], s84 offen sc1
v_mfma_f32_16x16x32_bf16 a[8:11], a[184:187], a[160:163], a[8:11]
v_mfma_f32_16x16x32_bf16 a[28:31], a[184:187], a[164:167], a[28:31]
s_add_u32 s86, s79, 12
s_mul_i32 s86, s86, 0xa000
s_add_u32 s86, s86, s30
buffer_load_dwordx4 a[108:111], v2, s[36:39], s86 offen offset:0 sc1
v_mfma_f32_16x16x32_bf16 a[48:51], a[184:187], a[168:171], a[48:51]
v_mfma_f32_16x16x32_bf16 a[68:71], a[184:187], a[172:175], a[68:71]
buffer_load_dwordx4 a[112:115], v2, s[36:39], s86 offen offset:1024 sc1
v_mfma_f32_16x16x32_bf16 a[12:15], a[188:191], a[160:163], a[12:15]
v_mfma_f32_16x16x32_bf16 a[32:35], a[188:191], a[164:167], a[32:35]
buffer_load_dwordx4 a[116:119], v2, s[36:39], s86 offen offset:2048 sc1
v_mfma_f32_16x16x32_bf16 a[52:55], a[188:191], a[168:171], a[52:55]
v_mfma_f32_16x16x32_bf16 a[72:75], a[188:191], a[172:175], a[72:75]
buffer_load_dwordx4 a[120:123], v2, s[36:39], s86 offen offset:3072 sc1
v_mfma_f32_16x16x32_bf16 a[16:19], a[192:195], a[160:163], a[16:19]
v_mfma_f32_16x16x32_bf16 a[36:39], a[192:195], a[164:167], a[36:39]
buffer_load_dwordx4 a[124:127], v21, s[36:39], s86 offen offset:0 sc1
v_mfma_f32_16x16x32_bf16 a[56:59], a[192:195], a[168:171], a[56:59]
v_mfma_f32_16x16x32_bf16 a[76:79], a[192:195], a[172:175], a[76:79]
s_waitcnt vmcnt(22)
v_mfma_f32_16x16x32_bf16 a[0:3], a[212:215], a[196:199], a[0:3]
v_mfma_f32_16x16x32_bf16 a[20:23], a[212:215], a[200:203], a[20:23]
s_add_u32 s87, s29, 0x800
buffer_load_dwordx2 a[160:161], v17, s[36:39], s87 offen sc1
v_mfma_f32_16x16x32_bf16 a[40:43], a[212:215], a[204:207], a[40:43]
v_mfma_f32_16x16x32_bf16 a[60:63], a[212:215], a[208:211], a[60:63]
buffer_load_dwordx2 a[162:163], v17, s[36:39], s87 offen offset:2560 sc1
s_waitcnt vmcnt(23)
v_mfma_f32_16x16x32_bf16 a[4:7], a[216:219], a[196:199], a[4:7]
v_mfma_f32_16x16x32_bf16 a[24:27], a[216:219], a[200:203], a[24:27]
buffer_load_dwordx2 a[164:165], v18, s[36:39], s87 offen sc1
v_mfma_f32_16x16x32_bf16 a[44:47], a[216:219], a[204:207], a[44:47]
v_mfma_f32_16x16x32_bf16 a[64:67], a[216:219], a[208:211], a[64:67]
buffer_load_dwordx2 a[166:167], v18, s[36:39], s87 offen offset:2560 sc1
s_waitcnt vmcnt(24)
v_mfma_f32_16x16x32_bf16 a[8:11], a[220:223], a[196:199], a[8:11]
v_mfma_f32_16x16x32_bf16 a[28:31], a[220:223], a[200:203], a[28:31]
buffer_load_dwordx2 a[168:169], v19, s[36:39], s87 offen sc1
v_mfma_f32_16x16x32_bf16 a[48:51], a[220:223], a[204:207], a[48:51]
v_mfma_f32_16x16x32_bf16 a[68:71], a[220:223], a[208:211], a[68:71]
buffer_load_dwordx2 a[170:171], v19, s[36:39], s87 offen offset:2560 sc1
s_waitcnt vmcnt(25)
v_mfma_f32_16x16x32_bf16 a[12:15], a[224:227], a[196:199], a[12:15]
v_mfma_f32_16x16x32_bf16 a[32:35], a[224:227], a[200:203], a[32:35]
buffer_load_dwordx2 a[172:173], v20, s[36:39], s87 offen sc1
v_mfma_f32_16x16x32_bf16 a[52:55], a[224:227], a[204:207], a[52:55]
buffer_load_dwordx2 a[174:175], v20, s[36:39], s87 offen offset:2560 sc1
v_mfma_f32_16x16x32_bf16 a[72:75], a[224:227], a[208:211], a[72:75]
s_add_u32 s88, s30, 0xa0000
buffer_load_dwordx4 a[176:179], v2, s[36:39], s88 offen offset:0 sc1
s_waitcnt vmcnt(27)
v_mfma_f32_16x16x32_bf16 a[16:19], a[228:231], a[196:199], a[16:19]
buffer_load_dwordx4 a[180:183], v2, s[36:39], s88 offen offset:1024 sc1
v_mfma_f32_16x16x32_bf16 a[36:39], a[228:231], a[200:203], a[36:39]
buffer_load_dwordx4 a[184:187], v2, s[36:39], s88 offen offset:2048 sc1
v_mfma_f32_16x16x32_bf16 a[56:59], a[228:231], a[204:207], a[56:59]
buffer_load_dwordx4 a[188:191], v2, s[36:39], s88 offen offset:3072 sc1
v_mfma_f32_16x16x32_bf16 a[76:79], a[228:231], a[208:211], a[76:79]
buffer_load_dwordx4 a[192:195], v21, s[36:39], s88 offen offset:0 sc1
s_waitcnt vmcnt(26)
v_mfma_f32_16x16x32_bf16 a[0:3], a[248:251], a[232:235], a[0:3]
v_mfma_f32_16x16x32_bf16 a[20:23], a[248:251], a[236:239], a[20:23]
v_mfma_f32_16x16x32_bf16 a[40:43], a[248:251], a[240:243], a[40:43]
v_mfma_f32_16x16x32_bf16 a[60:63], a[248:251], a[244:247], a[60:63]
s_waitcnt vmcnt(25)
v_mfma_f32_16x16x32_bf16 a[4:7], a[252:255], a[232:235], a[4:7]
v_mfma_f32_16x16x32_bf16 a[24:27], a[252:255], a[236:239], a[24:27]
v_mfma_f32_16x16x32_bf16 a[44:47], a[252:255], a[240:243], a[44:47]
v_mfma_f32_16x16x32_bf16 a[64:67], a[252:255], a[244:247], a[64:67]
s_waitcnt vmcnt(24)
v_mfma_f32_16x16x32_bf16 a[8:11], a[80:83], a[232:235], a[8:11]
v_mfma_f32_16x16x32_bf16 a[28:31], a[80:83], a[236:239], a[28:31]
v_mfma_f32_16x16x32_bf16 a[48:51], a[80:83], a[240:243], a[48:51]
v_mfma_f32_16x16x32_bf16 a[68:71], a[80:83], a[244:247], a[68:71]
s_waitcnt vmcnt(23)
v_mfma_f32_16x16x32_bf16 a[12:15], a[84:87], a[232:235], a[12:15]
v_mfma_f32_16x16x32_bf16 a[32:35], a[84:87], a[236:239], a[32:35]
v_mfma_f32_16x16x32_bf16 a[52:55], a[84:87], a[240:243], a[52:55]
v_mfma_f32_16x16x32_bf16 a[72:75], a[84:87], a[244:247], a[72:75]
s_waitcnt vmcnt(22)
v_mfma_f32_16x16x32_bf16 a[16:19], a[88:91], a[232:235], a[16:19]
v_mfma_f32_16x16x32_bf16 a[36:39], a[88:91], a[236:239], a[36:39]
v_mfma_f32_16x16x32_bf16 a[56:59], a[88:91], a[240:243], a[56:59]
v_mfma_f32_16x16x32_bf16 a[76:79], a[88:91], a[244:247], a[76:79]
s_waitcnt vmcnt(17)
v_mfma_f32_16x16x32_bf16 a[0:3], a[108:111], a[92:95], a[0:3]
v_mfma_f32_16x16x32_bf16 a[20:23], a[108:111], a[96:99], a[20:23]
v_mfma_f32_16x16x32_bf16 a[40:43], a[108:111], a[100:103], a[40:43]
v_mfma_f32_16x16x32_bf16 a[60:63], a[108:111], a[104:107], a[60:63]
s_waitcnt vmcnt(16)
v_mfma_f32_16x16x32_bf16 a[4:7], a[112:115], a[92:95], a[4:7]
v_mfma_f32_16x16x32_bf16 a[24:27], a[112:115], a[96:99], a[24:27]
v_mfma_f32_16x16x32_bf16 a[44:47], a[112:115], a[100:103], a[44:47]
v_mfma_f32_16x16x32_bf16 a[64:67], a[112:115], a[104:107], a[64:67]
s_waitcnt vmcnt(15)
v_mfma_f32_16x16x32_bf16 a[8:11], a[116:119], a[92:95], a[8:11]
v_mfma_f32_16x16x32_bf16 a[28:31], a[116:119], a[96:99], a[28:31]
v_mfma_f32_16x16x32_bf16 a[48:51], a[116:119], a[100:103], a[48:51]
v_mfma_f32_16x16x32_bf16 a[68:71], a[116:119], a[104:107], a[68:71]
s_waitcnt vmcnt(14)
v_mfma_f32_16x16x32_bf16 a[12:15], a[120:123], a[92:95], a[12:15]
v_mfma_f32_16x16x32_bf16 a[32:35], a[120:123], a[96:99], a[32:35]
v_mfma_f32_16x16x32_bf16 a[52:55], a[120:123], a[100:103], a[52:55]
v_mfma_f32_16x16x32_bf16 a[72:75], a[120:123], a[104:107], a[72:75]
s_waitcnt vmcnt(13)
v_mfma_f32_16x16x32_bf16 a[16:19], a[124:127], a[92:95], a[16:19]
v_mfma_f32_16x16x32_bf16 a[36:39], a[124:127], a[96:99], a[36:39]
v_mfma_f32_16x16x32_bf16 a[56:59], a[124:127], a[100:103], a[56:59]
v_mfma_f32_16x16x32_bf16 a[76:79], a[124:127], a[104:107], a[76:79]
v_lshrrev_b32 v84, 4, v1
v_and_b32 v85, 15, v1
v_mul_u32_u24 v86, 0x150, v85
v_lshl_add_u32 v86, v84, 4, v86
s_mul_i32 s57, s52, 0x5400
s_add_u32 s57, s57, 0x4000
v_add_u32 v86, s57, v86
s_waitcnt vmcnt(4)
v_mfma_f32_16x16x32_bf16 a[0:3], a[176:179], a[160:163], a[0:3]
v_mfma_f32_16x16x32_bf16 a[20:23], a[176:179], a[164:167], a[20:23]
v_mfma_f32_16x16x32_bf16 a[40:43], a[176:179], a[168:171], a[40:43]
v_mfma_f32_16x16x32_bf16 a[60:63], a[176:179], a[172:175], a[60:63]
s_waitcnt vmcnt(3)
v_mfma_f32_16x16x32_bf16 a[4:7], a[180:183], a[160:163], a[4:7]
v_mfma_f32_16x16x32_bf16 a[24:27], a[180:183], a[164:167], a[24:27]
s_nop 1
ds_write_b128 v86, a[0:3] offset:0
v_mfma_f32_16x16x32_bf16 a[44:47], a[180:183], a[168:171], a[44:47]
ds_write_b128 v86, a[20:23] offset:5376
v_mfma_f32_16x16x32_bf16 a[64:67], a[180:183], a[172:175], a[64:67]
ds_write_b128 v86, a[40:43] offset:10752
s_waitcnt vmcnt(2)
v_mfma_f32_16x16x32_bf16 a[8:11], a[184:187], a[160:163], a[8:11]
ds_write_b128 v86, a[60:63] offset:16128
v_mfma_f32_16x16x32_bf16 a[28:31], a[184:187], a[164:167], a[28:31]
ds_write_b128 v86, a[4:7] offset:64
v_mfma_f32_16x16x32_bf16 a[48:51], a[184:187], a[168:171], a[48:51]
ds_write_b128 v86, a[24:27] offset:5440
v_mfma_f32_16x16x32_bf16 a[68:71], a[184:187], a[172:175], a[68:71]
ds_write_b128 v86, a[44:47] offset:10816
s_waitcnt vmcnt(1)
v_mfma_f32_16x16x32_bf16 a[12:15], a[188:191], a[160:163], a[12:15]
ds_write_b128 v86, a[64:67] offset:16192
v_mfma_f32_16x16x32_bf16 a[32:35], a[188:191], a[164:167], a[32:35]
ds_write_b128 v86, a[8:11] offset:128
v_mfma_f32_16x16x32_bf16 a[52:55], a[188:191], a[168:171], a[52:55]
ds_write_b128 v86, a[28:31] offset:5504
v_mfma_f32_16x16x32_bf16 a[72:75], a[188:191], a[172:175], a[72:75]
ds_write_b128 v86, a[48:51] offset:10880
s_waitcnt vmcnt(0)
v_mfma_f32_16x16x32_bf16 a[16:19], a[192:195], a[160:163], a[16:19]
ds_write_b128 v86, a[68:71] offset:16256
v_mfma_f32_16x16x32_bf16 a[36:39], a[192:195], a[164:167], a[36:39]
ds_write_b128 v86, a[12:15] offset:192
v_mfma_f32_16x16x32_bf16 a[56:59], a[192:195], a[168:171], a[56:59]
ds_write_b128 v86, a[32:35] offset:5568
v_mfma_f32_16x16x32_bf16 a[76:79], a[192:195], a[172:175], a[76:79]
ds_write_b128 v86, a[52:55] offset:10944
ds_write_b128 v86, a[72:75] offset:16320
ds_write_b128 v86, a[16:19] offset:256
s_nop 0
ds_write_b128 v86, a[36:39] offset:5632
s_nop 0
ds_write_b128 v86, a[56:59] offset:11008
s_nop 0
ds_write_b128 v86, a[76:79] offset:16384
s_waitcnt lgkmcnt(0)
s_barrier
ds_read_b128 v[96:99], v69 offset:0
ds_read_b128 v[100:103], v69 offset:21504
ds_read_b128 v[104:107], v69 offset:43008
ds_read_b128 v[108:111], v69 offset:64512
ds_read_b128 v[112:115], v70 offset:0
ds_read_b128 v[116:119], v70 offset:21504
ds_read_b128 v[120:123], v70 offset:43008
ds_read_b128 v[124:127], v70 offset:64512
ds_read_b128 v[128:131], v71 offset:0
ds_read_b128 v[132:135], v71 offset:21504
ds_read_b128 v[136:139], v71 offset:43008
ds_read_b128 v[140:143], v71 offset:64512
ds_read_b128 v[144:147], v72 offset:0
ds_read_b128 v[148:151], v72 offset:21504
ds_read_b128 v[152:155], v72 offset:43008
ds_read_b128 v[156:159], v72 offset:64512
ds_read_b128 v[160:163], v73 offset:0
ds_read_b128 v[164:167], v73 offset:21504
ds_read_b128 v[168:171], v73 offset:43008
ds_read_b128 v[172:175], v73 offset:64512
s_mov_b32 s57, 0xffff0000
s_waitcnt lgkmcnt(15)
v_add_f32 v96, v96, v100
v_add_f32 v104, v104, v108
v_add_f32 v97, v97, v101
v_add_f32 v105, v105, v109
v_add_f32 v98, v98, v102
v_add_f32 v106, v106, v110
v_add_f32 v99, v99, v103
v_add_f32 v107, v107, v111
v_lshlrev_b32 v100, 16, v74
v_and_b32 v101, s57, v74
v_lshlrev_b32 v102, 16, v75
v_and_b32 v103, s57, v75
v_add_f32 v96, v96, v104
v_add_f32 v97, v97, v105
v_add_f32 v98, v98, v106
v_add_f32 v99, v99, v107
v_add_f32 v96, v96, v100
v_add_f32 v97, v97, v101
v_add_f32 v98, v98, v102
v_add_f32 v99, v99, v103
v_cvt_pk_bf16_f32 v96, v96, v97
v_cvt_pk_bf16_f32 v97, v98, v99
buffer_store_dwordx2 v[96:97], v64, s[44:47], 0 offen sc1
s_waitcnt lgkmcnt(14)
v_add_f32 v112, v112, v116
s_waitcnt lgkmcnt(12)
v_add_f32 v120, v120, v124
v_add_f32 v113, v113, v117
v_add_f32 v121, v121, v125
v_add_f32 v114, v114, v118
v_add_f32 v122, v122, v126
v_add_f32 v115, v115, v119
v_add_f32 v123, v123, v127
v_lshlrev_b32 v116, 16, v76
v_and_b32 v117, s57, v76
v_lshlrev_b32 v118, 16, v77
v_and_b32 v119, s57, v77
v_add_f32 v112, v112, v120
v_add_f32 v113, v113, v121
v_add_f32 v114, v114, v122
v_add_f32 v115, v115, v123
v_add_f32 v112, v112, v116
v_add_f32 v113, v113, v117
v_add_f32 v114, v114, v118
v_add_f32 v115, v115, v119
v_cvt_pk_bf16_f32 v112, v112, v113
v_cvt_pk_bf16_f32 v113, v114, v115
buffer_store_dwordx2 v[112:113], v65, s[44:47], 0 offen sc1
s_waitcnt lgkmcnt(10)
v_add_f32 v128, v128, v132
s_waitcnt lgkmcnt(8)
v_add_f32 v136, v136, v140
v_add_f32 v129, v129, v133
v_add_f32 v137, v137, v141
v_add_f32 v130, v130, v134
v_add_f32 v138, v138, v142
v_add_f32 v131, v131, v135
v_add_f32 v139, v139, v143
v_lshlrev_b32 v132, 16, v78
v_and_b32 v133, s57, v78
v_lshlrev_b32 v134, 16, v79
v_and_b32 v135, s57, v79
v_add_f32 v128, v128, v136
v_add_f32 v129, v129, v137
v_add_f32 v130, v130, v138
v_add_f32 v131, v131, v139
v_add_f32 v128, v128, v132
v_add_f32 v129, v129, v133
v_add_f32 v130, v130, v134
v_add_f32 v131, v131, v135
v_cvt_pk_bf16_f32 v128, v128, v129
v_cvt_pk_bf16_f32 v129, v130, v131
buffer_store_dwordx2 v[128:129], v66, s[44:47], 0 offen sc1
s_waitcnt lgkmcnt(6)
v_add_f32 v144, v144, v148
s_waitcnt lgkmcnt(4)
v_add_f32 v152, v152, v156
v_add_f32 v145, v145, v149
v_add_f32 v153, v153, v157
v_add_f32 v146, v146, v150
v_add_f32 v154, v154, v158
v_add_f32 v147, v147, v151
v_add_f32 v155, v155, v159
v_lshlrev_b32 v148, 16, v80
v_and_b32 v149, s57, v80
v_lshlrev_b32 v150, 16, v81
v_and_b32 v151, s57, v81
v_add_f32 v144, v144, v152
v_add_f32 v145, v145, v153
v_add_f32 v146, v146, v154
v_add_f32 v147, v147, v155
v_add_f32 v144, v144, v148
v_add_f32 v145, v145, v149
v_add_f32 v146, v146, v150
v_add_f32 v147, v147, v151
v_cvt_pk_bf16_f32 v144, v144, v145
v_cvt_pk_bf16_f32 v145, v146, v147
buffer_store_dwordx2 v[144:145], v67, s[44:47], 0 offen sc1
s_waitcnt lgkmcnt(2)
v_add_f32 v160, v160, v164
s_waitcnt lgkmcnt(0)
v_add_f32 v168, v168, v172
v_add_f32 v161, v161, v165
v_add_f32 v169, v169, v173
v_add_f32 v162, v162, v166
v_add_f32 v170, v170, v174
v_add_f32 v163, v163, v167
v_add_f32 v171, v171, v175
v_lshlrev_b32 v164, 16, v82
v_and_b32 v165, s57, v82
v_lshlrev_b32 v166, 16, v83
v_and_b32 v167, s57, v83
v_add_f32 v160, v160, v168
v_add_f32 v161, v161, v169
v_add_f32 v162, v162, v170
v_add_f32 v163, v163, v171
v_add_f32 v160, v160, v164
v_add_f32 v161, v161, v165
v_add_f32 v162, v162, v166
v_add_f32 v163, v163, v167
v_cvt_pk_bf16_f32 v160, v160, v161
v_cvt_pk_bf16_f32 v161, v162, v163
buffer_store_dwordx2 v[160:161], v68, s[44:47], 0 offen sc1
s_endpgm
F_Y:
s_nop 11
s_lshl_b32 s16, s53, 7
s_lshl_b32 s58, s52, 5
s_add_u32 s16, s16, s58
s_mul_i32 s16, s16, 0x500
s_mul_i32 s17, s52, 0x7000
s_add_u32 s17, s17, 0xa000
s_mov_b32 s18, s55
s_add_u32 m0, s17, 0
s_lshl_b32 s59, s18, 7
s_add_u32 s59, s59, s16
buffer_load_dwordx4 v27, s[24:27], s59 offen offset:0 lds
buffer_load_dwordx4 v28, s[24:27], s59 offen offset:1024 lds
buffer_load_dwordx4 v29, s[24:27], s59 offen offset:2048 lds
buffer_load_dwordx4 v30, s[24:27], s59 offen offset:3072 lds
s_add_u32 s18, s18, 1
s_cmp_eq_u32 s18, 10
s_cselect_b32 s18, 0, s18
v_mov_b32 v32, 0
v_mov_b32 v33, 0
v_mov_b32 v34, 0
v_mov_b32 v35, 0
s_mul_i32 s4, s54, 0xc80
s_mul_i32 s5, s52, 0x320
s_add_u32 s4, s4, s5
s_add_u32 m0, s5, 0x26000
s_nop 0
buffer_load_dwordx4 v2, s[40:43], s4 offen lds
s_or_b32 s4, s53, s54
s_cmp_eq_u32 s4, 0
s_cselect_b32 s4, 0, 0x7ff00000
s_mul_i32 s6, s52, 0x2c00
s_add_u32 s6, s6, 0xb46000
s_lshl_b32 s5, s52, 2
s_add_u32 s5, s5, 64
v_add_u32 v36, s4, v2
buffer_store_dwordx4 v[32:35], v36, s[36:39], s6 offen offset:0 sc1
buffer_store_dwordx4 v[32:35], v36, s[36:39], s6 offen offset:1024 sc1
buffer_store_dwordx4 v[32:35], v36, s[36:39], s6 offen offset:2048 sc1
buffer_store_dwordx4 v[32:35], v36, s[36:39], s6 offen offset:3072 sc1
s_add_u32 s6, s6, 0x1000
buffer_store_dwordx4 v[32:35], v36, s[36:39], s6 offen offset:0 sc1
buffer_store_dwordx4 v[32:35], v36, s[36:39], s6 offen offset:1024 sc1
buffer_store_dwordx4 v[32:35], v36, s[36:39], s6 offen offset:2048 sc1
buffer_store_dwordx4 v[32:35], v36, s[36:39], s6 offen offset:3072 sc1
s_add_u32 s6, s6, 0x1000
buffer_store_dwordx4 v[32:35], v36, s[36:39], s6 offen offset:0 sc1
buffer_store_dwordx4 v[32:35], v36, s[36:39], s6 offen offset:1024 sc1
buffer_store_dwordx4 v[32:35], v36, s[36:39], s6 offen offset:2048 sc1
v_mov_b32 v37, s5
v_add_u32 v37, s4, v37
s_add_u32 m0, s17, 0x1000
s_lshl_b32 s59, s18, 7
s_add_u32 s59, s59, s16
buffer_load_dwordx4 v27, s[24:27], s59 offen offset:0 lds
buffer_load_dwordx4 v28, s[24:27], s59 offen offset:1024 lds
buffer_load_dwordx4 v29, s[24:27], s59 offen offset:2048 lds
buffer_load_dwordx4 v30, s[24:27], s59 offen offset:3072 lds
s_add_u32 s18, s18, 1
s_cmp_eq_u32 s18, 10
s_cselect_b32 s18, 0, s18
v_add_u32 v42, 0x26e00, v2
ds_write_b128 v42, v[32:35]
ds_write_b128 v42, v[32:35] offset:1024
v_and_b32 v42, 31, v1
v_lshrrev_b32 v43, 5, v1
v_bfe_u32 v44, v1, 1, 3
v_xor_b32 v43, v43, v44
v_lshlrev_b32 v42, 7, v42
v_add_u32 v42, s17, v42
v_xor_b32 v44, 0, v43
v_lshl_add_u32 v38, v44, 4, v42
v_xor_b32 v44, 2, v43
v_lshl_add_u32 v39, v44, 4, v42
v_xor_b32 v44, 4, v43
v_lshl_add_u32 v40, v44, 4, v42
v_xor_b32 v44, 6, v43
v_lshl_add_u32 v41, v44, 4, v42
s_lshr_b32 s8, s52, 1
s_mul_i32 s8, s8, 0x2800
s_and_b32 s9, s52, 1
s_mul_i32 s9, s9, 0x1400
s_add_u32 s96, s8, s9
s_lshr_b32 s12, s52, 1
s_lshl_b32 s12, s12, 2
s_and_b32 s9, s52, 1
s_lshl_b32 s9, s9, 5
s_mul_i32 s13, s54, 0x180
s_add_u32 s13, s13, 0x100
s_mov_b32 s8, 0
v_add_u32 v42, 0, v1
v_mul_u32_u24 v43, 0x199a, v42
v_lshrrev_b32 v43, 16, v43
v_mul_u32_u24 v44, 10, v43
v_sub_u32 v44, v42, v44
v_min_u32 v44, 7, v44
v_lshl_add_u32 v44, v44, 4, s13
v_xor_b32 v43, s12, v43
v_add_u32 v43, s9, v43
v_mul_u32_u24 v43, 0xc00, v43
v_add_u32 v5, v43, v44
v_add_u32 v42, 64, v1
v_mul_u32_u24 v43, 0x199a, v42
v_lshrrev_b32 v43, 16, v43
v_mul_u32_u24 v44, 10, v43
v_sub_u32 v44, v42, v44
v_min_u32 v44, 7, v44
v_lshl_add_u32 v44, v44, 4, s13
v_xor_b32 v43, s12, v43
v_add_u32 v43, s9, v43
s_add_u32 m0, s17, 0x2000
s_lshl_b32 s59, s18, 7
s_add_u32 s59, s59, s16
buffer_load_dwordx4 v27, s[24:27], s59 offen offset:0 lds
buffer_load_dwordx4 v28, s[24:27], s59 offen offset:1024 lds
buffer_load_dwordx4 v29, s[24:27], s59 offen offset:2048 lds
buffer_load_dwordx4 v30, s[24:27], s59 offen offset:3072 lds
s_add_u32 s18, s18, 1
s_cmp_eq_u32 s18, 10
s_cselect_b32 s18, 0, s18
v_mul_u32_u24 v43, 0xc00, v43
v_add_u32 v43, v43, v44
v_subrev_u32 v6, 0x400, v43
v_add_u32 v42, 0x80, v1
v_mul_u32_u24 v43, 0x199a, v42
v_lshrrev_b32 v43, 16, v43
v_mul_u32_u24 v44, 10, v43
v_sub_u32 v44, v42, v44
v_min_u32 v44, 7, v44
v_lshl_add_u32 v44, v44, 4, s13
v_xor_b32 v43, s12, v43
v_add_u32 v43, s9, v43
v_mul_u32_u24 v43, 0xc00, v43
v_add_u32 v43, v43, v44
v_subrev_u32 v7, 0x800, v43
v_add_u32 v42, 0xc0, v1
v_mul_u32_u24 v43, 0x199a, v42
v_lshrrev_b32 v43, 16, v43
v_mul_u32_u24 v44, 10, v43
v_sub_u32 v44, v42, v44
v_min_u32 v44, 7, v44
v_lshl_add_u32 v44, v44, 4, s13
v_xor_b32 v43, s12, v43
v_add_u32 v43, s9, v43
v_mul_u32_u24 v43, 0xc00, v43
v_add_u32 v43, v43, v44
v_subrev_u32 v8, 0xc00, v43
v_add_u32 v42, 0x100, v1
v_mul_u32_u24 v43, 0x199a, v42
v_lshrrev_b32 v43, 16, v43
v_mul_u32_u24 v44, 10, v43
v_sub_u32 v44, v42, v44
v_min_u32 v44, 7, v44
v_lshl_add_u32 v44, v44, 4, s13
v_xor_b32 v43, s12, v43
v_add_u32 v43, s9, v43
v_mul_u32_u24 v43, 0xc00, v43
v_add_u32 v9, v43, v44
v_bfe_u32 v42, v1, 4, 1
v_lshrrev_b32 v43, 5, v1
v_bfe_u32 v44, v1, 2, 2
v_and_b32 v45, 3, v1
v_lshl_add_u32 v44, v43, 3, v44
v_mul_u32_u24 v44, 0xa0, v44
v_lshl_add_u32 v44, v45, 3, v44
v_mul_u32_u24 v43, 0x2a80, v42
v_add3_u32 v16, v44, v43, s8
v_mul_u32_u24 v43, 0x2580, v42
v_add_u32 v43, 0x280, v43
v_add3_u32 v17, v44, v43, s8
s_add_u32 m0, s17, 0x3000
s_lshl_b32 s59, s18, 7
s_add_u32 s59, s59, s16
buffer_load_dwordx4 v27, s[24:27], s59 offen offset:0 lds
buffer_load_dwordx4 v28, s[24:27], s59 offen offset:1024 lds
buffer_load_dwordx4 v29, s[24:27], s59 offen offset:2048 lds
buffer_load_dwordx4 v30, s[24:27], s59 offen offset:3072 lds
s_add_u32 s18, s18, 1
s_cmp_eq_u32 s18, 10
s_cselect_b32 s18, 0, s18
s_mul_i32 s97, s52, 0xc00
s_lshl_b32 s9, s52, 4
s_mul_i32 s13, s54, 0xa0
s_mov_b32 s8, 0xf000
v_add_u32 v42, 0, v1
v_mul_u32_u24 v43, 0x1556, v42
v_lshrrev_b32 v43, 16, v43
v_mul_u32_u24 v44, 12, v43
v_sub_u32 v44, v42, v44
v_mul_u32_u24 v45, 43, v44
v_lshrrev_b32 v45, 8, v45
v_mul_u32_u24 v42, 6, v45
v_sub_u32 v44, v44, v42
v_min_u32 v44, 4, v44
v_lshlrev_b32 v44, 4, v44
v_mul_u32_u24 v45, 0x50, v45
v_add3_u32 v44, v44, v45, s13
v_add_u32 v43, s9, v43
v_mul_u32_u24 v43, 0xf00, v43
v_add_u32 v10, v43, v44
v_add_u32 v42, 64, v1
v_mul_u32_u24 v43, 0x1556, v42
v_lshrrev_b32 v43, 16, v43
v_mul_u32_u24 v44, 12, v43
v_sub_u32 v44, v42, v44
v_mul_u32_u24 v45, 43, v44
v_lshrrev_b32 v45, 8, v45
v_mul_u32_u24 v42, 6, v45
v_sub_u32 v44, v44, v42
v_min_u32 v44, 4, v44
v_lshlrev_b32 v44, 4, v44
v_mul_u32_u24 v45, 0x50, v45
v_add3_u32 v44, v44, v45, s13
v_add_u32 v43, s9, v43
v_mul_u32_u24 v43, 0xf00, v43
v_add_u32 v43, v43, v44
v_subrev_u32 v11, 0x400, v43
v_add_u32 v42, 0x80, v1
v_mul_u32_u24 v43, 0x1556, v42
v_lshrrev_b32 v43, 16, v43
v_mul_u32_u24 v44, 12, v43
v_sub_u32 v44, v42, v44
v_mul_u32_u24 v45, 43, v44
v_lshrrev_b32 v45, 8, v45
v_mul_u32_u24 v42, 6, v45
v_sub_u32 v44, v44, v42
v_min_u32 v44, 4, v44
v_lshlrev_b32 v44, 4, v44
v_mul_u32_u24 v45, 0x50, v45
v_add3_u32 v44, v44, v45, s13
v_add_u32 v43, s9, v43
v_mul_u32_u24 v43, 0xf00, v43
v_add_u32 v43, v43, v44
v_subrev_u32 v12, 0x800, v43
v_bfe_u32 v42, v1, 4, 1
v_lshrrev_b32 v43, 5, v1
v_bfe_u32 v44, v1, 2, 2
v_and_b32 v45, 3, v1
v_lshl_add_u32 v44, v43, 3, v44
v_mul_u32_u24 v44, 0xc0, v44
v_and_b32 v43, 1, v45
v_mul_u32_u24 v43, 0x60, v43
v_add_u32 v44, v44, v43
v_mov_b32 v51, 0
v_mov_b32 v52, 0
v_mov_b32 v53, 0
v_mov_b32 v54, 0
s_mov_b32 s19, 0x3f803f80
s_waitcnt vmcnt(24)
ds_read_b128 v[96:99], v38 offset:0
ds_read_b128 v[100:103], v39 offset:0
ds_read_b128 v[104:107], v40 offset:0
ds_read_b128 v[108:111], v41 offset:0
s_add_u32 m0, s17, 0x4000
s_lshl_b32 s59, s18, 7
s_add_u32 s59, s59, s16
buffer_load_dwordx4 v27, s[24:27], s59 offen offset:0 lds
buffer_load_dwordx4 v28, s[24:27], s59 offen offset:1024 lds
buffer_load_dwordx4 v29, s[24:27], s59 offen offset:2048 lds
buffer_load_dwordx4 v30, s[24:27], s59 offen offset:3072 lds
s_add_u32 s18, s18, 1
s_cmp_eq_u32 s18, 10
s_cselect_b32 s18, 0, s18
v_lshrrev_b32 v45, 1, v45
v_lshl_add_u32 v45, v42, 1, v45
v_lshl_add_u32 v44, v45, 3, v44
v_add_u32 v18, s8, v44
s_lshr_b32 s8, s52, 1
s_mul_i32 s8, s8, 0x1800
s_and_b32 s9, s52, 1
s_mul_i32 s9, s9, 0xc00
s_add_u32 s3, s8, s9
s_lshr_b32 s12, s52, 1
s_lshl_b32 s12, s12, 2
s_and_b32 s9, s52, 1
s_lshl_b32 s9, s9, 5
s_mul_i32 s13, s54, 0x180
s_add_u32 s13, s13, 0xa0
s_mov_b32 s8, 0x1e000
v_add_u32 v42, 0, v1
v_mul_u32_u24 v43, 0x2aab, v42
v_lshrrev_b32 v43, 16, v43
s_waitcnt vmcnt(12)
ds_read_b128 v[112:115], v38 offset:4096
ds_read_b128 v[116:119], v39 offset:4096
ds_read_b128 v[120:123], v40 offset:4096
ds_read_b128 v[124:127], v41 offset:4096
s_waitcnt lgkmcnt(7)
v_dot2c_f32_bf16 v51, s19, v96
v_dot2c_f32_bf16 v53, v96, v96
v_dot2c_f32_bf16 v52, s19, v97
v_dot2c_f32_bf16 v54, v97, v97
v_dot2c_f32_bf16 v51, s19, v98
v_dot2c_f32_bf16 v53, v98, v98
v_dot2c_f32_bf16 v52, s19, v99
v_dot2c_f32_bf16 v54, v99, v99
s_waitcnt lgkmcnt(6)
v_dot2c_f32_bf16 v51, s19, v100
v_dot2c_f32_bf16 v53, v100, v100
v_dot2c_f32_bf16 v52, s19, v101
v_dot2c_f32_bf16 v54, v101, v101
v_dot2c_f32_bf16 v51, s19, v102
v_dot2c_f32_bf16 v53, v102, v102
v_dot2c_f32_bf16 v52, s19, v103
v_dot2c_f32_bf16 v54, v103, v103
s_waitcnt lgkmcnt(5)
v_dot2c_f32_bf16 v51, s19, v104
v_dot2c_f32_bf16 v53, v104, v104
v_dot2c_f32_bf16 v52, s19, v105
v_dot2c_f32_bf16 v54, v105, v105
v_dot2c_f32_bf16 v51, s19, v106
v_dot2c_f32_bf16 v53, v106, v106
v_dot2c_f32_bf16 v52, s19, v107
v_dot2c_f32_bf16 v54, v107, v107
s_waitcnt lgkmcnt(4)
v_dot2c_f32_bf16 v51, s19, v108
v_dot2c_f32_bf16 v53, v108, v108
v_dot2c_f32_bf16 v52, s19, v109
v_dot2c_f32_bf16 v54, v109, v109
v_dot2c_f32_bf16 v51, s19, v110
v_dot2c_f32_bf16 v53, v110, v110
v_dot2c_f32_bf16 v52, s19, v111
v_dot2c_f32_bf16 v54, v111, v111
s_add_u32 m0, s17, 0x5000
s_lshl_b32 s59, s18, 7
s_add_u32 s59, s59, s16
buffer_load_dwordx4 v27, s[24:27], s59 offen offset:0 lds
buffer_load_dwordx4 v28, s[24:27], s59 offen offset:1024 lds
buffer_load_dwordx4 v29, s[24:27], s59 offen offset:2048 lds
buffer_load_dwordx4 v30, s[24:27], s59 offen offset:3072 lds
s_add_u32 s18, s18, 1
s_cmp_eq_u32 s18, 10
s_cselect_b32 s18, 0, s18
v_mul_u32_u24 v44, 6, v43
v_sub_u32 v44, v42, v44
v_lshl_add_u32 v44, v44, 4, s13
v_xor_b32 v43, s12, v43
v_add_u32 v43, s9, v43
v_mul_u32_u24 v43, 0xc00, v43
v_add_u32 v13, v43, v44
v_add_u32 v42, 64, v1
s_waitcnt vmcnt(12)
ds_read_b128 v[128:131], v38 offset:8192
ds_read_b128 v[132:135], v39 offset:8192
ds_read_b128 v[136:139], v40 offset:8192
ds_read_b128 v[140:143], v41 offset:8192
s_waitcnt lgkmcnt(7)
v_dot2c_f32_bf16 v51, s19, v112
v_dot2c_f32_bf16 v53, v112, v112
v_dot2c_f32_bf16 v52, s19, v113
v_dot2c_f32_bf16 v54, v113, v113
v_dot2c_f32_bf16 v51, s19, v114
v_dot2c_f32_bf16 v53, v114, v114
v_dot2c_f32_bf16 v52, s19, v115
v_dot2c_f32_bf16 v54, v115, v115
s_waitcnt lgkmcnt(6)
v_dot2c_f32_bf16 v51, s19, v116
v_dot2c_f32_bf16 v53, v116, v116
v_dot2c_f32_bf16 v52, s19, v117
v_dot2c_f32_bf16 v54, v117, v117
v_dot2c_f32_bf16 v51, s19, v118
v_dot2c_f32_bf16 v53, v118, v118
v_dot2c_f32_bf16 v52, s19, v119
v_dot2c_f32_bf16 v54, v119, v119
s_waitcnt lgkmcnt(5)
v_dot2c_f32_bf16 v51, s19, v120
v_dot2c_f32_bf16 v53, v120, v120
v_dot2c_f32_bf16 v52, s19, v121
v_dot2c_f32_bf16 v54, v121, v121
v_dot2c_f32_bf16 v51, s19, v122
v_dot2c_f32_bf16 v53, v122, v122
v_dot2c_f32_bf16 v52, s19, v123
v_dot2c_f32_bf16 v54, v123, v123
s_waitcnt lgkmcnt(4)
v_dot2c_f32_bf16 v51, s19, v124
v_dot2c_f32_bf16 v53, v124, v124
v_dot2c_f32_bf16 v52, s19, v125
v_dot2c_f32_bf16 v54, v125, v125
v_dot2c_f32_bf16 v51, s19, v126
v_dot2c_f32_bf16 v53, v126, v126
v_dot2c_f32_bf16 v52, s19, v127
v_dot2c_f32_bf16 v54, v127, v127
s_add_u32 m0, s17, 0x6000
s_lshl_b32 s59, s18, 7
s_add_u32 s59, s59, s16
buffer_load_dwordx4 v27, s[24:27], s59 offen offset:0 lds
buffer_load_dwordx4 v28, s[24:27], s59 offen offset:1024 lds
buffer_load_dwordx4 v29, s[24:27], s59 offen offset:2048 lds
buffer_load_dwordx4 v30, s[24:27], s59 offen offset:3072 lds
s_add_u32 s18, s18, 1
s_cmp_eq_u32 s18, 10
s_cselect_b32 s18, 0, s18
v_mul_u32_u24 v43, 0x2aab, v42
v_lshrrev_b32 v43, 16, v43
v_mul_u32_u24 v44, 6, v43
v_sub_u32 v44, v42, v44
v_lshl_add_u32 v44, v44, 4, s13
v_xor_b32 v43, s12, v43
v_add_u32 v43, s9, v43
v_mul_u32_u24 v43, 0xc00, v43
s_waitcnt vmcnt(12)
ds_read_b128 v[144:147], v38 offset:12288
ds_read_b128 v[148:151], v39 offset:12288
ds_read_b128 v[152:155], v40 offset:12288
ds_read_b128 v[156:159], v41 offset:12288
s_waitcnt lgkmcnt(7)
v_dot2c_f32_bf16 v51, s19, v128
v_dot2c_f32_bf16 v53, v128, v128
v_dot2c_f32_bf16 v52, s19, v129
v_dot2c_f32_bf16 v54, v129, v129
v_dot2c_f32_bf16 v51, s19, v130
v_dot2c_f32_bf16 v53, v130, v130
v_dot2c_f32_bf16 v52, s19, v131
v_dot2c_f32_bf16 v54, v131, v131
s_waitcnt lgkmcnt(6)
v_dot2c_f32_bf16 v51, s19, v132
v_dot2c_f32_bf16 v53, v132, v132
v_dot2c_f32_bf16 v52, s19, v133
v_dot2c_f32_bf16 v54, v133, v133
v_dot2c_f32_bf16 v51, s19, v134
v_dot2c_f32_bf16 v53, v134, v134
v_dot2c_f32_bf16 v52, s19, v135
v_dot2c_f32_bf16 v54, v135, v135
s_waitcnt lgkmcnt(5)
v_dot2c_f32_bf16 v51, s19, v136
v_dot2c_f32_bf16 v53, v136, v136
v_dot2c_f32_bf16 v52, s19, v137
v_dot2c_f32_bf16 v54, v137, v137
v_dot2c_f32_bf16 v51, s19, v138
v_dot2c_f32_bf16 v53, v138, v138
v_dot2c_f32_bf16 v52, s19, v139
v_dot2c_f32_bf16 v54, v139, v139
s_waitcnt lgkmcnt(4)
v_dot2c_f32_bf16 v51, s19, v140
v_dot2c_f32_bf16 v53, v140, v140
v_dot2c_f32_bf16 v52, s19, v141
v_dot2c_f32_bf16 v54, v141, v141
v_dot2c_f32_bf16 v51, s19, v142
v_dot2c_f32_bf16 v53, v142, v142
v_dot2c_f32_bf16 v52, s19, v143
v_dot2c_f32_bf16 v54, v143, v143
s_add_u32 m0, s17, 0
s_lshl_b32 s59, s18, 7
s_add_u32 s59, s59, s16
buffer_load_dwordx4 v27, s[24:27], s59 offen offset:0 lds
buffer_load_dwordx4 v28, s[24:27], s59 offen offset:1024 lds
buffer_load_dwordx4 v29, s[24:27], s59 offen offset:2048 lds
buffer_load_dwordx4 v30, s[24:27], s59 offen offset:3072 lds
s_add_u32 s18, s18, 1
s_cmp_eq_u32 s18, 10
s_cselect_b32 s18, 0, s18
v_add_u32 v43, v43, v44
v_subrev_u32 v14, 0x400, v43
v_add_u32 v42, 0x80, v1
v_mul_u32_u24 v43, 0x2aab, v42
v_lshrrev_b32 v43, 16, v43
v_mul_u32_u24 v44, 6, v43
v_sub_u32 v44, v42, v44
v_lshl_add_u32 v44, v44, 4, s13
s_waitcnt vmcnt(12)
ds_read_b128 v[160:163], v38 offset:16384
ds_read_b128 v[164:167], v39 offset:16384
ds_read_b128 v[168:171], v40 offset:16384
ds_read_b128 v[172:175], v41 offset:16384
s_waitcnt lgkmcnt(7)
v_dot2c_f32_bf16 v51, s19, v144
v_dot2c_f32_bf16 v53, v144, v144
v_dot2c_f32_bf16 v52, s19, v145
v_dot2c_f32_bf16 v54, v145, v145
v_dot2c_f32_bf16 v51, s19, v146
v_dot2c_f32_bf16 v53, v146, v146
v_dot2c_f32_bf16 v52, s19, v147
v_dot2c_f32_bf16 v54, v147, v147
s_waitcnt lgkmcnt(6)
v_dot2c_f32_bf16 v51, s19, v148
v_dot2c_f32_bf16 v53, v148, v148
v_dot2c_f32_bf16 v52, s19, v149
v_dot2c_f32_bf16 v54, v149, v149
v_dot2c_f32_bf16 v51, s19, v150
v_dot2c_f32_bf16 v53, v150, v150
v_dot2c_f32_bf16 v52, s19, v151
v_dot2c_f32_bf16 v54, v151, v151
s_waitcnt lgkmcnt(5)
v_dot2c_f32_bf16 v51, s19, v152
v_dot2c_f32_bf16 v53, v152, v152
v_dot2c_f32_bf16 v52, s19, v153
v_dot2c_f32_bf16 v54, v153, v153
v_dot2c_f32_bf16 v51, s19, v154
v_dot2c_f32_bf16 v53, v154, v154
v_dot2c_f32_bf16 v52, s19, v155
v_dot2c_f32_bf16 v54, v155, v155
s_waitcnt lgkmcnt(4)
v_dot2c_f32_bf16 v51, s19, v156
v_dot2c_f32_bf16 v53, v156, v156
v_dot2c_f32_bf16 v52, s19, v157
v_dot2c_f32_bf16 v54, v157, v157
v_dot2c_f32_bf16 v51, s19, v158
v_dot2c_f32_bf16 v53, v158, v158
v_dot2c_f32_bf16 v52, s19, v159
v_dot2c_f32_bf16 v54, v159, v159
s_add_u32 m0, s17, 0x1000
s_lshl_b32 s59, s18, 7
s_add_u32 s59, s59, s16
buffer_load_dwordx4 v27, s[24:27], s59 offen offset:0 lds
buffer_load_dwordx4 v28, s[24:27], s59 offen offset:1024 lds
buffer_load_dwordx4 v29, s[24:27], s59 offen offset:2048 lds
buffer_load_dwordx4 v30, s[24:27], s59 offen offset:3072 lds
s_add_u32 s18, s18, 1
s_cmp_eq_u32 s18, 10
s_cselect_b32 s18, 0, s18
v_xor_b32 v43, s12, v43
v_add_u32 v43, s9, v43
v_mul_u32_u24 v43, 0xc00, v43
v_add_u32 v43, v43, v44
v_subrev_u32 v15, 0x800, v43
v_bfe_u32 v42, v1, 4, 1
v_lshrrev_b32 v43, 5, v1
v_bfe_u32 v44, v1, 2, 2
s_waitcnt vmcnt(12)
ds_read_b128 v[176:179], v38 offset:20480
ds_read_b128 v[180:183], v39 offset:20480
ds_read_b128 v[184:187], v40 offset:20480
ds_read_b128 v[188:191], v41 offset:20480
s_waitcnt lgkmcnt(7)
v_dot2c_f32_bf16 v51, s19, v160
v_dot2c_f32_bf16 v53, v160, v160
v_dot2c_f32_bf16 v52, s19, v161
v_dot2c_f32_bf16 v54, v161, v161
v_dot2c_f32_bf16 v51, s19, v162
v_dot2c_f32_bf16 v53, v162, v162
v_dot2c_f32_bf16 v52, s19, v163
v_dot2c_f32_bf16 v54, v163, v163
s_waitcnt lgkmcnt(6)
v_dot2c_f32_bf16 v51, s19, v164
v_dot2c_f32_bf16 v53, v164, v164
v_dot2c_f32_bf16 v52, s19, v165
v_dot2c_f32_bf16 v54, v165, v165
v_dot2c_f32_bf16 v51, s19, v166
v_dot2c_f32_bf16 v53, v166, v166
v_dot2c_f32_bf16 v52, s19, v167
v_dot2c_f32_bf16 v54, v167, v167
s_waitcnt lgkmcnt(5)
v_dot2c_f32_bf16 v51, s19, v168
v_dot2c_f32_bf16 v53, v168, v168
v_dot2c_f32_bf16 v52, s19, v169
v_dot2c_f32_bf16 v54, v169, v169
v_dot2c_f32_bf16 v51, s19, v170
v_dot2c_f32_bf16 v53, v170, v170
v_dot2c_f32_bf16 v52, s19, v171
v_dot2c_f32_bf16 v54, v171, v171
s_waitcnt lgkmcnt(4)
v_dot2c_f32_bf16 v51, s19, v172
v_dot2c_f32_bf16 v53, v172, v172
v_dot2c_f32_bf16 v52, s19, v173
v_dot2c_f32_bf16 v54, v173, v173
v_dot2c_f32_bf16 v51, s19, v174
v_dot2c_f32_bf16 v53, v174, v174
v_dot2c_f32_bf16 v52, s19, v175
v_dot2c_f32_bf16 v54, v175, v175
s_add_u32 m0, s17, 0x2000
s_lshl_b32 s59, s18, 7
s_add_u32 s59, s59, s16
buffer_load_dwordx4 v27, s[24:27], s59 offen offset:0 lds
buffer_load_dwordx4 v28, s[24:27], s59 offen offset:1024 lds
buffer_load_dwordx4 v29, s[24:27], s59 offen offset:2048 lds
buffer_load_dwordx4 v30, s[24:27], s59 offen offset:3072 lds
s_add_u32 s18, s18, 1
s_cmp_eq_u32 s18, 10
s_cselect_b32 s18, 0, s18
v_and_b32 v45, 3, v1
v_lshl_add_u32 v44, v43, 3, v44
v_mul_u32_u24 v44, 0x60, v44
v_lshl_add_u32 v44, v45, 3, v44
v_mul_u32_u24 v43, 0x1980, v42
v_add3_u32 v19, v44, v43, s8
v_mul_u32_u24 v43, 0x1680, v42
v_add_u32 v43, 0x180, v43
s_waitcnt vmcnt(12)
ds_read_b128 v[192:195], v38 offset:24576
ds_read_b128 v[196:199], v39 offset:24576
ds_read_b128 v[200:203], v40 offset:24576
ds_read_b128 v[204:207], v41 offset:24576
s_waitcnt lgkmcnt(7)
v_dot2c_f32_bf16 v51, s19, v176
v_dot2c_f32_bf16 v53, v176, v176
v_dot2c_f32_bf16 v52, s19, v177
v_dot2c_f32_bf16 v54, v177, v177
v_dot2c_f32_bf16 v51, s19, v178
v_dot2c_f32_bf16 v53, v178, v178
v_dot2c_f32_bf16 v52, s19, v179
v_dot2c_f32_bf16 v54, v179, v179
s_waitcnt lgkmcnt(6)
v_dot2c_f32_bf16 v51, s19, v180
v_dot2c_f32_bf16 v53, v180, v180
v_dot2c_f32_bf16 v52, s19, v181
v_dot2c_f32_bf16 v54, v181, v181
v_dot2c_f32_bf16 v51, s19, v182
v_dot2c_f32_bf16 v53, v182, v182
v_dot2c_f32_bf16 v52, s19, v183
v_dot2c_f32_bf16 v54, v183, v183
s_waitcnt lgkmcnt(5)
v_dot2c_f32_bf16 v51, s19, v184
v_dot2c_f32_bf16 v53, v184, v184
v_dot2c_f32_bf16 v52, s19, v185
v_dot2c_f32_bf16 v54, v185, v185
v_dot2c_f32_bf16 v51, s19, v186
v_dot2c_f32_bf16 v53, v186, v186
v_dot2c_f32_bf16 v52, s19, v187
v_dot2c_f32_bf16 v54, v187, v187
s_waitcnt lgkmcnt(4)
v_dot2c_f32_bf16 v51, s19, v188
v_dot2c_f32_bf16 v53, v188, v188
v_dot2c_f32_bf16 v52, s19, v189
v_dot2c_f32_bf16 v54, v189, v189
v_dot2c_f32_bf16 v51, s19, v190
v_dot2c_f32_bf16 v53, v190, v190
v_dot2c_f32_bf16 v52, s19, v191
v_dot2c_f32_bf16 v54, v191, v191
s_mov_b32 s56, s21
s_add_u32 m0, s96, 0
s_nop 0
buffer_load_dwordx4 v5, s[32:35], s56 offen offset:0 lds
s_add_u32 m0, s96, 0
s_nop 0
buffer_load_dwordx4 v6, s[32:35], s56 offen offset:1024 lds
s_add_u32 m0, s96, 0
s_nop 0
buffer_load_dwordx4 v7, s[32:35], s56 offen offset:2048 lds
s_add_u32 m0, s96, 0
s_nop 0
buffer_load_dwordx4 v8, s[32:35], s56 offen offset:3072 lds
s_add_u32 m0, s96, 0x1000
s_nop 0
buffer_load_dwordx4 v9, s[32:35], s56 offen offset:0 lds
s_add_u32 s56, s56, 0x30000
s_cmp_eq_u32 s56, 0x1e0000
s_cselect_b32 s56, 0, s56
s_add_u32 m0, s96, 0x5000
s_nop 0
buffer_load_dwordx4 v5, s[32:35], s56 offen offset:0 lds
s_add_u32 m0, s96, 0x5000
s_nop 0
buffer_load_dwordx4 v6, s[32:35], s56 offen offset:1024 lds
s_add_u32 m0, s96, 0x5000
s_nop 0
buffer_load_dwordx4 v7, s[32:35], s56 offen offset:2048 lds
s_add_u32 m0, s96, 0x5000
s_nop 0
buffer_load_dwordx4 v8, s[32:35], s56 offen offset:3072 lds
s_add_u32 m0, s96, 0x6000
s_nop 0
buffer_load_dwordx4 v9, s[32:35], s56 offen offset:0 lds
s_add_u32 s56, s56, 0x30000
s_cmp_eq_u32 s56, 0x1e0000
s_cselect_b32 s56, 0, s56
v_add3_u32 v20, v44, v43, s8
v_lshrrev_b32 v42, 5, v1
v_bfe_u32 v43, v1, 4, 1
v_bfe_u32 v44, v1, 1, 1
v_lshl_add_u32 v43, v43, 1, v44
v_mul_u32_u24 v45, 0x640, v42
v_bfe_u32 v44, v1, 2, 2
v_mul_u32_u24 v44, 40, v44
s_waitcnt vmcnt(18)
ds_read_b128 v[208:211], v38 offset:0
ds_read_b128 v[212:215], v39 offset:0
ds_read_b128 v[216:219], v40 offset:0
ds_read_b128 v[220:223], v41 offset:0
s_waitcnt lgkmcnt(7)
v_dot2c_f32_bf16 v51, s19, v192
v_dot2c_f32_bf16 v53, v192, v192
v_dot2c_f32_bf16 v52, s19, v193
v_dot2c_f32_bf16 v54, v193, v193
v_dot2c_f32_bf16 v51, s19, v194
v_dot2c_f32_bf16 v53, v194, v194
v_dot2c_f32_bf16 v52, s19, v195
v_dot2c_f32_bf16 v54, v195, v195
s_waitcnt lgkmcnt(6)
v_dot2c_f32_bf16 v51, s19, v196
v_dot2c_f32_bf16 v53, v196, v196
v_dot2c_f32_bf16 v52, s19, v197
v_dot2c_f32_bf16 v54, v197, v197
v_dot2c_f32_bf16 v51, s19, v198
v_dot2c_f32_bf16 v53, v198, v198
v_dot2c_f32_bf16 v52, s19, v199
v_dot2c_f32_bf16 v54, v199, v199
s_waitcnt lgkmcnt(5)
v_dot2c_f32_bf16 v51, s19, v200
v_dot2c_f32_bf16 v53, v200, v200
v_dot2c_f32_bf16 v52, s19, v201
v_dot2c_f32_bf16 v54, v201, v201
v_dot2c_f32_bf16 v51, s19, v202
v_dot2c_f32_bf16 v53, v202, v202
v_dot2c_f32_bf16 v52, s19, v203
v_dot2c_f32_bf16 v54, v203, v203
s_waitcnt lgkmcnt(4)
v_dot2c_f32_bf16 v51, s19, v204
v_dot2c_f32_bf16 v53, v204, v204
v_dot2c_f32_bf16 v52, s19, v205
v_dot2c_f32_bf16 v54, v205, v205
v_dot2c_f32_bf16 v51, s19, v206
v_dot2c_f32_bf16 v53, v206, v206
v_dot2c_f32_bf16 v52, s19, v207
v_dot2c_f32_bf16 v54, v207, v207
v_add_u32 v45, v45, v44
v_lshl_add_u32 v45, v43, 3, v45
v_add_u32 v45, 0x26000, v45
v_and_b32 v44, 1, v1
v_mov_b32 v50, 0x26e00
v_cmp_eq_u32 vcc, v44, v42
s_nop 1
v_cndmask_b32 v46, v50, v45, vcc
v_cmp_eq_u32 vcc, 0, v43
s_waitcnt vmcnt(14)
ds_read_b128 v[224:227], v38 offset:4096
ds_read_b128 v[228:231], v39 offset:4096
ds_read_b128 v[232:235], v40 offset:4096
ds_read_b128 v[236:239], v41 offset:4096
s_waitcnt lgkmcnt(7)
v_dot2c_f32_bf16 v51, s19, v208
v_dot2c_f32_bf16 v53, v208, v208
v_dot2c_f32_bf16 v52, s19, v209
v_dot2c_f32_bf16 v54, v209, v209
v_dot2c_f32_bf16 v51, s19, v210
v_dot2c_f32_bf16 v53, v210, v210
v_dot2c_f32_bf16 v52, s19, v211
v_dot2c_f32_bf16 v54, v211, v211
s_waitcnt lgkmcnt(6)
v_dot2c_f32_bf16 v51, s19, v212
v_dot2c_f32_bf16 v53, v212, v212
v_dot2c_f32_bf16 v52, s19, v213
v_dot2c_f32_bf16 v54, v213, v213
v_dot2c_f32_bf16 v51, s19, v214
v_dot2c_f32_bf16 v53, v214, v214
v_dot2c_f32_bf16 v52, s19, v215
v_dot2c_f32_bf16 v54, v215, v215
s_waitcnt lgkmcnt(5)
v_dot2c_f32_bf16 v51, s19, v216
v_dot2c_f32_bf16 v53, v216, v216
v_dot2c_f32_bf16 v52, s19, v217
v_dot2c_f32_bf16 v54, v217, v217
v_dot2c_f32_bf16 v51, s19, v218
v_dot2c_f32_bf16 v53, v218, v218
v_dot2c_f32_bf16 v52, s19, v219
v_dot2c_f32_bf16 v54, v219, v219
s_waitcnt lgkmcnt(4)
v_dot2c_f32_bf16 v51, s19, v220
v_dot2c_f32_bf16 v53, v220, v220
v_dot2c_f32_bf16 v52, s19, v221
v_dot2c_f32_bf16 v54, v221, v221
v_dot2c_f32_bf16 v51, s19, v222
v_dot2c_f32_bf16 v53, v222, v222
v_dot2c_f32_bf16 v52, s19, v223
v_dot2c_f32_bf16 v54, v223, v223
v_cndmask_b32 v47, v50, v46, vcc
v_cmp_le_u32 vcc, 1, v43
s_nop 1
v_cndmask_b32 v48, v50, v46, vcc
v_cmp_ge_u32 vcc, 1, v43
s_nop 1
v_cndmask_b32 v49, v50, v46, vcc
s_waitcnt vmcnt(10)
ds_read_b128 v[240:243], v38 offset:8192
ds_read_b128 v[244:247], v39 offset:8192
ds_read_b128 v[248:251], v40 offset:8192
ds_read_b128 v[252:255], v41 offset:8192
s_waitcnt lgkmcnt(7)
v_dot2c_f32_bf16 v51, s19, v224
v_dot2c_f32_bf16 v53, v224, v224
v_dot2c_f32_bf16 v52, s19, v225
v_dot2c_f32_bf16 v54, v225, v225
v_dot2c_f32_bf16 v51, s19, v226
v_dot2c_f32_bf16 v53, v226, v226
v_dot2c_f32_bf16 v52, s19, v227
v_dot2c_f32_bf16 v54, v227, v227
s_waitcnt lgkmcnt(6)
v_dot2c_f32_bf16 v51, s19, v228
v_dot2c_f32_bf16 v53, v228, v228
v_dot2c_f32_bf16 v52, s19, v229
v_dot2c_f32_bf16 v54, v229, v229
v_dot2c_f32_bf16 v51, s19, v230
v_dot2c_f32_bf16 v53, v230, v230
v_dot2c_f32_bf16 v52, s19, v231
v_dot2c_f32_bf16 v54, v231, v231
s_waitcnt lgkmcnt(5)
v_dot2c_f32_bf16 v51, s19, v232
v_dot2c_f32_bf16 v53, v232, v232
v_dot2c_f32_bf16 v52, s19, v233
v_dot2c_f32_bf16 v54, v233, v233
v_dot2c_f32_bf16 v51, s19, v234
v_dot2c_f32_bf16 v53, v234, v234
v_dot2c_f32_bf16 v52, s19, v235
v_dot2c_f32_bf16 v54, v235, v235
s_waitcnt lgkmcnt(4)
v_dot2c_f32_bf16 v51, s19, v236
v_dot2c_f32_bf16 v53, v236, v236
v_dot2c_f32_bf16 v52, s19, v237
v_dot2c_f32_bf16 v54, v237, v237
v_dot2c_f32_bf16 v51, s19, v238
v_dot2c_f32_bf16 v53, v238, v238
v_dot2c_f32_bf16 v52, s19, v239
v_dot2c_f32_bf16 v54, v239, v239
s_waitcnt lgkmcnt(3)
v_dot2c_f32_bf16 v51, s19, v240
v_dot2c_f32_bf16 v53, v240, v240
v_dot2c_f32_bf16 v52, s19, v241
v_dot2c_f32_bf16 v54, v241, v241
v_dot2c_f32_bf16 v51, s19, v242
v_dot2c_f32_bf16 v53, v242, v242
v_dot2c_f32_bf16 v52, s19, v243
v_dot2c_f32_bf16 v54, v243, v243
s_waitcnt lgkmcnt(2)
v_dot2c_f32_bf16 v51, s19, v244
v_dot2c_f32_bf16 v53, v244, v244
v_dot2c_f32_bf16 v52, s19, v245
v_dot2c_f32_bf16 v54, v245, v245
v_dot2c_f32_bf16 v51, s19, v246
v_dot2c_f32_bf16 v53, v246, v246
v_dot2c_f32_bf16 v52, s19, v247
v_dot2c_f32_bf16 v54, v247, v247
s_waitcnt lgkmcnt(1)
v_dot2c_f32_bf16 v51, s19, v248
v_dot2c_f32_bf16 v53, v248, v248
v_dot2c_f32_bf16 v52, s19, v249
v_dot2c_f32_bf16 v54, v249, v249
v_dot2c_f32_bf16 v51, s19, v250
v_dot2c_f32_bf16 v53, v250, v250
v_dot2c_f32_bf16 v52, s19, v251
v_dot2c_f32_bf16 v54, v251, v251
s_waitcnt lgkmcnt(0)
v_dot2c_f32_bf16 v51, s19, v252
v_dot2c_f32_bf16 v53, v252, v252
v_dot2c_f32_bf16 v52, s19, v253
v_dot2c_f32_bf16 v54, v253, v253
v_dot2c_f32_bf16 v51, s19, v254
v_dot2c_f32_bf16 v53, v254, v254
v_dot2c_f32_bf16 v52, s19, v255
v_dot2c_f32_bf16 v54, v255, v255
v_mov_b32 v36, 1
s_mov_b64 exec, 1
buffer_store_dword v36, v37, s[48:51], 0 offen sc1
s_mov_b64 exec, -1
v_add_f32 v51, v51, v52
v_add_f32 v53, v53, v54
v_mov_b32 v52, v51
v_mov_b32 v54, v53
s_nop 0
v_permlane32_swap_b32 v51, v52
v_permlane32_swap_b32 v53, v54
v_add_f32 v51, v51, v52
v_add_f32 v53, v53, v54
v_mul_f32 v51, 0x3acccccd, v51
v_mul_f32 v53, 0x3acccccd, v53
v_fma_f32 v53, -v51, v51, v53
v_max_f32 v53, 0, v53
v_add_f32 v53, 0x3727c5ac, v53
v_rsq_f32 v21, v53
s_nop 0
v_mul_f32 v22, v51, v21
v_sub_f32 v22, 0, v22
v_lshlrev_b32 v23, 16, v96
v_and_b32 v24, s61, v96
v_fma_f32 v23, v23, v21, v22
v_fma_f32 v24, v24, v21, v22
v_cvt_pk_bf16_f32 v96, v23, v24
v_lshlrev_b32 v23, 16, v97
v_and_b32 v24, s61, v97
v_fma_f32 v23, v23, v21, v22
v_fma_f32 v24, v24, v21, v22
v_cvt_pk_bf16_f32 v97, v23, v24
v_lshlrev_b32 v23, 16, v98
v_and_b32 v24, s61, v98
v_fma_f32 v23, v23, v21, v22
v_fma_f32 v24, v24, v21, v22
v_cvt_pk_bf16_f32 v98, v23, v24
v_lshlrev_b32 v23, 16, v99
v_and_b32 v24, s61, v99
v_fma_f32 v23, v23, v21, v22
v_fma_f32 v24, v24, v21, v22
v_cvt_pk_bf16_f32 v99, v23, v24
v_lshlrev_b32 v23, 16, v100
v_and_b32 v24, s61, v100
v_fma_f32 v23, v23, v21, v22
v_fma_f32 v24, v24, v21, v22
v_cvt_pk_bf16_f32 v100, v23, v24
v_lshlrev_b32 v23, 16, v101
v_and_b32 v24, s61, v101
v_fma_f32 v23, v23, v21, v22
v_fma_f32 v24, v24, v21, v22
v_cvt_pk_bf16_f32 v101, v23, v24
v_lshlrev_b32 v23, 16, v102
v_and_b32 v24, s61, v102
v_fma_f32 v23, v23, v21, v22
v_fma_f32 v24, v24, v21, v22
v_cvt_pk_bf16_f32 v102, v23, v24
v_lshlrev_b32 v23, 16, v103
v_and_b32 v24, s61, v103
v_fma_f32 v23, v23, v21, v22
v_fma_f32 v24, v24, v21, v22
v_cvt_pk_bf16_f32 v103, v23, v24
s_waitcnt vmcnt(6)
s_barrier
ds_read_b64_tr_b16 a[160:161], v16 offset:0
ds_read_b64_tr_b16 a[162:163], v17 offset:0
ds_read_b64_tr_b16 a[164:165], v16 offset:32
ds_read_b64_tr_b16 a[166:167], v17 offset:32
ds_read_b64_tr_b16 a[168:169], v16 offset:64
ds_read_b64_tr_b16 a[170:171], v17 offset:64
ds_read_b64_tr_b16 a[172:173], v16 offset:96
ds_read_b64_tr_b16 a[174:175], v17 offset:96
ds_read_b64_tr_b16 a[176:177], v16 offset:2560
ds_read_b64_tr_b16 a[178:179], v17 offset:2560
ds_read_b64_tr_b16 a[180:181], v16 offset:2592
ds_read_b64_tr_b16 a[182:183], v17 offset:2592
ds_read_b64_tr_b16 a[184:185], v16 offset:2624
ds_read_b64_tr_b16 a[186:187], v17 offset:2624
s_waitcnt lgkmcnt(12)
v_mfma_f32_32x32x16_bf16 a[0:15], a[160:163], v[96:99], 0
s_add_u32 m0, s96, 0xa000
ds_read_b64_tr_b16 a[188:189], v16 offset:2656
ds_read_b64_tr_b16 a[190:191], v17 offset:2656
buffer_load_dwordx4 v5, s[32:35], s56 offen offset:0 lds
s_waitcnt lgkmcnt(6)
v_lshlrev_b32 v23, 16, v104
v_and_b32 v24, s61, v104
v_fma_f32 v23, v23, v21, v22
v_fma_f32 v24, v24, v21, v22
v_cvt_pk_bf16_f32 v104, v23, v24
v_mfma_f32_32x32x16_bf16 a[16:31], a[164:167], v[96:99], 0
s_add_u32 m0, s96, 0xa000
ds_read_b64_tr_b16 a[160:161], v16 offset:5120
ds_read_b64_tr_b16 a[162:163], v17 offset:5120
buffer_load_dwordx4 v6, s[32:35], s56 offen offset:1024 lds
v_lshlrev_b32 v23, 16, v105
v_and_b32 v24, s61, v105
v_fma_f32 v23, v23, v21, v22
v_fma_f32 v24, v24, v21, v22
v_cvt_pk_bf16_f32 v105, v23, v24
v_mfma_f32_32x32x16_bf16 a[32:47], a[168:171], v[96:99], 0
s_add_u32 m0, s96, 0xa000
ds_read_b64_tr_b16 a[164:165], v16 offset:5152
ds_read_b64_tr_b16 a[166:167], v17 offset:5152
buffer_load_dwordx4 v7, s[32:35], s56 offen offset:2048 lds
ds_read_b64_tr_b16 a[192:193], v46 offset:0
v_lshlrev_b32 v23, 16, v106
v_and_b32 v24, s61, v106
v_fma_f32 v23, v23, v21, v22
v_fma_f32 v24, v24, v21, v22
v_cvt_pk_bf16_f32 v106, v23, v24
v_mfma_f32_32x32x16_bf16 a[48:63], a[172:175], v[96:99], 0
s_add_u32 m0, s96, 0xa000
ds_read_b64_tr_b16 a[168:169], v16 offset:5184
ds_read_b64_tr_b16 a[170:171], v17 offset:5184
buffer_load_dwordx4 v8, s[32:35], s56 offen offset:3072 lds
v_lshlrev_b32 v23, 16, v107
v_and_b32 v24, s61, v107
v_fma_f32 v23, v23, v21, v22
v_fma_f32 v24, v24, v21, v22
v_cvt_pk_bf16_f32 v107, v23, v24
v_mfma_f32_32x32x16_bf16 a[0:15], a[176:179], v[100:103], a[0:15]
s_add_u32 m0, s96, 0xb000
ds_read_b64_tr_b16 a[172:173], v16 offset:5216
ds_read_b64_tr_b16 a[174:175], v17 offset:5216
buffer_load_dwordx4 v9, s[32:35], s56 offen offset:0 lds
s_add_u32 s56, s56, 0x30000
s_cmp_eq_u32 s56, 0x1e0000
s_cselect_b32 s56, 0, s56
s_waitcnt lgkmcnt(7)
v_lshlrev_b32 v25, 16, v108
v_and_b32 v26, s61, v108
v_fma_f32 v25, v25, v21, v22
v_fma_f32 v26, v26, v21, v22
v_cvt_pk_bf16_f32 v108, v25, v26
v_mfma_f32_32x32x16_bf16 a[16:31], a[180:183], v[100:103], a[16:31]
s_add_u32 m0, s96, 0xf000
ds_read_b64_tr_b16 a[176:177], v16 offset:7680
ds_read_b64_tr_b16 a[178:179], v17 offset:7680
buffer_load_dwordx4 v5, s[32:35], s56 offen offset:0 lds
v_lshlrev_b32 v25, 16, v109
v_and_b32 v26, s61, v109
v_fma_f32 v25, v25, v21, v22
v_fma_f32 v26, v26, v21, v22
v_cvt_pk_bf16_f32 v109, v25, v26
v_mfma_f32_32x32x16_bf16 a[32:47], a[184:187], v[100:103], a[32:47]
s_add_u32 m0, s96, 0xf000
ds_read_b64_tr_b16 a[180:181], v16 offset:7712
ds_read_b64_tr_b16 a[182:183], v17 offset:7712
buffer_load_dwordx4 v6, s[32:35], s56 offen offset:1024 lds
ds_read_b64_tr_b16 a[194:195], v46 offset:160
v_lshlrev_b32 v25, 16, v110
v_and_b32 v26, s61, v110
v_fma_f32 v25, v25, v21, v22
v_fma_f32 v26, v26, v21, v22
v_cvt_pk_bf16_f32 v110, v25, v26
v_mfma_f32_32x32x16_bf16 a[48:63], a[188:191], v[100:103], a[48:63]
s_add_u32 m0, s96, 0xf000
ds_read_b64_tr_b16 a[184:185], v16 offset:7744
ds_read_b64_tr_b16 a[186:187], v17 offset:7744
buffer_load_dwordx4 v7, s[32:35], s56 offen offset:2048 lds
v_lshlrev_b32 v25, 16, v111
v_and_b32 v26, s61, v111
v_fma_f32 v25, v25, v21, v22
v_fma_f32 v26, v26, v21, v22
v_cvt_pk_bf16_f32 v111, v25, v26
v_mfma_f32_32x32x16_bf16 a[0:15], a[160:163], v[104:107], a[0:15]
s_add_u32 m0, s96, 0xf000
ds_read_b64_tr_b16 a[188:189], v16 offset:7776
ds_read_b64_tr_b16 a[190:191], v17 offset:7776
buffer_load_dwordx4 v8, s[32:35], s56 offen offset:3072 lds
s_waitcnt lgkmcnt(7)
v_lshlrev_b32 v23, 16, v112
v_and_b32 v24, s61, v112
v_fma_f32 v23, v23, v21, v22
v_fma_f32 v24, v24, v21, v22
v_cvt_pk_bf16_f32 v112, v23, v24
v_mfma_f32_32x32x16_bf16 a[16:31], a[164:167], v[104:107], a[16:31]
s_waitcnt vmcnt(10)
s_barrier
v_add_u32 v16, 0x5000, v16
v_add_u32 v17, 0x5000, v17
ds_read_b64_tr_b16 a[160:161], v16 offset:0
ds_read_b64_tr_b16 a[162:163], v17 offset:0
v_lshlrev_b32 v23, 16, v113
v_and_b32 v24, s61, v113
v_fma_f32 v23, v23, v21, v22
v_fma_f32 v24, v24, v21, v22
v_cvt_pk_bf16_f32 v113, v23, v24
v_mfma_f32_32x32x16_bf16 a[32:47], a[168:171], v[104:107], a[32:47]
s_add_u32 m0, s96, 0x10000
ds_read_b64_tr_b16 a[164:165], v16 offset:32
ds_read_b64_tr_b16 a[166:167], v17 offset:32
buffer_load_dwordx4 v9, s[32:35], s56 offen offset:0 lds
s_add_u32 s56, s56, 0x30000
s_cmp_eq_u32 s56, 0x1e0000
s_cselect_b32 s56, 0, s56
ds_read_b64_tr_b16 a[196:197], v46 offset:320
v_lshlrev_b32 v23, 16, v114
v_and_b32 v24, s61, v114
v_fma_f32 v23, v23, v21, v22
v_fma_f32 v24, v24, v21, v22
v_cvt_pk_bf16_f32 v114, v23, v24
v_mfma_f32_32x32x16_bf16 a[48:63], a[172:175], v[104:107], a[48:63]
s_add_u32 m0, s96, 0x14000
ds_read_b64_tr_b16 a[168:169], v16 offset:64
ds_read_b64_tr_b16 a[170:171], v17 offset:64
buffer_load_dwordx4 v5, s[32:35], s56 offen offset:0 lds
v_lshlrev_b32 v23, 16, v115
v_and_b32 v24, s61, v115
v_fma_f32 v23, v23, v21, v22
v_fma_f32 v24, v24, v21, v22
v_cvt_pk_bf16_f32 v115, v23, v24
v_mfma_f32_32x32x16_bf16 a[0:15], a[176:179], v[108:111], a[0:15]
s_add_u32 m0, s96, 0x14000
ds_read_b64_tr_b16 a[172:173], v16 offset:96
ds_read_b64_tr_b16 a[174:175], v17 offset:96
buffer_load_dwordx4 v6, s[32:35], s56 offen offset:1024 lds
s_waitcnt lgkmcnt(7)
v_lshlrev_b32 v25, 16, v116
v_and_b32 v26, s61, v116
v_fma_f32 v25, v25, v21, v22
v_fma_f32 v26, v26, v21, v22
v_cvt_pk_bf16_f32 v116, v25, v26
v_mfma_f32_32x32x16_bf16 a[16:31], a[180:183], v[108:111], a[16:31]
s_add_u32 m0, s96, 0x14000
ds_read_b64_tr_b16 a[176:177], v16 offset:2560
ds_read_b64_tr_b16 a[178:179], v17 offset:2560
buffer_load_dwordx4 v7, s[32:35], s56 offen offset:2048 lds
v_lshlrev_b32 v25, 16, v117
v_and_b32 v26, s61, v117
v_fma_f32 v25, v25, v21, v22
v_fma_f32 v26, v26, v21, v22
v_cvt_pk_bf16_f32 v117, v25, v26
v_mfma_f32_32x32x16_bf16 a[32:47], a[184:187], v[108:111], a[32:47]
s_add_u32 m0, s96, 0x14000
ds_read_b64_tr_b16 a[180:181], v16 offset:2592
ds_read_b64_tr_b16 a[182:183], v17 offset:2592
buffer_load_dwordx4 v8, s[32:35], s56 offen offset:3072 lds
ds_read_b64_tr_b16 a[198:199], v46 offset:480
v_lshlrev_b32 v25, 16, v118
v_and_b32 v26, s61, v118
v_fma_f32 v25, v25, v21, v22
v_fma_f32 v26, v26, v21, v22
v_cvt_pk_bf16_f32 v118, v25, v26
v_mfma_f32_32x32x16_bf16 a[48:63], a[188:191], v[108:111], a[48:63]
s_add_u32 m0, s96, 0x15000
ds_read_b64_tr_b16 a[184:185], v16 offset:2624
ds_read_b64_tr_b16 a[186:187], v17 offset:2624
buffer_load_dwordx4 v9, s[32:35], s56 offen offset:0 lds
s_add_u32 s56, s56, 0x30000
s_cmp_eq_u32 s56, 0x1e0000
s_cselect_b32 s56, 0, s56
v_lshlrev_b32 v25, 16, v119
v_and_b32 v26, s61, v119
v_fma_f32 v25, v25, v21, v22
v_fma_f32 v26, v26, v21, v22
v_cvt_pk_bf16_f32 v119, v25, v26
v_mfma_f32_32x32x16_bf16 a[0:15], a[160:163], v[112:115], a[0:15]
s_add_u32 m0, s96, 0x19000
ds_read_b64_tr_b16 a[188:189], v16 offset:2656
ds_read_b64_tr_b16 a[190:191], v17 offset:2656
buffer_load_dwordx4 v5, s[32:35], s56 offen offset:0 lds
s_waitcnt lgkmcnt(7)
v_lshlrev_b32 v23, 16, v120
v_and_b32 v24, s61, v120
v_fma_f32 v23, v23, v21, v22
v_fma_f32 v24, v24, v21, v22
v_cvt_pk_bf16_f32 v120, v23, v24
v_mfma_f32_32x32x16_bf16 a[16:31], a[164:167], v[112:115], a[16:31]
s_add_u32 m0, s96, 0x19000
ds_read_b64_tr_b16 a[160:161], v16 offset:5120
ds_read_b64_tr_b16 a[162:163], v17 offset:5120
buffer_load_dwordx4 v6, s[32:35], s56 offen offset:1024 lds
v_lshlrev_b32 v23, 16, v121
v_and_b32 v24, s61, v121
v_fma_f32 v23, v23, v21, v22
v_fma_f32 v24, v24, v21, v22
v_cvt_pk_bf16_f32 v121, v23, v24
v_mfma_f32_32x32x16_bf16 a[32:47], a[168:171], v[112:115], a[32:47]
s_add_u32 m0, s96, 0x19000
ds_read_b64_tr_b16 a[164:165], v16 offset:5152
ds_read_b64_tr_b16 a[166:167], v17 offset:5152
buffer_load_dwordx4 v7, s[32:35], s56 offen offset:2048 lds
ds_read_b64_tr_b16 a[200:201], v46 offset:640
v_lshlrev_b32 v23, 16, v122
v_and_b32 v24, s61, v122
v_fma_f32 v23, v23, v21, v22
v_fma_f32 v24, v24, v21, v22
v_cvt_pk_bf16_f32 v122, v23, v24
v_mfma_f32_32x32x16_bf16 a[48:63], a[172:175], v[112:115], a[48:63]
s_add_u32 m0, s96, 0x19000
ds_read_b64_tr_b16 a[168:169], v16 offset:5184
ds_read_b64_tr_b16 a[170:171], v17 offset:5184
buffer_load_dwordx4 v8, s[32:35], s56 offen offset:3072 lds
v_lshlrev_b32 v23, 16, v123
v_and_b32 v24, s61, v123
v_fma_f32 v23, v23, v21, v22
v_fma_f32 v24, v24, v21, v22
v_cvt_pk_bf16_f32 v123, v23, v24
v_mfma_f32_32x32x16_bf16 a[0:15], a[176:179], v[116:119], a[0:15]
ds_read_b64_tr_b16 a[172:173], v16 offset:5216
ds_read_b64_tr_b16 a[174:175], v17 offset:5216
s_waitcnt lgkmcnt(7)
v_lshlrev_b32 v25, 16, v124
v_and_b32 v26, s61, v124
v_fma_f32 v25, v25, v21, v22
v_fma_f32 v26, v26, v21, v22
v_cvt_pk_bf16_f32 v124, v25, v26
v_mfma_f32_32x32x16_bf16 a[16:31], a[180:183], v[116:119], a[16:31]
ds_read_b64_tr_b16 a[176:177], v16 offset:7680
ds_read_b64_tr_b16 a[178:179], v17 offset:7680
v_lshlrev_b32 v25, 16, v125
v_and_b32 v26, s61, v125
v_fma_f32 v25, v25, v21, v22
v_fma_f32 v26, v26, v21, v22
v_cvt_pk_bf16_f32 v125, v25, v26
v_mfma_f32_32x32x16_bf16 a[32:47], a[184:187], v[116:119], a[32:47]
s_add_u32 m0, s96, 0x1a000
ds_read_b64_tr_b16 a[180:181], v16 offset:7712
ds_read_b64_tr_b16 a[182:183], v17 offset:7712
buffer_load_dwordx4 v9, s[32:35], s56 offen offset:0 lds
s_add_u32 s56, s56, 0x30000
s_cmp_eq_u32 s56, 0x1e0000
s_cselect_b32 s56, 0, s56
ds_read_b64_tr_b16 a[202:203], v50
v_lshlrev_b32 v25, 16, v126
v_and_b32 v26, s61, v126
v_fma_f32 v25, v25, v21, v22
v_fma_f32 v26, v26, v21, v22
v_cvt_pk_bf16_f32 v126, v25, v26
v_mfma_f32_32x32x16_bf16 a[48:63], a[188:191], v[116:119], a[48:63]
ds_read_b64_tr_b16 a[184:185], v16 offset:7744
ds_read_b64_tr_b16 a[186:187], v17 offset:7744
v_lshlrev_b32 v25, 16, v127
v_and_b32 v26, s61, v127
v_fma_f32 v25, v25, v21, v22
v_fma_f32 v26, v26, v21, v22
v_cvt_pk_bf16_f32 v127, v25, v26
v_mfma_f32_32x32x16_bf16 a[0:15], a[160:163], v[120:123], a[0:15]
ds_read_b64_tr_b16 a[188:189], v16 offset:7776
ds_read_b64_tr_b16 a[190:191], v17 offset:7776
s_waitcnt lgkmcnt(7)
v_lshlrev_b32 v23, 16, v128
v_and_b32 v24, s61, v128
v_fma_f32 v23, v23, v21, v22
v_fma_f32 v24, v24, v21, v22
v_cvt_pk_bf16_f32 v128, v23, v24
v_mfma_f32_32x32x16_bf16 a[16:31], a[164:167], v[120:123], a[16:31]
s_waitcnt vmcnt(15)
s_barrier
v_add_u32 v16, 0x5000, v16
v_add_u32 v17, 0x5000, v17
ds_read_b64_tr_b16 a[160:161], v16 offset:0
ds_read_b64_tr_b16 a[162:163], v17 offset:0
v_lshlrev_b32 v23, 16, v129
v_and_b32 v24, s61, v129
v_fma_f32 v23, v23, v21, v22
v_fma_f32 v24, v24, v21, v22
v_cvt_pk_bf16_f32 v129, v23, v24
v_mfma_f32_32x32x16_bf16 a[32:47], a[168:171], v[120:123], a[32:47]
s_add_u32 m0, s96, 0x1e000
ds_read_b64_tr_b16 a[164:165], v16 offset:32
ds_read_b64_tr_b16 a[166:167], v17 offset:32
buffer_load_dwordx4 v5, s[32:35], s56 offen offset:0 lds
ds_read_b64_tr_b16 a[204:205], v47 offset:32
v_lshlrev_b32 v23, 16, v130
v_and_b32 v24, s61, v130
v_fma_f32 v23, v23, v21, v22
v_fma_f32 v24, v24, v21, v22
v_cvt_pk_bf16_f32 v130, v23, v24
v_mfma_f32_32x32x16_bf16 a[48:63], a[172:175], v[120:123], a[48:63]
s_add_u32 m0, s96, 0x1e000
ds_read_b64_tr_b16 a[168:169], v16 offset:64
ds_read_b64_tr_b16 a[170:171], v17 offset:64
buffer_load_dwordx4 v6, s[32:35], s56 offen offset:1024 lds
v_lshlrev_b32 v23, 16, v131
v_and_b32 v24, s61, v131
v_fma_f32 v23, v23, v21, v22
v_fma_f32 v24, v24, v21, v22
v_cvt_pk_bf16_f32 v131, v23, v24
v_mfma_f32_32x32x16_bf16 a[0:15], a[176:179], v[124:127], a[0:15]
s_add_u32 m0, s96, 0x1e000
ds_read_b64_tr_b16 a[172:173], v16 offset:96
ds_read_b64_tr_b16 a[174:175], v17 offset:96
buffer_load_dwordx4 v7, s[32:35], s56 offen offset:2048 lds
s_waitcnt lgkmcnt(7)
v_lshlrev_b32 v25, 16, v132
v_and_b32 v26, s61, v132
v_fma_f32 v25, v25, v21, v22
v_fma_f32 v26, v26, v21, v22
v_cvt_pk_bf16_f32 v132, v25, v26
v_mfma_f32_32x32x16_bf16 a[16:31], a[180:183], v[124:127], a[16:31]
s_add_u32 m0, s96, 0x1e000
ds_read_b64_tr_b16 a[176:177], v16 offset:2560
ds_read_b64_tr_b16 a[178:179], v17 offset:2560
buffer_load_dwordx4 v8, s[32:35], s56 offen offset:3072 lds
v_lshlrev_b32 v25, 16, v133
v_and_b32 v26, s61, v133
v_fma_f32 v25, v25, v21, v22
v_fma_f32 v26, v26, v21, v22
v_cvt_pk_bf16_f32 v133, v25, v26
v_mfma_f32_32x32x16_bf16 a[32:47], a[184:187], v[124:127], a[32:47]
ds_read_b64_tr_b16 a[180:181], v16 offset:2592
ds_read_b64_tr_b16 a[182:183], v17 offset:2592
ds_read_b64_tr_b16 a[206:207], v47 offset:192
v_lshlrev_b32 v25, 16, v134
v_and_b32 v26, s61, v134
v_fma_f32 v25, v25, v21, v22
v_fma_f32 v26, v26, v21, v22
v_cvt_pk_bf16_f32 v134, v25, v26
v_mfma_f32_32x32x16_bf16 a[48:63], a[188:191], v[124:127], a[48:63]
ds_read_b64_tr_b16 a[184:185], v16 offset:2624
ds_read_b64_tr_b16 a[186:187], v17 offset:2624
v_lshlrev_b32 v25, 16, v135
v_and_b32 v26, s61, v135
v_fma_f32 v25, v25, v21, v22
v_fma_f32 v26, v26, v21, v22
v_cvt_pk_bf16_f32 v135, v25, v26
v_mfma_f32_32x32x16_bf16 a[0:15], a[160:163], v[128:131], a[0:15]
s_add_u32 m0, s96, 0x1f000
ds_read_b64_tr_b16 a[188:189], v16 offset:2656
ds_read_b64_tr_b16 a[190:191], v17 offset:2656
buffer_load_dwordx4 v9, s[32:35], s56 offen offset:0 lds
s_add_u32 s56, s56, 0x30000
s_cmp_eq_u32 s56, 0x1e0000
s_cselect_b32 s56, 0, s56
s_waitcnt lgkmcnt(7)
v_lshlrev_b32 v23, 16, v136
v_and_b32 v24, s61, v136
v_fma_f32 v23, v23, v21, v22
v_fma_f32 v24, v24, v21, v22
v_cvt_pk_bf16_f32 v136, v23, v24
v_mfma_f32_32x32x16_bf16 a[16:31], a[164:167], v[128:131], a[16:31]
ds_read_b64_tr_b16 a[160:161], v16 offset:5120
ds_read_b64_tr_b16 a[162:163], v17 offset:5120
v_lshlrev_b32 v23, 16, v137
v_and_b32 v24, s61, v137
v_fma_f32 v23, v23, v21, v22
v_fma_f32 v24, v24, v21, v22
v_cvt_pk_bf16_f32 v137, v23, v24
v_mfma_f32_32x32x16_bf16 a[32:47], a[168:171], v[128:131], a[32:47]
ds_read_b64_tr_b16 a[164:165], v16 offset:5152
ds_read_b64_tr_b16 a[166:167], v17 offset:5152
ds_read_b64_tr_b16 a[208:209], v47 offset:352
v_lshlrev_b32 v23, 16, v138
v_and_b32 v24, s61, v138
v_fma_f32 v23, v23, v21, v22
v_fma_f32 v24, v24, v21, v22
v_cvt_pk_bf16_f32 v138, v23, v24
v_mfma_f32_32x32x16_bf16 a[48:63], a[172:175], v[128:131], a[48:63]
s_add_u32 m0, s96, 0
ds_read_b64_tr_b16 a[168:169], v16 offset:5184
ds_read_b64_tr_b16 a[170:171], v17 offset:5184
buffer_load_dwordx4 v5, s[32:35], s56 offen offset:0 lds
v_lshlrev_b32 v23, 16, v139
v_and_b32 v24, s61, v139
v_fma_f32 v23, v23, v21, v22
v_fma_f32 v24, v24, v21, v22
v_cvt_pk_bf16_f32 v139, v23, v24
v_mfma_f32_32x32x16_bf16 a[0:15], a[176:179], v[132:135], a[0:15]
ds_read_b64_tr_b16 a[172:173], v16 offset:5216
ds_read_b64_tr_b16 a[174:175], v17 offset:5216
s_waitcnt lgkmcnt(7)
v_lshlrev_b32 v25, 16, v140
v_and_b32 v26, s61, v140
v_fma_f32 v25, v25, v21, v22
v_fma_f32 v26, v26, v21, v22
v_cvt_pk_bf16_f32 v140, v25, v26
v_mfma_f32_32x32x16_bf16 a[16:31], a[180:183], v[132:135], a[16:31]
ds_read_b64_tr_b16 a[176:177], v16 offset:7680
ds_read_b64_tr_b16 a[178:179], v17 offset:7680
v_lshlrev_b32 v25, 16, v141
v_and_b32 v26, s61, v141
v_fma_f32 v25, v25, v21, v22
v_fma_f32 v26, v26, v21, v22
v_cvt_pk_bf16_f32 v141, v25, v26
v_mfma_f32_32x32x16_bf16 a[32:47], a[184:187], v[132:135], a[32:47]
s_add_u32 m0, s96, 0
ds_read_b64_tr_b16 a[180:181], v16 offset:7712
ds_read_b64_tr_b16 a[182:183], v17 offset:7712
buffer_load_dwordx4 v6, s[32:35], s56 offen offset:1024 lds
ds_read_b64_tr_b16 a[210:211], v47 offset:512
v_lshlrev_b32 v25, 16, v142
v_and_b32 v26, s61, v142
v_fma_f32 v25, v25, v21, v22
v_fma_f32 v26, v26, v21, v22
v_cvt_pk_bf16_f32 v142, v25, v26
v_mfma_f32_32x32x16_bf16 a[48:63], a[188:191], v[132:135], a[48:63]
ds_read_b64_tr_b16 a[184:185], v16 offset:7744
ds_read_b64_tr_b16 a[186:187], v17 offset:7744
v_lshlrev_b32 v25, 16, v143
v_and_b32 v26, s61, v143
v_fma_f32 v25, v25, v21, v22
v_fma_f32 v26, v26, v21, v22
v_cvt_pk_bf16_f32 v143, v25, v26
v_mfma_f32_32x32x16_bf16 a[0:15], a[160:163], v[136:139], a[0:15]
ds_read_b64_tr_b16 a[188:189], v16 offset:7776
ds_read_b64_tr_b16 a[190:191], v17 offset:7776
s_waitcnt lgkmcnt(7)
v_lshlrev_b32 v23, 16, v144
v_and_b32 v24, s61, v144
v_fma_f32 v23, v23, v21, v22
v_fma_f32 v24, v24, v21, v22
v_cvt_pk_bf16_f32 v144, v23, v24
v_mfma_f32_32x32x16_bf16 a[16:31], a[164:167], v[136:139], a[16:31]
s_waitcnt vmcnt(17)
s_barrier
v_add_u32 v16, 0x5000, v16
v_add_u32 v17, 0x5000, v17
ds_read_b64_tr_b16 a[160:161], v16 offset:0
ds_read_b64_tr_b16 a[162:163], v17 offset:0
v_lshlrev_b32 v23, 16, v145
v_and_b32 v24, s61, v145
v_fma_f32 v23, v23, v21, v22
v_fma_f32 v24, v24, v21, v22
v_cvt_pk_bf16_f32 v145, v23, v24
v_mfma_f32_32x32x16_bf16 a[32:47], a[168:171], v[136:139], a[32:47]
s_add_u32 m0, s96, 0
ds_read_b64_tr_b16 a[164:165], v16 offset:32
ds_read_b64_tr_b16 a[166:167], v17 offset:32
buffer_load_dwordx4 v7, s[32:35], s56 offen offset:2048 lds
ds_read_b64_tr_b16 a[212:213], v47 offset:672
v_lshlrev_b32 v23, 16, v146
v_and_b32 v24, s61, v146
v_fma_f32 v23, v23, v21, v22
v_fma_f32 v24, v24, v21, v22
v_cvt_pk_bf16_f32 v146, v23, v24
v_mfma_f32_32x32x16_bf16 a[48:63], a[172:175], v[136:139], a[48:63]
s_add_u32 m0, s96, 0
ds_read_b64_tr_b16 a[168:169], v16 offset:64
ds_read_b64_tr_b16 a[170:171], v17 offset:64
buffer_load_dwordx4 v8, s[32:35], s56 offen offset:3072 lds
v_lshlrev_b32 v23, 16, v147
v_and_b32 v24, s61, v147
v_fma_f32 v23, v23, v21, v22
v_fma_f32 v24, v24, v21, v22
v_cvt_pk_bf16_f32 v147, v23, v24
v_mfma_f32_32x32x16_bf16 a[0:15], a[176:179], v[140:143], a[0:15]
ds_read_b64_tr_b16 a[172:173], v16 offset:96
ds_read_b64_tr_b16 a[174:175], v17 offset:96
s_waitcnt lgkmcnt(7)
v_lshlrev_b32 v25, 16, v148
v_and_b32 v26, s61, v148
v_fma_f32 v25, v25, v21, v22
v_fma_f32 v26, v26, v21, v22
v_cvt_pk_bf16_f32 v148, v25, v26
v_mfma_f32_32x32x16_bf16 a[16:31], a[180:183], v[140:143], a[16:31]
ds_read_b64_tr_b16 a[176:177], v16 offset:2560
ds_read_b64_tr_b16 a[178:179], v17 offset:2560
v_lshlrev_b32 v25, 16, v149
v_and_b32 v26, s61, v149
v_fma_f32 v25, v25, v21, v22
v_fma_f32 v26, v26, v21, v22
v_cvt_pk_bf16_f32 v149, v25, v26
v_mfma_f32_32x32x16_bf16 a[32:47], a[184:187], v[140:143], a[32:47]
s_add_u32 m0, s96, 0x1000
ds_read_b64_tr_b16 a[180:181], v16 offset:2592
ds_read_b64_tr_b16 a[182:183], v17 offset:2592
buffer_load_dwordx4 v9, s[32:35], s56 offen offset:0 lds
s_add_u32 s56, s56, 0x30000
s_cmp_eq_u32 s56, 0x1e0000
s_cselect_b32 s56, 0, s56
ds_read_b64_tr_b16 a[214:215], v48 offset:792
v_lshlrev_b32 v25, 16, v150
v_and_b32 v26, s61, v150
v_fma_f32 v25, v25, v21, v22
v_fma_f32 v26, v26, v21, v22
v_cvt_pk_bf16_f32 v150, v25, v26
v_mfma_f32_32x32x16_bf16 a[48:63], a[188:191], v[140:143], a[48:63]
ds_read_b64_tr_b16 a[184:185], v16 offset:2624
ds_read_b64_tr_b16 a[186:187], v17 offset:2624
v_lshlrev_b32 v25, 16, v151
v_and_b32 v26, s61, v151
v_fma_f32 v25, v25, v21, v22
v_fma_f32 v26, v26, v21, v22
v_cvt_pk_bf16_f32 v151, v25, v26
v_mfma_f32_32x32x16_bf16 a[0:15], a[160:163], v[144:147], a[0:15]
ds_read_b64_tr_b16 a[188:189], v16 offset:2656
ds_read_b64_tr_b16 a[190:191], v17 offset:2656
s_waitcnt lgkmcnt(7)
v_lshlrev_b32 v23, 16, v152
v_and_b32 v24, s61, v152
v_fma_f32 v23, v23, v21, v22
v_fma_f32 v24, v24, v21, v22
v_cvt_pk_bf16_f32 v152, v23, v24
v_mfma_f32_32x32x16_bf16 a[16:31], a[164:167], v[144:147], a[16:31]
s_add_u32 m0, s96, 0x5000
ds_read_b64_tr_b16 a[160:161], v16 offset:5120
ds_read_b64_tr_b16 a[162:163], v17 offset:5120
buffer_load_dwordx4 v5, s[32:35], s56 offen offset:0 lds
v_lshlrev_b32 v23, 16, v153
v_and_b32 v24, s61, v153
v_fma_f32 v23, v23, v21, v22
v_fma_f32 v24, v24, v21, v22
v_cvt_pk_bf16_f32 v153, v23, v24
v_mfma_f32_32x32x16_bf16 a[32:47], a[168:171], v[144:147], a[32:47]
ds_read_b64_tr_b16 a[164:165], v16 offset:5152
ds_read_b64_tr_b16 a[166:167], v17 offset:5152
ds_read_b64_tr_b16 a[216:217], v48 offset:952
v_lshlrev_b32 v23, 16, v154
v_and_b32 v24, s61, v154
v_fma_f32 v23, v23, v21, v22
v_fma_f32 v24, v24, v21, v22
v_cvt_pk_bf16_f32 v154, v23, v24
v_mfma_f32_32x32x16_bf16 a[48:63], a[172:175], v[144:147], a[48:63]
ds_read_b64_tr_b16 a[168:169], v16 offset:5184
ds_read_b64_tr_b16 a[170:171], v17 offset:5184
v_lshlrev_b32 v23, 16, v155
v_and_b32 v24, s61, v155
v_fma_f32 v23, v23, v21, v22
v_fma_f32 v24, v24, v21, v22
v_cvt_pk_bf16_f32 v155, v23, v24
v_mfma_f32_32x32x16_bf16 a[0:15], a[176:179], v[148:151], a[0:15]
s_add_u32 m0, s96, 0x5000
ds_read_b64_tr_b16 a[172:173], v16 offset:5216
ds_read_b64_tr_b16 a[174:175], v17 offset:5216
buffer_load_dwordx4 v6, s[32:35], s56 offen offset:1024 lds
s_waitcnt lgkmcnt(7)
v_lshlrev_b32 v25, 16, v156
v_and_b32 v26, s61, v156
v_fma_f32 v25, v25, v21, v22
v_fma_f32 v26, v26, v21, v22
v_cvt_pk_bf16_f32 v156, v25, v26
v_mfma_f32_32x32x16_bf16 a[16:31], a[180:183], v[148:151], a[16:31]
ds_read_b64_tr_b16 a[176:177], v16 offset:7680
ds_read_b64_tr_b16 a[178:179], v17 offset:7680
v_lshlrev_b32 v25, 16, v157
v_and_b32 v26, s61, v157
v_fma_f32 v25, v25, v21, v22
v_fma_f32 v26, v26, v21, v22
v_cvt_pk_bf16_f32 v157, v25, v26
v_mfma_f32_32x32x16_bf16 a[32:47], a[184:187], v[148:151], a[32:47]
ds_read_b64_tr_b16 a[180:181], v16 offset:7712
ds_read_b64_tr_b16 a[182:183], v17 offset:7712
ds_read_b64_tr_b16 a[218:219], v48 offset:1112
v_lshlrev_b32 v25, 16, v158
v_and_b32 v26, s61, v158
v_fma_f32 v25, v25, v21, v22
v_fma_f32 v26, v26, v21, v22
v_cvt_pk_bf16_f32 v158, v25, v26
v_mfma_f32_32x32x16_bf16 a[48:63], a[188:191], v[148:151], a[48:63]
s_add_u32 m0, s96, 0x5000
ds_read_b64_tr_b16 a[184:185], v16 offset:7744
ds_read_b64_tr_b16 a[186:187], v17 offset:7744
buffer_load_dwordx4 v7, s[32:35], s56 offen offset:2048 lds
v_lshlrev_b32 v25, 16, v159
v_and_b32 v26, s61, v159
v_fma_f32 v25, v25, v21, v22
v_fma_f32 v26, v26, v21, v22
v_cvt_pk_bf16_f32 v159, v25, v26
v_mfma_f32_32x32x16_bf16 a[0:15], a[160:163], v[152:155], a[0:15]
ds_read_b64_tr_b16 a[188:189], v16 offset:7776
ds_read_b64_tr_b16 a[190:191], v17 offset:7776
s_waitcnt lgkmcnt(7)
v_lshlrev_b32 v23, 16, v160
v_and_b32 v24, s61, v160
v_fma_f32 v23, v23, v21, v22
v_fma_f32 v24, v24, v21, v22
v_cvt_pk_bf16_f32 v160, v23, v24
v_mfma_f32_32x32x16_bf16 a[16:31], a[164:167], v[152:155], a[16:31]
s_waitcnt vmcnt(18)
s_barrier
v_add_u32 v16, 0x5000, v16
v_add_u32 v17, 0x5000, v17
ds_read_b64_tr_b16 a[160:161], v16 offset:0
ds_read_b64_tr_b16 a[162:163], v17 offset:0
v_lshlrev_b32 v23, 16, v161
v_and_b32 v24, s61, v161
v_fma_f32 v23, v23, v21, v22
v_fma_f32 v24, v24, v21, v22
v_cvt_pk_bf16_f32 v161, v23, v24
v_mfma_f32_32x32x16_bf16 a[32:47], a[168:171], v[152:155], a[32:47]
s_add_u32 m0, s96, 0x5000
ds_read_b64_tr_b16 a[164:165], v16 offset:32
ds_read_b64_tr_b16 a[166:167], v17 offset:32
buffer_load_dwordx4 v8, s[32:35], s56 offen offset:3072 lds
ds_read_b64_tr_b16 a[220:221], v48 offset:1272
v_lshlrev_b32 v23, 16, v162
v_and_b32 v24, s61, v162
v_fma_f32 v23, v23, v21, v22
v_fma_f32 v24, v24, v21, v22
v_cvt_pk_bf16_f32 v162, v23, v24
v_mfma_f32_32x32x16_bf16 a[48:63], a[172:175], v[152:155], a[48:63]
ds_read_b64_tr_b16 a[168:169], v16 offset:64
ds_read_b64_tr_b16 a[170:171], v17 offset:64
v_lshlrev_b32 v23, 16, v163
v_and_b32 v24, s61, v163
v_fma_f32 v23, v23, v21, v22
v_fma_f32 v24, v24, v21, v22
v_cvt_pk_bf16_f32 v163, v23, v24
v_mfma_f32_32x32x16_bf16 a[0:15], a[176:179], v[156:159], a[0:15]
ds_read_b64_tr_b16 a[172:173], v16 offset:96
ds_read_b64_tr_b16 a[174:175], v17 offset:96
s_waitcnt lgkmcnt(7)
v_lshlrev_b32 v25, 16, v164
v_and_b32 v26, s61, v164
v_fma_f32 v25, v25, v21, v22
v_fma_f32 v26, v26, v21, v22
v_cvt_pk_bf16_f32 v164, v25, v26
v_mfma_f32_32x32x16_bf16 a[16:31], a[180:183], v[156:159], a[16:31]
ds_read_b64_tr_b16 a[176:177], v16 offset:2560
ds_read_b64_tr_b16 a[178:179], v17 offset:2560
v_lshlrev_b32 v25, 16, v165
v_and_b32 v26, s61, v165
v_fma_f32 v25, v25, v21, v22
v_fma_f32 v26, v26, v21, v22
v_cvt_pk_bf16_f32 v165, v25, v26
v_mfma_f32_32x32x16_bf16 a[32:47], a[184:187], v[156:159], a[32:47]
ds_read_b64_tr_b16 a[180:181], v16 offset:2592
ds_read_b64_tr_b16 a[182:183], v17 offset:2592
ds_read_b64_tr_b16 a[222:223], v48 offset:1432
v_lshlrev_b32 v25, 16, v166
v_and_b32 v26, s61, v166
v_fma_f32 v25, v25, v21, v22
v_fma_f32 v26, v26, v21, v22
v_cvt_pk_bf16_f32 v166, v25, v26
v_mfma_f32_32x32x16_bf16 a[48:63], a[188:191], v[156:159], a[48:63]
s_add_u32 m0, s96, 0x6000
ds_read_b64_tr_b16 a[184:185], v16 offset:2624
ds_read_b64_tr_b16 a[186:187], v17 offset:2624
buffer_load_dwordx4 v9, s[32:35], s56 offen offset:0 lds
s_add_u32 s56, s56, 0x30000
s_cmp_eq_u32 s56, 0x1e0000
s_cselect_b32 s56, 0, s56
v_lshlrev_b32 v25, 16, v167
v_and_b32 v26, s61, v167
v_fma_f32 v25, v25, v21, v22
v_fma_f32 v26, v26, v21, v22
v_cvt_pk_bf16_f32 v167, v25, v26
v_mfma_f32_32x32x16_bf16 a[0:15], a[160:163], v[160:163], a[0:15]
ds_read_b64_tr_b16 a[188:189], v16 offset:2656
ds_read_b64_tr_b16 a[190:191], v17 offset:2656
s_waitcnt lgkmcnt(7)
v_lshlrev_b32 v23, 16, v168
v_and_b32 v24, s61, v168
v_fma_f32 v23, v23, v21, v22
v_fma_f32 v24, v24, v21, v22
v_cvt_pk_bf16_f32 v168, v23, v24
v_mfma_f32_32x32x16_bf16 a[16:31], a[164:167], v[160:163], a[16:31]
ds_read_b64_tr_b16 a[160:161], v16 offset:5120
ds_read_b64_tr_b16 a[162:163], v17 offset:5120
v_lshlrev_b32 v23, 16, v169
v_and_b32 v24, s61, v169
v_fma_f32 v23, v23, v21, v22
v_fma_f32 v24, v24, v21, v22
v_cvt_pk_bf16_f32 v169, v23, v24
v_mfma_f32_32x32x16_bf16 a[32:47], a[168:171], v[160:163], a[32:47]
ds_read_b64_tr_b16 a[164:165], v16 offset:5152
ds_read_b64_tr_b16 a[166:167], v17 offset:5152
ds_read_b64_tr_b16 a[224:225], v50
v_lshlrev_b32 v23, 16, v170
v_and_b32 v24, s61, v170
v_fma_f32 v23, v23, v21, v22
v_fma_f32 v24, v24, v21, v22
v_cvt_pk_bf16_f32 v170, v23, v24
v_mfma_f32_32x32x16_bf16 a[48:63], a[172:175], v[160:163], a[48:63]
ds_read_b64_tr_b16 a[168:169], v16 offset:5184
ds_read_b64_tr_b16 a[170:171], v17 offset:5184
v_lshlrev_b32 v23, 16, v171
v_and_b32 v24, s61, v171
v_fma_f32 v23, v23, v21, v22
v_fma_f32 v24, v24, v21, v22
v_cvt_pk_bf16_f32 v171, v23, v24
v_mfma_f32_32x32x16_bf16 a[0:15], a[176:179], v[164:167], a[0:15]
s_add_u32 m0, s96, 0xa000
ds_read_b64_tr_b16 a[172:173], v16 offset:5216
ds_read_b64_tr_b16 a[174:175], v17 offset:5216
buffer_load_dwordx4 v5, s[32:35], s56 offen offset:0 lds
s_waitcnt lgkmcnt(7)
v_lshlrev_b32 v25, 16, v172
v_and_b32 v26, s61, v172
v_fma_f32 v25, v25, v21, v22
v_fma_f32 v26, v26, v21, v22
v_cvt_pk_bf16_f32 v172, v25, v26
v_mfma_f32_32x32x16_bf16 a[16:31], a[180:183], v[164:167], a[16:31]
ds_read_b64_tr_b16 a[176:177], v16 offset:7680
ds_read_b64_tr_b16 a[178:179], v17 offset:7680
v_lshlrev_b32 v25, 16, v173
v_and_b32 v26, s61, v173
v_fma_f32 v25, v25, v21, v22
v_fma_f32 v26, v26, v21, v22
v_cvt_pk_bf16_f32 v173, v25, v26
v_mfma_f32_32x32x16_bf16 a[32:47], a[184:187], v[164:167], a[32:47]
ds_read_b64_tr_b16 a[180:181], v16 offset:7712
ds_read_b64_tr_b16 a[182:183], v17 offset:7712
ds_read_b64_tr_b16 a[226:227], v49 offset:824
v_lshlrev_b32 v25, 16, v174
v_and_b32 v26, s61, v174
v_fma_f32 v25, v25, v21, v22
v_fma_f32 v26, v26, v21, v22
v_cvt_pk_bf16_f32 v174, v25, v26
v_mfma_f32_32x32x16_bf16 a[48:63], a[188:191], v[164:167], a[48:63]
ds_read_b64_tr_b16 a[184:185], v16 offset:7744
ds_read_b64_tr_b16 a[186:187], v17 offset:7744
v_lshlrev_b32 v25, 16, v175
v_and_b32 v26, s61, v175
v_fma_f32 v25, v25, v21, v22
v_fma_f32 v26, v26, v21, v22
v_cvt_pk_bf16_f32 v175, v25, v26
v_mfma_f32_32x32x16_bf16 a[0:15], a[160:163], v[168:171], a[0:15]
ds_read_b64_tr_b16 a[188:189], v16 offset:7776
ds_read_b64_tr_b16 a[190:191], v17 offset:7776
s_waitcnt lgkmcnt(7)
v_lshlrev_b32 v23, 16, v176
v_and_b32 v24, s61, v176
v_fma_f32 v23, v23, v21, v22
v_fma_f32 v24, v24, v21, v22
v_cvt_pk_bf16_f32 v176, v23, v24
v_mfma_f32_32x32x16_bf16 a[16:31], a[164:167], v[168:171], a[16:31]
s_waitcnt vmcnt(16)
s_barrier
v_add_u32 v16, 0x5000, v16
v_add_u32 v17, 0x5000, v17
ds_read_b64_tr_b16 a[160:161], v16 offset:0
ds_read_b64_tr_b16 a[162:163], v17 offset:0
v_lshlrev_b32 v23, 16, v177
v_and_b32 v24, s61, v177
v_fma_f32 v23, v23, v21, v22
v_fma_f32 v24, v24, v21, v22
v_cvt_pk_bf16_f32 v177, v23, v24
v_mfma_f32_32x32x16_bf16 a[32:47], a[168:171], v[168:171], a[32:47]
s_add_u32 m0, s96, 0xa000
ds_read_b64_tr_b16 a[164:165], v16 offset:32
ds_read_b64_tr_b16 a[166:167], v17 offset:32
buffer_load_dwordx4 v6, s[32:35], s56 offen offset:1024 lds
ds_read_b64_tr_b16 a[228:229], v49 offset:984
v_lshlrev_b32 v23, 16, v178
v_and_b32 v24, s61, v178
v_fma_f32 v23, v23, v21, v22
v_fma_f32 v24, v24, v21, v22
v_cvt_pk_bf16_f32 v178, v23, v24
v_mfma_f32_32x32x16_bf16 a[48:63], a[172:175], v[168:171], a[48:63]
ds_read_b64_tr_b16 a[168:169], v16 offset:64
ds_read_b64_tr_b16 a[170:171], v17 offset:64
v_lshlrev_b32 v23, 16, v179
v_and_b32 v24, s61, v179
v_fma_f32 v23, v23, v21, v22
v_fma_f32 v24, v24, v21, v22
v_cvt_pk_bf16_f32 v179, v23, v24
v_mfma_f32_32x32x16_bf16 a[0:15], a[176:179], v[172:175], a[0:15]
ds_read_b64_tr_b16 a[172:173], v16 offset:96
ds_read_b64_tr_b16 a[174:175], v17 offset:96
s_waitcnt lgkmcnt(7)
v_lshlrev_b32 v25, 16, v180
v_and_b32 v26, s61, v180
v_fma_f32 v25, v25, v21, v22
v_fma_f32 v26, v26, v21, v22
v_cvt_pk_bf16_f32 v180, v25, v26
v_mfma_f32_32x32x16_bf16 a[16:31], a[180:183], v[172:175], a[16:31]
ds_read_b64_tr_b16 a[176:177], v16 offset:2560
ds_read_b64_tr_b16 a[178:179], v17 offset:2560
v_lshlrev_b32 v25, 16, v181
v_and_b32 v26, s61, v181
v_fma_f32 v25, v25, v21, v22
v_fma_f32 v26, v26, v21, v22
v_cvt_pk_bf16_f32 v181, v25, v26
v_mfma_f32_32x32x16_bf16 a[32:47], a[184:187], v[172:175], a[32:47]
ds_read_b64_tr_b16 a[180:181], v16 offset:2592
ds_read_b64_tr_b16 a[182:183], v17 offset:2592
ds_read_b64_tr_b16 a[230:231], v49 offset:1144
v_lshlrev_b32 v25, 16, v182
v_and_b32 v26, s61, v182
v_fma_f32 v25, v25, v21, v22
v_fma_f32 v26, v26, v21, v22
v_cvt_pk_bf16_f32 v182, v25, v26
v_mfma_f32_32x32x16_bf16 a[48:63], a[188:191], v[172:175], a[48:63]
s_add_u32 m0, s96, 0xa000
ds_read_b64_tr_b16 a[184:185], v16 offset:2624
ds_read_b64_tr_b16 a[186:187], v17 offset:2624
buffer_load_dwordx4 v7, s[32:35], s56 offen offset:2048 lds
v_lshlrev_b32 v25, 16, v183
v_and_b32 v26, s61, v183
v_fma_f32 v25, v25, v21, v22
v_fma_f32 v26, v26, v21, v22
v_cvt_pk_bf16_f32 v183, v25, v26
v_mfma_f32_32x32x16_bf16 a[0:15], a[160:163], v[176:179], a[0:15]
ds_read_b64_tr_b16 a[188:189], v16 offset:2656
ds_read_b64_tr_b16 a[190:191], v17 offset:2656
s_waitcnt lgkmcnt(7)
v_lshlrev_b32 v23, 16, v184
v_and_b32 v24, s61, v184
v_fma_f32 v23, v23, v21, v22
v_fma_f32 v24, v24, v21, v22
v_cvt_pk_bf16_f32 v184, v23, v24
v_mfma_f32_32x32x16_bf16 a[16:31], a[164:167], v[176:179], a[16:31]
ds_read_b64_tr_b16 a[160:161], v16 offset:5120
ds_read_b64_tr_b16 a[162:163], v17 offset:5120
v_lshlrev_b32 v23, 16, v185
v_and_b32 v24, s61, v185
v_fma_f32 v23, v23, v21, v22
v_fma_f32 v24, v24, v21, v22
v_cvt_pk_bf16_f32 v185, v23, v24
v_mfma_f32_32x32x16_bf16 a[32:47], a[168:171], v[176:179], a[32:47]
ds_read_b64_tr_b16 a[164:165], v16 offset:5152
ds_read_b64_tr_b16 a[166:167], v17 offset:5152
ds_read_b64_tr_b16 a[232:233], v49 offset:1304
v_lshlrev_b32 v23, 16, v186
v_and_b32 v24, s61, v186
v_fma_f32 v23, v23, v21, v22
v_fma_f32 v24, v24, v21, v22
v_cvt_pk_bf16_f32 v186, v23, v24
v_mfma_f32_32x32x16_bf16 a[48:63], a[172:175], v[176:179], a[48:63]
ds_read_b64_tr_b16 a[168:169], v16 offset:5184
ds_read_b64_tr_b16 a[170:171], v17 offset:5184
v_lshlrev_b32 v23, 16, v187
v_and_b32 v24, s61, v187
v_fma_f32 v23, v23, v21, v22
v_fma_f32 v24, v24, v21, v22
v_cvt_pk_bf16_f32 v187, v23, v24
v_mfma_f32_32x32x16_bf16 a[0:15], a[176:179], v[180:183], a[0:15]
s_add_u32 m0, s96, 0xa000
ds_read_b64_tr_b16 a[172:173], v16 offset:5216
ds_read_b64_tr_b16 a[174:175], v17 offset:5216
buffer_load_dwordx4 v8, s[32:35], s56 offen offset:3072 lds
s_waitcnt lgkmcnt(7)
v_lshlrev_b32 v25, 16, v188
v_and_b32 v26, s61, v188
v_fma_f32 v25, v25, v21, v22
v_fma_f32 v26, v26, v21, v22
v_cvt_pk_bf16_f32 v188, v25, v26
v_mfma_f32_32x32x16_bf16 a[16:31], a[180:183], v[180:183], a[16:31]
ds_read_b64_tr_b16 a[176:177], v16 offset:7680
ds_read_b64_tr_b16 a[178:179], v17 offset:7680
v_lshlrev_b32 v25, 16, v189
v_and_b32 v26, s61, v189
v_fma_f32 v25, v25, v21, v22
v_fma_f32 v26, v26, v21, v22
v_cvt_pk_bf16_f32 v189, v25, v26
v_mfma_f32_32x32x16_bf16 a[32:47], a[184:187], v[180:183], a[32:47]
ds_read_b64_tr_b16 a[180:181], v16 offset:7712
ds_read_b64_tr_b16 a[182:183], v17 offset:7712
ds_read_b64_tr_b16 a[234:235], v49 offset:1464
v_lshlrev_b32 v25, 16, v190
v_and_b32 v26, s61, v190
v_fma_f32 v25, v25, v21, v22
v_fma_f32 v26, v26, v21, v22
v_cvt_pk_bf16_f32 v190, v25, v26
v_mfma_f32_32x32x16_bf16 a[48:63], a[188:191], v[180:183], a[48:63]
ds_read_b64_tr_b16 a[184:185], v16 offset:7744
ds_read_b64_tr_b16 a[186:187], v17 offset:7744
v_lshlrev_b32 v25, 16, v191
v_and_b32 v26, s61, v191
v_fma_f32 v25, v25, v21, v22
v_fma_f32 v26, v26, v21, v22
v_cvt_pk_bf16_f32 v191, v25, v26
v_mfma_f32_32x32x16_bf16 a[0:15], a[160:163], v[184:187], a[0:15]
ds_read_b64_tr_b16 a[188:189], v16 offset:7776
ds_read_b64_tr_b16 a[190:191], v17 offset:7776
s_waitcnt lgkmcnt(7)
v_lshlrev_b32 v23, 16, v192
v_and_b32 v24, s61, v192
v_fma_f32 v23, v23, v21, v22
v_fma_f32 v24, v24, v21, v22
v_cvt_pk_bf16_f32 v192, v23, v24
v_mfma_f32_32x32x16_bf16 a[16:31], a[164:167], v[184:187], a[16:31]
s_waitcnt vmcnt(14)
s_barrier
v_add_u32 v16, 0x5000, v16
v_add_u32 v17, 0x5000, v17
ds_read_b64_tr_b16 a[160:161], v16 offset:0
ds_read_b64_tr_b16 a[162:163], v17 offset:0
v_lshlrev_b32 v23, 16, v193
v_and_b32 v24, s61, v193
v_fma_f32 v23, v23, v21, v22
v_fma_f32 v24, v24, v21, v22
v_cvt_pk_bf16_f32 v193, v23, v24
v_mfma_f32_32x32x16_bf16 a[32:47], a[168:171], v[184:187], a[32:47]
s_add_u32 m0, s96, 0xb000
ds_read_b64_tr_b16 a[164:165], v16 offset:32
ds_read_b64_tr_b16 a[166:167], v17 offset:32
buffer_load_dwordx4 v9, s[32:35], s56 offen offset:0 lds
s_add_u32 s56, s56, 0x30000
s_cmp_eq_u32 s56, 0x1e0000
s_cselect_b32 s56, 0, s56
v_lshlrev_b32 v23, 16, v194
v_and_b32 v24, s61, v194
v_fma_f32 v23, v23, v21, v22
v_fma_f32 v24, v24, v21, v22
v_cvt_pk_bf16_f32 v194, v23, v24
v_mfma_f32_32x32x16_bf16 a[48:63], a[172:175], v[184:187], a[48:63]
ds_read_b64_tr_b16 a[168:169], v16 offset:64
ds_read_b64_tr_b16 a[170:171], v17 offset:64
v_lshlrev_b32 v23, 16, v195
v_and_b32 v24, s61, v195
v_fma_f32 v23, v23, v21, v22
v_fma_f32 v24, v24, v21, v22
v_cvt_pk_bf16_f32 v195, v23, v24
v_mfma_f32_32x32x16_bf16 a[0:15], a[176:179], v[188:191], a[0:15]
ds_read_b64_tr_b16 a[172:173], v16 offset:96
ds_read_b64_tr_b16 a[174:175], v17 offset:96
s_waitcnt lgkmcnt(6)
v_lshlrev_b32 v25, 16, v196
v_and_b32 v26, s61, v196
v_fma_f32 v25, v25, v21, v22
v_fma_f32 v26, v26, v21, v22
v_cvt_pk_bf16_f32 v196, v25, v26
v_mfma_f32_32x32x16_bf16 a[16:31], a[180:183], v[188:191], a[16:31]
ds_read_b64_tr_b16 a[176:177], v16 offset:2560
ds_read_b64_tr_b16 a[178:179], v17 offset:2560
v_lshlrev_b32 v25, 16, v197
v_and_b32 v26, s61, v197
v_fma_f32 v25, v25, v21, v22
v_fma_f32 v26, v26, v21, v22
v_cvt_pk_bf16_f32 v197, v25, v26
v_mfma_f32_32x32x16_bf16 a[32:47], a[184:187], v[188:191], a[32:47]
ds_read_b64_tr_b16 a[180:181], v16 offset:2592
ds_read_b64_tr_b16 a[182:183], v17 offset:2592
v_lshlrev_b32 v25, 16, v198
v_and_b32 v26, s61, v198
v_fma_f32 v25, v25, v21, v22
v_fma_f32 v26, v26, v21, v22
v_cvt_pk_bf16_f32 v198, v25, v26
v_mfma_f32_32x32x16_bf16 a[48:63], a[188:191], v[188:191], a[48:63]
s_mov_b32 s56, s20
s_add_u32 m0, s97, 0xf000
ds_read_b64_tr_b16 a[184:185], v16 offset:2624
ds_read_b64_tr_b16 a[186:187], v17 offset:2624
buffer_load_dwordx4 v10, s[28:31], s56 offen offset:0 lds
v_lshlrev_b32 v25, 16, v199
v_and_b32 v26, s61, v199
v_fma_f32 v25, v25, v21, v22
v_fma_f32 v26, v26, v21, v22
v_cvt_pk_bf16_f32 v199, v25, v26
v_mfma_f32_32x32x16_bf16 a[0:15], a[160:163], v[192:195], a[0:15]
ds_read_b64_tr_b16 a[188:189], v16 offset:2656
ds_read_b64_tr_b16 a[190:191], v17 offset:2656
s_waitcnt lgkmcnt(6)
v_lshlrev_b32 v23, 16, v200
v_and_b32 v24, s61, v200
v_fma_f32 v23, v23, v21, v22
v_fma_f32 v24, v24, v21, v22
v_cvt_pk_bf16_f32 v200, v23, v24
v_mfma_f32_32x32x16_bf16 a[16:31], a[164:167], v[192:195], a[16:31]
ds_read_b64_tr_b16 a[160:161], v16 offset:5120
ds_read_b64_tr_b16 a[162:163], v17 offset:5120
v_lshlrev_b32 v23, 16, v201
v_and_b32 v24, s61, v201
v_fma_f32 v23, v23, v21, v22
v_fma_f32 v24, v24, v21, v22
v_cvt_pk_bf16_f32 v201, v23, v24
v_mfma_f32_32x32x16_bf16 a[32:47], a[168:171], v[192:195], a[32:47]
ds_read_b64_tr_b16 a[164:165], v16 offset:5152
ds_read_b64_tr_b16 a[166:167], v17 offset:5152
v_lshlrev_b32 v23, 16, v202
v_and_b32 v24, s61, v202
v_fma_f32 v23, v23, v21, v22
v_fma_f32 v24, v24, v21, v22
v_cvt_pk_bf16_f32 v202, v23, v24
v_mfma_f32_32x32x16_bf16 a[48:63], a[172:175], v[192:195], a[48:63]
ds_read_b64_tr_b16 a[168:169], v16 offset:5184
ds_read_b64_tr_b16 a[170:171], v17 offset:5184
v_lshlrev_b32 v23, 16, v203
v_and_b32 v24, s61, v203
v_fma_f32 v23, v23, v21, v22
v_fma_f32 v24, v24, v21, v22
v_cvt_pk_bf16_f32 v203, v23, v24
v_mfma_f32_32x32x16_bf16 a[0:15], a[176:179], v[196:199], a[0:15]
s_add_u32 m0, s97, 0xf000
ds_read_b64_tr_b16 a[172:173], v16 offset:5216
ds_read_b64_tr_b16 a[174:175], v17 offset:5216
buffer_load_dwordx4 v11, s[28:31], s56 offen offset:1024 lds
s_waitcnt lgkmcnt(6)
v_lshlrev_b32 v25, 16, v204
v_and_b32 v26, s61, v204
v_fma_f32 v25, v25, v21, v22
v_fma_f32 v26, v26, v21, v22
v_cvt_pk_bf16_f32 v204, v25, v26
v_mfma_f32_32x32x16_bf16 a[16:31], a[180:183], v[196:199], a[16:31]
ds_read_b64_tr_b16 a[176:177], v16 offset:7680
ds_read_b64_tr_b16 a[178:179], v17 offset:7680
v_lshlrev_b32 v25, 16, v205
v_and_b32 v26, s61, v205
v_fma_f32 v25, v25, v21, v22
v_fma_f32 v26, v26, v21, v22
v_cvt_pk_bf16_f32 v205, v25, v26
v_mfma_f32_32x32x16_bf16 a[32:47], a[184:187], v[196:199], a[32:47]
ds_read_b64_tr_b16 a[180:181], v16 offset:7712
ds_read_b64_tr_b16 a[182:183], v17 offset:7712
v_lshlrev_b32 v25, 16, v206
v_and_b32 v26, s61, v206
v_fma_f32 v25, v25, v21, v22
v_fma_f32 v26, v26, v21, v22
v_cvt_pk_bf16_f32 v206, v25, v26
v_mfma_f32_32x32x16_bf16 a[48:63], a[188:191], v[196:199], a[48:63]
ds_read_b64_tr_b16 a[184:185], v16 offset:7744
ds_read_b64_tr_b16 a[186:187], v17 offset:7744
v_lshlrev_b32 v25, 16, v207
v_and_b32 v26, s61, v207
v_fma_f32 v25, v25, v21, v22
v_fma_f32 v26, v26, v21, v22
v_cvt_pk_bf16_f32 v207, v25, v26
v_mfma_f32_32x32x16_bf16 a[0:15], a[160:163], v[200:203], a[0:15]
ds_read_b64_tr_b16 a[188:189], v16 offset:7776
ds_read_b64_tr_b16 a[190:191], v17 offset:7776
s_waitcnt lgkmcnt(6)
v_lshlrev_b32 v23, 16, v208
v_and_b32 v24, s61, v208
v_fma_f32 v23, v23, v21, v22
v_fma_f32 v24, v24, v21, v22
v_cvt_pk_bf16_f32 v208, v23, v24
v_mfma_f32_32x32x16_bf16 a[16:31], a[164:167], v[200:203], a[16:31]
s_waitcnt vmcnt(12)
s_barrier
v_add_u32 v16, 0xfffe2000, v16
v_add_u32 v17, 0xfffe2000, v17
ds_read_b64_tr_b16 a[160:161], v16 offset:0
ds_read_b64_tr_b16 a[162:163], v17 offset:0
v_lshlrev_b32 v23, 16, v209
v_and_b32 v24, s61, v209
v_fma_f32 v23, v23, v21, v22
v_fma_f32 v24, v24, v21, v22
v_cvt_pk_bf16_f32 v209, v23, v24
v_mfma_f32_32x32x16_bf16 a[32:47], a[168:171], v[200:203], a[32:47]
s_add_u32 m0, s97, 0xf000
ds_read_b64_tr_b16 a[164:165], v16 offset:32
ds_read_b64_tr_b16 a[166:167], v17 offset:32
buffer_load_dwordx4 v12, s[28:31], s56 offen offset:2048 lds
s_add_u32 s56, s56, 0x3c000
s_cmp_eq_u32 s56, 0x258000
s_cselect_b32 s56, 0, s56
v_lshlrev_b32 v23, 16, v210
v_and_b32 v24, s61, v210
v_fma_f32 v23, v23, v21, v22
v_fma_f32 v24, v24, v21, v22
v_cvt_pk_bf16_f32 v210, v23, v24
v_mfma_f32_32x32x16_bf16 a[48:63], a[172:175], v[200:203], a[48:63]
ds_read_b64_tr_b16 a[168:169], v16 offset:64
ds_read_b64_tr_b16 a[170:171], v17 offset:64
v_lshlrev_b32 v23, 16, v211
v_and_b32 v24, s61, v211
v_fma_f32 v23, v23, v21, v22
v_fma_f32 v24, v24, v21, v22
v_cvt_pk_bf16_f32 v211, v23, v24
v_mfma_f32_32x32x16_bf16 a[0:15], a[176:179], v[204:207], a[0:15]
ds_read_b64_tr_b16 a[172:173], v16 offset:96
ds_read_b64_tr_b16 a[174:175], v17 offset:96
s_waitcnt lgkmcnt(6)
v_lshlrev_b32 v25, 16, v212
v_and_b32 v26, s61, v212
v_fma_f32 v25, v25, v21, v22
v_fma_f32 v26, v26, v21, v22
v_cvt_pk_bf16_f32 v212, v25, v26
v_mfma_f32_32x32x16_bf16 a[16:31], a[180:183], v[204:207], a[16:31]
ds_read_b64_tr_b16 a[176:177], v16 offset:2560
ds_read_b64_tr_b16 a[178:179], v17 offset:2560
v_lshlrev_b32 v25, 16, v213
v_and_b32 v26, s61, v213
v_fma_f32 v25, v25, v21, v22
v_fma_f32 v26, v26, v21, v22
v_cvt_pk_bf16_f32 v213, v25, v26
v_mfma_f32_32x32x16_bf16 a[32:47], a[184:187], v[204:207], a[32:47]
ds_read_b64_tr_b16 a[180:181], v16 offset:2592
ds_read_b64_tr_b16 a[182:183], v17 offset:2592
v_lshlrev_b32 v25, 16, v214
v_and_b32 v26, s61, v214
v_fma_f32 v25, v25, v21, v22
v_fma_f32 v26, v26, v21, v22
v_cvt_pk_bf16_f32 v214, v25, v26
v_mfma_f32_32x32x16_bf16 a[48:63], a[188:191], v[204:207], a[48:63]
s_add_u32 m0, s97, 0x14000
ds_read_b64_tr_b16 a[184:185], v16 offset:2624
ds_read_b64_tr_b16 a[186:187], v17 offset:2624
buffer_load_dwordx4 v10, s[28:31], s56 offen offset:0 lds
v_lshlrev_b32 v25, 16, v215
v_and_b32 v26, s61, v215
v_fma_f32 v25, v25, v21, v22
v_fma_f32 v26, v26, v21, v22
v_cvt_pk_bf16_f32 v215, v25, v26
v_mfma_f32_32x32x16_bf16 a[0:15], a[160:163], v[208:211], a[0:15]
ds_read_b64_tr_b16 a[188:189], v16 offset:2656
ds_read_b64_tr_b16 a[190:191], v17 offset:2656
s_waitcnt lgkmcnt(6)
v_lshlrev_b32 v23, 16, v216
v_and_b32 v24, s61, v216
v_fma_f32 v23, v23, v21, v22
v_fma_f32 v24, v24, v21, v22
v_cvt_pk_bf16_f32 v216, v23, v24
v_mfma_f32_32x32x16_bf16 a[16:31], a[164:167], v[208:211], a[16:31]
ds_read_b64_tr_b16 a[160:161], v16 offset:5120
ds_read_b64_tr_b16 a[162:163], v17 offset:5120
v_lshlrev_b32 v23, 16, v217
v_and_b32 v24, s61, v217
v_fma_f32 v23, v23, v21, v22
v_fma_f32 v24, v24, v21, v22
v_cvt_pk_bf16_f32 v217, v23, v24
v_mfma_f32_32x32x16_bf16 a[32:47], a[168:171], v[208:211], a[32:47]
ds_read_b64_tr_b16 a[164:165], v16 offset:5152
ds_read_b64_tr_b16 a[166:167], v17 offset:5152
v_lshlrev_b32 v23, 16, v218
v_and_b32 v24, s61, v218
v_fma_f32 v23, v23, v21, v22
v_fma_f32 v24, v24, v21, v22
v_cvt_pk_bf16_f32 v218, v23, v24
v_mfma_f32_32x32x16_bf16 a[48:63], a[172:175], v[208:211], a[48:63]
ds_read_b64_tr_b16 a[168:169], v16 offset:5184
ds_read_b64_tr_b16 a[170:171], v17 offset:5184
v_lshlrev_b32 v23, 16, v219
v_and_b32 v24, s61, v219
v_fma_f32 v23, v23, v21, v22
v_fma_f32 v24, v24, v21, v22
v_cvt_pk_bf16_f32 v219, v23, v24
v_mfma_f32_32x32x16_bf16 a[0:15], a[176:179], v[212:215], a[0:15]
s_add_u32 m0, s97, 0x14000
ds_read_b64_tr_b16 a[172:173], v16 offset:5216
ds_read_b64_tr_b16 a[174:175], v17 offset:5216
buffer_load_dwordx4 v11, s[28:31], s56 offen offset:1024 lds
s_waitcnt lgkmcnt(6)
v_and_b32 v51, 3, v1
v_lshlrev_b32 v51, 2, v51
v_mfma_f32_32x32x16_bf16 a[16:31], a[180:183], v[212:215], a[16:31]
ds_read_b64_tr_b16 a[176:177], v16 offset:7680
ds_read_b64_tr_b16 a[178:179], v17 offset:7680
buffer_load_dword v52, v51, s[48:51], 0 offen offset:64 sc1
v_lshlrev_b32 v25, 16, v220
v_and_b32 v26, s61, v220
v_fma_f32 v25, v25, v21, v22
v_fma_f32 v26, v26, v21, v22
v_cvt_pk_bf16_f32 v220, v25, v26
v_mfma_f32_32x32x16_bf16 a[32:47], a[184:187], v[212:215], a[32:47]
ds_read_b64_tr_b16 a[180:181], v16 offset:7712
ds_read_b64_tr_b16 a[182:183], v17 offset:7712
v_lshlrev_b32 v25, 16, v221
v_and_b32 v26, s61, v221
v_fma_f32 v25, v25, v21, v22
v_fma_f32 v26, v26, v21, v22
v_cvt_pk_bf16_f32 v221, v25, v26
v_mfma_f32_32x32x16_bf16 a[48:63], a[188:191], v[212:215], a[48:63]
ds_read_b64_tr_b16 a[184:185], v16 offset:7744
ds_read_b64_tr_b16 a[186:187], v17 offset:7744
v_lshlrev_b32 v25, 16, v222
v_and_b32 v26, s61, v222
v_fma_f32 v25, v25, v21, v22
v_fma_f32 v26, v26, v21, v22
v_cvt_pk_bf16_f32 v222, v25, v26
v_mfma_f32_32x32x16_bf16 a[0:15], a[160:163], v[216:219], a[0:15]
ds_read_b64_tr_b16 a[188:189], v16 offset:7776
ds_read_b64_tr_b16 a[190:191], v17 offset:7776
s_waitcnt lgkmcnt(6)
v_lshlrev_b32 v25, 16, v223
v_and_b32 v26, s61, v223
v_fma_f32 v25, v25, v21, v22
v_fma_f32 v26, v26, v21, v22
v_cvt_pk_bf16_f32 v223, v25, v26
v_mfma_f32_32x32x16_bf16 a[16:31], a[164:167], v[216:219], a[16:31]
s_waitcnt vmcnt(11)
s_barrier
v_add_u32 v16, 0x5000, v16
v_add_u32 v17, 0x5000, v17
ds_read_b64_tr_b16 a[160:161], v16 offset:0
ds_read_b64_tr_b16 a[162:163], v17 offset:0
v_lshlrev_b32 v23, 16, v224
v_and_b32 v24, s61, v224
v_fma_f32 v23, v23, v21, v22
v_fma_f32 v24, v24, v21, v22
v_cvt_pk_bf16_f32 v224, v23, v24
v_mfma_f32_32x32x16_bf16 a[32:47], a[168:171], v[216:219], a[32:47]
s_add_u32 m0, s97, 0x14000
ds_read_b64_tr_b16 a[164:165], v16 offset:32
ds_read_b64_tr_b16 a[166:167], v17 offset:32
buffer_load_dwordx4 v12, s[28:31], s56 offen offset:2048 lds
s_add_u32 s56, s56, 0x3c000
s_cmp_eq_u32 s56, 0x258000
s_cselect_b32 s56, 0, s56
v_lshlrev_b32 v23, 16, v225
v_and_b32 v24, s61, v225
v_fma_f32 v23, v23, v21, v22
v_fma_f32 v24, v24, v21, v22
v_cvt_pk_bf16_f32 v225, v23, v24
v_mfma_f32_32x32x16_bf16 a[48:63], a[172:175], v[216:219], a[48:63]
ds_read_b64_tr_b16 a[168:169], v16 offset:64
ds_read_b64_tr_b16 a[170:171], v17 offset:64
v_lshlrev_b32 v23, 16, v226
v_and_b32 v24, s61, v226
v_fma_f32 v23, v23, v21, v22
v_fma_f32 v24, v24, v21, v22
v_cvt_pk_bf16_f32 v226, v23, v24
v_mfma_f32_32x32x16_bf16 a[0:15], a[176:179], v[220:223], a[0:15]
ds_read_b64_tr_b16 a[172:173], v16 offset:96
ds_read_b64_tr_b16 a[174:175], v17 offset:96
s_waitcnt lgkmcnt(6)
v_lshlrev_b32 v23, 16, v227
v_and_b32 v24, s61, v227
v_fma_f32 v23, v23, v21, v22
v_fma_f32 v24, v24, v21, v22
v_cvt_pk_bf16_f32 v227, v23, v24
v_mfma_f32_32x32x16_bf16 a[16:31], a[180:183], v[220:223], a[16:31]
ds_read_b64_tr_b16 a[176:177], v16 offset:2560
ds_read_b64_tr_b16 a[178:179], v17 offset:2560
v_lshlrev_b32 v25, 16, v228
v_and_b32 v26, s61, v228
v_fma_f32 v25, v25, v21, v22
v_fma_f32 v26, v26, v21, v22
v_cvt_pk_bf16_f32 v228, v25, v26
v_mfma_f32_32x32x16_bf16 a[32:47], a[184:187], v[220:223], a[32:47]
ds_read_b64_tr_b16 a[180:181], v16 offset:2592
ds_read_b64_tr_b16 a[182:183], v17 offset:2592
v_lshlrev_b32 v25, 16, v229
v_and_b32 v26, s61, v229
v_fma_f32 v25, v25, v21, v22
v_fma_f32 v26, v26, v21, v22
v_cvt_pk_bf16_f32 v229, v25, v26
v_mfma_f32_32x32x16_bf16 a[48:63], a[188:191], v[220:223], a[48:63]
s_add_u32 m0, s97, 0x19000
ds_read_b64_tr_b16 a[184:185], v16 offset:2624
ds_read_b64_tr_b16 a[186:187], v17 offset:2624
buffer_load_dwordx4 v10, s[28:31], s56 offen offset:0 lds
v_lshlrev_b32 v25, 16, v230
v_and_b32 v26, s61, v230
v_fma_f32 v25, v25, v21, v22
v_fma_f32 v26, v26, v21, v22
v_cvt_pk_bf16_f32 v230, v25, v26
v_mfma_f32_32x32x16_bf16 a[0:15], a[160:163], v[224:227], a[0:15]
ds_read_b64_tr_b16 a[188:189], v16 offset:2656
ds_read_b64_tr_b16 a[190:191], v17 offset:2656
s_waitcnt lgkmcnt(6)
v_lshlrev_b32 v25, 16, v231
v_and_b32 v26, s61, v231
v_fma_f32 v25, v25, v21, v22
v_fma_f32 v26, v26, v21, v22
v_cvt_pk_bf16_f32 v231, v25, v26
v_mfma_f32_32x32x16_bf16 a[16:31], a[164:167], v[224:227], a[16:31]
ds_read_b64_tr_b16 a[160:161], v16 offset:5120
ds_read_b64_tr_b16 a[162:163], v17 offset:5120
v_lshlrev_b32 v23, 16, v232
v_and_b32 v24, s61, v232
v_fma_f32 v23, v23, v21, v22
v_fma_f32 v24, v24, v21, v22
v_cvt_pk_bf16_f32 v232, v23, v24
v_mfma_f32_32x32x16_bf16 a[32:47], a[168:171], v[224:227], a[32:47]
ds_read_b64_tr_b16 a[164:165], v16 offset:5152
ds_read_b64_tr_b16 a[166:167], v17 offset:5152
v_lshlrev_b32 v23, 16, v233
v_and_b32 v24, s61, v233
v_fma_f32 v23, v23, v21, v22
v_fma_f32 v24, v24, v21, v22
v_cvt_pk_bf16_f32 v233, v23, v24
v_mfma_f32_32x32x16_bf16 a[48:63], a[172:175], v[224:227], a[48:63]
ds_read_b64_tr_b16 a[168:169], v16 offset:5184
ds_read_b64_tr_b16 a[170:171], v17 offset:5184
v_lshlrev_b32 v23, 16, v234
v_and_b32 v24, s61, v234
v_fma_f32 v23, v23, v21, v22
v_fma_f32 v24, v24, v21, v22
v_cvt_pk_bf16_f32 v234, v23, v24
v_mfma_f32_32x32x16_bf16 a[0:15], a[176:179], v[228:231], a[0:15]
s_add_u32 m0, s97, 0x19000
ds_read_b64_tr_b16 a[172:173], v16 offset:5216
ds_read_b64_tr_b16 a[174:175], v17 offset:5216
buffer_load_dwordx4 v11, s[28:31], s56 offen offset:1024 lds
s_waitcnt lgkmcnt(6)
v_lshlrev_b32 v23, 16, v235
v_and_b32 v24, s61, v235
v_fma_f32 v23, v23, v21, v22
v_fma_f32 v24, v24, v21, v22
v_cvt_pk_bf16_f32 v235, v23, v24
v_mfma_f32_32x32x16_bf16 a[16:31], a[180:183], v[228:231], a[16:31]
ds_read_b64_tr_b16 a[176:177], v16 offset:7680
ds_read_b64_tr_b16 a[178:179], v17 offset:7680
v_lshlrev_b32 v25, 16, v236
v_and_b32 v26, s61, v236
v_fma_f32 v25, v25, v21, v22
v_fma_f32 v26, v26, v21, v22
v_cvt_pk_bf16_f32 v236, v25, v26
v_mfma_f32_32x32x16_bf16 a[32:47], a[184:187], v[228:231], a[32:47]
ds_read_b64_tr_b16 a[180:181], v16 offset:7712
ds_read_b64_tr_b16 a[182:183], v17 offset:7712
v_lshlrev_b32 v25, 16, v237
v_and_b32 v26, s61, v237
v_fma_f32 v25, v25, v21, v22
v_fma_f32 v26, v26, v21, v22
v_cvt_pk_bf16_f32 v237, v25, v26
v_mfma_f32_32x32x16_bf16 a[48:63], a[188:191], v[228:231], a[48:63]
ds_read_b64_tr_b16 a[184:185], v16 offset:7744
ds_read_b64_tr_b16 a[186:187], v17 offset:7744
v_lshlrev_b32 v25, 16, v238
v_and_b32 v26, s61, v238
v_fma_f32 v25, v25, v21, v22
v_fma_f32 v26, v26, v21, v22
v_cvt_pk_bf16_f32 v238, v25, v26
v_mfma_f32_32x32x16_bf16 a[0:15], a[160:163], v[232:235], a[0:15]
ds_read_b64_tr_b16 a[188:189], v16 offset:7776
ds_read_b64_tr_b16 a[190:191], v17 offset:7776
s_waitcnt lgkmcnt(6)
v_lshlrev_b32 v25, 16, v239
v_and_b32 v26, s61, v239
v_fma_f32 v25, v25, v21, v22
v_fma_f32 v26, v26, v21, v22
v_cvt_pk_bf16_f32 v239, v25, v26
v_mfma_f32_32x32x16_bf16 a[16:31], a[164:167], v[232:235], a[16:31]
s_waitcnt vmcnt(9)
s_barrier
v_add_u32 v16, 0x5000, v16
v_add_u32 v17, 0x5000, v17
ds_read_b64_tr_b16 a[160:161], v16 offset:0
ds_read_b64_tr_b16 a[162:163], v17 offset:0
v_lshlrev_b32 v23, 16, v240
v_and_b32 v24, s61, v240
v_fma_f32 v23, v23, v21, v22
v_fma_f32 v24, v24, v21, v22
v_cvt_pk_bf16_f32 v240, v23, v24
v_mfma_f32_32x32x16_bf16 a[32:47], a[168:171], v[232:235], a[32:47]
s_add_u32 m0, s97, 0x19000
ds_read_b64_tr_b16 a[164:165], v16 offset:32
ds_read_b64_tr_b16 a[166:167], v17 offset:32
buffer_load_dwordx4 v12, s[28:31], s56 offen offset:2048 lds
s_add_u32 s56, s56, 0x3c000
s_cmp_eq_u32 s56, 0x258000
s_cselect_b32 s56, 0, s56
v_lshlrev_b32 v23, 16, v241
v_and_b32 v24, s61, v241
v_fma_f32 v23, v23, v21, v22
v_fma_f32 v24, v24, v21, v22
v_cvt_pk_bf16_f32 v241, v23, v24
v_mfma_f32_32x32x16_bf16 a[48:63], a[172:175], v[232:235], a[48:63]
ds_read_b64_tr_b16 a[168:169], v16 offset:64
ds_read_b64_tr_b16 a[170:171], v17 offset:64
v_lshlrev_b32 v23, 16, v242
v_and_b32 v24, s61, v242
v_fma_f32 v23, v23, v21, v22
v_fma_f32 v24, v24, v21, v22
v_cvt_pk_bf16_f32 v242, v23, v24
v_mfma_f32_32x32x16_bf16 a[0:15], a[176:179], v[236:239], a[0:15]
ds_read_b64_tr_b16 a[172:173], v16 offset:96
ds_read_b64_tr_b16 a[174:175], v17 offset:96
s_waitcnt lgkmcnt(6)
v_lshlrev_b32 v23, 16, v243
v_and_b32 v24, s61, v243
v_fma_f32 v23, v23, v21, v22
v_fma_f32 v24, v24, v21, v22
v_cvt_pk_bf16_f32 v243, v23, v24
v_mfma_f32_32x32x16_bf16 a[16:31], a[180:183], v[236:239], a[16:31]
ds_read_b64_tr_b16 a[176:177], v16 offset:2560
ds_read_b64_tr_b16 a[178:179], v17 offset:2560
v_lshlrev_b32 v25, 16, v244
v_and_b32 v26, s61, v244
v_fma_f32 v25, v25, v21, v22
v_fma_f32 v26, v26, v21, v22
v_cvt_pk_bf16_f32 v244, v25, v26
v_mfma_f32_32x32x16_bf16 a[32:47], a[184:187], v[236:239], a[32:47]
ds_read_b64_tr_b16 a[180:181], v16 offset:2592
ds_read_b64_tr_b16 a[182:183], v17 offset:2592
v_lshlrev_b32 v25, 16, v245
v_and_b32 v26, s61, v245
v_fma_f32 v25, v25, v21, v22
v_fma_f32 v26, v26, v21, v22
v_cvt_pk_bf16_f32 v245, v25, v26
v_mfma_f32_32x32x16_bf16 a[48:63], a[188:191], v[236:239], a[48:63]
s_add_u32 m0, s97, 0x1e000
ds_read_b64_tr_b16 a[184:185], v16 offset:2624
ds_read_b64_tr_b16 a[186:187], v17 offset:2624
buffer_load_dwordx4 v10, s[28:31], s56 offen offset:0 lds
v_lshlrev_b32 v25, 16, v246
v_and_b32 v26, s61, v246
v_fma_f32 v25, v25, v21, v22
v_fma_f32 v26, v26, v21, v22
v_cvt_pk_bf16_f32 v246, v25, v26
v_mfma_f32_32x32x16_bf16 a[0:15], a[160:163], v[240:243], a[0:15]
ds_read_b64_tr_b16 a[188:189], v16 offset:2656
ds_read_b64_tr_b16 a[190:191], v17 offset:2656
s_waitcnt lgkmcnt(6)
v_lshlrev_b32 v25, 16, v247
v_and_b32 v26, s61, v247
v_fma_f32 v25, v25, v21, v22
v_fma_f32 v26, v26, v21, v22
v_cvt_pk_bf16_f32 v247, v25, v26
v_mfma_f32_32x32x16_bf16 a[16:31], a[164:167], v[240:243], a[16:31]
ds_read_b64_tr_b16 a[160:161], v16 offset:5120
ds_read_b64_tr_b16 a[162:163], v17 offset:5120
v_lshlrev_b32 v23, 16, v248
v_and_b32 v24, s61, v248
v_fma_f32 v23, v23, v21, v22
v_fma_f32 v24, v24, v21, v22
v_cvt_pk_bf16_f32 v248, v23, v24
v_mfma_f32_32x32x16_bf16 a[32:47], a[168:171], v[240:243], a[32:47]
ds_read_b64_tr_b16 a[164:165], v16 offset:5152
ds_read_b64_tr_b16 a[166:167], v17 offset:5152
v_lshlrev_b32 v23, 16, v249
v_and_b32 v24, s61, v249
v_fma_f32 v23, v23, v21, v22
v_fma_f32 v24, v24, v21, v22
v_cvt_pk_bf16_f32 v249, v23, v24
v_mfma_f32_32x32x16_bf16 a[48:63], a[172:175], v[240:243], a[48:63]
ds_read_b64_tr_b16 a[168:169], v16 offset:5184
ds_read_b64_tr_b16 a[170:171], v17 offset:5184
v_lshlrev_b32 v23, 16, v250
v_and_b32 v24, s61, v250
v_fma_f32 v23, v23, v21, v22
v_fma_f32 v24, v24, v21, v22
v_cvt_pk_bf16_f32 v250, v23, v24
v_mfma_f32_32x32x16_bf16 a[0:15], a[176:179], v[244:247], a[0:15]
s_add_u32 m0, s97, 0x1e000
ds_read_b64_tr_b16 a[172:173], v16 offset:5216
ds_read_b64_tr_b16 a[174:175], v17 offset:5216
buffer_load_dwordx4 v11, s[28:31], s56 offen offset:1024 lds
s_waitcnt lgkmcnt(6)
v_lshlrev_b32 v23, 16, v251
v_and_b32 v24, s61, v251
v_fma_f32 v23, v23, v21, v22
v_fma_f32 v24, v24, v21, v22
v_cvt_pk_bf16_f32 v251, v23, v24
v_mfma_f32_32x32x16_bf16 a[16:31], a[180:183], v[244:247], a[16:31]
ds_read_b64_tr_b16 a[176:177], v16 offset:7680
ds_read_b64_tr_b16 a[178:179], v17 offset:7680
v_lshlrev_b32 v25, 16, v252
v_and_b32 v26, s61, v252
v_fma_f32 v25, v25, v21, v22
v_fma_f32 v26, v26, v21, v22
v_cvt_pk_bf16_f32 v252, v25, v26
v_mfma_f32_32x32x16_bf16 a[32:47], a[184:187], v[244:247], a[32:47]
ds_read_b64_tr_b16 a[180:181], v16 offset:7712
ds_read_b64_tr_b16 a[182:183], v17 offset:7712
v_lshlrev_b32 v25, 16, v253
v_and_b32 v26, s61, v253
v_fma_f32 v25, v25, v21, v22
v_fma_f32 v26, v26, v21, v22
v_cvt_pk_bf16_f32 v253, v25, v26
v_mfma_f32_32x32x16_bf16 a[48:63], a[188:191], v[244:247], a[48:63]
ds_read_b64_tr_b16 a[184:185], v16 offset:7744
ds_read_b64_tr_b16 a[186:187], v17 offset:7744
v_lshlrev_b32 v25, 16, v254
v_and_b32 v26, s61, v254
v_fma_f32 v25, v25, v21, v22
v_fma_f32 v26, v26, v21, v22
v_cvt_pk_bf16_f32 v254, v25, v26
v_mfma_f32_32x32x16_bf16 a[0:15], a[160:163], v[248:251], a[0:15]
ds_read_b64_tr_b16 a[188:189], v16 offset:7776
ds_read_b64_tr_b16 a[190:191], v17 offset:7776
s_waitcnt lgkmcnt(6)
v_lshlrev_b32 v25, 16, v255
v_and_b32 v26, s61, v255
v_fma_f32 v25, v25, v21, v22
v_fma_f32 v26, v26, v21, v22
v_cvt_pk_bf16_f32 v255, v25, v26
v_mfma_f32_32x32x16_bf16 a[16:31], a[164:167], v[248:251], a[16:31]
s_waitcnt vmcnt(9)
s_barrier
ds_read_b64_tr_b16 a[160:161], v18 offset:0
ds_read_b64_tr_b16 a[162:163], v18 offset:768
v_mfma_f32_32x32x16_bf16 a[32:47], a[168:171], v[248:251], a[32:47]
s_add_u32 m0, s97, 0x1e000
ds_read_b64_tr_b16 a[164:165], v18 offset:32
ds_read_b64_tr_b16 a[166:167], v18 offset:800
buffer_load_dwordx4 v12, s[28:31], s56 offen offset:2048 lds
s_add_u32 s56, s56, 0x3c000
s_cmp_eq_u32 s56, 0x258000
s_cselect_b32 s56, 0, s56
v_mfma_f32_32x32x16_bf16 a[48:63], a[172:175], v[248:251], a[48:63]
ds_read_b64_tr_b16 a[168:169], v18 offset:64
ds_read_b64_tr_b16 a[170:171], v18 offset:832
v_mfma_f32_32x32x16_bf16 a[0:15], a[176:179], v[252:255], a[0:15]
ds_read_b64_tr_b16 a[172:173], v18 offset:3072
ds_read_b64_tr_b16 a[174:175], v18 offset:3840
s_waitcnt lgkmcnt(6)
v_mfma_f32_32x32x16_bf16 a[16:31], a[180:183], v[252:255], a[16:31]
ds_read_b64_tr_b16 a[176:177], v18 offset:3104
ds_read_b64_tr_b16 a[178:179], v18 offset:3872
v_mfma_f32_32x32x16_bf16 a[32:47], a[184:187], v[252:255], a[32:47]
ds_read_b64_tr_b16 a[180:181], v18 offset:3136
ds_read_b64_tr_b16 a[182:183], v18 offset:3904
v_mfma_f32_32x32x16_bf16 a[48:63], a[188:191], v[252:255], a[48:63]
s_add_u32 m0, s97, 0
ds_read_b64_tr_b16 a[184:185], v18 offset:6144
ds_read_b64_tr_b16 a[186:187], v18 offset:6912
buffer_load_dwordx4 v10, s[28:31], s56 offen offset:0 lds
v_mfma_f32_32x32x16_bf16 a[80:95], a[160:163], v[96:99], 0
ds_read_b64_tr_b16 a[188:189], v18 offset:6176
ds_read_b64_tr_b16 a[190:191], v18 offset:6944
s_waitcnt lgkmcnt(6)
s_waitcnt vmcnt(8)
v_cmp_eq_u32 vcc, 1, v52
s_nop 3
s_cmp_eq_u64 vcc, -1
s_cbranch_scc1 Y_g_ok
s_mov_b32 s60, 0
Y_g_spin:
s_add_u32 s60, s60, 1
s_cmp_ge_u32 s60, 0x40000
s_cbranch_scc1 Y_g_ok
s_sleep 16
buffer_load_dword v52, v51, s[48:51], 0 offen offset:64 sc1
s_waitcnt vmcnt(0)
v_cmp_eq_u32 vcc, 1, v52
s_nop 3
s_cmp_eq_u64 vcc, -1
s_cbranch_scc0 Y_g_spin
Y_g_ok:
v_mfma_f32_32x32x16_bf16 a[96:111], a[164:167], v[96:99], 0
ds_read_b64_tr_b16 a[160:161], v18 offset:6208
ds_read_b64_tr_b16 a[162:163], v18 offset:6976
s_lshl_b32 s4, s53, 3
s_add_u32 s4, s4, s54
s_lshl_b32 s4, s4, 2
s_add_u32 s4, s4, s52
s_mul_i32 s5, s4, 0xcccd
s_lshr_b32 s5, s5, 19
s_mul_i32 s14, s5, 10
s_sub_u32 s6, s4, s14
s_mul_i32 s7, s5, 0xf10
s_lshr_b32 s7, s7, 16
s_mul_i32 s14, s7, 17
s_sub_u32 s8, s5, s14
s_mul_i32 s12, s7, 12
s_add_u32 s12, s12, s8
s_lshl_b32 s12, s12, 5
v_mfma_f32_32x32x16_bf16 a[112:127], a[168:171], v[96:99], 0
ds_read_b64_tr_b16 a[164:165], v18 offset:9216
ds_read_b64_tr_b16 a[166:167], v18 offset:9984
s_cmp_eq_u32 s8, 2
s_cselect_b32 s14, 1, 0
s_cmp_eq_u32 s8, 8
s_cselect_b32 s14, 1, s14
s_cmp_eq_u32 s14, 1
s_cselect_b32 s9, 16, 8
s_cselect_b32 s13, 8, 16
s_sub_u32 s14, s8, 12
s_lshr_b32 s15, s14, 1
s_mul_i32 s15, s15, 0x50
s_and_b32 s14, s14, 1
s_lshl_b32 s14, s14, 3
s_add_u32 s15, s15, s14
s_mul_i32 s4, s7, 0xa0
v_mfma_f32_32x32x16_bf16 a[80:95], a[172:175], v[100:103], a[80:95]
s_add_u32 m0, s97, 0
ds_read_b64_tr_b16 a[168:169], v18 offset:9248
ds_read_b64_tr_b16 a[170:171], v18 offset:10016
buffer_load_dwordx4 v11, s[28:31], s56 offen offset:1024 lds
s_cmp_eq_u32 s8, 16
s_cselect_b32 s15, 16, s15
s_cselect_b32 s14, 0x50, 4
s_add_u32 s15, s15, s4
s_cmp_ge_u32 s8, 12
s_cselect_b32 s12, s15, s12
s_cselect_b32 s9, s14, s9
s_cselect_b32 s13, 20, s13
s_cselect_b32 s14, 40, 4
s_cselect_b32 s44, s10, s98
s_cselect_b32 s45, s11, s99
s_cmp_ge_u32 s8, 12
s_mov_b32 s46, 0x1e0000
s_cselect_b32 s46, 0xc8000, s46
s_mov_b32 s47, 0x20000
s_mul_i32 s4, s7, 10
s_add_u32 s4, s4, s6
s_lshl_b32 s4, s4, 5
s_add_u32 s4, s4, s8
v_mfma_f32_32x32x16_bf16 a[96:111], a[176:179], v[100:103], a[96:111]
ds_read_b64_tr_b16 a[172:173], v18 offset:9280
ds_read_b64_tr_b16 a[174:175], v18 offset:10048
s_waitcnt lgkmcnt(6)
s_lshl_b32 s4, s4, 2
s_add_u32 s81, s4, 0xb4e000
v_lshrrev_b32 v94, 5, v1
v_mul_u32_u24 v94, s9, v94
v_bfe_u32 v92, v1, 3, 2
v_mfma_f32_32x32x16_bf16 a[112:127], a[180:183], v[100:103], a[112:127]
s_waitcnt vmcnt(8)
s_barrier
v_add_u32 v18, 0x5000, v18
ds_read_b64_tr_b16 a[176:177], v18 offset:0
ds_read_b64_tr_b16 a[178:179], v18 offset:768
v_add_u32 v94, v94, v92
v_mul_u32_u24 v94, 0x500, v94
v_and_b32 v92, 7, v1
v_mfma_f32_32x32x16_bf16 a[80:95], a[184:187], v[104:107], a[80:95]
s_add_u32 m0, s97, 0
ds_read_b64_tr_b16 a[180:181], v18 offset:32
ds_read_b64_tr_b16 a[182:183], v18 offset:800
buffer_load_dwordx4 v12, s[28:31], s56 offen offset:2048 lds
s_add_u32 s56, s56, 0x3c000
s_cmp_eq_u32 s56, 0x258000
s_cselect_b32 s56, 0, s56
v_lshl_add_u32 v93, v92, 4, v94
s_lshl_b32 s4, s6, 7
s_lshl_b32 s7, s52, 12
s_add_u32 s7, s7, 0x23000
v_mfma_f32_32x32x16_bf16 a[96:111], a[188:191], v[104:107], a[96:111]
ds_read_b64_tr_b16 a[184:185], v18 offset:64
ds_read_b64_tr_b16 a[186:187], v18 offset:832
s_mov_b32 m0, s7
s_mul_i32 s15, s13, 0
s_add_u32 s15, s15, s12
s_mul_i32 s15, s15, 0x500
s_add_u32 s15, s15, s4
buffer_load_dwordx4 v93, s[44:47], s15 offen offset:0 lds
s_mov_b32 m0, s7
s_mul_i32 s15, s13, 1
s_add_u32 s15, s15, s12
s_mul_i32 s15, s15, 0x500
s_add_u32 s15, s15, s4
s_sub_u32 s15, s15, 0x400
buffer_load_dwordx4 v93, s[44:47], s15 offen offset:1024 lds
v_mfma_f32_32x32x16_bf16 a[112:127], a[160:163], v[104:107], a[112:127]
ds_read_b64_tr_b16 a[188:189], v18 offset:3072
ds_read_b64_tr_b16 a[190:191], v18 offset:3840
s_waitcnt lgkmcnt(6)
s_mov_b32 m0, s7
s_mul_i32 s15, s13, 0
s_add_u32 s15, s15, s12
s_add_u32 s15, s15, s14
s_mul_i32 s15, s15, 0x500
s_add_u32 s15, s15, s4
s_sub_u32 s15, s15, 0x800
buffer_load_dwordx4 v93, s[44:47], s15 offen offset:2048 lds
s_mov_b32 m0, s7
s_mul_i32 s15, s13, 1
s_add_u32 s15, s15, s12
s_add_u32 s15, s15, s14
s_mul_i32 s15, s15, 0x500
s_add_u32 s15, s15, s4
s_sub_u32 s15, s15, 0xc00
buffer_load_dwordx4 v93, s[44:47], s15 offen offset:3072 lds
v_accvgpr_read_b32 v72, a0
v_accvgpr_read_b32 v73, a1
v_accvgpr_read_b32 v74, a2
v_mfma_f32_32x32x16_bf16 a[80:95], a[164:167], v[108:111], a[80:95]
ds_read_b64_tr_b16 a[160:161], v18 offset:3104
ds_read_b64_tr_b16 a[162:163], v18 offset:3872
v_accvgpr_read_b32 v75, a3
v_accvgpr_read_b32 v76, a4
v_accvgpr_read_b32 v77, a5
v_mfma_f32_32x32x16_bf16 a[96:111], a[168:171], v[108:111], a[96:111]
s_add_u32 m0, s97, 0x5000
ds_read_b64_tr_b16 a[164:165], v18 offset:3136
ds_read_b64_tr_b16 a[166:167], v18 offset:3904
buffer_load_dwordx4 v10, s[28:31], s56 offen offset:0 lds
v_accvgpr_read_b32 v78, a6
v_accvgpr_read_b32 v79, a7
v_accvgpr_read_b32 v80, a8
v_mfma_f32_32x32x16_bf16 a[112:127], a[172:175], v[108:111], a[112:127]
ds_read_b64_tr_b16 a[168:169], v18 offset:6144
ds_read_b64_tr_b16 a[170:171], v18 offset:6912
v_accvgpr_read_b32 v81, a9
v_accvgpr_read_b32 v82, a10
v_accvgpr_read_b32 v83, a11
v_mfma_f32_32x32x16_bf16 a[80:95], a[176:179], v[112:115], a[80:95]
ds_read_b64_tr_b16 a[172:173], v18 offset:6176
ds_read_b64_tr_b16 a[174:175], v18 offset:6944
s_waitcnt lgkmcnt(6)
v_accvgpr_read_b32 v84, a12
v_accvgpr_read_b32 v85, a13
v_accvgpr_read_b32 v86, a14
v_mfma_f32_32x32x16_bf16 a[96:111], a[180:183], v[112:115], a[96:111]
ds_read_b64_tr_b16 a[176:177], v18 offset:6208
ds_read_b64_tr_b16 a[178:179], v18 offset:6976
v_accvgpr_read_b32 v87, a15
v_max_f32 v72, 0, v72
v_max_f32 v73, 0, v73
v_mfma_f32_32x32x16_bf16 a[112:127], a[184:187], v[112:115], a[112:127]
s_add_u32 m0, s97, 0x5000
ds_read_b64_tr_b16 a[180:181], v18 offset:9216
ds_read_b64_tr_b16 a[182:183], v18 offset:9984
buffer_load_dwordx4 v11, s[28:31], s56 offen offset:1024 lds
v_max_f32 v74, 0, v74
v_max_f32 v75, 0, v75
v_max_f32 v76, 0, v76
v_mfma_f32_32x32x16_bf16 a[80:95], a[188:191], v[116:119], a[80:95]
ds_read_b64_tr_b16 a[184:185], v18 offset:9248
ds_read_b64_tr_b16 a[186:187], v18 offset:10016
v_max_f32 v77, 0, v77
v_max_f32 v78, 0, v78
v_max_f32 v79, 0, v79
v_mfma_f32_32x32x16_bf16 a[96:111], a[160:163], v[116:119], a[96:111]
ds_read_b64_tr_b16 a[188:189], v18 offset:9280
ds_read_b64_tr_b16 a[190:191], v18 offset:10048
s_waitcnt lgkmcnt(6)
v_mul_f32 v80, v72, v80
v_mul_f32 v81, v73, v81
v_mul_f32 v82, v74, v82
v_mfma_f32_32x32x16_bf16 a[112:127], a[164:167], v[116:119], a[112:127]
s_waitcnt vmcnt(12)
s_barrier
v_add_u32 v18, 0x5000, v18
ds_read_b64_tr_b16 a[160:161], v18 offset:0
ds_read_b64_tr_b16 a[162:163], v18 offset:768
v_mul_f32 v83, v75, v83
v_mul_f32 v84, v76, v84
v_mul_f32 v85, v77, v85
v_mfma_f32_32x32x16_bf16 a[80:95], a[168:171], v[120:123], a[80:95]
s_add_u32 m0, s97, 0x5000
ds_read_b64_tr_b16 a[164:165], v18 offset:32
ds_read_b64_tr_b16 a[166:167], v18 offset:800
buffer_load_dwordx4 v12, s[28:31], s56 offen offset:2048 lds
s_add_u32 s56, s56, 0x3c000
s_cmp_eq_u32 s56, 0x258000
s_cselect_b32 s56, 0, s56
v_mul_f32 v86, v78, v86
v_mul_f32 v87, v79, v87
v_cvt_pk_bf16_f32 v40, v80, v81
v_mfma_f32_32x32x16_bf16 a[96:111], a[172:175], v[120:123], a[96:111]
ds_read_b64_tr_b16 a[168:169], v18 offset:64
ds_read_b64_tr_b16 a[170:171], v18 offset:832
v_cvt_pk_bf16_f32 v41, v82, v83
v_cvt_pk_bf16_f32 v42, v84, v85
v_cvt_pk_bf16_f32 v43, v86, v87
v_mfma_f32_32x32x16_bf16 a[112:127], a[176:179], v[120:123], a[112:127]
ds_read_b64_tr_b16 a[172:173], v18 offset:3072
ds_read_b64_tr_b16 a[174:175], v18 offset:3840
s_waitcnt lgkmcnt(6)
v_accvgpr_read_b32 v72, a16
v_accvgpr_read_b32 v73, a17
v_accvgpr_read_b32 v74, a18
v_mfma_f32_32x32x16_bf16 a[80:95], a[180:183], v[124:127], a[80:95]
ds_read_b64_tr_b16 a[176:177], v18 offset:3104
ds_read_b64_tr_b16 a[178:179], v18 offset:3872
v_accvgpr_read_b32 v75, a19
v_accvgpr_read_b32 v76, a20
v_accvgpr_read_b32 v77, a21
v_mfma_f32_32x32x16_bf16 a[96:111], a[184:187], v[124:127], a[96:111]
s_add_u32 m0, s97, 0xa000
ds_read_b64_tr_b16 a[180:181], v18 offset:3136
ds_read_b64_tr_b16 a[182:183], v18 offset:3904
buffer_load_dwordx4 v10, s[28:31], s56 offen offset:0 lds
v_accvgpr_read_b32 v78, a22
v_accvgpr_read_b32 v79, a23
v_accvgpr_read_b32 v80, a24
v_mfma_f32_32x32x16_bf16 a[112:127], a[188:191], v[124:127], a[112:127]
ds_read_b64_tr_b16 a[184:185], v18 offset:6144
ds_read_b64_tr_b16 a[186:187], v18 offset:6912
v_accvgpr_read_b32 v81, a25
v_accvgpr_read_b32 v82, a26
v_accvgpr_read_b32 v83, a27
v_mfma_f32_32x32x16_bf16 a[80:95], a[160:163], v[128:131], a[80:95]
ds_read_b64_tr_b16 a[188:189], v18 offset:6176
ds_read_b64_tr_b16 a[190:191], v18 offset:6944
s_waitcnt lgkmcnt(6)
v_accvgpr_read_b32 v84, a28
v_accvgpr_read_b32 v85, a29
v_accvgpr_read_b32 v86, a30
v_mfma_f32_32x32x16_bf16 a[96:111], a[164:167], v[128:131], a[96:111]
ds_read_b64_tr_b16 a[160:161], v18 offset:6208
ds_read_b64_tr_b16 a[162:163], v18 offset:6976
v_accvgpr_read_b32 v87, a31
v_max_f32 v72, 0, v72
v_max_f32 v73, 0, v73
v_mfma_f32_32x32x16_bf16 a[112:127], a[168:171], v[128:131], a[112:127]
s_add_u32 m0, s97, 0xa000
ds_read_b64_tr_b16 a[164:165], v18 offset:9216
ds_read_b64_tr_b16 a[166:167], v18 offset:9984
buffer_load_dwordx4 v11, s[28:31], s56 offen offset:1024 lds
v_max_f32 v74, 0, v74
v_max_f32 v75, 0, v75
v_max_f32 v76, 0, v76
v_mfma_f32_32x32x16_bf16 a[80:95], a[172:175], v[132:135], a[80:95]
ds_read_b64_tr_b16 a[168:169], v18 offset:9248
ds_read_b64_tr_b16 a[170:171], v18 offset:10016
v_max_f32 v77, 0, v77
v_max_f32 v78, 0, v78
v_max_f32 v79, 0, v79
v_mfma_f32_32x32x16_bf16 a[96:111], a[176:179], v[132:135], a[96:111]
ds_read_b64_tr_b16 a[172:173], v18 offset:9280
ds_read_b64_tr_b16 a[174:175], v18 offset:10048
s_waitcnt lgkmcnt(6)
v_mul_f32 v80, v72, v80
v_mul_f32 v81, v73, v81
v_mul_f32 v82, v74, v82
v_mfma_f32_32x32x16_bf16 a[112:127], a[180:183], v[132:135], a[112:127]
s_waitcnt vmcnt(12)
s_barrier
v_add_u32 v18, 0x5000, v18
ds_read_b64_tr_b16 a[176:177], v18 offset:0
ds_read_b64_tr_b16 a[178:179], v18 offset:768
v_mul_f32 v83, v75, v83
v_mul_f32 v84, v76, v84
v_mul_f32 v85, v77, v85
v_mfma_f32_32x32x16_bf16 a[80:95], a[184:187], v[136:139], a[80:95]
s_add_u32 m0, s97, 0xa000
ds_read_b64_tr_b16 a[180:181], v18 offset:32
ds_read_b64_tr_b16 a[182:183], v18 offset:800
buffer_load_dwordx4 v12, s[28:31], s56 offen offset:2048 lds
s_add_u32 s56, s56, 0x3c000
s_cmp_eq_u32 s56, 0x258000
s_cselect_b32 s56, 0, s56
v_mul_f32 v86, v78, v86
v_mul_f32 v87, v79, v87
v_cvt_pk_bf16_f32 v44, v80, v81
v_mfma_f32_32x32x16_bf16 a[96:111], a[188:191], v[136:139], a[96:111]
ds_read_b64_tr_b16 a[184:185], v18 offset:64
ds_read_b64_tr_b16 a[186:187], v18 offset:832
v_cvt_pk_bf16_f32 v45, v82, v83
v_cvt_pk_bf16_f32 v46, v84, v85
v_cvt_pk_bf16_f32 v47, v86, v87
v_mfma_f32_32x32x16_bf16 a[112:127], a[160:163], v[136:139], a[112:127]
ds_read_b64_tr_b16 a[188:189], v18 offset:3072
ds_read_b64_tr_b16 a[190:191], v18 offset:3840
s_waitcnt lgkmcnt(6)
v_permlane16_swap_b32 v40, v44
v_permlane16_swap_b32 v41, v45
v_permlane16_swap_b32 v42, v46
v_mfma_f32_32x32x16_bf16 a[80:95], a[164:167], v[140:143], a[80:95]
ds_read_b64_tr_b16 a[160:161], v18 offset:3104
ds_read_b64_tr_b16 a[162:163], v18 offset:3872
v_permlane16_swap_b32 v43, v47
v_mfma_f32_32x32x16_bf16 a[96:111], a[168:171], v[140:143], a[96:111]
s_add_u32 m0, s97, 0xf000
ds_read_b64_tr_b16 a[164:165], v18 offset:3136
ds_read_b64_tr_b16 a[166:167], v18 offset:3904
buffer_load_dwordx4 v10, s[28:31], s56 offen offset:0 lds
s_add_u32 s57, s22, 0x1000
buffer_store_dwordx4 v[40:43], v2, s[36:39], s57 offen sc1
s_add_u32 s57, s22, 0xd000
buffer_store_dwordx4 v[44:47], v2, s[36:39], s57 offen sc1
v_mfma_f32_32x32x16_bf16 a[112:127], a[172:175], v[140:143], a[112:127]
ds_read_b64_tr_b16 a[168:169], v18 offset:6144
ds_read_b64_tr_b16 a[170:171], v18 offset:6912
v_mfma_f32_32x32x16_bf16 a[80:95], a[176:179], v[144:147], a[80:95]
ds_read_b64_tr_b16 a[172:173], v18 offset:6176
ds_read_b64_tr_b16 a[174:175], v18 offset:6944
s_waitcnt lgkmcnt(6)
v_lshrrev_b32 v23, 4, v1
v_bfe_u32 v92, v1, 2, 2
v_lshl_add_u32 v23, v23, 3, v92
v_mfma_f32_32x32x16_bf16 a[96:111], a[180:183], v[144:147], a[96:111]
ds_read_b64_tr_b16 a[176:177], v18 offset:6208
ds_read_b64_tr_b16 a[178:179], v18 offset:6976
v_lshlrev_b32 v23, 7, v23
v_and_b32 v92, 3, v1
v_lshl_add_u32 v23, v92, 3, v23
s_lshl_b32 s15, s52, 12
s_add_u32 s15, s15, 0x23000
v_mfma_f32_32x32x16_bf16 a[112:127], a[184:187], v[144:147], a[112:127]
s_add_u32 m0, s97, 0xf000
ds_read_b64_tr_b16 a[180:181], v18 offset:9216
ds_read_b64_tr_b16 a[182:183], v18 offset:9984
buffer_load_dwordx4 v11, s[28:31], s56 offen offset:1024 lds
v_add_u32 v23, s15, v23
s_waitcnt vmcnt(10)
v_mfma_f32_32x32x16_bf16 a[80:95], a[188:191], v[148:151], a[80:95]
ds_read_b64_tr_b16 a[184:185], v18 offset:9248
ds_read_b64_tr_b16 a[186:187], v18 offset:10016
ds_read_b64_tr_b16 v[24:25], v23 offset:0
ds_read_b64_tr_b16 v[26:27], v23 offset:512
v_mfma_f32_32x32x16_bf16 a[96:111], a[160:163], v[148:151], a[96:111]
ds_read_b64_tr_b16 a[188:189], v18 offset:9280
ds_read_b64_tr_b16 a[190:191], v18 offset:10048
s_waitcnt lgkmcnt(8)
ds_read_b64_tr_b16 v[28:29], v23 offset:32
ds_read_b64_tr_b16 v[30:31], v23 offset:544
v_mfma_f32_32x32x16_bf16 a[112:127], a[164:167], v[148:151], a[112:127]
s_barrier
v_add_u32 v18, 0xfffe2000, v18
ds_read_b64_tr_b16 a[160:161], v18 offset:0
ds_read_b64_tr_b16 a[162:163], v18 offset:768
ds_read_b64_tr_b16 v[32:33], v23 offset:64
ds_read_b64_tr_b16 v[34:35], v23 offset:576
v_mfma_f32_32x32x16_bf16 a[80:95], a[168:171], v[152:155], a[80:95]
s_add_u32 m0, s97, 0xf000
ds_read_b64_tr_b16 a[164:165], v18 offset:32
ds_read_b64_tr_b16 a[166:167], v18 offset:800
buffer_load_dwordx4 v12, s[28:31], s56 offen offset:2048 lds
s_add_u32 s56, s56, 0x3c000
s_cmp_eq_u32 s56, 0x258000
s_cselect_b32 s56, 0, s56
ds_read_b64_tr_b16 v[36:37], v23 offset:96
ds_read_b64_tr_b16 v[38:39], v23 offset:608
v_mfma_f32_32x32x16_bf16 a[96:111], a[172:175], v[152:155], a[96:111]
ds_read_b64_tr_b16 a[168:169], v18 offset:64
ds_read_b64_tr_b16 a[170:171], v18 offset:832
s_mul_i32 s15, s5, 40
s_lshl_b32 s4, s6, 2
s_add_u32 s15, s15, s4
s_lshl_b32 s15, s15, 10
s_add_u32 s15, s15, 0x880000
s_waitcnt lgkmcnt(14)
buffer_store_dwordx4 v[24:27], v2, s[36:39], s15 offen offset:0 sc1
v_mfma_f32_32x32x16_bf16 a[112:127], a[176:179], v[152:155], a[112:127]
ds_read_b64_tr_b16 a[172:173], v18 offset:3072
ds_read_b64_tr_b16 a[174:175], v18 offset:3840
s_waitcnt lgkmcnt(10)
buffer_store_dwordx4 v[28:31], v2, s[36:39], s15 offen offset:1024 sc1
s_waitcnt lgkmcnt(8)
buffer_store_dwordx4 v[32:35], v2, s[36:39], s15 offen offset:2048 sc1
v_mfma_f32_32x32x16_bf16 a[80:95], a[180:183], v[156:159], a[80:95]
ds_read_b64_tr_b16 a[176:177], v18 offset:3104
ds_read_b64_tr_b16 a[178:179], v18 offset:3872
s_waitcnt lgkmcnt(6)
buffer_store_dwordx4 v[36:39], v2, s[36:39], s15 offen offset:3072 sc1
s_lshl_b32 s4, s53, 3
s_add_u32 s4, s4, s54
s_lshl_b32 s4, s4, 2
s_add_u32 s4, s4, s52
s_add_u32 s4, s4, 0x200
s_cmp_ge_u32 s4, 0x2a8
s_cselect_b32 s14, 0x158, 0
s_sub_u32 s4, s4, s14
s_mul_i32 s5, s4, 0xcccd
s_lshr_b32 s5, s5, 19
s_mul_i32 s14, s5, 10
s_sub_u32 s6, s4, s14
v_mfma_f32_32x32x16_bf16 a[96:111], a[184:187], v[156:159], a[96:111]
s_add_u32 m0, s97, 0x14000
ds_read_b64_tr_b16 a[180:181], v18 offset:3136
ds_read_b64_tr_b16 a[182:183], v18 offset:3904
buffer_load_dwordx4 v10, s[28:31], s56 offen offset:0 lds
s_mul_i32 s7, s5, 0xf10
s_lshr_b32 s7, s7, 16
s_mul_i32 s14, s7, 17
s_sub_u32 s8, s5, s14
s_mul_i32 s12, s7, 12
s_add_u32 s12, s12, s8
s_lshl_b32 s12, s12, 5
s_cmp_eq_u32 s8, 2
s_cselect_b32 s14, 1, 0
s_cmp_eq_u32 s8, 8
s_cselect_b32 s14, 1, s14
s_cmp_eq_u32 s14, 1
s_cselect_b32 s9, 16, 8
s_cselect_b32 s13, 8, 16
v_mfma_f32_32x32x16_bf16 a[112:127], a[188:191], v[156:159], a[112:127]
ds_read_b64_tr_b16 a[184:185], v18 offset:6144
ds_read_b64_tr_b16 a[186:187], v18 offset:6912
s_sub_u32 s14, s8, 12
s_lshr_b32 s15, s14, 1
s_mul_i32 s15, s15, 0x50
s_and_b32 s14, s14, 1
s_lshl_b32 s14, s14, 3
s_add_u32 s15, s15, s14
s_mul_i32 s4, s7, 0xa0
s_cmp_eq_u32 s8, 16
s_cselect_b32 s15, 16, s15
s_cselect_b32 s14, 0x50, 4
s_add_u32 s15, s15, s4
v_mfma_f32_32x32x16_bf16 a[80:95], a[160:163], v[160:163], a[80:95]
ds_read_b64_tr_b16 a[188:189], v18 offset:6176
ds_read_b64_tr_b16 a[190:191], v18 offset:6944
s_waitcnt lgkmcnt(6)
s_cmp_ge_u32 s8, 12
s_cselect_b32 s12, s15, s12
s_cselect_b32 s9, s14, s9
s_cselect_b32 s13, 20, s13
s_cselect_b32 s14, 40, 4
s_cselect_b32 s44, s10, s98
s_cselect_b32 s45, s11, s99
s_cmp_ge_u32 s8, 12
s_mov_b32 s46, 0x1e0000
s_cselect_b32 s46, 0xc8000, s46
s_mov_b32 s47, 0x20000
s_mul_i32 s4, s7, 10
s_add_u32 s4, s4, s6
s_lshl_b32 s4, s4, 5
s_add_u32 s4, s4, s8
s_lshl_b32 s4, s4, 2
s_add_u32 s89, s4, 0xb4e000
v_lshrrev_b32 v94, 5, v1
v_mul_u32_u24 v94, s9, v94
v_bfe_u32 v92, v1, 3, 2
v_mfma_f32_32x32x16_bf16 a[96:111], a[164:167], v[160:163], a[96:111]
ds_read_b64_tr_b16 a[160:161], v18 offset:6208
ds_read_b64_tr_b16 a[162:163], v18 offset:6976
v_add_u32 v94, v94, v92
v_mul_u32_u24 v94, 0x500, v94
v_and_b32 v92, 7, v1
v_mfma_f32_32x32x16_bf16 a[112:127], a[168:171], v[160:163], a[112:127]
s_add_u32 m0, s97, 0x14000
ds_read_b64_tr_b16 a[164:165], v18 offset:9216
ds_read_b64_tr_b16 a[166:167], v18 offset:9984
buffer_load_dwordx4 v11, s[28:31], s56 offen offset:1024 lds
v_lshl_add_u32 v93, v92, 4, v94
s_lshl_b32 s4, s6, 7
s_lshl_b32 s7, s52, 12
s_add_u32 s7, s7, 0x23000
v_mfma_f32_32x32x16_bf16 a[80:95], a[172:175], v[164:167], a[80:95]
ds_read_b64_tr_b16 a[168:169], v18 offset:9248
ds_read_b64_tr_b16 a[170:171], v18 offset:10016
s_mov_b32 m0, s7
s_mul_i32 s15, s13, 0
s_add_u32 s15, s15, s12
s_mul_i32 s15, s15, 0x500
s_add_u32 s15, s15, s4
buffer_load_dwordx4 v93, s[44:47], s15 offen offset:0 lds
s_mov_b32 m0, s7
s_mul_i32 s15, s13, 1
s_add_u32 s15, s15, s12
s_mul_i32 s15, s15, 0x500
s_add_u32 s15, s15, s4
s_sub_u32 s15, s15, 0x400
buffer_load_dwordx4 v93, s[44:47], s15 offen offset:1024 lds
v_mfma_f32_32x32x16_bf16 a[96:111], a[176:179], v[164:167], a[96:111]
ds_read_b64_tr_b16 a[172:173], v18 offset:9280
ds_read_b64_tr_b16 a[174:175], v18 offset:10048
s_waitcnt lgkmcnt(6)
s_mov_b32 m0, s7
s_mul_i32 s15, s13, 0
s_add_u32 s15, s15, s12
s_add_u32 s15, s15, s14
s_mul_i32 s15, s15, 0x500
s_add_u32 s15, s15, s4
s_sub_u32 s15, s15, 0x800
buffer_load_dwordx4 v93, s[44:47], s15 offen offset:2048 lds
s_mov_b32 m0, s7
s_mul_i32 s15, s13, 1
s_add_u32 s15, s15, s12
s_add_u32 s15, s15, s14
s_mul_i32 s15, s15, 0x500
s_add_u32 s15, s15, s4
s_sub_u32 s15, s15, 0xc00
buffer_load_dwordx4 v93, s[44:47], s15 offen offset:3072 lds
v_accvgpr_read_b32 v72, a32
v_accvgpr_read_b32 v73, a33
v_accvgpr_read_b32 v74, a34
v_mfma_f32_32x32x16_bf16 a[112:127], a[180:183], v[164:167], a[112:127]
s_waitcnt vmcnt(18)
s_barrier
v_add_u32 v18, 0x5000, v18
ds_read_b64_tr_b16 a[176:177], v18 offset:0
ds_read_b64_tr_b16 a[178:179], v18 offset:768
v_accvgpr_read_b32 v75, a35
v_accvgpr_read_b32 v76, a36
v_accvgpr_read_b32 v77, a37
v_mfma_f32_32x32x16_bf16 a[80:95], a[184:187], v[168:171], a[80:95]
s_add_u32 m0, s97, 0x14000
ds_read_b64_tr_b16 a[180:181], v18 offset:32
ds_read_b64_tr_b16 a[182:183], v18 offset:800
buffer_load_dwordx4 v12, s[28:31], s56 offen offset:2048 lds
s_add_u32 s56, s56, 0x3c000
s_cmp_eq_u32 s56, 0x258000
s_cselect_b32 s56, 0, s56
v_accvgpr_read_b32 v78, a38
v_accvgpr_read_b32 v79, a39
v_accvgpr_read_b32 v80, a40
v_mfma_f32_32x32x16_bf16 a[96:111], a[188:191], v[168:171], a[96:111]
ds_read_b64_tr_b16 a[184:185], v18 offset:64
ds_read_b64_tr_b16 a[186:187], v18 offset:832
v_accvgpr_read_b32 v81, a41
v_accvgpr_read_b32 v82, a42
v_accvgpr_read_b32 v83, a43
v_mfma_f32_32x32x16_bf16 a[112:127], a[160:163], v[168:171], a[112:127]
ds_read_b64_tr_b16 a[188:189], v18 offset:3072
ds_read_b64_tr_b16 a[190:191], v18 offset:3840
s_waitcnt lgkmcnt(6)
v_accvgpr_read_b32 v84, a44
v_accvgpr_read_b32 v85, a45
v_accvgpr_read_b32 v86, a46
v_mfma_f32_32x32x16_bf16 a[80:95], a[164:167], v[172:175], a[80:95]
ds_read_b64_tr_b16 a[160:161], v18 offset:3104
ds_read_b64_tr_b16 a[162:163], v18 offset:3872
v_accvgpr_read_b32 v87, a47
v_max_f32 v72, 0, v72
v_max_f32 v73, 0, v73
v_mfma_f32_32x32x16_bf16 a[96:111], a[168:171], v[172:175], a[96:111]
s_add_u32 m0, s97, 0x19000
ds_read_b64_tr_b16 a[164:165], v18 offset:3136
ds_read_b64_tr_b16 a[166:167], v18 offset:3904
buffer_load_dwordx4 v10, s[28:31], s56 offen offset:0 lds
v_max_f32 v74, 0, v74
v_max_f32 v75, 0, v75
v_max_f32 v76, 0, v76
v_mfma_f32_32x32x16_bf16 a[112:127], a[172:175], v[172:175], a[112:127]
ds_read_b64_tr_b16 a[168:169], v18 offset:6144
ds_read_b64_tr_b16 a[170:171], v18 offset:6912
v_max_f32 v77, 0, v77
v_max_f32 v78, 0, v78
v_max_f32 v79, 0, v79
v_mfma_f32_32x32x16_bf16 a[80:95], a[176:179], v[176:179], a[80:95]
ds_read_b64_tr_b16 a[172:173], v18 offset:6176
ds_read_b64_tr_b16 a[174:175], v18 offset:6944
s_waitcnt lgkmcnt(6)
v_mul_f32 v80, v72, v80
v_mul_f32 v81, v73, v81
v_mul_f32 v82, v74, v82
v_mfma_f32_32x32x16_bf16 a[96:111], a[180:183], v[176:179], a[96:111]
ds_read_b64_tr_b16 a[176:177], v18 offset:6208
ds_read_b64_tr_b16 a[178:179], v18 offset:6976
v_mul_f32 v83, v75, v83
v_mul_f32 v84, v76, v84
v_mul_f32 v85, v77, v85
v_mfma_f32_32x32x16_bf16 a[112:127], a[184:187], v[176:179], a[112:127]
s_add_u32 m0, s97, 0x19000
ds_read_b64_tr_b16 a[180:181], v18 offset:9216
ds_read_b64_tr_b16 a[182:183], v18 offset:9984
buffer_load_dwordx4 v11, s[28:31], s56 offen offset:1024 lds
v_mul_f32 v86, v78, v86
v_mul_f32 v87, v79, v87
v_cvt_pk_bf16_f32 v40, v80, v81
v_mfma_f32_32x32x16_bf16 a[80:95], a[188:191], v[180:183], a[80:95]
ds_read_b64_tr_b16 a[184:185], v18 offset:9248
ds_read_b64_tr_b16 a[186:187], v18 offset:10016
v_cvt_pk_bf16_f32 v41, v82, v83
v_cvt_pk_bf16_f32 v42, v84, v85
v_cvt_pk_bf16_f32 v43, v86, v87
v_mfma_f32_32x32x16_bf16 a[96:111], a[160:163], v[180:183], a[96:111]
ds_read_b64_tr_b16 a[188:189], v18 offset:9280
ds_read_b64_tr_b16 a[190:191], v18 offset:10048
s_waitcnt lgkmcnt(6)
v_accvgpr_read_b32 v72, a48
v_accvgpr_read_b32 v73, a49
v_accvgpr_read_b32 v74, a50
v_mfma_f32_32x32x16_bf16 a[112:127], a[164:167], v[180:183], a[112:127]
s_waitcnt vmcnt(18)
s_barrier
v_add_u32 v18, 0x5000, v18
ds_read_b64_tr_b16 a[160:161], v18 offset:0
ds_read_b64_tr_b16 a[162:163], v18 offset:768
v_accvgpr_read_b32 v75, a51
v_accvgpr_read_b32 v76, a52
v_accvgpr_read_b32 v77, a53
v_mfma_f32_32x32x16_bf16 a[80:95], a[168:171], v[184:187], a[80:95]
s_add_u32 m0, s97, 0x19000
ds_read_b64_tr_b16 a[164:165], v18 offset:32
ds_read_b64_tr_b16 a[166:167], v18 offset:800
buffer_load_dwordx4 v12, s[28:31], s56 offen offset:2048 lds
s_add_u32 s56, s56, 0x3c000
s_cmp_eq_u32 s56, 0x258000
s_cselect_b32 s56, 0, s56
v_accvgpr_read_b32 v78, a54
v_accvgpr_read_b32 v79, a55
v_accvgpr_read_b32 v80, a56
v_mfma_f32_32x32x16_bf16 a[96:111], a[172:175], v[184:187], a[96:111]
ds_read_b64_tr_b16 a[168:169], v18 offset:64
ds_read_b64_tr_b16 a[170:171], v18 offset:832
v_accvgpr_read_b32 v81, a57
v_accvgpr_read_b32 v82, a58
v_accvgpr_read_b32 v83, a59
v_mfma_f32_32x32x16_bf16 a[112:127], a[176:179], v[184:187], a[112:127]
ds_read_b64_tr_b16 a[172:173], v18 offset:3072
ds_read_b64_tr_b16 a[174:175], v18 offset:3840
s_waitcnt lgkmcnt(6)
v_accvgpr_read_b32 v84, a60
v_accvgpr_read_b32 v85, a61
v_accvgpr_read_b32 v86, a62
v_mfma_f32_32x32x16_bf16 a[80:95], a[180:183], v[188:191], a[80:95]
ds_read_b64_tr_b16 a[176:177], v18 offset:3104
ds_read_b64_tr_b16 a[178:179], v18 offset:3872
v_accvgpr_read_b32 v87, a63
v_max_f32 v72, 0, v72
v_max_f32 v73, 0, v73
v_mfma_f32_32x32x16_bf16 a[96:111], a[184:187], v[188:191], a[96:111]
s_mov_b32 s56, s21
s_add_u32 m0, s3, 0x1e000
ds_read_b64_tr_b16 a[180:181], v18 offset:3136
ds_read_b64_tr_b16 a[182:183], v18 offset:3904
buffer_load_dwordx4 v13, s[32:35], s56 offen offset:0 lds
v_max_f32 v74, 0, v74
v_max_f32 v75, 0, v75
v_max_f32 v76, 0, v76
v_mfma_f32_32x32x16_bf16 a[112:127], a[188:191], v[188:191], a[112:127]
ds_read_b64_tr_b16 a[184:185], v18 offset:6144
ds_read_b64_tr_b16 a[186:187], v18 offset:6912
v_max_f32 v77, 0, v77
v_max_f32 v78, 0, v78
v_max_f32 v79, 0, v79
v_mfma_f32_32x32x16_bf16 a[80:95], a[160:163], v[192:195], a[80:95]
ds_read_b64_tr_b16 a[188:189], v18 offset:6176
ds_read_b64_tr_b16 a[190:191], v18 offset:6944
s_waitcnt lgkmcnt(6)
v_mul_f32 v80, v72, v80
v_mul_f32 v81, v73, v81
v_mul_f32 v82, v74, v82
v_mfma_f32_32x32x16_bf16 a[96:111], a[164:167], v[192:195], a[96:111]
ds_read_b64_tr_b16 a[160:161], v18 offset:6208
ds_read_b64_tr_b16 a[162:163], v18 offset:6976
v_mul_f32 v83, v75, v83
v_mul_f32 v84, v76, v84
v_mul_f32 v85, v77, v85
v_mfma_f32_32x32x16_bf16 a[112:127], a[168:171], v[192:195], a[112:127]
s_add_u32 m0, s3, 0x1e000
ds_read_b64_tr_b16 a[164:165], v18 offset:9216
ds_read_b64_tr_b16 a[166:167], v18 offset:9984
buffer_load_dwordx4 v14, s[32:35], s56 offen offset:1024 lds
v_mul_f32 v86, v78, v86
v_mul_f32 v87, v79, v87
v_cvt_pk_bf16_f32 v44, v80, v81
v_mfma_f32_32x32x16_bf16 a[80:95], a[172:175], v[196:199], a[80:95]
ds_read_b64_tr_b16 a[168:169], v18 offset:9248
ds_read_b64_tr_b16 a[170:171], v18 offset:10016
v_cvt_pk_bf16_f32 v45, v82, v83
v_cvt_pk_bf16_f32 v46, v84, v85
v_cvt_pk_bf16_f32 v47, v86, v87
v_mfma_f32_32x32x16_bf16 a[96:111], a[176:179], v[196:199], a[96:111]
ds_read_b64_tr_b16 a[172:173], v18 offset:9280
ds_read_b64_tr_b16 a[174:175], v18 offset:10048
s_waitcnt lgkmcnt(6)
v_permlane16_swap_b32 v40, v44
v_permlane16_swap_b32 v41, v45
v_permlane16_swap_b32 v42, v46
v_mfma_f32_32x32x16_bf16 a[112:127], a[180:183], v[196:199], a[112:127]
s_waitcnt vmcnt(16)
s_barrier
v_add_u32 v18, 0x5000, v18
ds_read_b64_tr_b16 a[176:177], v18 offset:0
ds_read_b64_tr_b16 a[178:179], v18 offset:768
v_permlane16_swap_b32 v43, v47
v_mfma_f32_32x32x16_bf16 a[80:95], a[184:187], v[200:203], a[80:95]
s_add_u32 m0, s3, 0x1e000
ds_read_b64_tr_b16 a[180:181], v18 offset:32
ds_read_b64_tr_b16 a[182:183], v18 offset:800
buffer_load_dwordx4 v15, s[32:35], s56 offen offset:2048 lds
s_add_u32 s56, s56, 0x30000
s_cmp_eq_u32 s56, 0x1e0000
s_cselect_b32 s56, 0, s56
s_add_u32 s57, s22, 0x1400
buffer_store_dwordx4 v[40:43], v2, s[36:39], s57 offen sc1
s_add_u32 s57, s22, 0xd400
buffer_store_dwordx4 v[44:47], v2, s[36:39], s57 offen sc1
v_lshrrev_b32 v23, 4, v1
v_bfe_u32 v92, v1, 2, 2
v_lshl_add_u32 v23, v23, 3, v92
v_mfma_f32_32x32x16_bf16 a[96:111], a[188:191], v[200:203], a[96:111]
ds_read_b64_tr_b16 a[184:185], v18 offset:64
ds_read_b64_tr_b16 a[186:187], v18 offset:832
v_lshlrev_b32 v23, 7, v23
v_and_b32 v92, 3, v1
v_lshl_add_u32 v23, v92, 3, v23
s_lshl_b32 s15, s52, 12
s_add_u32 s15, s15, 0x23000
v_mfma_f32_32x32x16_bf16 a[112:127], a[160:163], v[200:203], a[112:127]
ds_read_b64_tr_b16 a[188:189], v18 offset:3072
ds_read_b64_tr_b16 a[190:191], v18 offset:3840
s_waitcnt lgkmcnt(6)
v_add_u32 v23, s15, v23
s_waitcnt vmcnt(9)
v_mfma_f32_32x32x16_bf16 a[80:95], a[164:167], v[204:207], a[80:95]
ds_read_b64_tr_b16 a[160:161], v18 offset:3104
ds_read_b64_tr_b16 a[162:163], v18 offset:3872
ds_read_b64_tr_b16 v[24:25], v23 offset:0
ds_read_b64_tr_b16 v[26:27], v23 offset:512
v_mfma_f32_32x32x16_bf16 a[96:111], a[168:171], v[204:207], a[96:111]
s_add_u32 m0, s3, 0
ds_read_b64_tr_b16 a[164:165], v18 offset:3136
ds_read_b64_tr_b16 a[166:167], v18 offset:3904
buffer_load_dwordx4 v13, s[32:35], s56 offen offset:0 lds
ds_read_b64_tr_b16 v[28:29], v23 offset:32
ds_read_b64_tr_b16 v[30:31], v23 offset:544
v_mfma_f32_32x32x16_bf16 a[112:127], a[172:175], v[204:207], a[112:127]
ds_read_b64_tr_b16 a[168:169], v18 offset:6144
ds_read_b64_tr_b16 a[170:171], v18 offset:6912
ds_read_b64_tr_b16 v[32:33], v23 offset:64
ds_read_b64_tr_b16 v[34:35], v23 offset:576
v_mfma_f32_32x32x16_bf16 a[80:95], a[176:179], v[208:211], a[80:95]
ds_read_b64_tr_b16 a[172:173], v18 offset:6176
ds_read_b64_tr_b16 a[174:175], v18 offset:6944
s_waitcnt lgkmcnt(12)
ds_read_b64_tr_b16 v[36:37], v23 offset:96
ds_read_b64_tr_b16 v[38:39], v23 offset:608
v_mfma_f32_32x32x16_bf16 a[96:111], a[180:183], v[208:211], a[96:111]
ds_read_b64_tr_b16 a[176:177], v18 offset:6208
ds_read_b64_tr_b16 a[178:179], v18 offset:6976
s_mul_i32 s15, s5, 40
s_lshl_b32 s4, s6, 2
s_add_u32 s15, s15, s4
s_lshl_b32 s15, s15, 10
s_add_u32 s15, s15, 0x880000
s_waitcnt lgkmcnt(14)
buffer_store_dwordx4 v[24:27], v2, s[36:39], s15 offen offset:0 sc1
v_mfma_f32_32x32x16_bf16 a[112:127], a[184:187], v[208:211], a[112:127]
s_add_u32 m0, s3, 0
ds_read_b64_tr_b16 a[180:181], v18 offset:9216
ds_read_b64_tr_b16 a[182:183], v18 offset:9984
buffer_load_dwordx4 v14, s[32:35], s56 offen offset:1024 lds
s_waitcnt lgkmcnt(12)
buffer_store_dwordx4 v[28:31], v2, s[36:39], s15 offen offset:1024 sc1
s_waitcnt lgkmcnt(8)
buffer_store_dwordx4 v[32:35], v2, s[36:39], s15 offen offset:2048 sc1
v_mfma_f32_32x32x16_bf16 a[80:95], a[188:191], v[212:215], a[80:95]
ds_read_b64_tr_b16 a[184:185], v18 offset:9248
ds_read_b64_tr_b16 a[186:187], v18 offset:10016
s_waitcnt lgkmcnt(6)
buffer_store_dwordx4 v[36:39], v2, s[36:39], s15 offen offset:3072 sc1
v_mfma_f32_32x32x16_bf16 a[96:111], a[160:163], v[212:215], a[96:111]
ds_read_b64_tr_b16 a[188:189], v18 offset:9280
ds_read_b64_tr_b16 a[190:191], v18 offset:10048
s_waitcnt lgkmcnt(6)
v_mfma_f32_32x32x16_bf16 a[112:127], a[164:167], v[212:215], a[112:127]
s_waitcnt vmcnt(14)
s_barrier
v_add_u32 v18, 0x5000, v18
ds_read_b64_tr_b16 a[160:161], v18 offset:0
ds_read_b64_tr_b16 a[162:163], v18 offset:768
v_mfma_f32_32x32x16_bf16 a[80:95], a[168:171], v[216:219], a[80:95]
s_add_u32 m0, s3, 0
ds_read_b64_tr_b16 a[164:165], v18 offset:32
ds_read_b64_tr_b16 a[166:167], v18 offset:800
buffer_load_dwordx4 v15, s[32:35], s56 offen offset:2048 lds
s_add_u32 s56, s56, 0x30000
s_cmp_eq_u32 s56, 0x1e0000
s_cselect_b32 s56, 0, s56
v_mov_b32 v92, 1
s_mov_b64 exec, 1
buffer_store_dword v92, off, s[36:39], s81 sc1
s_mov_b64 exec, -1
v_mfma_f32_32x32x16_bf16 a[96:111], a[172:175], v[216:219], a[96:111]
ds_read_b64_tr_b16 a[168:169], v18 offset:64
ds_read_b64_tr_b16 a[170:171], v18 offset:832
v_mfma_f32_32x32x16_bf16 a[112:127], a[176:179], v[216:219], a[112:127]
ds_read_b64_tr_b16 a[172:173], v18 offset:3072
ds_read_b64_tr_b16 a[174:175], v18 offset:3840
s_waitcnt lgkmcnt(6)
v_mfma_f32_32x32x16_bf16 a[80:95], a[180:183], v[220:223], a[80:95]
ds_read_b64_tr_b16 a[176:177], v18 offset:3104
ds_read_b64_tr_b16 a[178:179], v18 offset:3872
v_mfma_f32_32x32x16_bf16 a[96:111], a[184:187], v[220:223], a[96:111]
s_add_u32 m0, s3, 0x5000
ds_read_b64_tr_b16 a[180:181], v18 offset:3136
ds_read_b64_tr_b16 a[182:183], v18 offset:3904
buffer_load_dwordx4 v13, s[32:35], s56 offen offset:0 lds
v_mfma_f32_32x32x16_bf16 a[112:127], a[188:191], v[220:223], a[112:127]
ds_read_b64_tr_b16 a[184:185], v18 offset:6144
ds_read_b64_tr_b16 a[186:187], v18 offset:6912
v_mfma_f32_32x32x16_bf16 a[80:95], a[160:163], v[224:227], a[80:95]
ds_read_b64_tr_b16 a[188:189], v18 offset:6176
ds_read_b64_tr_b16 a[190:191], v18 offset:6944
s_waitcnt lgkmcnt(6)
v_mfma_f32_32x32x16_bf16 a[96:111], a[164:167], v[224:227], a[96:111]
ds_read_b64_tr_b16 a[160:161], v18 offset:6208
ds_read_b64_tr_b16 a[162:163], v18 offset:6976
v_mfma_f32_32x32x16_bf16 a[112:127], a[168:171], v[224:227], a[112:127]
s_add_u32 m0, s3, 0x5000
ds_read_b64_tr_b16 a[164:165], v18 offset:9216
ds_read_b64_tr_b16 a[166:167], v18 offset:9984
buffer_load_dwordx4 v14, s[32:35], s56 offen offset:1024 lds
v_mfma_f32_32x32x16_bf16 a[80:95], a[172:175], v[228:231], a[80:95]
ds_read_b64_tr_b16 a[168:169], v18 offset:9248
ds_read_b64_tr_b16 a[170:171], v18 offset:10016
v_mfma_f32_32x32x16_bf16 a[96:111], a[176:179], v[228:231], a[96:111]
ds_read_b64_tr_b16 a[172:173], v18 offset:9280
ds_read_b64_tr_b16 a[174:175], v18 offset:10048
s_waitcnt lgkmcnt(6)
v_mfma_f32_32x32x16_bf16 a[112:127], a[180:183], v[228:231], a[112:127]
s_waitcnt vmcnt(15)
s_barrier
v_add_u32 v18, 0x5000, v18
ds_read_b64_tr_b16 a[176:177], v18 offset:0
ds_read_b64_tr_b16 a[178:179], v18 offset:768
v_mfma_f32_32x32x16_bf16 a[80:95], a[184:187], v[232:235], a[80:95]
s_add_u32 m0, s3, 0x5000
ds_read_b64_tr_b16 a[180:181], v18 offset:32
ds_read_b64_tr_b16 a[182:183], v18 offset:800
buffer_load_dwordx4 v15, s[32:35], s56 offen offset:2048 lds
s_add_u32 s56, s56, 0x30000
s_cmp_eq_u32 s56, 0x1e0000
s_cselect_b32 s56, 0, s56
v_mfma_f32_32x32x16_bf16 a[96:111], a[188:191], v[232:235], a[96:111]
ds_read_b64_tr_b16 a[184:185], v18 offset:64
ds_read_b64_tr_b16 a[186:187], v18 offset:832
v_mfma_f32_32x32x16_bf16 a[112:127], a[160:163], v[232:235], a[112:127]
ds_read_b64_tr_b16 a[188:189], v18 offset:3072
ds_read_b64_tr_b16 a[190:191], v18 offset:3840
s_waitcnt lgkmcnt(6)
v_mfma_f32_32x32x16_bf16 a[80:95], a[164:167], v[236:239], a[80:95]
ds_read_b64_tr_b16 a[160:161], v18 offset:3104
ds_read_b64_tr_b16 a[162:163], v18 offset:3872
v_mfma_f32_32x32x16_bf16 a[96:111], a[168:171], v[236:239], a[96:111]
s_add_u32 m0, s3, 0xa000
ds_read_b64_tr_b16 a[164:165], v18 offset:3136
ds_read_b64_tr_b16 a[166:167], v18 offset:3904
buffer_load_dwordx4 v13, s[32:35], s56 offen offset:0 lds
v_mfma_f32_32x32x16_bf16 a[112:127], a[172:175], v[236:239], a[112:127]
ds_read_b64_tr_b16 a[168:169], v18 offset:6144
ds_read_b64_tr_b16 a[170:171], v18 offset:6912
v_mfma_f32_32x32x16_bf16 a[80:95], a[176:179], v[240:243], a[80:95]
ds_read_b64_tr_b16 a[172:173], v18 offset:6176
ds_read_b64_tr_b16 a[174:175], v18 offset:6944
s_waitcnt lgkmcnt(6)
v_mfma_f32_32x32x16_bf16 a[96:111], a[180:183], v[240:243], a[96:111]
ds_read_b64_tr_b16 a[176:177], v18 offset:6208
ds_read_b64_tr_b16 a[178:179], v18 offset:6976
v_mfma_f32_32x32x16_bf16 a[112:127], a[184:187], v[240:243], a[112:127]
s_add_u32 m0, s3, 0xa000
ds_read_b64_tr_b16 a[180:181], v18 offset:9216
ds_read_b64_tr_b16 a[182:183], v18 offset:9984
buffer_load_dwordx4 v14, s[32:35], s56 offen offset:1024 lds
v_mfma_f32_32x32x16_bf16 a[80:95], a[188:191], v[244:247], a[80:95]
ds_read_b64_tr_b16 a[184:185], v18 offset:9248
ds_read_b64_tr_b16 a[186:187], v18 offset:10016
v_mfma_f32_32x32x16_bf16 a[96:111], a[160:163], v[244:247], a[96:111]
ds_read_b64_tr_b16 a[188:189], v18 offset:9280
ds_read_b64_tr_b16 a[190:191], v18 offset:10048
s_waitcnt lgkmcnt(6)
s_waitcnt vmcnt(13)
s_lshl_b32 s16, s53, 1
s_lshr_b32 s17, s52, 1
s_add_u32 s16, s16, s17
s_lshl_b32 s16, s16, 3
s_add_u32 s16, s16, s54
s_lshl_b32 s16, s16, 1
s_and_b32 s17, s52, 1
s_add_u32 s16, s16, s17
s_lshl_b32 s16, s16, 2
s_add_u32 s16, s16, 0xb4f400
v_mov_b32 v92, 1
s_mov_b64 exec, 1
buffer_store_dword v92, off, s[36:39], s16 sc1
s_mov_b64 exec, -1
v_mfma_f32_32x32x16_bf16 a[112:127], a[164:167], v[244:247], a[112:127]
s_barrier
ds_read_b64_tr_b16 a[160:161], v19 offset:0
ds_read_b64_tr_b16 a[162:163], v20 offset:0
v_mfma_f32_32x32x16_bf16 a[80:95], a[168:171], v[248:251], a[80:95]
s_add_u32 m0, s3, 0xa000
ds_read_b64_tr_b16 a[164:165], v19 offset:32
ds_read_b64_tr_b16 a[166:167], v20 offset:32
buffer_load_dwordx4 v15, s[32:35], s56 offen offset:2048 lds
s_add_u32 s56, s56, 0x30000
s_cmp_eq_u32 s56, 0x1e0000
s_cselect_b32 s56, 0, s56
v_mfma_f32_32x32x16_bf16 a[96:111], a[172:175], v[248:251], a[96:111]
ds_read_b64_tr_b16 a[168:169], v19 offset:64
ds_read_b64_tr_b16 a[170:171], v20 offset:64
v_mfma_f32_32x32x16_bf16 a[112:127], a[176:179], v[248:251], a[112:127]
ds_read_b64_tr_b16 a[172:173], v19 offset:1536
ds_read_b64_tr_b16 a[174:175], v20 offset:1536
s_waitcnt lgkmcnt(6)
v_mfma_f32_32x32x16_bf16 a[80:95], a[180:183], v[252:255], a[80:95]
ds_read_b64_tr_b16 a[176:177], v19 offset:1568
ds_read_b64_tr_b16 a[178:179], v20 offset:1568
v_mfma_f32_32x32x16_bf16 a[96:111], a[184:187], v[252:255], a[96:111]
s_add_u32 m0, s3, 0xf000
ds_read_b64_tr_b16 a[180:181], v19 offset:1600
ds_read_b64_tr_b16 a[182:183], v20 offset:1600
buffer_load_dwordx4 v13, s[32:35], s56 offen offset:0 lds
v_mfma_f32_32x32x16_bf16 a[112:127], a[188:191], v[252:255], a[112:127]
ds_read_b64_tr_b16 a[184:185], v19 offset:3072
ds_read_b64_tr_b16 a[186:187], v20 offset:3072
v_mfma_f32_32x32x16_bf16 a[0:15], a[160:163], v[96:99], 0
ds_read_b64_tr_b16 a[188:189], v19 offset:3104
ds_read_b64_tr_b16 a[190:191], v20 offset:3104
s_waitcnt lgkmcnt(6)
v_accvgpr_read_b32 v23, a80
v_accvgpr_read_b32 v92, a81
v_cvt_pk_bf16_f32 v72, v23, v92
v_mfma_f32_32x32x16_bf16 a[16:31], a[164:167], v[96:99], 0
ds_read_b64_tr_b16 a[160:161], v19 offset:3136
ds_read_b64_tr_b16 a[162:163], v20 offset:3136
v_accvgpr_read_b32 v94, a82
v_accvgpr_read_b32 v95, a83
v_cvt_pk_bf16_f32 v73, v94, v95
v_mfma_f32_32x32x16_bf16 a[32:47], a[168:171], v[96:99], 0
s_add_u32 m0, s3, 0xf000
ds_read_b64_tr_b16 a[164:165], v19 offset:4608
ds_read_b64_tr_b16 a[166:167], v20 offset:4608
buffer_load_dwordx4 v14, s[32:35], s56 offen offset:1024 lds
v_accvgpr_read_b32 v23, a84
v_accvgpr_read_b32 v92, a85
v_cvt_pk_bf16_f32 v74, v23, v92
v_mfma_f32_32x32x16_bf16 a[0:15], a[172:175], v[100:103], a[0:15]
ds_read_b64_tr_b16 a[168:169], v19 offset:4640
ds_read_b64_tr_b16 a[170:171], v20 offset:4640
v_accvgpr_read_b32 v94, a86
v_accvgpr_read_b32 v95, a87
v_cvt_pk_bf16_f32 v75, v94, v95
v_mfma_f32_32x32x16_bf16 a[16:31], a[176:179], v[100:103], a[16:31]
ds_read_b64_tr_b16 a[172:173], v19 offset:4672
ds_read_b64_tr_b16 a[174:175], v20 offset:4672
s_waitcnt lgkmcnt(6)
v_accvgpr_read_b32 v23, a88
v_accvgpr_read_b32 v92, a89
v_cvt_pk_bf16_f32 v76, v23, v92
v_mfma_f32_32x32x16_bf16 a[32:47], a[180:183], v[100:103], a[32:47]
s_waitcnt vmcnt(10)
s_barrier
v_add_u32 v19, 0xfffe2000, v19
v_add_u32 v20, 0xfffe2000, v20
ds_read_b64_tr_b16 a[176:177], v19 offset:0
ds_read_b64_tr_b16 a[178:179], v20 offset:0
v_accvgpr_read_b32 v94, a90
v_accvgpr_read_b32 v95, a91
v_cvt_pk_bf16_f32 v77, v94, v95
v_mfma_f32_32x32x16_bf16 a[0:15], a[184:187], v[104:107], a[0:15]
s_add_u32 m0, s3, 0xf000
ds_read_b64_tr_b16 a[180:181], v19 offset:32
ds_read_b64_tr_b16 a[182:183], v20 offset:32
buffer_load_dwordx4 v15, s[32:35], s56 offen offset:2048 lds
s_add_u32 s56, s56, 0x30000
s_cmp_eq_u32 s56, 0x1e0000
s_cselect_b32 s56, 0, s56
v_accvgpr_read_b32 v23, a92
v_accvgpr_read_b32 v92, a93
v_cvt_pk_bf16_f32 v78, v23, v92
v_mfma_f32_32x32x16_bf16 a[16:31], a[188:191], v[104:107], a[16:31]
ds_read_b64_tr_b16 a[184:185], v19 offset:64
ds_read_b64_tr_b16 a[186:187], v20 offset:64
v_accvgpr_read_b32 v94, a94
v_accvgpr_read_b32 v95, a95
v_cvt_pk_bf16_f32 v79, v94, v95
v_mfma_f32_32x32x16_bf16 a[32:47], a[160:163], v[104:107], a[32:47]
ds_read_b64_tr_b16 a[188:189], v19 offset:1536
ds_read_b64_tr_b16 a[190:191], v20 offset:1536
s_waitcnt lgkmcnt(6)
v_accvgpr_read_b32 v23, a96
v_accvgpr_read_b32 v92, a97
v_cvt_pk_bf16_f32 v80, v23, v92
v_mfma_f32_32x32x16_bf16 a[0:15], a[164:167], v[108:111], a[0:15]
ds_read_b64_tr_b16 a[160:161], v19 offset:1568
ds_read_b64_tr_b16 a[162:163], v20 offset:1568
v_accvgpr_read_b32 v94, a98
v_accvgpr_read_b32 v95, a99
v_cvt_pk_bf16_f32 v81, v94, v95
v_mfma_f32_32x32x16_bf16 a[16:31], a[168:171], v[108:111], a[16:31]
s_add_u32 m0, s3, 0x14000
ds_read_b64_tr_b16 a[164:165], v19 offset:1600
ds_read_b64_tr_b16 a[166:167], v20 offset:1600
buffer_load_dwordx4 v13, s[32:35], s56 offen offset:0 lds
v_accvgpr_read_b32 v23, a100
v_accvgpr_read_b32 v92, a101
v_cvt_pk_bf16_f32 v82, v23, v92
v_mfma_f32_32x32x16_bf16 a[32:47], a[172:175], v[108:111], a[32:47]
ds_read_b64_tr_b16 a[168:169], v19 offset:3072
ds_read_b64_tr_b16 a[170:171], v20 offset:3072
v_accvgpr_read_b32 v94, a102
v_accvgpr_read_b32 v95, a103
v_cvt_pk_bf16_f32 v83, v94, v95
v_mfma_f32_32x32x16_bf16 a[0:15], a[176:179], v[112:115], a[0:15]
ds_read_b64_tr_b16 a[172:173], v19 offset:3104
ds_read_b64_tr_b16 a[174:175], v20 offset:3104
s_waitcnt lgkmcnt(6)
v_accvgpr_read_b32 v23, a104
v_accvgpr_read_b32 v92, a105
v_cvt_pk_bf16_f32 v84, v23, v92
v_mfma_f32_32x32x16_bf16 a[16:31], a[180:183], v[112:115], a[16:31]
ds_read_b64_tr_b16 a[176:177], v19 offset:3136
ds_read_b64_tr_b16 a[178:179], v20 offset:3136
v_accvgpr_read_b32 v94, a106
v_accvgpr_read_b32 v95, a107
v_cvt_pk_bf16_f32 v85, v94, v95
v_mfma_f32_32x32x16_bf16 a[32:47], a[184:187], v[112:115], a[32:47]
s_add_u32 m0, s3, 0x14000
ds_read_b64_tr_b16 a[180:181], v19 offset:4608
ds_read_b64_tr_b16 a[182:183], v20 offset:4608
buffer_load_dwordx4 v14, s[32:35], s56 offen offset:1024 lds
v_accvgpr_read_b32 v23, a108
v_accvgpr_read_b32 v92, a109
v_cvt_pk_bf16_f32 v86, v23, v92
v_mfma_f32_32x32x16_bf16 a[0:15], a[188:191], v[116:119], a[0:15]
ds_read_b64_tr_b16 a[184:185], v19 offset:4640
ds_read_b64_tr_b16 a[186:187], v20 offset:4640
v_accvgpr_read_b32 v94, a110
v_accvgpr_read_b32 v95, a111
v_cvt_pk_bf16_f32 v87, v94, v95
v_mfma_f32_32x32x16_bf16 a[16:31], a[160:163], v[116:119], a[16:31]
ds_read_b64_tr_b16 a[188:189], v19 offset:4672
ds_read_b64_tr_b16 a[190:191], v20 offset:4672
s_waitcnt lgkmcnt(6)
v_accvgpr_read_b32 v23, a112
v_accvgpr_read_b32 v92, a113
v_cvt_pk_bf16_f32 v88, v23, v92
v_mfma_f32_32x32x16_bf16 a[32:47], a[164:167], v[116:119], a[32:47]
s_waitcnt vmcnt(9)
s_barrier
v_add_u32 v19, 0x5000, v19
v_add_u32 v20, 0x5000, v20
ds_read_b64_tr_b16 a[160:161], v19 offset:0
ds_read_b64_tr_b16 a[162:163], v20 offset:0
v_accvgpr_read_b32 v94, a114
v_accvgpr_read_b32 v95, a115
v_cvt_pk_bf16_f32 v89, v94, v95
v_mfma_f32_32x32x16_bf16 a[0:15], a[168:171], v[120:123], a[0:15]
s_add_u32 m0, s3, 0x14000
ds_read_b64_tr_b16 a[164:165], v19 offset:32
ds_read_b64_tr_b16 a[166:167], v20 offset:32
buffer_load_dwordx4 v15, s[32:35], s56 offen offset:2048 lds
s_add_u32 s56, s56, 0x30000
s_cmp_eq_u32 s56, 0x1e0000
s_cselect_b32 s56, 0, s56
v_accvgpr_read_b32 v23, a116
v_accvgpr_read_b32 v92, a117
v_cvt_pk_bf16_f32 v90, v23, v92
v_mfma_f32_32x32x16_bf16 a[16:31], a[172:175], v[120:123], a[16:31]
ds_read_b64_tr_b16 a[168:169], v19 offset:64
ds_read_b64_tr_b16 a[170:171], v20 offset:64
v_accvgpr_read_b32 v94, a118
v_accvgpr_read_b32 v95, a119
v_cvt_pk_bf16_f32 v91, v94, v95
v_mfma_f32_32x32x16_bf16 v[24:39], a[192:195], v[72:75], 0
v_mfma_f32_32x32x16_bf16 v[24:39], a[196:199], v[76:79], v[24:39]
v_mfma_f32_32x32x16_bf16 v[24:39], a[200:203], v[80:83], v[24:39]
v_mfma_f32_32x32x16_bf16 v[40:55], a[204:207], v[72:75], 0
v_mfma_f32_32x32x16_bf16 v[40:55], a[208:211], v[76:79], v[40:55]
v_mfma_f32_32x32x16_bf16 v[40:55], a[212:215], v[80:83], v[40:55]
v_mfma_f32_32x32x16_bf16 v[40:55], a[216:219], v[84:87], v[40:55]
v_mfma_f32_32x32x16_bf16 v[40:55], a[220:223], v[88:91], v[40:55]
v_mfma_f32_32x32x16_bf16 v[56:71], a[224:227], v[80:83], 0
v_mfma_f32_32x32x16_bf16 v[56:71], a[228:231], v[84:87], v[56:71]
v_mfma_f32_32x32x16_bf16 v[56:71], a[232:235], v[88:91], v[56:71]
v_mov_b32 v92, 1
s_mov_b64 exec, 1
buffer_store_dword v92, off, s[36:39], s89 sc1
s_mov_b64 exec, -1
v_mfma_f32_32x32x16_bf16 a[32:47], a[176:179], v[120:123], a[32:47]
ds_read_b64_tr_b16 a[172:173], v19 offset:1536
ds_read_b64_tr_b16 a[174:175], v20 offset:1536
s_waitcnt lgkmcnt(6)
v_max3_f32 v23, v24, v25, v26
v_min3_f32 v92, v24, v25, v26
v_max3_f32 v23, v23, v27, v28
v_mfma_f32_32x32x16_bf16 a[0:15], a[180:183], v[124:127], a[0:15]
ds_read_b64_tr_b16 a[176:177], v19 offset:1568
ds_read_b64_tr_b16 a[178:179], v20 offset:1568
v_min3_f32 v92, v92, v27, v28
v_max3_f32 v23, v23, v29, v30
v_min3_f32 v92, v92, v29, v30
v_mfma_f32_32x32x16_bf16 a[16:31], a[184:187], v[124:127], a[16:31]
s_add_u32 m0, s3, 0x19000
ds_read_b64_tr_b16 a[180:181], v19 offset:1600
ds_read_b64_tr_b16 a[182:183], v20 offset:1600
buffer_load_dwordx4 v13, s[32:35], s56 offen offset:0 lds
v_max3_f32 v23, v23, v31, v32
v_min3_f32 v92, v92, v31, v32
v_max3_f32 v23, v23, v33, v34
v_mfma_f32_32x32x16_bf16 a[32:47], a[188:191], v[124:127], a[32:47]
ds_read_b64_tr_b16 a[184:185], v19 offset:3072
ds_read_b64_tr_b16 a[186:187], v20 offset:3072
v_min3_f32 v92, v92, v33, v34
v_max3_f32 v23, v23, v35, v36
v_min3_f32 v92, v92, v35, v36
v_mfma_f32_32x32x16_bf16 a[0:15], a[160:163], v[128:131], a[0:15]
ds_read_b64_tr_b16 a[188:189], v19 offset:3104
ds_read_b64_tr_b16 a[190:191], v20 offset:3104
s_waitcnt lgkmcnt(6)
v_max3_f32 v23, v23, v37, v38
v_min3_f32 v92, v92, v37, v38
v_max3_f32 v23, v23, v39, v40
v_mfma_f32_32x32x16_bf16 a[16:31], a[164:167], v[128:131], a[16:31]
ds_read_b64_tr_b16 a[160:161], v19 offset:3136
ds_read_b64_tr_b16 a[162:163], v20 offset:3136
v_min3_f32 v92, v92, v39, v40
v_max3_f32 v23, v23, v41, v42
v_min3_f32 v92, v92, v41, v42
v_mfma_f32_32x32x16_bf16 a[32:47], a[168:171], v[128:131], a[32:47]
s_add_u32 m0, s3, 0x19000
ds_read_b64_tr_b16 a[164:165], v19 offset:4608
ds_read_b64_tr_b16 a[166:167], v20 offset:4608
buffer_load_dwordx4 v14, s[32:35], s56 offen offset:1024 lds
v_max_f32 v23, v23, v43
v_min_f32 v92, v92, v43
v_mul_f32 v23, s62, v23
v_mfma_f32_32x32x16_bf16 a[0:15], a[172:175], v[132:135], a[0:15]
ds_read_b64_tr_b16 a[168:169], v19 offset:4640
ds_read_b64_tr_b16 a[170:171], v20 offset:4640
v_mul_f32 v92, s62, v92
v_fma_f32 v72, v24, s62, -v23
v_fma_f32 v24, -v24, s62, v92
v_mfma_f32_32x32x16_bf16 a[16:31], a[176:179], v[132:135], a[16:31]
ds_read_b64_tr_b16 a[172:173], v19 offset:4672
ds_read_b64_tr_b16 a[174:175], v20 offset:4672
s_waitcnt lgkmcnt(6)
v_fma_f32 v73, v25, s62, -v23
v_fma_f32 v25, -v25, s62, v92
v_fma_f32 v74, v26, s62, -v23
v_mfma_f32_32x32x16_bf16 a[32:47], a[180:183], v[132:135], a[32:47]
s_waitcnt vmcnt(9)
s_barrier
v_add_u32 v19, 0x5000, v19
v_add_u32 v20, 0x5000, v20
ds_read_b64_tr_b16 a[176:177], v19 offset:0
ds_read_b64_tr_b16 a[178:179], v20 offset:0
v_fma_f32 v26, -v26, s62, v92
v_fma_f32 v75, v27, s62, -v23
v_fma_f32 v27, -v27, s62, v92
v_mfma_f32_32x32x16_bf16 a[0:15], a[184:187], v[136:139], a[0:15]
s_add_u32 m0, s3, 0x19000
ds_read_b64_tr_b16 a[180:181], v19 offset:32
ds_read_b64_tr_b16 a[182:183], v20 offset:32
buffer_load_dwordx4 v15, s[32:35], s56 offen offset:2048 lds
s_add_u32 s56, s56, 0x30000
s_cmp_eq_u32 s56, 0x1e0000
s_cselect_b32 s56, 0, s56
v_fma_f32 v76, v28, s62, -v23
v_fma_f32 v28, -v28, s62, v92
v_fma_f32 v77, v29, s62, -v23
v_mfma_f32_32x32x16_bf16 a[16:31], a[188:191], v[136:139], a[16:31]
ds_read_b64_tr_b16 a[184:185], v19 offset:64
ds_read_b64_tr_b16 a[186:187], v20 offset:64
v_fma_f32 v29, -v29, s62, v92
v_fma_f32 v78, v30, s62, -v23
v_fma_f32 v30, -v30, s62, v92
v_mfma_f32_32x32x16_bf16 a[32:47], a[160:163], v[136:139], a[32:47]
ds_read_b64_tr_b16 a[188:189], v19 offset:1536
ds_read_b64_tr_b16 a[190:191], v20 offset:1536
s_waitcnt lgkmcnt(6)
v_fma_f32 v79, v31, s62, -v23
v_fma_f32 v31, -v31, s62, v92
v_fma_f32 v80, v32, s62, -v23
v_mfma_f32_32x32x16_bf16 a[0:15], a[164:167], v[140:143], a[0:15]
ds_read_b64_tr_b16 a[160:161], v19 offset:1568
ds_read_b64_tr_b16 a[162:163], v20 offset:1568
v_fma_f32 v32, -v32, s62, v92
v_fma_f32 v81, v33, s62, -v23
v_fma_f32 v33, -v33, s62, v92
v_mfma_f32_32x32x16_bf16 a[16:31], a[168:171], v[140:143], a[16:31]
s_add_u32 m0, s3, 0x1e000
ds_read_b64_tr_b16 a[164:165], v19 offset:1600
ds_read_b64_tr_b16 a[166:167], v20 offset:1600
buffer_load_dwordx4 v13, s[32:35], s56 offen offset:0 lds
v_fma_f32 v82, v34, s62, -v23
v_fma_f32 v34, -v34, s62, v92
v_fma_f32 v83, v35, s62, -v23
v_mfma_f32_32x32x16_bf16 a[32:47], a[172:175], v[140:143], a[32:47]
ds_read_b64_tr_b16 a[168:169], v19 offset:3072
ds_read_b64_tr_b16 a[170:171], v20 offset:3072
v_fma_f32 v35, -v35, s62, v92
v_fma_f32 v84, v36, s62, -v23
v_fma_f32 v36, -v36, s62, v92
v_mfma_f32_32x32x16_bf16 a[0:15], a[176:179], v[144:147], a[0:15]
ds_read_b64_tr_b16 a[172:173], v19 offset:3104
ds_read_b64_tr_b16 a[174:175], v20 offset:3104
s_waitcnt lgkmcnt(6)
v_fma_f32 v85, v37, s62, -v23
v_fma_f32 v37, -v37, s62, v92
v_fma_f32 v86, v38, s62, -v23
v_mfma_f32_32x32x16_bf16 a[16:31], a[180:183], v[144:147], a[16:31]
ds_read_b64_tr_b16 a[176:177], v19 offset:3136
ds_read_b64_tr_b16 a[178:179], v20 offset:3136
v_fma_f32 v38, -v38, s62, v92
v_fma_f32 v87, v39, s62, -v23
v_fma_f32 v39, -v39, s62, v92
v_mfma_f32_32x32x16_bf16 a[32:47], a[184:187], v[144:147], a[32:47]
s_add_u32 m0, s3, 0x1e000
ds_read_b64_tr_b16 a[180:181], v19 offset:4608
ds_read_b64_tr_b16 a[182:183], v20 offset:4608
buffer_load_dwordx4 v14, s[32:35], s56 offen offset:1024 lds
v_fma_f32 v88, v40, s62, -v23
v_fma_f32 v40, -v40, s62, v92
v_fma_f32 v89, v41, s62, -v23
v_mfma_f32_32x32x16_bf16 a[0:15], a[188:191], v[148:151], a[0:15]
ds_read_b64_tr_b16 a[184:185], v19 offset:4640
ds_read_b64_tr_b16 a[186:187], v20 offset:4640
v_fma_f32 v41, -v41, s62, v92
v_fma_f32 v90, v42, s62, -v23
v_fma_f32 v42, -v42, s62, v92
v_mfma_f32_32x32x16_bf16 a[16:31], a[160:163], v[148:151], a[16:31]
ds_read_b64_tr_b16 a[188:189], v19 offset:4672
ds_read_b64_tr_b16 a[190:191], v20 offset:4672
s_waitcnt lgkmcnt(6)
v_fma_f32 v91, v43, s62, -v23
v_fma_f32 v43, -v43, s62, v92
v_mfma_f32_32x32x16_bf16 a[32:47], a[164:167], v[148:151], a[32:47]
s_waitcnt vmcnt(9)
s_barrier
v_add_u32 v19, 0x5000, v19
v_add_u32 v20, 0x5000, v20
ds_read_b64_tr_b16 a[160:161], v19 offset:0
ds_read_b64_tr_b16 a[162:163], v20 offset:0
v_exp_f32 v72, v72
v_mfma_f32_32x32x16_bf16 a[0:15], a[168:171], v[152:155], a[0:15]
s_add_u32 m0, s3, 0x1e000
ds_read_b64_tr_b16 a[164:165], v19 offset:32
ds_read_b64_tr_b16 a[166:167], v20 offset:32
buffer_load_dwordx4 v15, s[32:35], s56 offen offset:2048 lds
s_add_u32 s56, s56, 0x30000
s_cmp_eq_u32 s56, 0x1e0000
s_cselect_b32 s56, 0, s56
v_exp_f32 v24, v24
v_mfma_f32_32x32x16_bf16 a[16:31], a[172:175], v[152:155], a[16:31]
ds_read_b64_tr_b16 a[168:169], v19 offset:64
ds_read_b64_tr_b16 a[170:171], v20 offset:64
v_exp_f32 v73, v73
v_mfma_f32_32x32x16_bf16 a[32:47], a[176:179], v[152:155], a[32:47]
ds_read_b64_tr_b16 a[172:173], v19 offset:1536
ds_read_b64_tr_b16 a[174:175], v20 offset:1536
s_waitcnt lgkmcnt(6)
v_exp_f32 v25, v25
v_mfma_f32_32x32x16_bf16 a[0:15], a[180:183], v[156:159], a[0:15]
ds_read_b64_tr_b16 a[176:177], v19 offset:1568
ds_read_b64_tr_b16 a[178:179], v20 offset:1568
v_exp_f32 v74, v74
v_mfma_f32_32x32x16_bf16 a[16:31], a[184:187], v[156:159], a[16:31]
s_add_u32 m0, s3, 0
ds_read_b64_tr_b16 a[180:181], v19 offset:1600
ds_read_b64_tr_b16 a[182:183], v20 offset:1600
buffer_load_dwordx4 v13, s[32:35], s56 offen offset:0 lds
v_exp_f32 v26, v26
v_mfma_f32_32x32x16_bf16 a[32:47], a[188:191], v[156:159], a[32:47]
ds_read_b64_tr_b16 a[184:185], v19 offset:3072
ds_read_b64_tr_b16 a[186:187], v20 offset:3072
v_exp_f32 v75, v75
v_mfma_f32_32x32x16_bf16 a[0:15], a[160:163], v[160:163], a[0:15]
ds_read_b64_tr_b16 a[188:189], v19 offset:3104
ds_read_b64_tr_b16 a[190:191], v20 offset:3104
s_waitcnt lgkmcnt(6)
v_exp_f32 v27, v27
v_mfma_f32_32x32x16_bf16 a[16:31], a[164:167], v[160:163], a[16:31]
ds_read_b64_tr_b16 a[160:161], v19 offset:3136
ds_read_b64_tr_b16 a[162:163], v20 offset:3136
v_exp_f32 v76, v76
v_mfma_f32_32x32x16_bf16 a[32:47], a[168:171], v[160:163], a[32:47]
s_add_u32 m0, s3, 0
ds_read_b64_tr_b16 a[164:165], v19 offset:4608
ds_read_b64_tr_b16 a[166:167], v20 offset:4608
buffer_load_dwordx4 v14, s[32:35], s56 offen offset:1024 lds
v_exp_f32 v28, v28
v_mfma_f32_32x32x16_bf16 a[0:15], a[172:175], v[164:167], a[0:15]
ds_read_b64_tr_b16 a[168:169], v19 offset:4640
ds_read_b64_tr_b16 a[170:171], v20 offset:4640
v_exp_f32 v77, v77
v_mfma_f32_32x32x16_bf16 a[16:31], a[176:179], v[164:167], a[16:31]
ds_read_b64_tr_b16 a[172:173], v19 offset:4672
ds_read_b64_tr_b16 a[174:175], v20 offset:4672
s_waitcnt lgkmcnt(6)
v_exp_f32 v29, v29
v_mfma_f32_32x32x16_bf16 a[32:47], a[180:183], v[164:167], a[32:47]
s_waitcnt vmcnt(9)
s_barrier
v_add_u32 v19, 0x5000, v19
v_add_u32 v20, 0x5000, v20
ds_read_b64_tr_b16 a[176:177], v19 offset:0
ds_read_b64_tr_b16 a[178:179], v20 offset:0
v_exp_f32 v78, v78
v_mfma_f32_32x32x16_bf16 a[0:15], a[184:187], v[168:171], a[0:15]
s_add_u32 m0, s3, 0
ds_read_b64_tr_b16 a[180:181], v19 offset:32
ds_read_b64_tr_b16 a[182:183], v20 offset:32
buffer_load_dwordx4 v15, s[32:35], s56 offen offset:2048 lds
s_add_u32 s56, s56, 0x30000
s_cmp_eq_u32 s56, 0x1e0000
s_cselect_b32 s56, 0, s56
v_exp_f32 v30, v30
v_mfma_f32_32x32x16_bf16 a[16:31], a[188:191], v[168:171], a[16:31]
ds_read_b64_tr_b16 a[184:185], v19 offset:64
ds_read_b64_tr_b16 a[186:187], v20 offset:64
v_exp_f32 v79, v79
v_mfma_f32_32x32x16_bf16 a[32:47], a[160:163], v[168:171], a[32:47]
ds_read_b64_tr_b16 a[188:189], v19 offset:1536
ds_read_b64_tr_b16 a[190:191], v20 offset:1536
s_waitcnt lgkmcnt(6)
v_exp_f32 v31, v31
v_mfma_f32_32x32x16_bf16 a[0:15], a[164:167], v[172:175], a[0:15]
ds_read_b64_tr_b16 a[160:161], v19 offset:1568
ds_read_b64_tr_b16 a[162:163], v20 offset:1568
v_exp_f32 v80, v80
v_mfma_f32_32x32x16_bf16 a[16:31], a[168:171], v[172:175], a[16:31]
s_add_u32 m0, s3, 0x5000
ds_read_b64_tr_b16 a[164:165], v19 offset:1600
ds_read_b64_tr_b16 a[166:167], v20 offset:1600
buffer_load_dwordx4 v13, s[32:35], s56 offen offset:0 lds
v_exp_f32 v32, v32
v_mfma_f32_32x32x16_bf16 a[32:47], a[172:175], v[172:175], a[32:47]
ds_read_b64_tr_b16 a[168:169], v19 offset:3072
ds_read_b64_tr_b16 a[170:171], v20 offset:3072
v_exp_f32 v81, v81
v_mfma_f32_32x32x16_bf16 a[0:15], a[176:179], v[176:179], a[0:15]
ds_read_b64_tr_b16 a[172:173], v19 offset:3104
ds_read_b64_tr_b16 a[174:175], v20 offset:3104
s_waitcnt lgkmcnt(6)
v_exp_f32 v33, v33
v_mfma_f32_32x32x16_bf16 a[16:31], a[180:183], v[176:179], a[16:31]
ds_read_b64_tr_b16 a[176:177], v19 offset:3136
ds_read_b64_tr_b16 a[178:179], v20 offset:3136
v_exp_f32 v82, v82
v_mfma_f32_32x32x16_bf16 a[32:47], a[184:187], v[176:179], a[32:47]
s_add_u32 m0, s3, 0x5000
ds_read_b64_tr_b16 a[180:181], v19 offset:4608
ds_read_b64_tr_b16 a[182:183], v20 offset:4608
buffer_load_dwordx4 v14, s[32:35], s56 offen offset:1024 lds
v_exp_f32 v34, v34
v_mfma_f32_32x32x16_bf16 a[0:15], a[188:191], v[180:183], a[0:15]
ds_read_b64_tr_b16 a[184:185], v19 offset:4640
ds_read_b64_tr_b16 a[186:187], v20 offset:4640
v_exp_f32 v83, v83
v_mfma_f32_32x32x16_bf16 a[16:31], a[160:163], v[180:183], a[16:31]
ds_read_b64_tr_b16 a[188:189], v19 offset:4672
ds_read_b64_tr_b16 a[190:191], v20 offset:4672
s_waitcnt lgkmcnt(6)
v_exp_f32 v35, v35
v_mfma_f32_32x32x16_bf16 a[32:47], a[164:167], v[180:183], a[32:47]
s_waitcnt vmcnt(8)
s_barrier
v_add_u32 v19, 0x5000, v19
v_add_u32 v20, 0x5000, v20
ds_read_b64_tr_b16 a[160:161], v19 offset:0
ds_read_b64_tr_b16 a[162:163], v20 offset:0
v_exp_f32 v84, v84
v_mfma_f32_32x32x16_bf16 a[0:15], a[168:171], v[184:187], a[0:15]
s_add_u32 m0, s3, 0x5000
ds_read_b64_tr_b16 a[164:165], v19 offset:32
ds_read_b64_tr_b16 a[166:167], v20 offset:32
buffer_load_dwordx4 v15, s[32:35], s56 offen offset:2048 lds
s_add_u32 s56, s56, 0x30000
s_cmp_eq_u32 s56, 0x1e0000
s_cselect_b32 s56, 0, s56
v_exp_f32 v36, v36
v_mfma_f32_32x32x16_bf16 a[16:31], a[172:175], v[184:187], a[16:31]
ds_read_b64_tr_b16 a[168:169], v19 offset:64
ds_read_b64_tr_b16 a[170:171], v20 offset:64
v_exp_f32 v85, v85
v_mfma_f32_32x32x16_bf16 a[32:47], a[176:179], v[184:187], a[32:47]
ds_read_b64_tr_b16 a[172:173], v19 offset:1536
ds_read_b64_tr_b16 a[174:175], v20 offset:1536
s_waitcnt lgkmcnt(6)
v_exp_f32 v37, v37
v_mfma_f32_32x32x16_bf16 a[0:15], a[180:183], v[188:191], a[0:15]
ds_read_b64_tr_b16 a[176:177], v19 offset:1568
ds_read_b64_tr_b16 a[178:179], v20 offset:1568
v_exp_f32 v86, v86
v_mfma_f32_32x32x16_bf16 a[16:31], a[184:187], v[188:191], a[16:31]
ds_read_b64_tr_b16 a[180:181], v19 offset:1600
ds_read_b64_tr_b16 a[182:183], v20 offset:1600
v_exp_f32 v38, v38
v_mfma_f32_32x32x16_bf16 a[32:47], a[188:191], v[188:191], a[32:47]
ds_read_b64_tr_b16 a[184:185], v19 offset:3072
ds_read_b64_tr_b16 a[186:187], v20 offset:3072
v_exp_f32 v87, v87
v_mfma_f32_32x32x16_bf16 a[0:15], a[160:163], v[192:195], a[0:15]
ds_read_b64_tr_b16 a[188:189], v19 offset:3104
ds_read_b64_tr_b16 a[190:191], v20 offset:3104
s_waitcnt lgkmcnt(6)
v_exp_f32 v39, v39
v_mfma_f32_32x32x16_bf16 a[16:31], a[164:167], v[192:195], a[16:31]
ds_read_b64_tr_b16 a[160:161], v19 offset:3136
ds_read_b64_tr_b16 a[162:163], v20 offset:3136
v_exp_f32 v88, v88
v_mfma_f32_32x32x16_bf16 a[32:47], a[168:171], v[192:195], a[32:47]
ds_read_b64_tr_b16 a[164:165], v19 offset:4608
ds_read_b64_tr_b16 a[166:167], v20 offset:4608
v_exp_f32 v40, v40
v_mfma_f32_32x32x16_bf16 a[0:15], a[172:175], v[196:199], a[0:15]
ds_read_b64_tr_b16 a[168:169], v19 offset:4640
ds_read_b64_tr_b16 a[170:171], v20 offset:4640
v_exp_f32 v89, v89
v_mfma_f32_32x32x16_bf16 a[16:31], a[176:179], v[196:199], a[16:31]
ds_read_b64_tr_b16 a[172:173], v19 offset:4672
ds_read_b64_tr_b16 a[174:175], v20 offset:4672
s_waitcnt lgkmcnt(6)
v_exp_f32 v41, v41
v_mfma_f32_32x32x16_bf16 a[32:47], a[180:183], v[196:199], a[32:47]
s_waitcnt vmcnt(6)
s_barrier
v_add_u32 v19, 0x5000, v19
v_add_u32 v20, 0x5000, v20
ds_read_b64_tr_b16 a[176:177], v19 offset:0
ds_read_b64_tr_b16 a[178:179], v20 offset:0
v_exp_f32 v90, v90
v_mfma_f32_32x32x16_bf16 a[0:15], a[184:187], v[200:203], a[0:15]
ds_read_b64_tr_b16 a[180:181], v19 offset:32
ds_read_b64_tr_b16 a[182:183], v20 offset:32
v_exp_f32 v42, v42
v_mfma_f32_32x32x16_bf16 a[16:31], a[188:191], v[200:203], a[16:31]
ds_read_b64_tr_b16 a[184:185], v19 offset:64
ds_read_b64_tr_b16 a[186:187], v20 offset:64
v_exp_f32 v91, v91
v_mfma_f32_32x32x16_bf16 a[32:47], a[160:163], v[200:203], a[32:47]
ds_read_b64_tr_b16 a[188:189], v19 offset:1536
ds_read_b64_tr_b16 a[190:191], v20 offset:1536
s_waitcnt lgkmcnt(6)
v_exp_f32 v43, v43
v_add_f32 v93, v72, v73
v_mfma_f32_32x32x16_bf16 a[0:15], a[164:167], v[204:207], a[0:15]
ds_read_b64_tr_b16 a[160:161], v19 offset:1568
ds_read_b64_tr_b16 a[162:163], v20 offset:1568
v_add_f32 v94, v24, v25
v_add_f32 v23, v74, v75
v_add_f32 v92, v26, v27
v_mfma_f32_32x32x16_bf16 a[16:31], a[168:171], v[204:207], a[16:31]
ds_read_b64_tr_b16 a[164:165], v19 offset:1600
ds_read_b64_tr_b16 a[166:167], v20 offset:1600
v_add_f32 v93, v93, v76
v_add_f32 v94, v94, v28
v_add_f32 v23, v23, v77
v_mfma_f32_32x32x16_bf16 a[32:47], a[172:175], v[204:207], a[32:47]
ds_read_b64_tr_b16 a[168:169], v19 offset:3072
ds_read_b64_tr_b16 a[170:171], v20 offset:3072
v_add_f32 v92, v92, v29
v_add_f32 v93, v93, v78
v_add_f32 v94, v94, v30
v_mfma_f32_32x32x16_bf16 a[0:15], a[176:179], v[208:211], a[0:15]
ds_read_b64_tr_b16 a[172:173], v19 offset:3104
ds_read_b64_tr_b16 a[174:175], v20 offset:3104
s_waitcnt lgkmcnt(6)
v_add_f32 v23, v23, v79
v_add_f32 v92, v92, v31
v_add_f32 v93, v93, v80
v_mfma_f32_32x32x16_bf16 a[16:31], a[180:183], v[208:211], a[16:31]
ds_read_b64_tr_b16 a[176:177], v19 offset:3136
ds_read_b64_tr_b16 a[178:179], v20 offset:3136
v_add_f32 v94, v94, v32
v_add_f32 v23, v23, v81
v_add_f32 v92, v92, v33
v_mfma_f32_32x32x16_bf16 a[32:47], a[184:187], v[208:211], a[32:47]
ds_read_b64_tr_b16 a[180:181], v19 offset:4608
ds_read_b64_tr_b16 a[182:183], v20 offset:4608
v_add_f32 v93, v93, v82
v_add_f32 v94, v94, v34
v_add_f32 v23, v23, v83
v_mfma_f32_32x32x16_bf16 a[0:15], a[188:191], v[212:215], a[0:15]
ds_read_b64_tr_b16 a[184:185], v19 offset:4640
ds_read_b64_tr_b16 a[186:187], v20 offset:4640
v_add_f32 v92, v92, v35
v_add_f32 v93, v93, v84
v_add_f32 v94, v94, v36
v_mfma_f32_32x32x16_bf16 a[16:31], a[160:163], v[212:215], a[16:31]
ds_read_b64_tr_b16 a[188:189], v19 offset:4672
ds_read_b64_tr_b16 a[190:191], v20 offset:4672
s_waitcnt lgkmcnt(6)
v_add_f32 v23, v23, v85
v_add_f32 v92, v92, v37
v_add_f32 v93, v93, v86
v_mfma_f32_32x32x16_bf16 a[32:47], a[164:167], v[212:215], a[32:47]
s_waitcnt vmcnt(3)
s_barrier
v_add_u32 v19, 0xfffe2000, v19
v_add_u32 v20, 0xfffe2000, v20
ds_read_b64_tr_b16 a[160:161], v19 offset:0
ds_read_b64_tr_b16 a[162:163], v20 offset:0
v_add_f32 v94, v94, v38
v_add_f32 v23, v23, v87
v_add_f32 v92, v92, v39
v_mfma_f32_32x32x16_bf16 a[0:15], a[168:171], v[216:219], a[0:15]
ds_read_b64_tr_b16 a[164:165], v19 offset:32
ds_read_b64_tr_b16 a[166:167], v20 offset:32
v_add_f32 v93, v93, v88
v_add_f32 v94, v94, v40
v_add_f32 v23, v23, v89
v_mfma_f32_32x32x16_bf16 a[16:31], a[172:175], v[216:219], a[16:31]
ds_read_b64_tr_b16 a[168:169], v19 offset:64
ds_read_b64_tr_b16 a[170:171], v20 offset:64
v_add_f32 v92, v92, v41
v_add_f32 v93, v93, v90
v_add_f32 v94, v94, v42
v_mfma_f32_32x32x16_bf16 a[32:47], a[176:179], v[216:219], a[32:47]
ds_read_b64_tr_b16 a[172:173], v19 offset:1536
ds_read_b64_tr_b16 a[174:175], v20 offset:1536
s_waitcnt lgkmcnt(6)
v_add_f32 v23, v23, v91
v_add_f32 v92, v92, v43
v_add_f32 v93, v93, v23
v_mfma_f32_32x32x16_bf16 a[0:15], a[180:183], v[220:223], a[0:15]
ds_read_b64_tr_b16 a[176:177], v19 offset:1568
ds_read_b64_tr_b16 a[178:179], v20 offset:1568
v_add_f32 v94, v94, v92
v_rcp_f32 v93, v93
v_mfma_f32_32x32x16_bf16 a[16:31], a[184:187], v[220:223], a[16:31]
ds_read_b64_tr_b16 a[180:181], v19 offset:1600
ds_read_b64_tr_b16 a[182:183], v20 offset:1600
v_rcp_f32 v94, v94
v_mul_f32 v72, v93, v72
v_mfma_f32_32x32x16_bf16 a[32:47], a[188:191], v[220:223], a[32:47]
ds_read_b64_tr_b16 a[184:185], v19 offset:3072
ds_read_b64_tr_b16 a[186:187], v20 offset:3072
v_mul_f32 v73, v93, v73
v_mul_f32 v74, v93, v74
v_mul_f32 v75, v93, v75
v_mfma_f32_32x32x16_bf16 a[0:15], a[160:163], v[224:227], a[0:15]
ds_read_b64_tr_b16 a[188:189], v19 offset:3104
ds_read_b64_tr_b16 a[190:191], v20 offset:3104
s_waitcnt lgkmcnt(6)
v_mul_f32 v76, v93, v76
v_mul_f32 v77, v93, v77
v_mul_f32 v78, v93, v78
v_mfma_f32_32x32x16_bf16 a[16:31], a[164:167], v[224:227], a[16:31]
ds_read_b64_tr_b16 a[160:161], v19 offset:3136
ds_read_b64_tr_b16 a[162:163], v20 offset:3136
v_mul_f32 v79, v93, v79
v_mul_f32 v80, v93, v80
v_mul_f32 v81, v93, v81
v_mfma_f32_32x32x16_bf16 a[32:47], a[168:171], v[224:227], a[32:47]
ds_read_b64_tr_b16 a[164:165], v19 offset:4608
ds_read_b64_tr_b16 a[166:167], v20 offset:4608
v_mul_f32 v82, v93, v82
v_mul_f32 v83, v93, v83
v_mul_f32 v84, v93, v84
v_mfma_f32_32x32x16_bf16 a[0:15], a[172:175], v[228:231], a[0:15]
ds_read_b64_tr_b16 a[168:169], v19 offset:4640
ds_read_b64_tr_b16 a[170:171], v20 offset:4640
v_mul_f32 v85, v93, v85
v_mul_f32 v86, v93, v86
v_mul_f32 v87, v93, v87
v_mfma_f32_32x32x16_bf16 a[16:31], a[176:179], v[228:231], a[16:31]
ds_read_b64_tr_b16 a[172:173], v19 offset:4672
ds_read_b64_tr_b16 a[174:175], v20 offset:4672
s_waitcnt lgkmcnt(6)
v_mul_f32 v88, v93, v88
v_mul_f32 v89, v93, v89
v_mul_f32 v90, v93, v90
v_mfma_f32_32x32x16_bf16 a[32:47], a[180:183], v[228:231], a[32:47]
s_waitcnt vmcnt(0)
s_barrier
v_add_u32 v19, 0x5000, v19
v_add_u32 v20, 0x5000, v20
ds_read_b64_tr_b16 a[176:177], v19 offset:0
ds_read_b64_tr_b16 a[178:179], v20 offset:0
v_mul_f32 v91, v93, v91
v_mul_f32 v24, v94, v24
v_mul_f32 v25, v94, v25
v_mfma_f32_32x32x16_bf16 a[0:15], a[184:187], v[232:235], a[0:15]
ds_read_b64_tr_b16 a[180:181], v19 offset:1536
ds_read_b64_tr_b16 a[182:183], v20 offset:1536
v_mul_f32 v26, v94, v26
v_mul_f32 v27, v94, v27
v_mul_f32 v28, v94, v28
v_mfma_f32_32x32x16_bf16 a[16:31], a[188:191], v[232:235], a[16:31]
ds_read_b64_tr_b16 a[184:185], v19 offset:3072
ds_read_b64_tr_b16 a[186:187], v20 offset:3072
v_mul_f32 v29, v94, v29
v_mul_f32 v30, v94, v30
v_mul_f32 v31, v94, v31
v_mfma_f32_32x32x16_bf16 a[32:47], a[160:163], v[232:235], a[32:47]
ds_read_b64_tr_b16 a[188:189], v19 offset:4608
ds_read_b64_tr_b16 a[190:191], v20 offset:4608
s_waitcnt lgkmcnt(6)
v_mul_f32 v32, v94, v32
v_mul_f32 v33, v94, v33
v_mul_f32 v34, v94, v34
v_mfma_f32_32x32x16_bf16 a[0:15], a[164:167], v[236:239], a[0:15]
ds_read_b64_tr_b16 a[160:161], v19 offset:32
ds_read_b64_tr_b16 a[162:163], v20 offset:32
v_mul_f32 v35, v94, v35
v_mul_f32 v36, v94, v36
v_mul_f32 v37, v94, v37
v_mfma_f32_32x32x16_bf16 a[16:31], a[168:171], v[236:239], a[16:31]
ds_read_b64_tr_b16 a[164:165], v19 offset:1568
ds_read_b64_tr_b16 a[166:167], v20 offset:1568
v_mul_f32 v38, v94, v38
v_mul_f32 v39, v94, v39
v_mul_f32 v40, v94, v40
v_mfma_f32_32x32x16_bf16 a[32:47], a[172:175], v[236:239], a[32:47]
ds_read_b64_tr_b16 a[168:169], v19 offset:3104
ds_read_b64_tr_b16 a[170:171], v20 offset:3104
v_mul_f32 v41, v94, v41
v_mul_f32 v42, v94, v42
v_mul_f32 v43, v94, v43
v_mfma_f32_32x32x16_bf16 a[0:15], a[176:179], v[240:243], a[0:15]
ds_read_b64_tr_b16 a[172:173], v19 offset:4640
ds_read_b64_tr_b16 a[174:175], v20 offset:4640
s_waitcnt lgkmcnt(6)
v_cvt_pk_bf16_f32 v24, v24, v25
v_cvt_pk_bf16_f32 v25, v26, v27
v_cvt_pk_bf16_f32 v26, v28, v29
v_mfma_f32_32x32x16_bf16 a[0:15], a[180:183], v[244:247], a[0:15]
ds_read_b64_tr_b16 a[176:177], v19 offset:64
ds_read_b64_tr_b16 a[178:179], v20 offset:64
v_cvt_pk_bf16_f32 v27, v30, v31
v_cvt_pk_bf16_f32 v28, v32, v33
v_cvt_pk_bf16_f32 v29, v34, v35
v_mfma_f32_32x32x16_bf16 a[0:15], a[184:187], v[248:251], a[0:15]
ds_read_b64_tr_b16 a[180:181], v19 offset:1600
ds_read_b64_tr_b16 a[182:183], v20 offset:1600
v_cvt_pk_bf16_f32 v30, v36, v37
v_cvt_pk_bf16_f32 v31, v38, v39
v_cvt_pk_bf16_f32 v32, v40, v41
v_mfma_f32_32x32x16_bf16 a[0:15], a[188:191], v[252:255], a[0:15]
ds_read_b64_tr_b16 a[184:185], v19 offset:3136
ds_read_b64_tr_b16 a[186:187], v20 offset:3136
v_cvt_pk_bf16_f32 v33, v42, v43
v_cvt_pk_bf16_f32 v34, v72, v73
v_cvt_pk_bf16_f32 v35, v74, v75
v_mfma_f32_32x32x16_bf16 a[16:31], a[160:163], v[240:243], a[16:31]
ds_read_b64_tr_b16 a[188:189], v19 offset:4672
ds_read_b64_tr_b16 a[190:191], v20 offset:4672
s_waitcnt lgkmcnt(6)
v_cvt_pk_bf16_f32 v36, v76, v77
v_cvt_pk_bf16_f32 v37, v78, v79
v_cvt_pk_bf16_f32 v38, v80, v81
v_mfma_f32_32x32x16_bf16 a[16:31], a[164:167], v[244:247], a[16:31]
v_cvt_pk_bf16_f32 v39, v82, v83
v_cvt_pk_bf16_f32 v40, v84, v85
v_cvt_pk_bf16_f32 v41, v86, v87
v_mfma_f32_32x32x16_bf16 a[16:31], a[168:171], v[248:251], a[16:31]
v_cvt_pk_bf16_f32 v42, v88, v89
v_cvt_pk_bf16_f32 v43, v90, v91
v_max3_f32 v23, v44, v45, v46
v_mfma_f32_32x32x16_bf16 a[16:31], a[172:175], v[252:255], a[16:31]
v_min3_f32 v92, v44, v45, v46
v_max3_f32 v23, v23, v47, v48
v_min3_f32 v92, v92, v47, v48
v_mfma_f32_32x32x16_bf16 a[32:47], a[176:179], v[240:243], a[32:47]
s_waitcnt lgkmcnt(0)
v_max3_f32 v23, v23, v49, v50
v_min3_f32 v92, v92, v49, v50
v_max3_f32 v23, v23, v51, v52
v_mfma_f32_32x32x16_bf16 a[32:47], a[180:183], v[244:247], a[32:47]
v_min3_f32 v92, v92, v51, v52
v_max3_f32 v23, v23, v53, v54
v_min3_f32 v92, v92, v53, v54
v_mfma_f32_32x32x16_bf16 a[32:47], a[184:187], v[248:251], a[32:47]
v_max3_f32 v23, v23, v55, v56
v_min3_f32 v92, v92, v55, v56
v_max3_f32 v23, v23, v57, v58
v_mfma_f32_32x32x16_bf16 a[32:47], a[188:191], v[252:255], a[32:47]
v_min3_f32 v92, v92, v57, v58
v_max3_f32 v23, v23, v59, v60
v_min3_f32 v92, v92, v59, v60
s_barrier
v_accvgpr_read_b32 v112, a0
v_accvgpr_read_b32 v113, a1
v_accvgpr_read_b32 v114, a2
v_accvgpr_read_b32 v115, a3
v_accvgpr_read_b32 v116, a4
v_accvgpr_read_b32 v117, a5
v_accvgpr_read_b32 v118, a6
v_accvgpr_read_b32 v119, a7
v_accvgpr_read_b32 v120, a8
v_accvgpr_read_b32 v121, a9
v_accvgpr_read_b32 v122, a10
v_accvgpr_read_b32 v123, a11
v_accvgpr_read_b32 v124, a12
v_accvgpr_read_b32 v125, a13
v_accvgpr_read_b32 v126, a14
v_accvgpr_read_b32 v127, a15
v_max_f32 v112, 0, v112
v_max_f32 v113, 0, v113
v_max_f32 v114, 0, v114
v_max_f32 v115, 0, v115
v_max_f32 v116, 0, v116
v_max_f32 v117, 0, v117
v_max_f32 v118, 0, v118
v_max_f32 v119, 0, v119
v_mul_f32 v120, v112, v120
v_mul_f32 v121, v113, v121
v_mul_f32 v122, v114, v122
v_mul_f32 v123, v115, v123
v_mul_f32 v124, v116, v124
v_mul_f32 v125, v117, v125
v_mul_f32 v126, v118, v126
v_mul_f32 v127, v119, v127
v_cvt_pk_bf16_f32 v128, v120, v121
v_cvt_pk_bf16_f32 v129, v122, v123
v_cvt_pk_bf16_f32 v130, v124, v125
v_cvt_pk_bf16_f32 v131, v126, v127
s_nop 0
v_permlane16_swap_b32 v128, v130
v_permlane16_swap_b32 v129, v131
s_add_u32 s57, s22, 0xa00
buffer_store_dwordx2 v[128:129], v3, s[36:39], s57 offen sc1
s_add_u32 s57, s22, 0xca00
buffer_store_dwordx2 v[130:131], v3, s[36:39], s57 offen sc1
v_accvgpr_read_b32 v112, a16
v_accvgpr_read_b32 v113, a17
v_accvgpr_read_b32 v114, a18
v_accvgpr_read_b32 v115, a19
v_accvgpr_read_b32 v116, a20
v_accvgpr_read_b32 v117, a21
v_accvgpr_read_b32 v118, a22
v_accvgpr_read_b32 v119, a23
v_accvgpr_read_b32 v120, a24
v_accvgpr_read_b32 v121, a25
v_accvgpr_read_b32 v122, a26
v_accvgpr_read_b32 v123, a27
v_accvgpr_read_b32 v124, a28
v_accvgpr_read_b32 v125, a29
v_accvgpr_read_b32 v126, a30
v_accvgpr_read_b32 v127, a31
v_max_f32 v112, 0, v112
v_max_f32 v113, 0, v113
v_max_f32 v114, 0, v114
v_max_f32 v115, 0, v115
v_max_f32 v116, 0, v116
v_max_f32 v117, 0, v117
v_max_f32 v118, 0, v118
v_max_f32 v119, 0, v119
v_mul_f32 v120, v112, v120
v_mul_f32 v121, v113, v121
v_mul_f32 v122, v114, v122
v_mul_f32 v123, v115, v123
v_mul_f32 v124, v116, v124
v_mul_f32 v125, v117, v125
v_mul_f32 v126, v118, v126
v_mul_f32 v127, v119, v127
v_cvt_pk_bf16_f32 v128, v120, v121
v_cvt_pk_bf16_f32 v129, v122, v123
v_cvt_pk_bf16_f32 v130, v124, v125
v_cvt_pk_bf16_f32 v131, v126, v127
v_accvgpr_read_b32 v112, a32
v_accvgpr_read_b32 v113, a33
v_accvgpr_read_b32 v114, a34
v_accvgpr_read_b32 v115, a35
v_accvgpr_read_b32 v116, a36
v_accvgpr_read_b32 v117, a37
v_accvgpr_read_b32 v118, a38
v_accvgpr_read_b32 v119, a39
v_accvgpr_read_b32 v120, a40
v_accvgpr_read_b32 v121, a41
v_accvgpr_read_b32 v122, a42
v_accvgpr_read_b32 v123, a43
v_accvgpr_read_b32 v124, a44
v_accvgpr_read_b32 v125, a45
v_accvgpr_read_b32 v126, a46
v_accvgpr_read_b32 v127, a47
v_max_f32 v112, 0, v112
v_max_f32 v113, 0, v113
v_max_f32 v114, 0, v114
v_max_f32 v115, 0, v115
v_max_f32 v116, 0, v116
v_max_f32 v117, 0, v117
v_max_f32 v118, 0, v118
v_max_f32 v119, 0, v119
v_mul_f32 v120, v112, v120
v_mul_f32 v121, v113, v121
v_mul_f32 v122, v114, v122
v_mul_f32 v123, v115, v123
v_mul_f32 v124, v116, v124
v_mul_f32 v125, v117, v125
v_mul_f32 v126, v118, v126
v_mul_f32 v127, v119, v127
v_cvt_pk_bf16_f32 v132, v120, v121
v_cvt_pk_bf16_f32 v133, v122, v123
v_cvt_pk_bf16_f32 v134, v124, v125
v_cvt_pk_bf16_f32 v135, v126, v127
v_permlane16_swap_b32 v128, v132
v_permlane16_swap_b32 v129, v133
v_permlane16_swap_b32 v130, v134
v_permlane16_swap_b32 v131, v135
s_add_u32 s57, s22, 0xc00
buffer_store_dwordx4 v[128:131], v2, s[36:39], s57 offen sc1
s_add_u32 s57, s22, 0xcc00
buffer_store_dwordx4 v[132:135], v2, s[36:39], s57 offen sc1
s_and_b32 s85, s2, 7
s_lshr_b32 s86, s2, 3
s_lshr_b32 s43, s85, 1
s_lshl_b32 s43, s43, 3
s_and_b32 s87, s86, 7
s_add_u32 s43, s43, s87
s_and_b32 s23, s85, 1
s_lshl_b32 s23, s23, 2
s_lshr_b32 s88, s86, 3
s_add_u32 s23, s23, s88
s_mul_i32 s88, s88, 3
s_add_u32 s80, s88, s87
s_add_u32 s85, s80, 0
s_and_b32 s76, s85, 3
s_lshr_b32 s86, s76, 1
s_mul_i32 s86, s86, 4
s_add_u32 s86, s86, s76
s_add_u32 s86, s86, 4
s_lshl_b32 s64, s86, 10
s_add_u32 s85, s80, 1
s_and_b32 s77, s85, 3
s_lshr_b32 s86, s77, 1
s_mul_i32 s86, s86, 4
s_add_u32 s86, s86, s77
s_add_u32 s86, s86, 4
s_lshl_b32 s65, s86, 10
s_add_u32 s85, s80, 2
s_and_b32 s78, s85, 3
s_lshr_b32 s86, s78, 1
s_mul_i32 s86, s86, 4
s_add_u32 s86, s86, s78
s_add_u32 s86, s86, 4
s_lshl_b32 s66, s86, 10
s_add_u32 s85, s80, 3
s_and_b32 s79, s85, 3
s_lshr_b32 s86, s79, 1
s_mul_i32 s86, s86, 4
s_add_u32 s86, s86, s79
s_add_u32 s86, s86, 4
s_lshl_b32 s67, s86, 10
s_lshl_b32 s85, s43, 5
s_lshl_b32 s86, s52, 1
s_add_u32 s85, s85, s86
s_mul_i32 s28, s85, 0x1800
s_mul_i32 s29, s85, 0xa00
s_add_u32 s29, s29, 0x600000
s_mul_i32 s30, s52, 0x2a8
s_mul_i32 s86, s23, 5
s_add_u32 s30, s30, s86
s_lshl_b32 s30, s30, 10
s_add_u32 s30, s30, 0x880000
s_lshl_b32 s85, s43, 3
s_lshl_b32 s86, s52, 1
s_add_u32 s85, s85, s86
s_lshl_b32 s42, s85, 3
s_add_u32 s42, s42, 0xb4f400
s_lshl_b32 s85, s43, 2
s_add_u32 s85, s85, s52
s_lshl_b32 s85, s85, 7
s_add_u32 s31, s85, 0xb46000
s_add_u32 s40, s85, 0xb4a000
s_mul_i32 s85, s23, 0x50
s_lshr_b32 s85, s85, 6
s_mul_i32 s86, s52, 10
s_add_u32 s85, s85, s86
s_lshl_b32 s41, s85, 7
s_add_u32 s41, s41, 0xb4e000
v_and_b32 v105, 31, v1
v_min_u32 v105, 16, v105
v_lshrrev_b32 v104, 5, v1
v_lshlrev_b32 v104, 7, v104
v_lshl_add_u32 v105, v105, 2, v104
buffer_load_dword v104, v105, s[36:39], s41 offen sc1
v_and_b32 v107, 3, v1
v_lshlrev_b32 v107, 2, v107
buffer_load_dword v106, v107, s[36:39], s42 offen sc1
v_add_u32 v9, 0, v3
v_add_u32 v13, 0, v2
v_add_u32 v17, 0, v3
v_add_u32 v10, 0xc000, v3
v_add_u32 v14, 0x5000, v2
v_add_u32 v18, 0x5000, v3
v_add_u32 v11, 0x18000, v3
v_add_u32 v15, 0xa000, v2
v_add_u32 v19, 0xa000, v3
v_add_u32 v12, 0x24000, v3
v_add_u32 v16, 0xf000, v2
v_add_u32 v20, 0xf000, v3
v_mov_b32 v160, 0
v_mov_b32 v161, 0
v_mov_b32 v162, 0
v_mov_b32 v163, 0
v_add_u32 v204, 0x1e00, v2
ds_write_b128 v204, v[160:163] offset:0
ds_write_b128 v204, v[160:163] offset:1024
ds_write_b128 v204, v[160:163] offset:2048
ds_write_b128 v204, v[160:163] offset:3072
s_mul_i32 s16, s52, 0x780
v_add_u32 v206, s16, v4
v_lshrrev_b32 v204, 5, v1
v_bfe_u32 v205, v1, 2, 1
v_cmp_eq_u32 vcc, v204, v205
v_mul_u32_u24 v204, 0xf00, v204
v_bfe_u32 v205, v1, 3, 2
v_lshlrev_b32 v205, 2, v205
v_and_b32 v207, 3, v1
v_add_u32 v205, v205, v207
v_mul_u32_u24 v205, 0x50, v205
v_add_u32 v204, v204, v205
v_mov_b32 v205, 0x1e00
v_cndmask_b32 v207, v205, v204, vcc
s_waitcnt vmcnt(2)
s_lshl_b32 s57, s53, 1
s_lshr_b32 s58, s52, 1
s_add_u32 s57, s57, s58
s_lshl_b32 s57, s57, 2
s_lshr_b32 s58, s54, 1
s_add_u32 s57, s57, s58
s_lshl_b32 s57, s57, 5
s_and_b32 s58, s54, 1
s_lshl_b32 s58, s58, 2
s_add_u32 s57, s57, s58
s_and_b32 s58, s52, 1
s_add_u32 s57, s57, s58
s_add_u32 s57, s57, 2
s_lshl_b32 s57, s57, 2
s_add_u32 s57, s57, 0xb46000
v_mov_b32 v136, 1
s_mov_b64 exec, 1
buffer_store_dword v136, off, s[36:39], s57 sc1
s_mov_b64 exec, -1
v_max3_f32 v23, v23, v61, v62
v_min3_f32 v92, v92, v61, v62
v_max_f32 v23, v23, v63
v_min_f32 v92, v92, v63
v_mul_f32 v23, s62, v23
v_mul_f32 v92, s62, v92
v_fma_f32 v72, v44, s62, -v23
v_fma_f32 v44, -v44, s62, v92
v_fma_f32 v73, v45, s62, -v23
v_fma_f32 v45, -v45, s62, v92
v_fma_f32 v74, v46, s62, -v23
v_fma_f32 v46, -v46, s62, v92
v_fma_f32 v75, v47, s62, -v23
v_fma_f32 v47, -v47, s62, v92
v_fma_f32 v76, v48, s62, -v23
v_fma_f32 v48, -v48, s62, v92
v_fma_f32 v77, v49, s62, -v23
v_fma_f32 v49, -v49, s62, v92
v_fma_f32 v78, v50, s62, -v23
v_fma_f32 v50, -v50, s62, v92
v_fma_f32 v79, v51, s62, -v23
v_fma_f32 v51, -v51, s62, v92
v_fma_f32 v80, v52, s62, -v23
v_fma_f32 v52, -v52, s62, v92
v_fma_f32 v81, v53, s62, -v23
v_fma_f32 v53, -v53, s62, v92
v_fma_f32 v82, v54, s62, -v23
v_fma_f32 v54, -v54, s62, v92
v_fma_f32 v83, v55, s62, -v23
v_fma_f32 v55, -v55, s62, v92
v_fma_f32 v84, v56, s62, -v23
v_fma_f32 v56, -v56, s62, v92
v_fma_f32 v85, v57, s62, -v23
v_fma_f32 v57, -v57, s62, v92
v_fma_f32 v86, v58, s62, -v23
v_fma_f32 v58, -v58, s62, v92
v_fma_f32 v87, v59, s62, -v23
v_fma_f32 v59, -v59, s62, v92
v_fma_f32 v88, v60, s62, -v23
v_fma_f32 v60, -v60, s62, v92
v_fma_f32 v89, v61, s62, -v23
v_fma_f32 v61, -v61, s62, v92
v_fma_f32 v90, v62, s62, -v23
v_fma_f32 v62, -v62, s62, v92
v_fma_f32 v91, v63, s62, -v23
v_fma_f32 v63, -v63, s62, v92
v_exp_f32 v72, v72
v_exp_f32 v44, v44
v_exp_f32 v73, v73
v_exp_f32 v45, v45
v_exp_f32 v74, v74
v_exp_f32 v46, v46
v_exp_f32 v75, v75
v_exp_f32 v47, v47
v_exp_f32 v76, v76
v_exp_f32 v48, v48
v_exp_f32 v77, v77
v_exp_f32 v49, v49
v_exp_f32 v78, v78
v_exp_f32 v50, v50
v_exp_f32 v79, v79
v_exp_f32 v51, v51
v_exp_f32 v80, v80
v_exp_f32 v52, v52
v_exp_f32 v81, v81
v_exp_f32 v53, v53
v_exp_f32 v82, v82
v_exp_f32 v54, v54
v_exp_f32 v83, v83
v_exp_f32 v55, v55
v_exp_f32 v84, v84
v_exp_f32 v56, v56
v_exp_f32 v85, v85
v_exp_f32 v57, v57
v_exp_f32 v86, v86
v_exp_f32 v58, v58
v_exp_f32 v87, v87
v_exp_f32 v59, v59
v_exp_f32 v88, v88
v_exp_f32 v60, v60
v_exp_f32 v89, v89
v_exp_f32 v61, v61
v_exp_f32 v90, v90
v_exp_f32 v62, v62
v_exp_f32 v91, v91
v_exp_f32 v63, v63
v_add_f32 v93, v72, v73
v_add_f32 v94, v44, v45
v_add_f32 v23, v74, v75
v_add_f32 v92, v46, v47
v_add_f32 v93, v93, v76
v_add_f32 v94, v94, v48
v_add_f32 v23, v23, v77
v_add_f32 v92, v92, v49
v_add_f32 v93, v93, v78
v_add_f32 v94, v94, v50
v_add_f32 v23, v23, v79
v_add_f32 v92, v92, v51
v_add_f32 v93, v93, v80
v_add_f32 v94, v94, v52
v_add_f32 v23, v23, v81
v_add_f32 v92, v92, v53
v_add_f32 v93, v93, v82
v_add_f32 v94, v94, v54
v_add_f32 v23, v23, v83
v_add_f32 v92, v92, v55
v_add_f32 v93, v93, v84
v_add_f32 v94, v94, v56
v_add_f32 v23, v23, v85
v_add_f32 v92, v92, v57
v_add_f32 v93, v93, v86
v_add_f32 v94, v94, v58
v_add_f32 v23, v23, v87
v_add_f32 v92, v92, v59
v_add_f32 v93, v93, v88
v_add_f32 v94, v94, v60
v_add_f32 v23, v23, v89
v_add_f32 v92, v92, v61
v_add_f32 v93, v93, v90
v_add_f32 v94, v94, v62
v_add_f32 v23, v23, v91
v_add_f32 v92, v92, v63
v_add_f32 v93, v93, v23
v_add_f32 v94, v94, v92
v_rcp_f32 v93, v93
v_rcp_f32 v94, v94
v_mul_f32 v72, v93, v72
v_mul_f32 v73, v93, v73
v_mul_f32 v74, v93, v74
v_mul_f32 v75, v93, v75
v_mul_f32 v76, v93, v76
v_mul_f32 v77, v93, v77
v_mul_f32 v78, v93, v78
v_mul_f32 v79, v93, v79
v_mul_f32 v80, v93, v80
v_mul_f32 v81, v93, v81
v_mul_f32 v82, v93, v82
v_mul_f32 v83, v93, v83
v_mul_f32 v84, v93, v84
v_mul_f32 v85, v93, v85
v_mul_f32 v86, v93, v86
v_mul_f32 v87, v93, v87
v_mul_f32 v88, v93, v88
v_mul_f32 v89, v93, v89
v_mul_f32 v90, v93, v90
v_mul_f32 v91, v93, v91
v_mul_f32 v44, v94, v44
v_mul_f32 v45, v94, v45
v_mul_f32 v46, v94, v46
v_mul_f32 v47, v94, v47
v_mul_f32 v48, v94, v48
v_mul_f32 v49, v94, v49
v_mul_f32 v50, v94, v50
v_mul_f32 v51, v94, v51
v_mul_f32 v52, v94, v52
v_mul_f32 v53, v94, v53
v_mul_f32 v54, v94, v54
v_mul_f32 v55, v94, v55
v_mul_f32 v56, v94, v56
v_mul_f32 v57, v94, v57
v_mul_f32 v58, v94, v58
v_mul_f32 v59, v94, v59
v_mul_f32 v60, v94, v60
v_mul_f32 v61, v94, v61
v_mul_f32 v62, v94, v62
v_mul_f32 v63, v94, v63
v_cvt_pk_bf16_f32 v44, v44, v45
v_cvt_pk_bf16_f32 v45, v46, v47
v_cvt_pk_bf16_f32 v46, v48, v49
v_cvt_pk_bf16_f32 v47, v50, v51
v_cvt_pk_bf16_f32 v48, v52, v53
v_cvt_pk_bf16_f32 v49, v54, v55
v_cvt_pk_bf16_f32 v50, v56, v57
v_cvt_pk_bf16_f32 v51, v58, v59
v_cvt_pk_bf16_f32 v52, v60, v61
v_cvt_pk_bf16_f32 v53, v62, v63
v_cvt_pk_bf16_f32 v54, v72, v73
v_cvt_pk_bf16_f32 v55, v74, v75
v_cvt_pk_bf16_f32 v56, v76, v77
v_cvt_pk_bf16_f32 v57, v78, v79
v_cvt_pk_bf16_f32 v58, v80, v81
v_cvt_pk_bf16_f32 v59, v82, v83
v_cvt_pk_bf16_f32 v60, v84, v85
v_cvt_pk_bf16_f32 v61, v86, v87
v_cvt_pk_bf16_f32 v62, v88, v89
v_cvt_pk_bf16_f32 v63, v90, v91
v_add_u32 v5, 0, v2
v_add_u32 v6, 0xc000, v2
v_add_u32 v7, 0x18000, v2
v_add_u32 v8, 0x24000, v2
v_add_u32 v21, 0x1000, v2
s_waitcnt vmcnt(2)
v_cmp_eq_u32 vcc, 1, v104
s_nop 3
s_cmp_eq_u64 vcc, -1
s_cbranch_scc1 Y_fw_ok
s_mov_b32 s60, 0
Y_fw_spin:
s_add_u32 s60, s60, 1
s_cmp_ge_u32 s60, 0x40000
s_cbranch_scc1 Y_fw_ok
s_sleep 16
buffer_load_dword v104, v105, s[36:39], s41 offen offset:0 sc1
s_waitcnt vmcnt(0)
v_cmp_eq_u32 vcc, 1, v104
s_nop 3
s_cmp_eq_u64 vcc, -1
s_cbranch_scc0 Y_fw_spin
Y_fw_ok:
s_waitcnt vmcnt(1)
v_cmp_eq_u32 vcc, 1, v106
s_nop 3
s_cmp_eq_u64 vcc, -1
s_cbranch_scc1 Y_fe_ok
s_mov_b32 s60, 0
Y_fe_spin:
s_add_u32 s60, s60, 1
s_cmp_ge_u32 s60, 0x40000
s_cbranch_scc1 Y_fe_ok
s_sleep 16
buffer_load_dword v106, v107, s[36:39], s42 offen offset:0 sc1
s_waitcnt vmcnt(0)
v_cmp_eq_u32 vcc, 1, v106
s_nop 3
s_cmp_eq_u64 vcc, -1
s_cbranch_scc0 Y_fe_spin
Y_fe_ok:
s_add_u32 s83, s64, s28
buffer_load_dwordx4 a[160:163], v5, s[36:39], s83 offen sc1
buffer_load_dwordx4 a[164:167], v6, s[36:39], s83 offen sc1
buffer_load_dwordx4 a[168:171], v7, s[36:39], s83 offen sc1
buffer_load_dwordx4 a[172:175], v8, s[36:39], s83 offen sc1
s_mul_i32 s84, s64, 40
s_add_u32 s84, s84, s30
buffer_load_dwordx4 a[176:179], v2, s[36:39], s84 offen offset:0 sc1
buffer_load_dwordx4 a[180:183], v2, s[36:39], s84 offen offset:1024 sc1
buffer_load_dwordx4 a[184:187], v2, s[36:39], s84 offen offset:2048 sc1
buffer_load_dwordx4 a[188:191], v2, s[36:39], s84 offen offset:3072 sc1
buffer_load_dwordx4 a[192:195], v21, s[36:39], s84 offen offset:0 sc1
s_add_u32 s85, s65, s28
buffer_load_dwordx4 a[196:199], v5, s[36:39], s85 offen sc1
buffer_load_dwordx4 a[200:203], v6, s[36:39], s85 offen sc1
buffer_load_dwordx4 a[204:207], v7, s[36:39], s85 offen sc1
buffer_load_dwordx4 a[208:211], v8, s[36:39], s85 offen sc1
s_mul_i32 s86, s65, 40
s_add_u32 s86, s86, s30
buffer_load_dwordx4 a[212:215], v2, s[36:39], s86 offen offset:0 sc1
buffer_load_dwordx4 a[216:219], v2, s[36:39], s86 offen offset:1024 sc1
buffer_load_dwordx4 a[220:223], v2, s[36:39], s86 offen offset:2048 sc1
buffer_load_dwordx4 a[224:227], v2, s[36:39], s86 offen offset:3072 sc1
buffer_load_dwordx4 a[228:231], v21, s[36:39], s86 offen offset:0 sc1
s_add_u32 s87, s66, s28
buffer_load_dwordx4 a[232:235], v5, s[36:39], s87 offen sc1
buffer_load_dwordx4 a[236:239], v6, s[36:39], s87 offen sc1
buffer_load_dwordx4 a[240:243], v7, s[36:39], s87 offen sc1
buffer_load_dwordx4 a[244:247], v8, s[36:39], s87 offen sc1
s_mul_i32 s88, s66, 40
s_add_u32 s88, s88, s30
buffer_load_dwordx4 a[248:251], v2, s[36:39], s88 offen offset:0 sc1
buffer_load_dwordx4 a[252:255], v2, s[36:39], s88 offen offset:1024 sc1
buffer_load_dwordx4 a[80:83], v2, s[36:39], s88 offen offset:2048 sc1
buffer_load_dwordx4 a[84:87], v2, s[36:39], s88 offen offset:3072 sc1
buffer_load_dwordx4 a[88:91], v21, s[36:39], s88 offen offset:0 sc1
s_mul_i32 s4, s80, 43
s_lshr_b32 s4, s4, 8
s_mul_i32 s4, s4, 6
s_sub_u32 s4, s80, s4
s_cmp_ge_u32 s4, 3
s_cselect_b32 s5, 3, 0
s_sub_u32 s6, s4, s5
s_lshl_b32 s5, s5, 1
s_add_u32 s5, s5, s6
s_cmp_ge_u32 s6, 2
s_cselect_b32 s6, 1, 0
s_add_u32 s5, s5, s6
s_lshl_b32 s68, s5, 10
s_add_u32 s4, s4, 1
s_cmp_eq_u32 s4, 6
s_cselect_b32 s4, 0, s4
s_cmp_ge_u32 s4, 3
s_cselect_b32 s5, 3, 0
s_sub_u32 s6, s4, s5
s_lshl_b32 s5, s5, 1
s_add_u32 s5, s5, s6
s_cmp_ge_u32 s6, 2
s_cselect_b32 s6, 1, 0
s_add_u32 s5, s5, s6
s_lshl_b32 s69, s5, 10
s_add_u32 s4, s4, 1
s_cmp_eq_u32 s4, 6
s_cselect_b32 s4, 0, s4
s_cmp_ge_u32 s4, 3
s_cselect_b32 s5, 3, 0
s_sub_u32 s6, s4, s5
s_lshl_b32 s5, s5, 1
s_add_u32 s5, s5, s6
s_cmp_ge_u32 s6, 2
s_cselect_b32 s6, 1, 0
s_add_u32 s5, s5, s6
s_lshl_b32 s71, s5, 10
s_add_u32 s4, s4, 1
s_cmp_eq_u32 s4, 6
s_cselect_b32 s4, 0, s4
s_cmp_ge_u32 s4, 3
s_cselect_b32 s5, 3, 0
s_sub_u32 s6, s4, s5
s_lshl_b32 s5, s5, 1
s_add_u32 s5, s5, s6
s_cmp_ge_u32 s6, 2
s_cselect_b32 s6, 1, 0
s_add_u32 s5, s5, s6
s_lshl_b32 s72, s5, 10
s_add_u32 s4, s4, 1
s_cmp_eq_u32 s4, 6
s_cselect_b32 s4, 0, s4
s_cmp_ge_u32 s4, 3
s_cselect_b32 s5, 3, 0
s_sub_u32 s6, s4, s5
s_lshl_b32 s5, s5, 1
s_add_u32 s5, s5, s6
s_cmp_ge_u32 s6, 2
s_cselect_b32 s6, 1, 0
s_add_u32 s5, s5, s6
s_lshl_b32 s73, s5, 10
s_add_u32 s4, s4, 1
s_cmp_eq_u32 s4, 6
s_cselect_b32 s4, 0, s4
s_cmp_ge_u32 s4, 3
s_cselect_b32 s5, 3, 0
s_sub_u32 s6, s4, s5
s_lshl_b32 s5, s5, 1
s_add_u32 s5, s5, s6
s_cmp_ge_u32 s6, 2
s_cselect_b32 s6, 1, 0
s_add_u32 s5, s5, s6
s_lshl_b32 s75, s5, 10
s_and_b32 s4, s80, 1
s_mul_i32 s5, s4, 0x1800
s_add_u32 s70, s5, 0x800
s_sub_u32 s74, 0x2000, s5
s_mov_b32 s44, s94
s_mov_b32 s45, s95
s_mov_b32 s46, 0x280000
s_mov_b32 s47, 0x20000
v_and_b32 v23, 7, v1
v_lshlrev_b32 v23, 2, v23
buffer_load_dword v22, v23, s[36:39], s31 offen sc1
v_and_b32 v203, 15, v1
v_lshlrev_b32 v203, 2, v203
s_lshl_b32 s16, s54, 2
s_add_u32 s16, s16, s52
s_lshl_b32 s16, s16, 6
s_add_u32 s16, s16, 0xb4fc00
buffer_load_dword v202, v203, s[36:39], s16 offen sc1
s_waitcnt vmcnt(24)
v_mfma_f32_16x16x32_bf16 a[0:3], a[176:179], a[160:163], 0
v_mfma_f32_16x16x32_bf16 a[20:23], a[176:179], a[164:167], 0
s_add_u32 s89, s67, s28
buffer_load_dwordx4 a[92:95], v5, s[36:39], s89 offen sc1
v_mfma_f32_16x16x32_bf16 a[40:43], a[176:179], a[168:171], 0
v_mfma_f32_16x16x32_bf16 a[60:63], a[176:179], a[172:175], 0
buffer_load_dwordx4 a[96:99], v6, s[36:39], s89 offen sc1
s_waitcnt vmcnt(25)
v_mfma_f32_16x16x32_bf16 a[4:7], a[180:183], a[160:163], 0
v_mfma_f32_16x16x32_bf16 a[24:27], a[180:183], a[164:167], 0
buffer_load_dwordx4 a[100:103], v7, s[36:39], s89 offen sc1
v_mfma_f32_16x16x32_bf16 a[44:47], a[180:183], a[168:171], 0
v_mfma_f32_16x16x32_bf16 a[64:67], a[180:183], a[172:175], 0
buffer_load_dwordx4 a[104:107], v8, s[36:39], s89 offen sc1
s_waitcnt vmcnt(26)
v_mfma_f32_16x16x32_bf16 a[8:11], a[184:187], a[160:163], 0
v_mfma_f32_16x16x32_bf16 a[28:31], a[184:187], a[164:167], 0
s_mul_i32 s82, s67, 40
s_add_u32 s82, s82, s30
buffer_load_dwordx4 a[108:111], v2, s[36:39], s82 offen offset:0 sc1
v_mfma_f32_16x16x32_bf16 a[48:51], a[184:187], a[168:171], 0
v_mfma_f32_16x16x32_bf16 a[68:71], a[184:187], a[172:175], 0
buffer_load_dwordx4 a[112:115], v2, s[36:39], s82 offen offset:1024 sc1
s_waitcnt vmcnt(27)
v_mfma_f32_16x16x32_bf16 a[12:15], a[188:191], a[160:163], 0
v_mfma_f32_16x16x32_bf16 a[32:35], a[188:191], a[164:167], 0
buffer_load_dwordx4 a[116:119], v2, s[36:39], s82 offen offset:2048 sc1
v_mfma_f32_16x16x32_bf16 a[52:55], a[188:191], a[168:171], 0
v_mfma_f32_16x16x32_bf16 a[72:75], a[188:191], a[172:175], 0
buffer_load_dwordx4 a[120:123], v2, s[36:39], s82 offen offset:3072 sc1
s_waitcnt vmcnt(28)
v_mfma_f32_16x16x32_bf16 a[16:19], a[192:195], a[160:163], 0
v_mfma_f32_16x16x32_bf16 a[36:39], a[192:195], a[164:167], 0
buffer_load_dwordx4 a[124:127], v21, s[36:39], s82 offen offset:0 sc1
v_mfma_f32_16x16x32_bf16 a[56:59], a[192:195], a[168:171], 0
v_mfma_f32_16x16x32_bf16 a[76:79], a[192:195], a[172:175], 0
s_waitcnt vmcnt(10)
v_cmp_eq_u32 vcc, 1, v22
s_nop 3
s_cmp_eq_u64 vcc, -1
s_cbranch_scc1 Y_fh_ok
s_mov_b32 s60, 0
Y_fh_spin:
s_add_u32 s60, s60, 1
s_cmp_ge_u32 s60, 0x40000
s_cbranch_scc1 Y_fh_ok
s_sleep 16
buffer_load_dword v22, v23, s[36:39], s31 offen offset:0 sc1
s_waitcnt vmcnt(0)
v_cmp_eq_u32 vcc, 1, v22
s_nop 3
s_cmp_eq_u64 vcc, -1
s_cbranch_scc0 Y_fh_spin
Y_fh_ok:
s_waitcnt vmcnt(9)
v_cmp_eq_u32 vcc, 1, v202
s_nop 3
s_cmp_eq_u64 vcc, -1
s_cbranch_scc1 Y_kc_ok
s_mov_b32 s60, 0
Y_kc_spin:
s_add_u32 s60, s60, 1
s_cmp_ge_u32 s60, 0x40000
s_cbranch_scc1 Y_kc_ok
s_sleep 20
buffer_load_dword v202, v203, s[36:39], s16 offen offset:0 sc1
s_waitcnt vmcnt(0)
v_cmp_eq_u32 vcc, 1, v202
s_nop 3
s_cmp_eq_u64 vcc, -1
s_cbranch_scc0 Y_kc_spin
Y_kc_ok:
s_lshl_b32 s16, s54, 2
s_add_u32 s16, s16, s52
s_mul_i32 s16, s16, 0xf00
s_add_u32 s16, s16, 0xb28000
buffer_load_dwordx2 v[96:97], v3, s[36:39], s16 offen offset:0 sc1
buffer_load_dwordx2 v[98:99], v3, s[36:39], s16 offen offset:512 sc1
buffer_load_dwordx2 v[100:101], v3, s[36:39], s16 offen offset:1024 sc1
buffer_load_dwordx2 v[102:103], v3, s[36:39], s16 offen offset:1536 sc1
buffer_load_dwordx2 v[104:105], v3, s[36:39], s16 offen offset:2048 sc1
buffer_load_dwordx2 v[106:107], v3, s[36:39], s16 offen offset:2560 sc1
buffer_load_dwordx2 v[108:109], v3, s[36:39], s16 offen offset:3072 sc1
s_waitcnt vmcnt(6)
v_cvt_pk_bf16_f32 v96, v96, v97
s_waitcnt vmcnt(5)
v_cvt_pk_bf16_f32 v98, v98, v99
s_waitcnt vmcnt(4)
v_cvt_pk_bf16_f32 v100, v100, v101
s_waitcnt vmcnt(3)
v_cvt_pk_bf16_f32 v102, v102, v103
s_waitcnt vmcnt(2)
v_cvt_pk_bf16_f32 v104, v104, v105
s_waitcnt vmcnt(1)
v_cvt_pk_bf16_f32 v106, v106, v107
s_waitcnt vmcnt(0)
v_cvt_pk_bf16_f32 v108, v108, v109
ds_write_b32 v206, v96 offset:0
ds_write_b32 v206, v98 offset:256
ds_write_b32 v206, v100 offset:512
ds_write_b32 v206, v102 offset:768
ds_write_b32 v206, v104 offset:1024
ds_write_b32 v206, v106 offset:1280
s_add_u32 s83, s68, s28
buffer_load_dwordx4 a[160:163], v5, s[36:39], s83 offen sc1
ds_write_b32 v206, v108 offset:1536
s_waitcnt lgkmcnt(0)
s_barrier
ds_read_b128 v[120:123], v207 offset:0
ds_read_b128 v[124:127], v207 offset:16
ds_read_b128 v[128:131], v207 offset:32
ds_read_b128 v[132:135], v207 offset:48
ds_read_b128 v[136:139], v207 offset:64
ds_read_b128 v[140:143], v207 offset:1280
s_waitcnt lgkmcnt(5)
v_mfma_f32_32x32x16_bf16 v[152:167], v[120:123], v[24:27], 0
ds_read_b128 v[144:147], v207 offset:1296
s_waitcnt lgkmcnt(5)
v_mfma_f32_32x32x16_bf16 v[152:167], v[124:127], v[28:31], v[152:167]
ds_read_b128 v[148:151], v207 offset:1312
s_waitcnt lgkmcnt(5)
v_mfma_f32_32x32x16_bf16 v[152:167], v[128:131], v[32:35], v[152:167]
buffer_load_dwordx4 a[164:167], v6, s[36:39], s83 offen sc1
ds_read_b128 v[120:123], v207 offset:1328
s_waitcnt lgkmcnt(5)
v_mfma_f32_32x32x16_bf16 v[152:167], v[132:135], v[36:39], v[152:167]
ds_read_b128 v[124:127], v207 offset:1344
s_waitcnt lgkmcnt(5)
v_mfma_f32_32x32x16_bf16 v[152:167], v[136:139], v[40:43], v[152:167]
s_waitcnt lgkmcnt(4)
v_mfma_f32_32x32x16_bf16 v[168:183], v[140:143], v[24:27], 0
s_waitcnt lgkmcnt(3)
v_mfma_f32_32x32x16_bf16 v[168:183], v[144:147], v[28:31], v[168:183]
s_waitcnt lgkmcnt(2)
v_mfma_f32_32x32x16_bf16 v[168:183], v[148:151], v[32:35], v[168:183]
s_waitcnt lgkmcnt(1)
v_mfma_f32_32x32x16_bf16 v[168:183], v[120:123], v[36:39], v[168:183]
s_waitcnt lgkmcnt(0)
v_mfma_f32_32x32x16_bf16 v[168:183], v[124:127], v[40:43], v[168:183]
s_nop 11
v_add_f32 v204, 0x358637bd, v172
v_rcp_f32 v204, v204
s_nop 0
v_mul_f32 v152, v204, v152
v_mul_f32 v153, v204, v153
buffer_load_dwordx4 a[168:171], v7, s[36:39], s83 offen sc1
v_mul_f32 v154, v204, v154
v_mul_f32 v155, v204, v155
v_mul_f32 v156, v204, v156
v_mul_f32 v157, v204, v157
v_mul_f32 v158, v204, v158
v_mul_f32 v159, v204, v159
v_mul_f32 v160, v204, v160
v_mul_f32 v161, v204, v161
v_mul_f32 v162, v204, v162
v_mul_f32 v163, v204, v163
v_mul_f32 v164, v204, v164
v_mul_f32 v165, v204, v165
v_mul_f32 v166, v204, v166
buffer_load_dwordx4 a[172:175], v8, s[36:39], s83 offen sc1
v_mul_f32 v167, v204, v167
v_mul_f32 v168, v204, v168
v_mul_f32 v169, v204, v169
v_mul_f32 v170, v204, v170
v_mul_f32 v171, v204, v171
v_cvt_pk_bf16_f32 v184, v152, v153
v_cvt_pk_bf16_f32 v185, v154, v155
v_cvt_pk_bf16_f32 v186, v156, v157
v_cvt_pk_bf16_f32 v187, v158, v159
v_cvt_pk_bf16_f32 v188, v160, v161
v_cvt_pk_bf16_f32 v189, v162, v163
v_cvt_pk_bf16_f32 v190, v164, v165
v_cvt_pk_bf16_f32 v191, v166, v167
s_mul_i32 s84, s68, 40
s_add_u32 s84, s84, s30
buffer_load_dwordx4 a[176:179], v2, s[36:39], s84 offen offset:0 sc1
v_cvt_pk_bf16_f32 v192, v168, v169
v_cvt_pk_bf16_f32 v193, v170, v171
ds_read_b128 v[120:123], v207 offset:1920
ds_read_b128 v[124:127], v207 offset:1936
ds_read_b128 v[128:131], v207 offset:1952
ds_read_b128 v[132:135], v207 offset:1968
ds_read_b128 v[136:139], v207 offset:1984
ds_read_b128 v[140:143], v207 offset:3200
s_waitcnt lgkmcnt(5)
v_mfma_f32_32x32x16_bf16 v[152:167], v[120:123], v[44:47], 0
ds_read_b128 v[144:147], v207 offset:3216
s_waitcnt lgkmcnt(5)
v_mfma_f32_32x32x16_bf16 v[152:167], v[124:127], v[48:51], v[152:167]
ds_read_b128 v[148:151], v207 offset:3232
s_waitcnt lgkmcnt(5)
v_mfma_f32_32x32x16_bf16 v[152:167], v[128:131], v[52:55], v[152:167]
buffer_load_dwordx4 a[180:183], v2, s[36:39], s84 offen offset:1024 sc1
ds_read_b128 v[120:123], v207 offset:3248
s_waitcnt lgkmcnt(5)
v_mfma_f32_32x32x16_bf16 v[152:167], v[132:135], v[56:59], v[152:167]
ds_read_b128 v[124:127], v207 offset:3264
s_waitcnt lgkmcnt(5)
v_mfma_f32_32x32x16_bf16 v[152:167], v[136:139], v[60:63], v[152:167]
s_waitcnt lgkmcnt(4)
v_mfma_f32_32x32x16_bf16 v[168:183], v[140:143], v[44:47], 0
s_waitcnt lgkmcnt(3)
v_mfma_f32_32x32x16_bf16 v[168:183], v[144:147], v[48:51], v[168:183]
s_waitcnt lgkmcnt(2)
v_mfma_f32_32x32x16_bf16 v[168:183], v[148:151], v[52:55], v[168:183]
s_waitcnt lgkmcnt(1)
v_mfma_f32_32x32x16_bf16 v[168:183], v[120:123], v[56:59], v[168:183]
s_waitcnt lgkmcnt(0)
v_mfma_f32_32x32x16_bf16 v[168:183], v[124:127], v[60:63], v[168:183]
s_nop 11
v_add_f32 v204, 0x358637bd, v172
v_rcp_f32 v204, v204
s_nop 0
v_mul_f32 v152, v204, v152
v_mul_f32 v153, v204, v153
buffer_load_dwordx4 a[184:187], v2, s[36:39], s84 offen offset:2048 sc1
v_mul_f32 v154, v204, v154
v_mul_f32 v155, v204, v155
v_mul_f32 v156, v204, v156
v_mul_f32 v157, v204, v157
v_mul_f32 v158, v204, v158
v_mul_f32 v159, v204, v159
v_mul_f32 v160, v204, v160
v_mul_f32 v161, v204, v161
v_mul_f32 v162, v204, v162
v_mul_f32 v163, v204, v163
v_mul_f32 v164, v204, v164
v_mul_f32 v165, v204, v165
v_mul_f32 v166, v204, v166
buffer_load_dwordx4 a[188:191], v2, s[36:39], s84 offen offset:3072 sc1
v_mul_f32 v167, v204, v167
v_mul_f32 v168, v204, v168
v_mul_f32 v169, v204, v169
v_mul_f32 v170, v204, v170
v_mul_f32 v171, v204, v171
v_cvt_pk_bf16_f32 v194, v152, v153
v_cvt_pk_bf16_f32 v195, v154, v155
v_cvt_pk_bf16_f32 v196, v156, v157
v_cvt_pk_bf16_f32 v197, v158, v159
v_cvt_pk_bf16_f32 v198, v160, v161
v_cvt_pk_bf16_f32 v199, v162, v163
v_cvt_pk_bf16_f32 v200, v164, v165
v_cvt_pk_bf16_f32 v201, v166, v167
buffer_load_dwordx4 a[192:195], v21, s[36:39], s84 offen offset:0 sc1
v_cvt_pk_bf16_f32 v202, v168, v169
v_cvt_pk_bf16_f32 v203, v170, v171
v_permlane16_swap_b32 v184, v194
v_permlane16_swap_b32 v185, v195
v_permlane16_swap_b32 v186, v196
v_permlane16_swap_b32 v187, v197
v_permlane16_swap_b32 v188, v198
v_permlane16_swap_b32 v189, v199
v_permlane16_swap_b32 v190, v200
v_permlane16_swap_b32 v191, v201
v_permlane16_swap_b32 v192, v202
v_permlane16_swap_b32 v193, v203
s_lshl_b32 s16, s53, 3
s_lshl_b32 s17, s52, 1
s_add_u32 s16, s16, s17
s_lshl_b32 s16, s16, 3
s_add_u32 s16, s16, s54
s_mul_i32 s16, s16, 0xa00
s_add_u32 s16, s16, 0x600000
s_add_u32 s17, s16, 0x5000
buffer_store_dwordx4 v[184:187], v2, s[36:39], s16 offen sc1
buffer_store_dwordx4 v[188:191], v2, s[36:39], s16 offen offset:1024 sc1
buffer_store_dwordx2 v[192:193], v3, s[36:39], s16 offen offset:2048 sc1
buffer_store_dwordx4 v[194:197], v2, s[36:39], s17 offen sc1
buffer_store_dwordx4 v[198:201], v2, s[36:39], s17 offen offset:1024 sc1
buffer_store_dwordx2 v[202:203], v3, s[36:39], s17 offen offset:2048 sc1
v_mfma_f32_16x16x32_bf16 a[0:3], a[212:215], a[196:199], a[0:3]
v_mfma_f32_16x16x32_bf16 a[20:23], a[212:215], a[200:203], a[20:23]
v_mfma_f32_16x16x32_bf16 a[40:43], a[212:215], a[204:207], a[40:43]
v_mfma_f32_16x16x32_bf16 a[60:63], a[212:215], a[208:211], a[60:63]
v_mfma_f32_16x16x32_bf16 a[4:7], a[216:219], a[196:199], a[4:7]
v_mfma_f32_16x16x32_bf16 a[24:27], a[216:219], a[200:203], a[24:27]
v_mfma_f32_16x16x32_bf16 a[44:47], a[216:219], a[204:207], a[44:47]
v_mfma_f32_16x16x32_bf16 a[64:67], a[216:219], a[208:211], a[64:67]
v_mfma_f32_16x16x32_bf16 a[8:11], a[220:223], a[196:199], a[8:11]
v_mfma_f32_16x16x32_bf16 a[28:31], a[220:223], a[200:203], a[28:31]
v_mfma_f32_16x16x32_bf16 a[48:51], a[220:223], a[204:207], a[48:51]
v_mfma_f32_16x16x32_bf16 a[68:71], a[220:223], a[208:211], a[68:71]
v_mfma_f32_16x16x32_bf16 a[12:15], a[224:227], a[196:199], a[12:15]
v_mfma_f32_16x16x32_bf16 a[32:35], a[224:227], a[200:203], a[32:35]
v_mfma_f32_16x16x32_bf16 a[52:55], a[224:227], a[204:207], a[52:55]
v_mfma_f32_16x16x32_bf16 a[72:75], a[224:227], a[208:211], a[72:75]
v_mfma_f32_16x16x32_bf16 a[16:19], a[228:231], a[196:199], a[16:19]
v_mfma_f32_16x16x32_bf16 a[36:39], a[228:231], a[200:203], a[36:39]
v_mfma_f32_16x16x32_bf16 a[56:59], a[228:231], a[204:207], a[56:59]
v_mfma_f32_16x16x32_bf16 a[76:79], a[228:231], a[208:211], a[76:79]
v_mfma_f32_16x16x32_bf16 a[0:3], a[248:251], a[232:235], a[0:3]
v_mfma_f32_16x16x32_bf16 a[20:23], a[248:251], a[236:239], a[20:23]
s_add_u32 s85, s69, s28
buffer_load_dwordx4 a[196:199], v5, s[36:39], s85 offen sc1
v_mfma_f32_16x16x32_bf16 a[40:43], a[248:251], a[240:243], a[40:43]
v_mfma_f32_16x16x32_bf16 a[60:63], a[248:251], a[244:247], a[60:63]
buffer_load_dwordx4 a[200:203], v6, s[36:39], s85 offen sc1
v_mfma_f32_16x16x32_bf16 a[4:7], a[252:255], a[232:235], a[4:7]
v_mfma_f32_16x16x32_bf16 a[24:27], a[252:255], a[236:239], a[24:27]
buffer_load_dwordx4 a[204:207], v7, s[36:39], s85 offen sc1
v_mfma_f32_16x16x32_bf16 a[44:47], a[252:255], a[240:243], a[44:47]
v_mfma_f32_16x16x32_bf16 a[64:67], a[252:255], a[244:247], a[64:67]
buffer_load_dwordx4 a[208:211], v8, s[36:39], s85 offen sc1
v_mfma_f32_16x16x32_bf16 a[8:11], a[80:83], a[232:235], a[8:11]
v_mfma_f32_16x16x32_bf16 a[28:31], a[80:83], a[236:239], a[28:31]
s_mul_i32 s86, s69, 40
s_add_u32 s86, s86, s30
buffer_load_dwordx4 a[212:215], v2, s[36:39], s86 offen offset:0 sc1
v_mfma_f32_16x16x32_bf16 a[48:51], a[80:83], a[240:243], a[48:51]
v_mfma_f32_16x16x32_bf16 a[68:71], a[80:83], a[244:247], a[68:71]
buffer_load_dwordx4 a[216:219], v2, s[36:39], s86 offen offset:1024 sc1
v_mfma_f32_16x16x32_bf16 a[12:15], a[84:87], a[232:235], a[12:15]
v_mfma_f32_16x16x32_bf16 a[32:35], a[84:87], a[236:239], a[32:35]
buffer_load_dwordx4 a[220:223], v2, s[36:39], s86 offen offset:2048 sc1
v_mfma_f32_16x16x32_bf16 a[52:55], a[84:87], a[240:243], a[52:55]
v_mfma_f32_16x16x32_bf16 a[72:75], a[84:87], a[244:247], a[72:75]
buffer_load_dwordx4 a[224:227], v2, s[36:39], s86 offen offset:3072 sc1
v_mfma_f32_16x16x32_bf16 a[16:19], a[88:91], a[232:235], a[16:19]
v_mfma_f32_16x16x32_bf16 a[36:39], a[88:91], a[236:239], a[36:39]
buffer_load_dwordx4 a[228:231], v21, s[36:39], s86 offen offset:0 sc1
v_mfma_f32_16x16x32_bf16 a[56:59], a[88:91], a[240:243], a[56:59]
v_mfma_f32_16x16x32_bf16 a[76:79], a[88:91], a[244:247], a[76:79]
s_waitcnt vmcnt(9)
s_lshl_b32 s16, s53, 1
s_lshr_b32 s17, s52, 1
s_add_u32 s16, s16, s17
s_lshl_b32 s16, s16, 2
s_lshr_b32 s17, s54, 1
s_add_u32 s16, s16, s17
s_lshl_b32 s16, s16, 5
s_and_b32 s17, s54, 1
s_lshl_b32 s17, s17, 1
s_add_u32 s16, s16, s17
s_and_b32 s17, s52, 1
s_add_u32 s16, s16, s17
s_lshl_b32 s16, s16, 2
s_add_u32 s16, s16, 0xb4a000
v_mov_b32 v204, 1
s_mov_b64 exec, 1
buffer_store_dword v204, off, s[36:39], s16 sc1
s_mov_b64 exec, -1
v_mfma_f32_16x16x32_bf16 a[0:3], a[108:111], a[92:95], a[0:3]
v_mfma_f32_16x16x32_bf16 a[20:23], a[108:111], a[96:99], a[20:23]
s_add_u32 s87, s70, s28
buffer_load_dwordx2 a[232:233], v9, s[36:39], s87 offen sc1
v_mfma_f32_16x16x32_bf16 a[40:43], a[108:111], a[100:103], a[40:43]
v_mfma_f32_16x16x32_bf16 a[60:63], a[108:111], a[104:107], a[60:63]
buffer_load_dwordx2 a[234:235], v9, s[36:39], s87 offen offset:512 sc1
v_mfma_f32_16x16x32_bf16 a[4:7], a[112:115], a[92:95], a[4:7]
v_mfma_f32_16x16x32_bf16 a[24:27], a[112:115], a[96:99], a[24:27]
buffer_load_dwordx2 a[236:237], v10, s[36:39], s87 offen sc1
v_mfma_f32_16x16x32_bf16 a[44:47], a[112:115], a[100:103], a[44:47]
v_mfma_f32_16x16x32_bf16 a[64:67], a[112:115], a[104:107], a[64:67]
buffer_load_dwordx2 a[238:239], v10, s[36:39], s87 offen offset:512 sc1
v_mfma_f32_16x16x32_bf16 a[8:11], a[116:119], a[92:95], a[8:11]
v_mfma_f32_16x16x32_bf16 a[28:31], a[116:119], a[96:99], a[28:31]
buffer_load_dwordx2 a[240:241], v11, s[36:39], s87 offen sc1
v_mfma_f32_16x16x32_bf16 a[48:51], a[116:119], a[100:103], a[48:51]
v_mfma_f32_16x16x32_bf16 a[68:71], a[116:119], a[104:107], a[68:71]
buffer_load_dwordx2 a[242:243], v11, s[36:39], s87 offen offset:512 sc1
v_mfma_f32_16x16x32_bf16 a[12:15], a[120:123], a[92:95], a[12:15]
v_mfma_f32_16x16x32_bf16 a[32:35], a[120:123], a[96:99], a[32:35]
buffer_load_dwordx2 a[244:245], v12, s[36:39], s87 offen sc1
v_mfma_f32_16x16x32_bf16 a[52:55], a[120:123], a[100:103], a[52:55]
buffer_load_dwordx2 a[246:247], v12, s[36:39], s87 offen offset:512 sc1
v_mfma_f32_16x16x32_bf16 a[72:75], a[120:123], a[104:107], a[72:75]
s_mul_i32 s88, s70, 40
s_add_u32 s88, s88, s30
buffer_load_dwordx4 a[248:251], v2, s[36:39], s88 offen offset:0 sc1
v_mfma_f32_16x16x32_bf16 a[16:19], a[124:127], a[92:95], a[16:19]
buffer_load_dwordx4 a[252:255], v2, s[36:39], s88 offen offset:1024 sc1
v_mfma_f32_16x16x32_bf16 a[36:39], a[124:127], a[96:99], a[36:39]
buffer_load_dwordx4 a[80:83], v2, s[36:39], s88 offen offset:2048 sc1
v_mfma_f32_16x16x32_bf16 a[56:59], a[124:127], a[100:103], a[56:59]
buffer_load_dwordx4 a[84:87], v2, s[36:39], s88 offen offset:3072 sc1
v_mfma_f32_16x16x32_bf16 a[76:79], a[124:127], a[104:107], a[76:79]
buffer_load_dwordx4 a[88:91], v21, s[36:39], s88 offen offset:0 sc1
v_mfma_f32_16x16x32_bf16 a[0:3], a[176:179], a[160:163], a[0:3]
v_mfma_f32_16x16x32_bf16 a[20:23], a[176:179], a[164:167], a[20:23]
s_add_u32 s89, s71, s28
buffer_load_dwordx4 a[92:95], v5, s[36:39], s89 offen sc1
v_mfma_f32_16x16x32_bf16 a[40:43], a[176:179], a[168:171], a[40:43]
v_mfma_f32_16x16x32_bf16 a[60:63], a[176:179], a[172:175], a[60:63]
buffer_load_dwordx4 a[96:99], v6, s[36:39], s89 offen sc1
v_mfma_f32_16x16x32_bf16 a[4:7], a[180:183], a[160:163], a[4:7]
v_mfma_f32_16x16x32_bf16 a[24:27], a[180:183], a[164:167], a[24:27]
buffer_load_dwordx4 a[100:103], v7, s[36:39], s89 offen sc1
v_mfma_f32_16x16x32_bf16 a[44:47], a[180:183], a[168:171], a[44:47]
v_mfma_f32_16x16x32_bf16 a[64:67], a[180:183], a[172:175], a[64:67]
buffer_load_dwordx4 a[104:107], v8, s[36:39], s89 offen sc1
v_mfma_f32_16x16x32_bf16 a[8:11], a[184:187], a[160:163], a[8:11]
v_mfma_f32_16x16x32_bf16 a[28:31], a[184:187], a[164:167], a[28:31]
s_mul_i32 s82, s71, 40
s_add_u32 s82, s82, s30
buffer_load_dwordx4 a[108:111], v2, s[36:39], s82 offen offset:0 sc1
v_mfma_f32_16x16x32_bf16 a[48:51], a[184:187], a[168:171], a[48:51]
v_mfma_f32_16x16x32_bf16 a[68:71], a[184:187], a[172:175], a[68:71]
buffer_load_dwordx4 a[112:115], v2, s[36:39], s82 offen offset:1024 sc1
v_mfma_f32_16x16x32_bf16 a[12:15], a[188:191], a[160:163], a[12:15]
v_mfma_f32_16x16x32_bf16 a[32:35], a[188:191], a[164:167], a[32:35]
buffer_load_dwordx4 a[116:119], v2, s[36:39], s82 offen offset:2048 sc1
v_mfma_f32_16x16x32_bf16 a[52:55], a[188:191], a[168:171], a[52:55]
v_mfma_f32_16x16x32_bf16 a[72:75], a[188:191], a[172:175], a[72:75]
buffer_load_dwordx4 a[120:123], v2, s[36:39], s82 offen offset:3072 sc1
v_mfma_f32_16x16x32_bf16 a[16:19], a[192:195], a[160:163], a[16:19]
v_mfma_f32_16x16x32_bf16 a[36:39], a[192:195], a[164:167], a[36:39]
buffer_load_dwordx4 a[124:127], v21, s[36:39], s82 offen offset:0 sc1
v_mfma_f32_16x16x32_bf16 a[56:59], a[192:195], a[168:171], a[56:59]
v_mfma_f32_16x16x32_bf16 a[76:79], a[192:195], a[172:175], a[76:79]
s_waitcnt vmcnt(27)
v_mfma_f32_16x16x32_bf16 a[0:3], a[212:215], a[196:199], a[0:3]
v_mfma_f32_16x16x32_bf16 a[20:23], a[212:215], a[200:203], a[20:23]
s_add_u32 s83, s72, s28
buffer_load_dwordx4 a[160:163], v5, s[36:39], s83 offen sc1
v_mfma_f32_16x16x32_bf16 a[40:43], a[212:215], a[204:207], a[40:43]
v_mfma_f32_16x16x32_bf16 a[60:63], a[212:215], a[208:211], a[60:63]
buffer_load_dwordx4 a[164:167], v6, s[36:39], s83 offen sc1
s_waitcnt vmcnt(28)
v_mfma_f32_16x16x32_bf16 a[4:7], a[216:219], a[196:199], a[4:7]
v_mfma_f32_16x16x32_bf16 a[24:27], a[216:219], a[200:203], a[24:27]
buffer_load_dwordx4 a[168:171], v7, s[36:39], s83 offen sc1
v_mfma_f32_16x16x32_bf16 a[44:47], a[216:219], a[204:207], a[44:47]
v_mfma_f32_16x16x32_bf16 a[64:67], a[216:219], a[208:211], a[64:67]
buffer_load_dwordx4 a[172:175], v8, s[36:39], s83 offen sc1
s_waitcnt vmcnt(29)
v_mfma_f32_16x16x32_bf16 a[8:11], a[220:223], a[196:199], a[8:11]
v_mfma_f32_16x16x32_bf16 a[28:31], a[220:223], a[200:203], a[28:31]
s_mul_i32 s84, s72, 40
s_add_u32 s84, s84, s30
buffer_load_dwordx4 a[176:179], v2, s[36:39], s84 offen offset:0 sc1
v_mfma_f32_16x16x32_bf16 a[48:51], a[220:223], a[204:207], a[48:51]
v_mfma_f32_16x16x32_bf16 a[68:71], a[220:223], a[208:211], a[68:71]
buffer_load_dwordx4 a[180:183], v2, s[36:39], s84 offen offset:1024 sc1
s_waitcnt vmcnt(30)
v_mfma_f32_16x16x32_bf16 a[12:15], a[224:227], a[196:199], a[12:15]
v_mfma_f32_16x16x32_bf16 a[32:35], a[224:227], a[200:203], a[32:35]
buffer_load_dwordx4 a[184:187], v2, s[36:39], s84 offen offset:2048 sc1
v_mfma_f32_16x16x32_bf16 a[52:55], a[224:227], a[204:207], a[52:55]
v_mfma_f32_16x16x32_bf16 a[72:75], a[224:227], a[208:211], a[72:75]
buffer_load_dwordx4 a[188:191], v2, s[36:39], s84 offen offset:3072 sc1
s_waitcnt vmcnt(31)
v_mfma_f32_16x16x32_bf16 a[16:19], a[228:231], a[196:199], a[16:19]
v_mfma_f32_16x16x32_bf16 a[36:39], a[228:231], a[200:203], a[36:39]
buffer_load_dwordx4 a[192:195], v21, s[36:39], s84 offen offset:0 sc1
v_mfma_f32_16x16x32_bf16 a[56:59], a[228:231], a[204:207], a[56:59]
v_mfma_f32_16x16x32_bf16 a[76:79], a[228:231], a[208:211], a[76:79]
s_waitcnt vmcnt(22)
v_mfma_f32_16x16x32_bf16 a[0:3], a[248:251], a[232:235], a[0:3]
v_mfma_f32_16x16x32_bf16 a[20:23], a[248:251], a[236:239], a[20:23]
s_add_u32 s85, s73, s28
buffer_load_dwordx4 a[196:199], v5, s[36:39], s85 offen sc1
v_mfma_f32_16x16x32_bf16 a[40:43], a[248:251], a[240:243], a[40:43]
v_mfma_f32_16x16x32_bf16 a[60:63], a[248:251], a[244:247], a[60:63]
buffer_load_dwordx4 a[200:203], v6, s[36:39], s85 offen sc1
s_waitcnt vmcnt(23)
v_mfma_f32_16x16x32_bf16 a[4:7], a[252:255], a[232:235], a[4:7]
v_mfma_f32_16x16x32_bf16 a[24:27], a[252:255], a[236:239], a[24:27]
buffer_load_dwordx4 a[204:207], v7, s[36:39], s85 offen sc1
v_mfma_f32_16x16x32_bf16 a[44:47], a[252:255], a[240:243], a[44:47]
v_mfma_f32_16x16x32_bf16 a[64:67], a[252:255], a[244:247], a[64:67]
buffer_load_dwordx4 a[208:211], v8, s[36:39], s85 offen sc1
s_waitcnt vmcnt(24)
v_mfma_f32_16x16x32_bf16 a[8:11], a[80:83], a[232:235], a[8:11]
v_mfma_f32_16x16x32_bf16 a[28:31], a[80:83], a[236:239], a[28:31]
s_mul_i32 s86, s73, 40
s_add_u32 s86, s86, s30
buffer_load_dwordx4 a[212:215], v2, s[36:39], s86 offen offset:0 sc1
v_mfma_f32_16x16x32_bf16 a[48:51], a[80:83], a[240:243], a[48:51]
v_mfma_f32_16x16x32_bf16 a[68:71], a[80:83], a[244:247], a[68:71]
buffer_load_dwordx4 a[216:219], v2, s[36:39], s86 offen offset:1024 sc1
s_waitcnt vmcnt(25)
v_mfma_f32_16x16x32_bf16 a[12:15], a[84:87], a[232:235], a[12:15]
v_mfma_f32_16x16x32_bf16 a[32:35], a[84:87], a[236:239], a[32:35]
buffer_load_dwordx4 a[220:223], v2, s[36:39], s86 offen offset:2048 sc1
v_mfma_f32_16x16x32_bf16 a[52:55], a[84:87], a[240:243], a[52:55]
v_mfma_f32_16x16x32_bf16 a[72:75], a[84:87], a[244:247], a[72:75]
buffer_load_dwordx4 a[224:227], v2, s[36:39], s86 offen offset:3072 sc1
s_waitcnt vmcnt(26)
v_mfma_f32_16x16x32_bf16 a[16:19], a[88:91], a[232:235], a[16:19]
v_mfma_f32_16x16x32_bf16 a[36:39], a[88:91], a[236:239], a[36:39]
buffer_load_dwordx4 a[228:231], v21, s[36:39], s86 offen offset:0 sc1
v_mfma_f32_16x16x32_bf16 a[56:59], a[88:91], a[240:243], a[56:59]
v_mfma_f32_16x16x32_bf16 a[76:79], a[88:91], a[244:247], a[76:79]
s_waitcnt vmcnt(22)
v_mfma_f32_16x16x32_bf16 a[0:3], a[108:111], a[92:95], a[0:3]
v_mfma_f32_16x16x32_bf16 a[20:23], a[108:111], a[96:99], a[20:23]
s_add_u32 s87, s74, s28
buffer_load_dwordx2 a[232:233], v9, s[36:39], s87 offen sc1
v_mfma_f32_16x16x32_bf16 a[40:43], a[108:111], a[100:103], a[40:43]
v_mfma_f32_16x16x32_bf16 a[60:63], a[108:111], a[104:107], a[60:63]
buffer_load_dwordx2 a[234:235], v9, s[36:39], s87 offen offset:512 sc1
s_waitcnt vmcnt(23)
v_mfma_f32_16x16x32_bf16 a[4:7], a[112:115], a[92:95], a[4:7]
v_mfma_f32_16x16x32_bf16 a[24:27], a[112:115], a[96:99], a[24:27]
buffer_load_dwordx2 a[236:237], v10, s[36:39], s87 offen sc1
v_mfma_f32_16x16x32_bf16 a[44:47], a[112:115], a[100:103], a[44:47]
v_mfma_f32_16x16x32_bf16 a[64:67], a[112:115], a[104:107], a[64:67]
buffer_load_dwordx2 a[238:239], v10, s[36:39], s87 offen offset:512 sc1
s_waitcnt vmcnt(24)
v_mfma_f32_16x16x32_bf16 a[8:11], a[116:119], a[92:95], a[8:11]
v_mfma_f32_16x16x32_bf16 a[28:31], a[116:119], a[96:99], a[28:31]
buffer_load_dwordx2 a[240:241], v11, s[36:39], s87 offen sc1
v_mfma_f32_16x16x32_bf16 a[48:51], a[116:119], a[100:103], a[48:51]
v_mfma_f32_16x16x32_bf16 a[68:71], a[116:119], a[104:107], a[68:71]
buffer_load_dwordx2 a[242:243], v11, s[36:39], s87 offen offset:512 sc1
s_waitcnt vmcnt(25)
v_mfma_f32_16x16x32_bf16 a[12:15], a[120:123], a[92:95], a[12:15]
v_mfma_f32_16x16x32_bf16 a[32:35], a[120:123], a[96:99], a[32:35]
buffer_load_dwordx2 a[244:245], v12, s[36:39], s87 offen sc1
v_mfma_f32_16x16x32_bf16 a[52:55], a[120:123], a[100:103], a[52:55]
buffer_load_dwordx2 a[246:247], v12, s[36:39], s87 offen offset:512 sc1
v_mfma_f32_16x16x32_bf16 a[72:75], a[120:123], a[104:107], a[72:75]
s_mul_i32 s88, s74, 40
s_add_u32 s88, s88, s30
buffer_load_dwordx4 a[248:251], v2, s[36:39], s88 offen offset:0 sc1
s_waitcnt vmcnt(27)
v_mfma_f32_16x16x32_bf16 a[16:19], a[124:127], a[92:95], a[16:19]
buffer_load_dwordx4 a[252:255], v2, s[36:39], s88 offen offset:1024 sc1
v_mfma_f32_16x16x32_bf16 a[36:39], a[124:127], a[96:99], a[36:39]
buffer_load_dwordx4 a[80:83], v2, s[36:39], s88 offen offset:2048 sc1
v_mfma_f32_16x16x32_bf16 a[56:59], a[124:127], a[100:103], a[56:59]
buffer_load_dwordx4 a[84:87], v2, s[36:39], s88 offen offset:3072 sc1
v_mfma_f32_16x16x32_bf16 a[76:79], a[124:127], a[104:107], a[76:79]
buffer_load_dwordx4 a[88:91], v21, s[36:39], s88 offen offset:0 sc1
s_waitcnt vmcnt(26)
v_mfma_f32_16x16x32_bf16 a[0:3], a[176:179], a[160:163], a[0:3]
v_mfma_f32_16x16x32_bf16 a[20:23], a[176:179], a[164:167], a[20:23]
s_add_u32 s89, s75, s28
buffer_load_dwordx4 a[92:95], v5, s[36:39], s89 offen sc1
v_mfma_f32_16x16x32_bf16 a[40:43], a[176:179], a[168:171], a[40:43]
v_mfma_f32_16x16x32_bf16 a[60:63], a[176:179], a[172:175], a[60:63]
buffer_load_dwordx4 a[96:99], v6, s[36:39], s89 offen sc1
s_waitcnt vmcnt(27)
v_mfma_f32_16x16x32_bf16 a[4:7], a[180:183], a[160:163], a[4:7]
v_mfma_f32_16x16x32_bf16 a[24:27], a[180:183], a[164:167], a[24:27]
buffer_load_dwordx4 a[100:103], v7, s[36:39], s89 offen sc1
v_mfma_f32_16x16x32_bf16 a[44:47], a[180:183], a[168:171], a[44:47]
v_mfma_f32_16x16x32_bf16 a[64:67], a[180:183], a[172:175], a[64:67]
buffer_load_dwordx4 a[104:107], v8, s[36:39], s89 offen sc1
s_waitcnt vmcnt(28)
v_mfma_f32_16x16x32_bf16 a[8:11], a[184:187], a[160:163], a[8:11]
v_mfma_f32_16x16x32_bf16 a[28:31], a[184:187], a[164:167], a[28:31]
s_mul_i32 s82, s75, 40
s_add_u32 s82, s82, s30
buffer_load_dwordx4 a[108:111], v2, s[36:39], s82 offen offset:0 sc1
v_mfma_f32_16x16x32_bf16 a[48:51], a[184:187], a[168:171], a[48:51]
v_mfma_f32_16x16x32_bf16 a[68:71], a[184:187], a[172:175], a[68:71]
buffer_load_dwordx4 a[112:115], v2, s[36:39], s82 offen offset:1024 sc1
s_waitcnt vmcnt(29)
v_mfma_f32_16x16x32_bf16 a[12:15], a[188:191], a[160:163], a[12:15]
v_mfma_f32_16x16x32_bf16 a[32:35], a[188:191], a[164:167], a[32:35]
buffer_load_dwordx4 a[116:119], v2, s[36:39], s82 offen offset:2048 sc1
v_mfma_f32_16x16x32_bf16 a[52:55], a[188:191], a[168:171], a[52:55]
v_mfma_f32_16x16x32_bf16 a[72:75], a[188:191], a[172:175], a[72:75]
buffer_load_dwordx4 a[120:123], v2, s[36:39], s82 offen offset:3072 sc1
s_waitcnt vmcnt(30)
v_mfma_f32_16x16x32_bf16 a[16:19], a[192:195], a[160:163], a[16:19]
v_mfma_f32_16x16x32_bf16 a[36:39], a[192:195], a[164:167], a[36:39]
buffer_load_dwordx4 a[124:127], v21, s[36:39], s82 offen offset:0 sc1
v_mfma_f32_16x16x32_bf16 a[56:59], a[192:195], a[168:171], a[56:59]
v_mfma_f32_16x16x32_bf16 a[76:79], a[192:195], a[172:175], a[76:79]
v_and_b32 v23, 3, v1
v_lshlrev_b32 v23, 2, v23
buffer_load_dword v22, v23, s[36:39], s40 offen sc1
s_waitcnt vmcnt(27)
v_mfma_f32_16x16x32_bf16 a[0:3], a[212:215], a[196:199], a[0:3]
v_mfma_f32_16x16x32_bf16 a[20:23], a[212:215], a[200:203], a[20:23]
s_add_u32 s83, s76, 12
s_mul_i32 s83, s83, 0xa000
s_add_u32 s83, s83, s30
buffer_load_dwordx4 a[176:179], v2, s[36:39], s83 offen offset:0 sc1
v_mfma_f32_16x16x32_bf16 a[40:43], a[212:215], a[204:207], a[40:43]
v_mfma_f32_16x16x32_bf16 a[60:63], a[212:215], a[208:211], a[60:63]
buffer_load_dwordx4 a[180:183], v2, s[36:39], s83 offen offset:1024 sc1
s_waitcnt vmcnt(28)
v_mfma_f32_16x16x32_bf16 a[4:7], a[216:219], a[196:199], a[4:7]
v_mfma_f32_16x16x32_bf16 a[24:27], a[216:219], a[200:203], a[24:27]
buffer_load_dwordx4 a[184:187], v2, s[36:39], s83 offen offset:2048 sc1
v_mfma_f32_16x16x32_bf16 a[44:47], a[216:219], a[204:207], a[44:47]
v_mfma_f32_16x16x32_bf16 a[64:67], a[216:219], a[208:211], a[64:67]
buffer_load_dwordx4 a[188:191], v2, s[36:39], s83 offen offset:3072 sc1
s_waitcnt vmcnt(29)
v_mfma_f32_16x16x32_bf16 a[8:11], a[220:223], a[196:199], a[8:11]
v_mfma_f32_16x16x32_bf16 a[28:31], a[220:223], a[200:203], a[28:31]
buffer_load_dwordx4 a[192:195], v21, s[36:39], s83 offen offset:0 sc1
v_mfma_f32_16x16x32_bf16 a[48:51], a[220:223], a[204:207], a[48:51]
v_mfma_f32_16x16x32_bf16 a[68:71], a[220:223], a[208:211], a[68:71]
s_waitcnt vmcnt(29)
v_mfma_f32_16x16x32_bf16 a[12:15], a[224:227], a[196:199], a[12:15]
v_mfma_f32_16x16x32_bf16 a[32:35], a[224:227], a[200:203], a[32:35]
v_mfma_f32_16x16x32_bf16 a[52:55], a[224:227], a[204:207], a[52:55]
v_mfma_f32_16x16x32_bf16 a[72:75], a[224:227], a[208:211], a[72:75]
s_waitcnt vmcnt(28)
v_mfma_f32_16x16x32_bf16 a[16:19], a[228:231], a[196:199], a[16:19]
v_mfma_f32_16x16x32_bf16 a[36:39], a[228:231], a[200:203], a[36:39]
v_mfma_f32_16x16x32_bf16 a[56:59], a[228:231], a[204:207], a[56:59]
v_mfma_f32_16x16x32_bf16 a[76:79], a[228:231], a[208:211], a[76:79]
s_waitcnt vmcnt(5)
v_cmp_eq_u32 vcc, 1, v22
s_nop 3
s_cmp_eq_u64 vcc, -1
s_cbranch_scc1 Y_fo_ok
s_mov_b32 s60, 0
Y_fo_spin:
s_add_u32 s60, s60, 1
s_cmp_ge_u32 s60, 0x40000
s_cbranch_scc1 Y_fo_ok
s_sleep 16
buffer_load_dword v22, v23, s[36:39], s40 offen offset:0 sc1
s_waitcnt vmcnt(0)
v_cmp_eq_u32 vcc, 1, v22
s_nop 3
s_cmp_eq_u64 vcc, -1
s_cbranch_scc0 Y_fo_spin
Y_fo_ok:
v_mfma_f32_16x16x32_bf16 a[0:3], a[248:251], a[232:235], a[0:3]
s_lshl_b32 s80, s43, 6
s_mul_i32 s80, s80, 0x500
s_mul_i32 s81, s23, 0xa0
s_add_u32 s80, s80, s81
s_lshl_b32 s81, s52, 6
s_add_u32 s81, s81, 0
v_add_u32 v84, s81, v1
v_mul_u32_u24 v85, 0xccd, v84
v_lshrrev_b32 v85, 16, v85
v_mul_u32_u24 v86, 20, v85
v_mfma_f32_16x16x32_bf16 a[20:23], a[248:251], a[236:239], a[20:23]
s_lshr_b32 s84, s76, 1
s_mul_i32 s84, s84, 0xa00
s_and_b32 s85, s76, 1
s_lshl_b32 s85, s85, 10
s_add_u32 s84, s84, s85
s_add_u32 s84, s84, s29
buffer_load_dwordx4 a[160:163], v13, s[36:39], s84 offen sc1
v_sub_u32 v86, v84, v86
v_mul_u32_u24 v87, 0x500, v85
v_lshl_add_u32 v87, v86, 3, v87
v_add_u32 v64, s80, v87
v_mfma_f32_16x16x32_bf16 a[40:43], a[248:251], a[240:243], a[40:43]
v_mul_u32_u24 v87, 0x150, v85
v_lshl_add_u32 v87, v86, 4, v87
v_add_u32 v69, 0x4000, v87
v_mfma_f32_16x16x32_bf16 a[60:63], a[248:251], a[244:247], a[60:63]
buffer_load_dwordx4 a[164:167], v14, s[36:39], s84 offen sc1
buffer_load_dwordx2 v[74:75], v64, s[24:27], 0 offen
s_lshl_b32 s81, s52, 6
s_add_u32 s81, s81, 0x100
v_add_u32 v84, s81, v1
v_mul_u32_u24 v85, 0xccd, v84
v_lshrrev_b32 v85, 16, v85
v_mul_u32_u24 v86, 20, v85
v_mfma_f32_16x16x32_bf16 a[4:7], a[252:255], a[232:235], a[4:7]
v_sub_u32 v86, v84, v86
v_mul_u32_u24 v87, 0x500, v85
v_lshl_add_u32 v87, v86, 3, v87
v_add_u32 v65, s80, v87
v_mfma_f32_16x16x32_bf16 a[24:27], a[252:255], a[236:239], a[24:27]
buffer_load_dwordx4 a[168:171], v15, s[36:39], s84 offen sc1
v_mul_u32_u24 v87, 0x150, v85
v_lshl_add_u32 v87, v86, 4, v87
v_add_u32 v70, 0x4000, v87
v_mfma_f32_16x16x32_bf16 a[44:47], a[252:255], a[240:243], a[44:47]
buffer_load_dwordx2 v[76:77], v65, s[24:27], 0 offen
s_lshl_b32 s81, s52, 6
s_add_u32 s81, s81, 0x200
v_add_u32 v84, s81, v1
v_mul_u32_u24 v85, 0xccd, v84
v_lshrrev_b32 v85, 16, v85
v_mul_u32_u24 v86, 20, v85
v_mfma_f32_16x16x32_bf16 a[64:67], a[252:255], a[244:247], a[64:67]
buffer_load_dwordx4 a[172:175], v16, s[36:39], s84 offen sc1
v_sub_u32 v86, v84, v86
v_mul_u32_u24 v87, 0x500, v85
v_lshl_add_u32 v87, v86, 3, v87
v_add_u32 v66, s80, v87
v_mfma_f32_16x16x32_bf16 a[8:11], a[80:83], a[232:235], a[8:11]
v_mul_u32_u24 v87, 0x150, v85
v_lshl_add_u32 v87, v86, 4, v87
v_add_u32 v71, 0x4000, v87
v_mfma_f32_16x16x32_bf16 a[28:31], a[80:83], a[236:239], a[28:31]
s_lshr_b32 s86, s77, 1
s_mul_i32 s86, s86, 0xa00
s_and_b32 s87, s77, 1
s_lshl_b32 s87, s87, 10
s_add_u32 s86, s86, s87
s_add_u32 s86, s86, s29
buffer_load_dwordx4 a[196:199], v13, s[36:39], s86 offen sc1
buffer_load_dwordx2 v[78:79], v66, s[24:27], 0 offen
s_lshl_b32 s81, s52, 6
s_add_u32 s81, s81, 0x300
v_add_u32 v84, s81, v1
v_mul_u32_u24 v85, 0xccd, v84
v_lshrrev_b32 v85, 16, v85
v_mul_u32_u24 v86, 20, v85
v_mfma_f32_16x16x32_bf16 a[48:51], a[80:83], a[240:243], a[48:51]
v_sub_u32 v86, v84, v86
v_mul_u32_u24 v87, 0x500, v85
v_lshl_add_u32 v87, v86, 3, v87
v_add_u32 v67, s80, v87
v_mfma_f32_16x16x32_bf16 a[68:71], a[80:83], a[244:247], a[68:71]
buffer_load_dwordx4 a[200:203], v14, s[36:39], s86 offen sc1
v_mul_u32_u24 v87, 0x150, v85
v_lshl_add_u32 v87, v86, 4, v87
v_add_u32 v72, 0x4000, v87
v_mfma_f32_16x16x32_bf16 a[12:15], a[84:87], a[232:235], a[12:15]
buffer_load_dwordx2 v[80:81], v67, s[24:27], 0 offen
s_lshl_b32 s81, s52, 6
s_add_u32 s81, s81, 0x400
v_add_u32 v84, s81, v1
v_mul_u32_u24 v85, 0xccd, v84
v_lshrrev_b32 v85, 16, v85
v_mul_u32_u24 v86, 20, v85
v_mfma_f32_16x16x32_bf16 a[32:35], a[84:87], a[236:239], a[32:35]
buffer_load_dwordx4 a[204:207], v15, s[36:39], s86 offen sc1
v_sub_u32 v86, v84, v86
v_mul_u32_u24 v87, 0x500, v85
v_lshl_add_u32 v87, v86, 3, v87
v_add_u32 v68, s80, v87
v_mfma_f32_16x16x32_bf16 a[52:55], a[84:87], a[240:243], a[52:55]
buffer_load_dwordx4 a[208:211], v16, s[36:39], s86 offen sc1
v_mul_u32_u24 v87, 0x150, v85
v_lshl_add_u32 v87, v86, 4, v87
v_add_u32 v73, 0x4000, v87
v_mfma_f32_16x16x32_bf16 a[72:75], a[84:87], a[244:247], a[72:75]
s_add_u32 s88, s77, 12
s_mul_i32 s88, s88, 0xa000
s_add_u32 s88, s88, s30
buffer_load_dwordx4 a[212:215], v2, s[36:39], s88 offen offset:0 sc1
buffer_load_dwordx2 v[82:83], v68, s[24:27], 0 offen
v_mfma_f32_16x16x32_bf16 a[16:19], a[88:91], a[232:235], a[16:19]
buffer_load_dwordx4 a[216:219], v2, s[36:39], s88 offen offset:1024 sc1
v_mfma_f32_16x16x32_bf16 a[36:39], a[88:91], a[236:239], a[36:39]
buffer_load_dwordx4 a[220:223], v2, s[36:39], s88 offen offset:2048 sc1
v_mfma_f32_16x16x32_bf16 a[56:59], a[88:91], a[240:243], a[56:59]
buffer_load_dwordx4 a[224:227], v2, s[36:39], s88 offen offset:3072 sc1
v_mfma_f32_16x16x32_bf16 a[76:79], a[88:91], a[244:247], a[76:79]
buffer_load_dwordx4 a[228:231], v21, s[36:39], s88 offen offset:0 sc1
v_mfma_f32_16x16x32_bf16 a[0:3], a[108:111], a[92:95], a[0:3]
v_mfma_f32_16x16x32_bf16 a[20:23], a[108:111], a[96:99], a[20:23]
s_lshr_b32 s89, s78, 1
s_mul_i32 s89, s89, 0xa00
s_and_b32 s82, s78, 1
s_lshl_b32 s82, s82, 10
s_add_u32 s89, s89, s82
s_add_u32 s89, s89, s29
buffer_load_dwordx4 a[232:235], v13, s[36:39], s89 offen sc1
v_mfma_f32_16x16x32_bf16 a[40:43], a[108:111], a[100:103], a[40:43]
v_mfma_f32_16x16x32_bf16 a[60:63], a[108:111], a[104:107], a[60:63]
buffer_load_dwordx4 a[236:239], v14, s[36:39], s89 offen sc1
v_mfma_f32_16x16x32_bf16 a[4:7], a[112:115], a[92:95], a[4:7]
v_mfma_f32_16x16x32_bf16 a[24:27], a[112:115], a[96:99], a[24:27]
buffer_load_dwordx4 a[240:243], v15, s[36:39], s89 offen sc1
v_mfma_f32_16x16x32_bf16 a[44:47], a[112:115], a[100:103], a[44:47]
v_mfma_f32_16x16x32_bf16 a[64:67], a[112:115], a[104:107], a[64:67]
buffer_load_dwordx4 a[244:247], v16, s[36:39], s89 offen sc1
v_mfma_f32_16x16x32_bf16 a[8:11], a[116:119], a[92:95], a[8:11]
v_mfma_f32_16x16x32_bf16 a[28:31], a[116:119], a[96:99], a[28:31]
s_add_u32 s83, s78, 12
s_mul_i32 s83, s83, 0xa000
s_add_u32 s83, s83, s30
buffer_load_dwordx4 a[248:251], v2, s[36:39], s83 offen offset:0 sc1
v_mfma_f32_16x16x32_bf16 a[48:51], a[116:119], a[100:103], a[48:51]
v_mfma_f32_16x16x32_bf16 a[68:71], a[116:119], a[104:107], a[68:71]
buffer_load_dwordx4 a[252:255], v2, s[36:39], s83 offen offset:1024 sc1
v_mfma_f32_16x16x32_bf16 a[12:15], a[120:123], a[92:95], a[12:15]
v_mfma_f32_16x16x32_bf16 a[32:35], a[120:123], a[96:99], a[32:35]
buffer_load_dwordx4 a[80:83], v2, s[36:39], s83 offen offset:2048 sc1
v_mfma_f32_16x16x32_bf16 a[52:55], a[120:123], a[100:103], a[52:55]
v_mfma_f32_16x16x32_bf16 a[72:75], a[120:123], a[104:107], a[72:75]
buffer_load_dwordx4 a[84:87], v2, s[36:39], s83 offen offset:3072 sc1
v_mfma_f32_16x16x32_bf16 a[16:19], a[124:127], a[92:95], a[16:19]
v_mfma_f32_16x16x32_bf16 a[36:39], a[124:127], a[96:99], a[36:39]
buffer_load_dwordx4 a[88:91], v21, s[36:39], s83 offen offset:0 sc1
v_mfma_f32_16x16x32_bf16 a[56:59], a[124:127], a[100:103], a[56:59]
v_mfma_f32_16x16x32_bf16 a[76:79], a[124:127], a[104:107], a[76:79]
s_waitcnt vmcnt(26)
v_mfma_f32_16x16x32_bf16 a[0:3], a[176:179], a[160:163], a[0:3]
s_waitcnt vmcnt(25)
v_mfma_f32_16x16x32_bf16 a[20:23], a[176:179], a[164:167], a[20:23]
s_lshr_b32 s84, s79, 1
s_mul_i32 s84, s84, 0xa00
s_and_b32 s85, s79, 1
s_lshl_b32 s85, s85, 10
s_add_u32 s84, s84, s85
s_add_u32 s84, s84, s29
buffer_load_dwordx4 a[92:95], v13, s[36:39], s84 offen sc1
s_waitcnt vmcnt(24)
v_mfma_f32_16x16x32_bf16 a[40:43], a[176:179], a[168:171], a[40:43]
s_waitcnt vmcnt(22)
v_mfma_f32_16x16x32_bf16 a[60:63], a[176:179], a[172:175], a[60:63]
buffer_load_dwordx4 a[96:99], v14, s[36:39], s84 offen sc1
v_mfma_f32_16x16x32_bf16 a[4:7], a[180:183], a[160:163], a[4:7]
v_mfma_f32_16x16x32_bf16 a[24:27], a[180:183], a[164:167], a[24:27]
buffer_load_dwordx4 a[100:103], v15, s[36:39], s84 offen sc1
v_mfma_f32_16x16x32_bf16 a[44:47], a[180:183], a[168:171], a[44:47]
v_mfma_f32_16x16x32_bf16 a[64:67], a[180:183], a[172:175], a[64:67]
buffer_load_dwordx4 a[104:107], v16, s[36:39], s84 offen sc1
v_mfma_f32_16x16x32_bf16 a[8:11], a[184:187], a[160:163], a[8:11]
v_mfma_f32_16x16x32_bf16 a[28:31], a[184:187], a[164:167], a[28:31]
s_add_u32 s86, s79, 12
s_mul_i32 s86, s86, 0xa000
s_add_u32 s86, s86, s30
buffer_load_dwordx4 a[108:111], v2, s[36:39], s86 offen offset:0 sc1
v_mfma_f32_16x16x32_bf16 a[48:51], a[184:187], a[168:171], a[48:51]
v_mfma_f32_16x16x32_bf16 a[68:71], a[184:187], a[172:175], a[68:71]
buffer_load_dwordx4 a[112:115], v2, s[36:39], s86 offen offset:1024 sc1
v_mfma_f32_16x16x32_bf16 a[12:15], a[188:191], a[160:163], a[12:15]
v_mfma_f32_16x16x32_bf16 a[32:35], a[188:191], a[164:167], a[32:35]
buffer_load_dwordx4 a[116:119], v2, s[36:39], s86 offen offset:2048 sc1
v_mfma_f32_16x16x32_bf16 a[52:55], a[188:191], a[168:171], a[52:55]
v_mfma_f32_16x16x32_bf16 a[72:75], a[188:191], a[172:175], a[72:75]
buffer_load_dwordx4 a[120:123], v2, s[36:39], s86 offen offset:3072 sc1
v_mfma_f32_16x16x32_bf16 a[16:19], a[192:195], a[160:163], a[16:19]
v_mfma_f32_16x16x32_bf16 a[36:39], a[192:195], a[164:167], a[36:39]
buffer_load_dwordx4 a[124:127], v21, s[36:39], s86 offen offset:0 sc1
v_mfma_f32_16x16x32_bf16 a[56:59], a[192:195], a[168:171], a[56:59]
v_mfma_f32_16x16x32_bf16 a[76:79], a[192:195], a[172:175], a[76:79]
s_waitcnt vmcnt(23)
v_mfma_f32_16x16x32_bf16 a[0:3], a[212:215], a[196:199], a[0:3]
v_mfma_f32_16x16x32_bf16 a[20:23], a[212:215], a[200:203], a[20:23]
s_add_u32 s87, s29, 0x800
buffer_load_dwordx2 a[160:161], v17, s[36:39], s87 offen sc1
v_mfma_f32_16x16x32_bf16 a[40:43], a[212:215], a[204:207], a[40:43]
v_mfma_f32_16x16x32_bf16 a[60:63], a[212:215], a[208:211], a[60:63]
buffer_load_dwordx2 a[162:163], v17, s[36:39], s87 offen offset:2560 sc1
s_waitcnt vmcnt(23)
v_mfma_f32_16x16x32_bf16 a[4:7], a[216:219], a[196:199], a[4:7]
v_mfma_f32_16x16x32_bf16 a[24:27], a[216:219], a[200:203], a[24:27]
buffer_load_dwordx2 a[164:165], v18, s[36:39], s87 offen sc1
v_mfma_f32_16x16x32_bf16 a[44:47], a[216:219], a[204:207], a[44:47]
v_mfma_f32_16x16x32_bf16 a[64:67], a[216:219], a[208:211], a[64:67]
buffer_load_dwordx2 a[166:167], v18, s[36:39], s87 offen offset:2560 sc1
s_waitcnt vmcnt(24)
v_mfma_f32_16x16x32_bf16 a[8:11], a[220:223], a[196:199], a[8:11]
v_mfma_f32_16x16x32_bf16 a[28:31], a[220:223], a[200:203], a[28:31]
buffer_load_dwordx2 a[168:169], v19, s[36:39], s87 offen sc1
v_mfma_f32_16x16x32_bf16 a[48:51], a[220:223], a[204:207], a[48:51]
v_mfma_f32_16x16x32_bf16 a[68:71], a[220:223], a[208:211], a[68:71]
buffer_load_dwordx2 a[170:171], v19, s[36:39], s87 offen offset:2560 sc1
s_waitcnt vmcnt(25)
v_mfma_f32_16x16x32_bf16 a[12:15], a[224:227], a[196:199], a[12:15]
v_mfma_f32_16x16x32_bf16 a[32:35], a[224:227], a[200:203], a[32:35]
buffer_load_dwordx2 a[172:173], v20, s[36:39], s87 offen sc1
v_mfma_f32_16x16x32_bf16 a[52:55], a[224:227], a[204:207], a[52:55]
buffer_load_dwordx2 a[174:175], v20, s[36:39], s87 offen offset:2560 sc1
v_mfma_f32_16x16x32_bf16 a[72:75], a[224:227], a[208:211], a[72:75]
s_add_u32 s88, s30, 0xa0000
buffer_load_dwordx4 a[176:179], v2, s[36:39], s88 offen offset:0 sc1
s_waitcnt vmcnt(27)
v_mfma_f32_16x16x32_bf16 a[16:19], a[228:231], a[196:199], a[16:19]
buffer_load_dwordx4 a[180:183], v2, s[36:39], s88 offen offset:1024 sc1
v_mfma_f32_16x16x32_bf16 a[36:39], a[228:231], a[200:203], a[36:39]
buffer_load_dwordx4 a[184:187], v2, s[36:39], s88 offen offset:2048 sc1
v_mfma_f32_16x16x32_bf16 a[56:59], a[228:231], a[204:207], a[56:59]
buffer_load_dwordx4 a[188:191], v2, s[36:39], s88 offen offset:3072 sc1
v_mfma_f32_16x16x32_bf16 a[76:79], a[228:231], a[208:211], a[76:79]
buffer_load_dwordx4 a[192:195], v21, s[36:39], s88 offen offset:0 sc1
s_waitcnt vmcnt(26)
v_mfma_f32_16x16x32_bf16 a[0:3], a[248:251], a[232:235], a[0:3]
v_mfma_f32_16x16x32_bf16 a[20:23], a[248:251], a[236:239], a[20:23]
v_mfma_f32_16x16x32_bf16 a[40:43], a[248:251], a[240:243], a[40:43]
v_mfma_f32_16x16x32_bf16 a[60:63], a[248:251], a[244:247], a[60:63]
s_waitcnt vmcnt(25)
v_mfma_f32_16x16x32_bf16 a[4:7], a[252:255], a[232:235], a[4:7]
v_mfma_f32_16x16x32_bf16 a[24:27], a[252:255], a[236:239], a[24:27]
v_mfma_f32_16x16x32_bf16 a[44:47], a[252:255], a[240:243], a[44:47]
v_mfma_f32_16x16x32_bf16 a[64:67], a[252:255], a[244:247], a[64:67]
s_waitcnt vmcnt(24)
v_mfma_f32_16x16x32_bf16 a[8:11], a[80:83], a[232:235], a[8:11]
v_mfma_f32_16x16x32_bf16 a[28:31], a[80:83], a[236:239], a[28:31]
v_mfma_f32_16x16x32_bf16 a[48:51], a[80:83], a[240:243], a[48:51]
v_mfma_f32_16x16x32_bf16 a[68:71], a[80:83], a[244:247], a[68:71]
s_waitcnt vmcnt(23)
v_mfma_f32_16x16x32_bf16 a[12:15], a[84:87], a[232:235], a[12:15]
v_mfma_f32_16x16x32_bf16 a[32:35], a[84:87], a[236:239], a[32:35]
v_mfma_f32_16x16x32_bf16 a[52:55], a[84:87], a[240:243], a[52:55]
v_mfma_f32_16x16x32_bf16 a[72:75], a[84:87], a[244:247], a[72:75]
s_waitcnt vmcnt(22)
v_mfma_f32_16x16x32_bf16 a[16:19], a[88:91], a[232:235], a[16:19]
v_mfma_f32_16x16x32_bf16 a[36:39], a[88:91], a[236:239], a[36:39]
v_mfma_f32_16x16x32_bf16 a[56:59], a[88:91], a[240:243], a[56:59]
v_mfma_f32_16x16x32_bf16 a[76:79], a[88:91], a[244:247], a[76:79]
s_waitcnt vmcnt(17)
v_mfma_f32_16x16x32_bf16 a[0:3], a[108:111], a[92:95], a[0:3]
v_mfma_f32_16x16x32_bf16 a[20:23], a[108:111], a[96:99], a[20:23]
v_mfma_f32_16x16x32_bf16 a[40:43], a[108:111], a[100:103], a[40:43]
v_mfma_f32_16x16x32_bf16 a[60:63], a[108:111], a[104:107], a[60:63]
s_waitcnt vmcnt(16)
v_mfma_f32_16x16x32_bf16 a[4:7], a[112:115], a[92:95], a[4:7]
v_mfma_f32_16x16x32_bf16 a[24:27], a[112:115], a[96:99], a[24:27]
v_mfma_f32_16x16x32_bf16 a[44:47], a[112:115], a[100:103], a[44:47]
v_mfma_f32_16x16x32_bf16 a[64:67], a[112:115], a[104:107], a[64:67]
s_waitcnt vmcnt(15)
v_mfma_f32_16x16x32_bf16 a[8:11], a[116:119], a[92:95], a[8:11]
v_mfma_f32_16x16x32_bf16 a[28:31], a[116:119], a[96:99], a[28:31]
v_mfma_f32_16x16x32_bf16 a[48:51], a[116:119], a[100:103], a[48:51]
v_mfma_f32_16x16x32_bf16 a[68:71], a[116:119], a[104:107], a[68:71]
s_waitcnt vmcnt(14)
v_mfma_f32_16x16x32_bf16 a[12:15], a[120:123], a[92:95], a[12:15]
v_mfma_f32_16x16x32_bf16 a[32:35], a[120:123], a[96:99], a[32:35]
v_mfma_f32_16x16x32_bf16 a[52:55], a[120:123], a[100:103], a[52:55]
v_mfma_f32_16x16x32_bf16 a[72:75], a[120:123], a[104:107], a[72:75]
s_waitcnt vmcnt(13)
v_mfma_f32_16x16x32_bf16 a[16:19], a[124:127], a[92:95], a[16:19]
v_mfma_f32_16x16x32_bf16 a[36:39], a[124:127], a[96:99], a[36:39]
v_mfma_f32_16x16x32_bf16 a[56:59], a[124:127], a[100:103], a[56:59]
v_mfma_f32_16x16x32_bf16 a[76:79], a[124:127], a[104:107], a[76:79]
v_lshrrev_b32 v84, 4, v1
v_and_b32 v85, 15, v1
v_mul_u32_u24 v86, 0x150, v85
v_lshl_add_u32 v86, v84, 4, v86
s_mul_i32 s57, s52, 0x5400
s_add_u32 s57, s57, 0x4000
v_add_u32 v86, s57, v86
s_waitcnt vmcnt(4)
v_mfma_f32_16x16x32_bf16 a[0:3], a[176:179], a[160:163], a[0:3]
v_mfma_f32_16x16x32_bf16 a[20:23], a[176:179], a[164:167], a[20:23]
v_mfma_f32_16x16x32_bf16 a[40:43], a[176:179], a[168:171], a[40:43]
v_mfma_f32_16x16x32_bf16 a[60:63], a[176:179], a[172:175], a[60:63]
s_waitcnt vmcnt(3)
v_mfma_f32_16x16x32_bf16 a[4:7], a[180:183], a[160:163], a[4:7]
v_mfma_f32_16x16x32_bf16 a[24:27], a[180:183], a[164:167], a[24:27]
s_nop 1
ds_write_b128 v86, a[0:3] offset:0
v_mfma_f32_16x16x32_bf16 a[44:47], a[180:183], a[168:171], a[44:47]
ds_write_b128 v86, a[20:23] offset:5376
v_mfma_f32_16x16x32_bf16 a[64:67], a[180:183], a[172:175], a[64:67]
ds_write_b128 v86, a[40:43] offset:10752
s_waitcnt vmcnt(2)
v_mfma_f32_16x16x32_bf16 a[8:11], a[184:187], a[160:163], a[8:11]
ds_write_b128 v86, a[60:63] offset:16128
v_mfma_f32_16x16x32_bf16 a[28:31], a[184:187], a[164:167], a[28:31]
ds_write_b128 v86, a[4:7] offset:64
v_mfma_f32_16x16x32_bf16 a[48:51], a[184:187], a[168:171], a[48:51]
ds_write_b128 v86, a[24:27] offset:5440
v_mfma_f32_16x16x32_bf16 a[68:71], a[184:187], a[172:175], a[68:71]
ds_write_b128 v86, a[44:47] offset:10816
s_waitcnt vmcnt(1)
v_mfma_f32_16x16x32_bf16 a[12:15], a[188:191], a[160:163], a[12:15]
ds_write_b128 v86, a[64:67] offset:16192
v_mfma_f32_16x16x32_bf16 a[32:35], a[188:191], a[164:167], a[32:35]
ds_write_b128 v86, a[8:11] offset:128
v_mfma_f32_16x16x32_bf16 a[52:55], a[188:191], a[168:171], a[52:55]
ds_write_b128 v86, a[28:31] offset:5504
v_mfma_f32_16x16x32_bf16 a[72:75], a[188:191], a[172:175], a[72:75]
ds_write_b128 v86, a[48:51] offset:10880
s_waitcnt vmcnt(0)
v_mfma_f32_16x16x32_bf16 a[16:19], a[192:195], a[160:163], a[16:19]
ds_write_b128 v86, a[68:71] offset:16256
v_mfma_f32_16x16x32_bf16 a[36:39], a[192:195], a[164:167], a[36:39]
ds_write_b128 v86, a[12:15] offset:192
v_mfma_f32_16x16x32_bf16 a[56:59], a[192:195], a[168:171], a[56:59]
ds_write_b128 v86, a[32:35] offset:5568
v_mfma_f32_16x16x32_bf16 a[76:79], a[192:195], a[172:175], a[76:79]
ds_write_b128 v86, a[52:55] offset:10944
ds_write_b128 v86, a[72:75] offset:16320
ds_write_b128 v86, a[16:19] offset:256
s_nop 0
ds_write_b128 v86, a[36:39] offset:5632
s_nop 0
ds_write_b128 v86, a[56:59] offset:11008
s_nop 0
ds_write_b128 v86, a[76:79] offset:16384
s_waitcnt lgkmcnt(0)
s_barrier
ds_read_b128 v[96:99], v69 offset:0
ds_read_b128 v[100:103], v69 offset:21504
ds_read_b128 v[104:107], v69 offset:43008
ds_read_b128 v[108:111], v69 offset:64512
ds_read_b128 v[112:115], v70 offset:0
ds_read_b128 v[116:119], v70 offset:21504
ds_read_b128 v[120:123], v70 offset:43008
ds_read_b128 v[124:127], v70 offset:64512
ds_read_b128 v[128:131], v71 offset:0
ds_read_b128 v[132:135], v71 offset:21504
ds_read_b128 v[136:139], v71 offset:43008
ds_read_b128 v[140:143], v71 offset:64512
ds_read_b128 v[144:147], v72 offset:0
ds_read_b128 v[148:151], v72 offset:21504
ds_read_b128 v[152:155], v72 offset:43008
ds_read_b128 v[156:159], v72 offset:64512
ds_read_b128 v[160:163], v73 offset:0
ds_read_b128 v[164:167], v73 offset:21504
ds_read_b128 v[168:171], v73 offset:43008
ds_read_b128 v[172:175], v73 offset:64512
s_mov_b32 s57, 0xffff0000
s_waitcnt lgkmcnt(15)
v_add_f32 v96, v96, v100
v_add_f32 v104, v104, v108
v_add_f32 v97, v97, v101
v_add_f32 v105, v105, v109
v_add_f32 v98, v98, v102
v_add_f32 v106, v106, v110
v_add_f32 v99, v99, v103
v_add_f32 v107, v107, v111
v_lshlrev_b32 v100, 16, v74
v_and_b32 v101, s57, v74
v_lshlrev_b32 v102, 16, v75
v_and_b32 v103, s57, v75
v_add_f32 v96, v96, v104
v_add_f32 v97, v97, v105
v_add_f32 v98, v98, v106
v_add_f32 v99, v99, v107
v_add_f32 v96, v96, v100
v_add_f32 v97, v97, v101
v_add_f32 v98, v98, v102
v_add_f32 v99, v99, v103
v_cvt_pk_bf16_f32 v96, v96, v97
v_cvt_pk_bf16_f32 v97, v98, v99
buffer_store_dwordx2 v[96:97], v64, s[44:47], 0 offen sc1
s_waitcnt lgkmcnt(14)
v_add_f32 v112, v112, v116
s_waitcnt lgkmcnt(12)
v_add_f32 v120, v120, v124
v_add_f32 v113, v113, v117
v_add_f32 v121, v121, v125
v_add_f32 v114, v114, v118
v_add_f32 v122, v122, v126
v_add_f32 v115, v115, v119
v_add_f32 v123, v123, v127
v_lshlrev_b32 v116, 16, v76
v_and_b32 v117, s57, v76
v_lshlrev_b32 v118, 16, v77
v_and_b32 v119, s57, v77
v_add_f32 v112, v112, v120
v_add_f32 v113, v113, v121
v_add_f32 v114, v114, v122
v_add_f32 v115, v115, v123
v_add_f32 v112, v112, v116
v_add_f32 v113, v113, v117
v_add_f32 v114, v114, v118
v_add_f32 v115, v115, v119
v_cvt_pk_bf16_f32 v112, v112, v113
v_cvt_pk_bf16_f32 v113, v114, v115
buffer_store_dwordx2 v[112:113], v65, s[44:47], 0 offen sc1
s_waitcnt lgkmcnt(10)
v_add_f32 v128, v128, v132
s_waitcnt lgkmcnt(8)
v_add_f32 v136, v136, v140
v_add_f32 v129, v129, v133
v_add_f32 v137, v137, v141
v_add_f32 v130, v130, v134
v_add_f32 v138, v138, v142
v_add_f32 v131, v131, v135
v_add_f32 v139, v139, v143
v_lshlrev_b32 v132, 16, v78
v_and_b32 v133, s57, v78
v_lshlrev_b32 v134, 16, v79
v_and_b32 v135, s57, v79
v_add_f32 v128, v128, v136
v_add_f32 v129, v129, v137
v_add_f32 v130, v130, v138
v_add_f32 v131, v131, v139
v_add_f32 v128, v128, v132
v_add_f32 v129, v129, v133
v_add_f32 v130, v130, v134
v_add_f32 v131, v131, v135
v_cvt_pk_bf16_f32 v128, v128, v129
v_cvt_pk_bf16_f32 v129, v130, v131
buffer_store_dwordx2 v[128:129], v66, s[44:47], 0 offen sc1
s_waitcnt lgkmcnt(6)
v_add_f32 v144, v144, v148
s_waitcnt lgkmcnt(4)
v_add_f32 v152, v152, v156
v_add_f32 v145, v145, v149
v_add_f32 v153, v153, v157
v_add_f32 v146, v146, v150
v_add_f32 v154, v154, v158
v_add_f32 v147, v147, v151
v_add_f32 v155, v155, v159
v_lshlrev_b32 v148, 16, v80
v_and_b32 v149, s57, v80
v_lshlrev_b32 v150, 16, v81
v_and_b32 v151, s57, v81
v_add_f32 v144, v144, v152
v_add_f32 v145, v145, v153
v_add_f32 v146, v146, v154
v_add_f32 v147, v147, v155
v_add_f32 v144, v144, v148
v_add_f32 v145, v145, v149
v_add_f32 v146, v146, v150
v_add_f32 v147, v147, v151
v_cvt_pk_bf16_f32 v144, v144, v145
v_cvt_pk_bf16_f32 v145, v146, v147
buffer_store_dwordx2 v[144:145], v67, s[44:47], 0 offen sc1
s_waitcnt lgkmcnt(2)
v_add_f32 v160, v160, v164
s_waitcnt lgkmcnt(0)
v_add_f32 v168, v168, v172
v_add_f32 v161, v161, v165
v_add_f32 v169, v169, v173
v_add_f32 v162, v162, v166
v_add_f32 v170, v170, v174
v_add_f32 v163, v163, v167
v_add_f32 v171, v171, v175
v_lshlrev_b32 v164, 16, v82
v_and_b32 v165, s57, v82
v_lshlrev_b32 v166, 16, v83
v_and_b32 v167, s57, v83
v_add_f32 v160, v160, v168
v_add_f32 v161, v161, v169
v_add_f32 v162, v162, v170
v_add_f32 v163, v163, v171
v_add_f32 v160, v160, v164
v_add_f32 v161, v161, v165
v_add_f32 v162, v162, v166
v_add_f32 v163, v163, v167
v_cvt_pk_bf16_f32 v160, v160, v161
v_cvt_pk_bf16_f32 v161, v162, v163
buffer_store_dwordx2 v[160:161], v68, s[44:47], 0 offen sc1
F_end:
s_endpgm
F_codeend:

.section .rodata,"a"
.p2align 6
.amdhsa_kernel parallel_sum__linear_kernel_hedgehog__glu_gated_reglu__prompt_kernel
  .amdhsa_next_free_vgpr 512
  .amdhsa_next_free_sgpr 102
  .amdhsa_accum_offset 256
  .amdhsa_group_segment_fixed_size 0
  .amdhsa_kernarg_size 88
  .amdhsa_user_sgpr_count 2
  .amdhsa_user_sgpr_kernarg_segment_ptr 1
  .amdhsa_system_sgpr_workgroup_id_x 1
.end_amdhsa_kernel
```
